```python
import torch

def _softmax(x, axis=-1):
    return torch.softmax(x, dim=axis)

def _gelu(x):
    return torch.nn.functional.gelu(x, approximate='tanh')

def _silu(x):
    return torch.nn.functional.silu(x)

def _sigmoid(x):
    return torch.sigmoid(x)

def _layernorm(x, axis=-1, eps=1e-05):
    m = x.mean(dim=axis, keepdim=True)
    v = x.var(dim=axis, keepdim=True, unbiased=False)
    return (x - m) / torch.sqrt(v + eps)

def _scatter_add(tgt, idx, src, axis=0):
    return tgt.clone().index_add_(axis, idx, src)

def _segment_sum(src, seg, n):
    out = torch.zeros((n,) + src.shape[1:], dtype=src.dtype)
    return out.index_add_(0, seg, src)

def _pad(x, pw):
    flat = tuple((v for pair in reversed(pw) for v in pair))
    return torch.nn.functional.pad(x, flat)
kernel_name = 'adaLN_cond__sliding_local_dilated__mixer_gmlp__prompt'

def setup_inputs():

    _w = lambda a: (lambda t: t.to(torch.bfloat16) if t.is_floating_point() else t)(torch.as_tensor(a))

    def _A_setup():
        B, S, D = (1, 2048, 576)
        return {'x': _w((lambda *s: torch.randn(*s, dtype=torch.bfloat16) * 0.05)(B, S, D)), 'wqkv': _w((lambda *s: torch.randn(*s, dtype=torch.bfloat16) * 0.05)(D, 3 * D)), 'wo': _w((lambda *s: torch.randn(*s, dtype=torch.bfloat16) * 0.05)(D, D))}
    _A_in = _A_setup()

    def _B_setup():
        B, S, D, F = (1, 2048, 576, 4608)
        Fh = F // 2
        return {'x': _w((lambda *s: torch.randn(*s, dtype=torch.bfloat16) * 0.05)(B, S, D)), 'w_in': _w((lambda *s: torch.randn(*s, dtype=torch.bfloat16) * 0.4)(D, 2 * Fh)), 'w_sp': _w(0.01 * (lambda *s: torch.randn(*s, dtype=torch.bfloat16) * 0.4)(S, S)), 'b_sp': _w(1.0 + 0.01 * (lambda *s: torch.randn(*s, dtype=torch.bfloat16) * 0.05)(S)), 'w_out': _w((lambda *s: torch.randn(*s, dtype=torch.bfloat16) * 0.05)(Fh, D))}
    _B_in = _B_setup()
    return {'A_x': _A_in['x'], 'A_wqkv': _A_in['wqkv'], 'A_wo': _A_in['wo'], 'B_x': _B_in['x'], 'B_w_in': _B_in['w_in'], 'B_w_sp': _B_in['w_sp'], 'B_b_sp': _B_in['b_sp'], 'B_w_out': _B_in['w_out'], 'c': _w((lambda *s: torch.randn(*s, dtype=torch.bfloat16) * 0.1)(1, 576) * 8.0), 'w_mod': _w((lambda *s: torch.randn(*s, dtype=torch.bfloat16) * 0.1)(576, 6 * 576) * 576 ** (-0.5) * 8.0)}

def reference(A_x, A_wqkv, A_wo, B_x, B_w_in, B_w_sp, B_b_sp, B_w_out, c, w_mod):

    def _A_ref(x, wqkv, wo):
        B, S, D = x.shape
        H = 32
        Dh = D // H
        W, dil = (8, 2)
        qkv = (lambda x, *d: x.permute(*d))((x @ wqkv).reshape(B, S, 3, H, Dh), 2, 0, 3, 1, 4)
        q, k, v = (qkv[0], qkv[1], qkv[2])
        scale = Dh ** (-0.5)
        pos = torch.arange(S)
        off = torch.arange(W) * dil
        idx = pos[:, None] - off[None, :]
        mask = idx >= 0
        idx_c = torch.where(mask, idx, 0).reshape(-1)
        kg = k[:, :, idx_c, :].reshape(B, H, S, W, Dh)
        vg = v[:, :, idx_c, :].reshape(B, H, S, W, Dh)
        logits = torch.einsum('bhsd,bhswd->bhsw', q, kg) * scale
        logits = torch.where(mask[None, None, :, :], logits, -1000000000.0)
        attn = _softmax(logits, axis=-1)
        o = torch.einsum('bhsw,bhswd->bhsd', attn, vg)
        return (lambda x, *d: x.permute(*d))(o, 0, 2, 1, 3).reshape(B, S, D) @ wo

    def _B_ref(x, w_in, w_sp, b_sp, w_out):
        B, S, D = x.shape
        F = w_in.shape[-1]
        Fh = F // 2
        z = _gelu(torch.einsum('bsd,df->bsf', x, w_in))
        z1 = z[..., :Fh].clone()
        z2 = _layernorm(z[..., Fh:], axis=-1)
        g = torch.einsum('ts,bsf->btf', w_sp, z2) + b_sp[None, :, None]
        return torch.einsum('bsf,fd->bsd', z1 * g, w_out)
    x = A_x
    mod = (_silu(c) @ w_mod).reshape(c.shape[0], 6, 1, -1)
    sa, ca, ga, sb, cb, gb = (mod[:, 0].clone(), mod[:, 1].clone(), mod[:, 2].clone(), mod[:, 3].clone(), mod[:, 4].clone(), mod[:, 5].clone())
    h = _layernorm(x, axis=-1) * (1 + ca) + sa
    x = x + ga * _A_ref(h, A_wqkv, A_wo)
    h = _layernorm(x, axis=-1) * (1 + cb) + sb
    x = x + gb * _B_ref(h, B_w_in, B_w_sp, B_b_sp, B_w_out)
    return x
```

```asm
; @launch grid=(256,1,1) block=(256,1,1) lds=163840
.amdgcn_target "amdgcn-amd-amdhsa--gfx950"
.text
.globl adaLN_cond__sliding_local_dilated__mixer_gmlp__prompt_kernel
.p2align 8
.type adaLN_cond__sliding_local_dilated__mixer_gmlp__prompt_kernel,@function
adaLN_cond__sliding_local_dilated__mixer_gmlp__prompt_kernel:
  s_sub_u32 s24, s2, 112
  s_cmp_ge_u32 s24, 16
  s_cbranch_scc1 L_m_not0
  s_getpc_b64 s[100:101]
  v_lshlrev_b32 v1, 7, v0
  global_load_dword a251, v1, s[100:101]
L_m_not0:
  s_cmp_ge_u32 s2, 256
  s_cbranch_scc1 L_m_end_x
  s_load_dwordx2 s[4:5], s[0:1], 96
  v_lshrrev_b32 v1, 6, v0
  v_and_b32 v2, 63, v0
  v_readfirstlane_b32 s3, v1
  v_and_b32 v3, 15, v2
  v_lshlrev_b32 v4, 4, v2
  v_lshrrev_b32 v5, 4, v2
  s_and_b32 s24, s2, 7
  s_lshr_b32 s25, s2, 3
  s_and_b32 s20, s24, 1
  s_lshl_b32 s20, s20, 3
  s_and_b32 s26, s25, 7
  s_add_u32 s20, s20, s26
  s_lshr_b32 s21, s24, 1
  s_lshl_b32 s21, s21, 2
  s_lshr_b32 s26, s25, 3
  s_add_u32 s21, s21, s26
  s_lshr_b32 s26, s21, 3
  s_lshl_b32 s22, s20, 1
  s_add_u32 s22, s22, s26
  s_and_b32 s23, s21, 7
  s_load_dwordx2 s[6:7], s[0:1], 0
  s_load_dwordx2 s[34:35], s[0:1], 40
  s_load_dwordx2 s[60:61], s[0:1], 48
  s_load_dwordx2 s[62:63], s[0:1], 80
  s_load_dwordx2 s[54:55], s[0:1], 32
  s_load_dwordx2 s[48:49], s[0:1], 56
  s_load_dwordx2 s[40:41], s[0:1], 8
  s_load_dwordx2 s[42:43], s[0:1], 16
  s_load_dwordx2 s[44:45], s[0:1], 64
  s_load_dwordx2 s[46:47], s[0:1], 72
  s_load_dwordx2 s[30:31], s[0:1], 88
  s_memrealtime s[32:33]
  s_lshr_b32 s26, s2, 4
  s_lshl_b32 s26, s26, 3
  s_and_b32 s27, s2, 7
  s_add_u32 s28, s26, s27
  s_bfe_u32 s29, s2, 0x10003
  s_mov_b32 s100, -1
  v_lshrrev_b32 v155, 2, v3
  v_lshl_add_u32 v155, v5, 3, v155
  v_and_b32 v19, 3, v3
  v_lshlrev_b32 v19, 3, v19
  v_mov_b32 v103, v4
  s_waitcnt lgkmcnt(0)
  s_mov_b32 s36, s30
  s_mov_b32 s37, s31
  s_mov_b32 s38, 256
  s_mov_b32 s39, 0x20000
  s_or_b32 s32, s32, 1
  v_mov_b32 v1, 0
  s_cmp_lg_u32 s2, 255
  s_cbranch_scc1 L_m_notag
  s_cmp_lg_u32 s3, 0
  s_cbranch_scc1 L_m_notag
  v_mov_b32 v9, s32
  s_mov_b64 exec, 1
  buffer_store_dword v9, v1, s[36:39], 0 offen sc1
  s_mov_b64 exec, -1
L_m_notag:
  s_cmp_ge_u32 s28, 54
  s_cbranch_scc1 L_m_nogv1
  s_mul_i32 s26, s3, 72
  s_mul_i32 s27, s29, 288
  s_add_u32 s26, s26, s27
  v_lshrrev_b32 v6, 3, v2
  v_add_u32 v6, s26, v6
  v_and_b32 v7, 7, v2
  v_lshlrev_b32 v7, 4, v7
  s_lshl_b32 s26, s28, 7
  v_add_u32 v7, s26, v7
  s_movk_i32 s27, 6912
  v_mad_u32_u24 v7, v6, s27, v7
  v_lshlrev_b32 v8, 1, v6
  s_mul_i32 s27, s29, 13824
  s_lshl_b32 s100, s28, 8
  s_add_u32 s100, s100, s27
  s_mov_b32 s26, 0
  s_mov_b32 s8, s46
  s_mov_b32 s9, s47
  s_mov_b32 s10, 3981312
  s_mov_b32 s11, 0x20000
  s_mov_b32 s12, s44
  s_mov_b32 s13, s45
  s_mov_b32 s14, 1152
  s_mov_b32 s15, 0x20000
  buffer_load_ushort v20, v8, s[12:15], 0 offen offset:0
  buffer_load_ushort v21, v8, s[12:15], 0 offen offset:16
  buffer_load_ushort v22, v8, s[12:15], 0 offen offset:32
  buffer_load_ushort v23, v8, s[12:15], 0 offen offset:48
  buffer_load_ushort v24, v8, s[12:15], 0 offen offset:64
  buffer_load_ushort v25, v8, s[12:15], 0 offen offset:80
  buffer_load_ushort v26, v8, s[12:15], 0 offen offset:96
  buffer_load_ushort v27, v8, s[12:15], 0 offen offset:112
  buffer_load_ushort v28, v8, s[12:15], 0 offen offset:128
  buffer_load_dwordx4 v[40:43], v7, s[8:11], s26 offen nt
  s_add_u32 s26, s26, 55296
  buffer_load_dwordx4 v[44:47], v7, s[8:11], s26 offen nt
  s_add_u32 s26, s26, 55296
  buffer_load_dwordx4 v[48:51], v7, s[8:11], s26 offen nt
  s_add_u32 s26, s26, 55296
  buffer_load_dwordx4 v[52:55], v7, s[8:11], s26 offen nt
  s_add_u32 s26, s26, 55296
  buffer_load_dwordx4 v[56:59], v7, s[8:11], s26 offen nt
  s_add_u32 s26, s26, 55296
  buffer_load_dwordx4 v[60:63], v7, s[8:11], s26 offen nt
  s_add_u32 s26, s26, 55296
  buffer_load_dwordx4 v[64:67], v7, s[8:11], s26 offen nt
  s_add_u32 s26, s26, 55296
  buffer_load_dwordx4 v[68:71], v7, s[8:11], s26 offen nt
  s_add_u32 s26, s26, 55296
  buffer_load_dwordx4 v[72:75], v7, s[8:11], s26 offen nt
  s_add_u32 s26, s26, 55296
L_m_nogv1:
  s_mov_b32 s16, s40
  s_mov_b32 s17, s41
  s_mov_b32 s18, 1990656
  s_mov_b32 s19, 0x20000
  s_mov_b32 s12, s6
  s_mov_b32 s13, s7
  s_mov_b32 s14, 2359296
  s_mov_b32 s15, 0x20000
  s_mov_b32 s96, 0
  s_cmp_ge_u32 s3, 2
  s_cbranch_scc1 L_m_rln
  s_cmp_lt_u32 s2, 112
  s_cbranch_scc1 L_m_rdone
  s_and_b32 s32, s2, 7
  s_mul_i32 s32, s32, 18
  s_sub_u32 s26, s2, 112
  s_lshr_b32 s26, s26, 3
  s_add_u32 s32, s32, s26
  s_lshr_b32 s33, s32, 3
  s_and_b32 s32, s32, 7
  s_mul_i32 s101, s32, 258048
  s_lshl_b32 s27, s33, 10
  s_add_u32 s101, s101, s27
  s_mul_i32 s27, s32, 144
  s_mul_i32 s26, s33, 110592
  s_add_u32 s26, s26, s27
  s_cmp_eq_u32 s3, 1
  s_cbranch_scc1 L_m_rv
  s_mov_b32 s96, 1
  v_mul_u32_u24 v100, 3456, v5
  v_lshl_add_u32 v100, v3, 4, v100
  v_cmp_gt_u32 vcc, 9, v3
  v_mov_b32 v101, -144
  v_mov_b32 v102, 1152
  v_cndmask_b32 v101, v101, v102, vcc
  v_add_u32 v100, v100, v101
  v_lshrrev_b32 v101, 1, v2
  v_mul_u32_u24 v101, 3456, v101
  v_and_b32 v102, 1, v2
  v_lshl_add_u32 v101, v102, 4, v101
  v_add_u32 v101, 112, v101
  s_mov_b32 m0, 24576
  s_nop 0
  buffer_load_dwordx4 v101, s[16:19], s26 offen nt lds
  s_mov_b32 m0, 16384
  s_nop 0
  buffer_load_dwordx4 v100, s[16:19], s26 offen nt lds
  s_add_u32 s26, s26, 13824
  s_mov_b32 m0, 17408
  s_nop 0
  buffer_load_dwordx4 v100, s[16:19], s26 offen nt lds
  s_add_u32 s26, s26, 13824
  s_mov_b32 m0, 18432
  s_nop 0
  buffer_load_dwordx4 v100, s[16:19], s26 offen nt lds
  s_add_u32 s26, s26, 13824
  s_mov_b32 m0, 19456
  s_nop 0
  buffer_load_dwordx4 v100, s[16:19], s26 offen nt lds
  s_add_u32 s26, s26, 13824
  s_mov_b32 m0, 20480
  s_nop 0
  buffer_load_dwordx4 v100, s[16:19], s26 offen nt lds
  s_add_u32 s26, s26, 13824
  s_mov_b32 m0, 21504
  s_nop 0
  buffer_load_dwordx4 v100, s[16:19], s26 offen nt lds
  s_add_u32 s26, s26, 13824
  s_mov_b32 m0, 22528
  s_nop 0
  buffer_load_dwordx4 v100, s[16:19], s26 offen nt lds
  s_add_u32 s26, s26, 13824
  s_mov_b32 m0, 23552
  s_nop 0
  buffer_load_dwordx4 v100, s[16:19], s26 offen nt lds
  s_add_u32 s26, s26, 13824
  s_branch L_m_rdone
L_m_rv:
  s_mov_b32 s96, 2
  s_add_u32 s26, s26, 2304
  v_lshrrev_b32 v102, 3, v2
  v_mul_u32_u24 v102, 3456, v102
  v_and_b32 v103, 7, v2
  v_lshl_add_u32 v102, v103, 4, v102
  v_mul_u32_u24 v103, 3456, v2
  v_add_u32 v103, 128, v103
  s_mov_b32 m0, 61440
  s_mov_b32 exec_hi, 0
  buffer_load_dwordx4 v103, s[16:19], s26 offen nt lds
  s_mov_b32 exec_hi, -1
  s_mov_b32 m0, 57344
  s_nop 0
  buffer_load_dwordx4 v102, s[16:19], s26 offen nt lds
  s_add_u32 s26, s26, 27648
  s_mov_b32 m0, 58368
  s_nop 0
  buffer_load_dwordx4 v102, s[16:19], s26 offen nt lds
  s_add_u32 s26, s26, 27648
  s_mov_b32 m0, 59392
  s_nop 0
  buffer_load_dwordx4 v102, s[16:19], s26 offen nt lds
  s_add_u32 s26, s26, 27648
  s_mov_b32 m0, 60416
  s_nop 0
  buffer_load_dwordx4 v102, s[16:19], s26 offen nt lds
  s_add_u32 s26, s26, 27648
  s_branch L_m_rdone
L_m_rln:
  s_cmp_lt_u32 s2, 128
  s_cbranch_scc1 L_m_rdone
  s_mov_b32 s96, 3
  s_sub_u32 s26, s2, 128
  s_lshl_b32 s26, s26, 4
  s_lshl_b32 s27, s3, 3
  s_add_u32 s26, s26, s27
  s_sub_u32 s26, s26, 16
  v_lshrrev_b32 v100, 3, v2
  v_add_u32 v100, s26, v100
  v_and_b32 v101, 7, v2
  v_lshlrev_b32 v102, 4, v101
  s_movk_i32 s27, 1152
  v_mad_u32_u24 v102, v100, s27, v102
  buffer_load_dwordx4 v[108:111], v102, s[12:15], 0 offen offset:0
  buffer_load_dwordx4 v[112:115], v102, s[12:15], 0 offen offset:128
  buffer_load_dwordx4 v[116:119], v102, s[12:15], 0 offen offset:256
  buffer_load_dwordx4 v[120:123], v102, s[12:15], 0 offen offset:384
  buffer_load_dwordx4 v[124:127], v102, s[12:15], 0 offen offset:512
  buffer_load_dwordx4 v[128:131], v102, s[12:15], 0 offen offset:640
  buffer_load_dwordx4 v[132:135], v102, s[12:15], 0 offen offset:768
  buffer_load_dwordx4 v[136:139], v102, s[12:15], 0 offen offset:896
  buffer_load_dwordx4 v[140:143], v102, s[12:15], 0 offen offset:1024
  v_lshrrev_b32 v103, 4, v100
  v_mul_u32_u24 v103, 18432, v103
  v_lshl_add_u32 v103, v101, 8, v103
  v_and_b32 v100, 15, v100
  v_lshl_add_u32 v103, v100, 4, v103
L_m_rdone:
  buffer_load_dword v98, v1, s[36:39], 0 offen sc1
L_code_p0:
  s_add_u32 s8, s4, 50331648
  s_addc_u32 s9, s5, 0
  s_mov_b32 s10, 27648
  s_mov_b32 s11, 0x20000
  s_add_u32 s16, s4, 2834432
  s_addc_u32 s17, s5, 0
  s_mov_b32 s18, 2064384
  s_mov_b32 s19, 0x20000
  s_add_u32 s12, s4, 475136
  s_addc_u32 s13, s5, 0
  s_mov_b32 s14, 2359296
  s_mov_b32 s15, 0x20000
  s_add_u32 s56, s4, 50069504
  s_addc_u32 s57, s5, 0
  s_mov_b32 s58, 262144
  s_mov_b32 s59, 0x20000
  s_sub_u32 s40, s3, 1
  s_lshl_b32 s40, s40, 4
  s_add_u32 s40, s40, s20
  s_cmp_lt_u32 s40, 36
  s_cselect_b32 s41, 0, 0x80000000
  s_cselect_b32 s40, s40, 0
  s_cmp_ge_u32 s40, 18
  s_cselect_b32 s42, 18, 0
  s_cselect_b32 s43, 4608, 0
  s_sub_u32 s40, s40, s42
  s_lshr_b32 s44, s42, 1
  s_mul_i32 s45, s21, 18
  s_add_u32 s44, s44, s45
  s_mul_i32 s44, s44, 18
  s_add_u32 s44, s44, s40
  s_lshl_b32 s47, s44, 10
  s_lshl_b32 s45, s21, 8
  s_add_u32 s43, s43, s45
  s_lshr_b32 s44, s40, 1
  s_mul_i32 s44, s44, 72
  s_and_b32 s45, s40, 1
  s_lshl_b32 s45, s45, 5
  s_add_u32 s44, s44, s45
  s_sub_u32 s45, s40, 16
  s_mul_i32 s45, s45, 288
  s_add_u32 s45, s45, 64
  s_cmp_lt_u32 s40, 16
  s_cselect_b32 s44, s44, s45
  s_cselect_b32 s45, 4, 72
  s_cselect_b32 s46, 16, 4
  s_mul_i32 s44, s44, 9216
  s_add_u32 s43, s43, s44
  v_mul_u32_u24 v17, 9216, v5
  v_lshl_add_u32 v17, v3, 4, v17
  v_add_u32 v17, s41, v17
  v_mul_u32_u24 v18, s45, v5
  v_bfe_u32 v104, v2, 3, 1
  v_mul_u32_u24 v104, s46, v104
  v_add_u32 v18, v18, v104
  v_bfe_u32 v104, v2, 1, 2
  v_add_u32 v18, v18, v104
  v_mul_u32_u24 v18, 9216, v18
  v_and_b32 v104, 1, v2
  v_lshl_add_u32 v18, v104, 4, v18
  s_mul_i32 s44, s21, 224
  s_sub_u32 s44, 4096, s44
  v_add_u32 v18, s44, v18
  v_add_u32 v18, s41, v18
  v_add_u32 v154, s41, v4
  s_mul_i32 s45, s45, 9216
  s_mul_i32 s46, s46, 9216
  s_mul_i32 s40, s3, 9216
  s_add_u32 s40, s40, 110592
  s_cmp_eq_u32 s3, 0
  s_cselect_b32 s40, 163840, s40
  s_lshl_b32 s26, s3, 5
  s_add_u32 s26, s26, s22
  s_cmp_lt_u32 s26, 18
  s_cselect_b32 s24, 0, 0x80000000
  s_cselect_b32 s26, s26, 0
  s_mul_i32 s27, s23, 18
  s_add_u32 s27, s27, s26
  s_mul_i32 s27, s27, 5120
  s_lshl_b32 s26, s26, 2
  v_and_b32 v104, 7, v2
  v_lshlrev_b32 v104, 4, v104
  v_add_u32 v104, s24, v104
  v_lshrrev_b32 v105, 3, v2
  v_mul_u32_u24 v15, 1152, v105
  v_add_u32 v15, v15, v104
  v_lshrrev_b32 v106, 1, v105
  v_mul_u32_u24 v106, 18, v106
  v_and_b32 v105, 1, v105
  v_add_u32 v106, v106, v105
  v_mul_u32_u24 v152, 1152, v106
  v_add_u32 v152, v152, v104
  v_bfe_u32 v104, v2, 3, 2
  v_add_u32 v104, s26, v104
  v_mul_u32_u24 v105, 57, v104
  v_lshrrev_b32 v105, 9, v105
  v_mul_u32_u24 v106, 9, v105
  v_sub_u32 v106, v104, v106
  v_mul_u32_u24 v105, 72, v105
  v_and_b32 v104, 7, v2
  v_lshrrev_b32 v107, 1, v106
  v_mul_u32_u24 v107, 18, v107
  v_and_b32 v16, 1, v106
  v_lshl_add_u32 v107, v16, 3, v107
  v_add_u32 v107, v107, v104
  v_lshrrev_b32 v16, 1, v104
  v_mul_u32_u24 v16, 18, v16
  v_and_b32 v104, 1, v104
  v_add3_u32 v16, v16, v104, 16
  v_cmp_gt_u32 vcc, 8, v106
  s_nop 1
  v_cndmask_b32 v16, v16, v107, vcc
  v_add_u32 v16, v16, v105
  v_mul_u32_u24 v16, 1152, v16
  v_add_u32 v16, 128, v16
  v_add_u32 v16, s24, v16
  s_mul_i32 s41, s23, 144
  s_mov_b32 s42, 163840
  s_cmp_eq_u32 s3, 0
  s_cselect_b32 s42, 110592, s42
  s_add_u32 s25, s26, 0
  s_mul_i32 s32, s25, 57
  s_lshr_b32 s32, s32, 9
  s_mul_i32 s33, s32, 9
  s_sub_u32 s25, s25, s33
  s_mul_i32 s32, s32, 72
  s_lshr_b32 s33, s25, 1
  s_mul_i32 s33, s33, 18
  s_and_b32 s24, s25, 1
  s_lshl_b32 s24, s24, 3
  s_add_u32 s33, s33, s24
  s_cmp_lt_u32 s25, 8
  s_cselect_b32 s33, s33, 16
  s_cselect_b64 vcc, -1, 0
  s_add_u32 s32, s32, s33
  s_mul_i32 s32, s32, 1152
  v_cndmask_b32 v148, v152, v15, vcc
  v_add_u32 v148, s32, v148
  s_add_u32 s25, s26, 1
  s_mul_i32 s32, s25, 57
  s_lshr_b32 s32, s32, 9
  s_mul_i32 s33, s32, 9
  s_sub_u32 s25, s25, s33
  s_mul_i32 s32, s32, 72
  s_lshr_b32 s33, s25, 1
  s_mul_i32 s33, s33, 18
  s_and_b32 s24, s25, 1
  s_lshl_b32 s24, s24, 3
  s_add_u32 s33, s33, s24
  s_cmp_lt_u32 s25, 8
  s_cselect_b32 s33, s33, 16
  s_cselect_b64 vcc, -1, 0
  s_add_u32 s32, s32, s33
  s_mul_i32 s32, s32, 1152
  v_cndmask_b32 v149, v152, v15, vcc
  v_add_u32 v149, s32, v149
  s_add_u32 s25, s26, 2
  s_mul_i32 s32, s25, 57
  s_lshr_b32 s32, s32, 9
  s_mul_i32 s33, s32, 9
  s_sub_u32 s25, s25, s33
  s_mul_i32 s32, s32, 72
  s_lshr_b32 s33, s25, 1
  s_mul_i32 s33, s33, 18
  s_and_b32 s24, s25, 1
  s_lshl_b32 s24, s24, 3
  s_add_u32 s33, s33, s24
  s_cmp_lt_u32 s25, 8
  s_cselect_b32 s33, s33, 16
  s_cselect_b64 vcc, -1, 0
  s_add_u32 s32, s32, s33
  s_mul_i32 s32, s32, 1152
  v_cndmask_b32 v150, v152, v15, vcc
  v_add_u32 v150, s32, v150
  s_add_u32 s25, s26, 3
  s_mul_i32 s32, s25, 57
  s_lshr_b32 s32, s32, 9
  s_mul_i32 s33, s32, 9
  s_sub_u32 s25, s25, s33
  s_mul_i32 s32, s32, 72
  s_lshr_b32 s33, s25, 1
  s_mul_i32 s33, s33, 18
  s_and_b32 s24, s25, 1
  s_lshl_b32 s24, s24, 3
  s_add_u32 s33, s33, s24
  s_cmp_lt_u32 s25, 8
  s_cselect_b32 s33, s33, 16
  s_cselect_b64 vcc, -1, 0
  s_add_u32 s32, s32, s33
  s_mul_i32 s32, s32, 1152
  v_cndmask_b32 v151, v152, v15, vcc
  v_add_u32 v151, s32, v151
  s_cmp_eq_u32 s22, 0
  s_cselect_b32 s26, 0x80000000, 0
  v_add_u32 v7, s26, v4
  s_cmp_ge_u32 s3, 2
  s_cselect_b32 s26, 0x80000000, 0
  v_add_u32 v8, s26, v4
  v_or_b32 v9, v7, v8
  s_mul_i32 s29, s22, 73728
  s_lshl_b32 s26, s3, 10
  s_add_u32 s29, s29, s26
  s_sub_u32 s28, s29, 18432
  s_max_i32 s28, s28, 0
  s_mul_i32 s30, s23, 14
  s_add_u32 s30, s30, s3
  s_mul_i32 s30, s30, 18432
  s_mul_i32 s26, s3, 5120
  v_add_u32 v10, s26, v4
  v_add_u32 v11, 40960, v10
  v_add_u32 v12, 81920, v10
  s_lshl_b32 s26, s3, 7
  v_lshlrev_b32 v13, 5, v5
  v_add_u32 v13, s26, v13
  v_add_u32 v13, 102400, v13
  v_add_u32 v14, 61440, v4
  s_add_u32 s31, s30, 73728
  s_add_u32 s32, s30, 147456
  s_add_u32 s33, s30, 221184
  s_add_u32 s26, s3, 0
  s_and_b32 s26, s26, 3
  s_lshl_b32 s50, s26, 1
  s_add_u32 s26, s3, 1
  s_and_b32 s26, s26, 3
  s_lshl_b32 s51, s26, 1
  s_add_u32 s26, s3, 2
  s_and_b32 s26, s26, 3
  s_lshl_b32 s52, s26, 1
  s_add_u32 s26, s3, 3
  s_and_b32 s26, s26, 3
  s_lshl_b32 s53, s26, 1
  v_mul_u32_u24 v228, 57, v0
  v_lshrrev_b32 v228, 10, v228
  v_mul_u32_u24 v229, 18, v228
  v_sub_u32 v229, v0, v229
  v_lshlrev_b32 v230, 7, v228
  v_lshrrev_b32 v231, 3, v229
  v_lshl_add_u32 v230, v231, 6, v230
  v_and_b32 v231, 3, v229
  v_lshl_add_u32 v230, v231, 4, v230
  v_bfe_u32 v231, v229, 2, 1
  v_lshl_add_u32 v230, v231, 3, v230
  v_lshlrev_b32 v231, 4, v228
  v_and_b32 v232, 1, v229
  v_lshl_add_u32 v231, v232, 3, v231
  v_add_u32 v231, 1024, v231
  v_cmp_gt_u32 vcc, 16, v229
  s_nop 1
  v_cndmask_b32 v230, v231, v230, vcc
  v_add_u32 v230, 158208, v230
  v_lshlrev_b32 v229, 4, v0
  v_add_u32 v231, 153600, v229
  v_add_u32 v228, 102400, v229
  v_cmp_gt_u32 vcc, 144, v0
  v_mov_b32 v99, 0x80000000
  s_nop 0
  v_cndmask_b32 v99, v99, v229, vcc
  s_nop 0
  s_cmp_eq_u32 s100, -1
  s_cbranch_scc1 L_m_nogv2
  s_cmp_lg_u32 s3, 0
  s_cselect_b32 s24, 0x80000000, 0
  v_lshlrev_b32 v91, 2, v2
  v_add_u32 v91, s24, v91
  s_waitcnt vmcnt(10)
  v_lshlrev_b32 v20, 16, v20
  v_lshlrev_b32 v21, 16, v21
  v_lshlrev_b32 v22, 16, v22
  v_mul_f32 v30, 0xbfb8aa3b, v20
  v_mul_f32 v31, 0xbfb8aa3b, v21
  v_mul_f32 v32, 0xbfb8aa3b, v22
  v_exp_f32 v30, v30
  v_exp_f32 v31, v31
  v_exp_f32 v32, v32
  v_add_f32 v30, 1.0, v30
  v_add_f32 v31, 1.0, v31
  v_add_f32 v32, 1.0, v32
  v_rcp_f32 v30, v30
  v_rcp_f32 v31, v31
  v_rcp_f32 v32, v32
  v_mul_f32 v30, v30, v20
  v_mul_f32 v31, v31, v21
  v_mul_f32 v32, v32, v22
  v_cvt_pk_bf16_f32 v30, v30, v30
  v_cvt_pk_bf16_f32 v31, v31, v31
  v_cvt_pk_bf16_f32 v32, v32, v32
  v_lshlrev_b32 v20, 16, v30
  v_lshlrev_b32 v21, 16, v31
  v_lshlrev_b32 v22, 16, v32
  v_lshlrev_b32 v23, 16, v23
  v_lshlrev_b32 v24, 16, v24
  v_lshlrev_b32 v25, 16, v25
  v_mul_f32 v30, 0xbfb8aa3b, v23
  v_mul_f32 v31, 0xbfb8aa3b, v24
  v_mul_f32 v32, 0xbfb8aa3b, v25
  v_exp_f32 v30, v30
  v_exp_f32 v31, v31
  v_exp_f32 v32, v32
  v_add_f32 v30, 1.0, v30
  v_add_f32 v31, 1.0, v31
  v_add_f32 v32, 1.0, v32
  v_rcp_f32 v30, v30
  v_rcp_f32 v31, v31
  v_rcp_f32 v32, v32
  v_mul_f32 v30, v30, v23
  v_mul_f32 v31, v31, v24
  v_mul_f32 v32, v32, v25
  v_cvt_pk_bf16_f32 v30, v30, v30
  v_cvt_pk_bf16_f32 v31, v31, v31
  v_cvt_pk_bf16_f32 v32, v32, v32
  v_lshlrev_b32 v23, 16, v30
  v_lshlrev_b32 v24, 16, v31
  v_lshlrev_b32 v25, 16, v32
  v_lshlrev_b32 v26, 16, v26
  v_lshlrev_b32 v27, 16, v27
  v_lshlrev_b32 v28, 16, v28
  v_mul_f32 v30, 0xbfb8aa3b, v26
  v_mul_f32 v31, 0xbfb8aa3b, v27
  v_mul_f32 v32, 0xbfb8aa3b, v28
  v_exp_f32 v30, v30
  v_exp_f32 v31, v31
  v_exp_f32 v32, v32
  v_add_f32 v30, 1.0, v30
  v_add_f32 v31, 1.0, v31
  v_add_f32 v32, 1.0, v32
  v_rcp_f32 v30, v30
  v_rcp_f32 v31, v31
  v_rcp_f32 v32, v32
  v_mul_f32 v30, v30, v26
  v_mul_f32 v31, v31, v27
  v_mul_f32 v32, v32, v28
  v_cvt_pk_bf16_f32 v30, v30, v30
  v_cvt_pk_bf16_f32 v31, v31, v31
  v_cvt_pk_bf16_f32 v32, v32, v32
  v_lshlrev_b32 v26, 16, v30
  v_lshlrev_b32 v27, 16, v31
  v_lshlrev_b32 v28, 16, v32
  s_waitcnt vmcnt(9)
  v_lshlrev_b32 v30, 16, v40
  v_and_b32 v31, 0xffff0000, v40
  v_pk_mul_f32 v[76:77], v[30:31], v[20:21] op_sel:[0,0] op_sel_hi:[1,0]
  v_lshlrev_b32 v32, 16, v41
  v_and_b32 v33, 0xffff0000, v41
  v_pk_mul_f32 v[78:79], v[32:33], v[20:21] op_sel:[0,0] op_sel_hi:[1,0]
  v_lshlrev_b32 v30, 16, v42
  v_and_b32 v31, 0xffff0000, v42
  v_pk_mul_f32 v[80:81], v[30:31], v[20:21] op_sel:[0,0] op_sel_hi:[1,0]
  v_lshlrev_b32 v32, 16, v43
  v_and_b32 v33, 0xffff0000, v43
  v_pk_mul_f32 v[82:83], v[32:33], v[20:21] op_sel:[0,0] op_sel_hi:[1,0]
  s_waitcnt vmcnt(8)
  v_lshlrev_b32 v30, 16, v44
  v_and_b32 v31, 0xffff0000, v44
  v_pk_fma_f32 v[76:77], v[30:31], v[20:21], v[76:77] op_sel:[0,1,0] op_sel_hi:[1,1,1]
  v_lshlrev_b32 v32, 16, v45
  v_and_b32 v33, 0xffff0000, v45
  v_pk_fma_f32 v[78:79], v[32:33], v[20:21], v[78:79] op_sel:[0,1,0] op_sel_hi:[1,1,1]
  v_lshlrev_b32 v30, 16, v46
  v_and_b32 v31, 0xffff0000, v46
  v_pk_fma_f32 v[80:81], v[30:31], v[20:21], v[80:81] op_sel:[0,1,0] op_sel_hi:[1,1,1]
  v_lshlrev_b32 v32, 16, v47
  v_and_b32 v33, 0xffff0000, v47
  v_pk_fma_f32 v[82:83], v[32:33], v[20:21], v[82:83] op_sel:[0,1,0] op_sel_hi:[1,1,1]
  s_waitcnt vmcnt(7)
  v_lshlrev_b32 v30, 16, v48
  v_and_b32 v31, 0xffff0000, v48
  v_pk_fma_f32 v[76:77], v[30:31], v[22:23], v[76:77] op_sel:[0,0,0] op_sel_hi:[1,0,1]
  v_lshlrev_b32 v32, 16, v49
  v_and_b32 v33, 0xffff0000, v49
  v_pk_fma_f32 v[78:79], v[32:33], v[22:23], v[78:79] op_sel:[0,0,0] op_sel_hi:[1,0,1]
  v_lshlrev_b32 v30, 16, v50
  v_and_b32 v31, 0xffff0000, v50
  v_pk_fma_f32 v[80:81], v[30:31], v[22:23], v[80:81] op_sel:[0,0,0] op_sel_hi:[1,0,1]
  v_lshlrev_b32 v32, 16, v51
  v_and_b32 v33, 0xffff0000, v51
  v_pk_fma_f32 v[82:83], v[32:33], v[22:23], v[82:83] op_sel:[0,0,0] op_sel_hi:[1,0,1]
  s_waitcnt vmcnt(6)
  v_lshlrev_b32 v30, 16, v52
  v_and_b32 v31, 0xffff0000, v52
  v_pk_fma_f32 v[76:77], v[30:31], v[22:23], v[76:77] op_sel:[0,1,0] op_sel_hi:[1,1,1]
  v_lshlrev_b32 v32, 16, v53
  v_and_b32 v33, 0xffff0000, v53
  v_pk_fma_f32 v[78:79], v[32:33], v[22:23], v[78:79] op_sel:[0,1,0] op_sel_hi:[1,1,1]
  v_lshlrev_b32 v30, 16, v54
  v_and_b32 v31, 0xffff0000, v54
  v_pk_fma_f32 v[80:81], v[30:31], v[22:23], v[80:81] op_sel:[0,1,0] op_sel_hi:[1,1,1]
  v_lshlrev_b32 v32, 16, v55
  v_and_b32 v33, 0xffff0000, v55
  v_pk_fma_f32 v[82:83], v[32:33], v[22:23], v[82:83] op_sel:[0,1,0] op_sel_hi:[1,1,1]
  s_waitcnt vmcnt(5)
  v_lshlrev_b32 v30, 16, v56
  v_and_b32 v31, 0xffff0000, v56
  v_pk_fma_f32 v[76:77], v[30:31], v[24:25], v[76:77] op_sel:[0,0,0] op_sel_hi:[1,0,1]
  v_lshlrev_b32 v32, 16, v57
  v_and_b32 v33, 0xffff0000, v57
  v_pk_fma_f32 v[78:79], v[32:33], v[24:25], v[78:79] op_sel:[0,0,0] op_sel_hi:[1,0,1]
  v_lshlrev_b32 v30, 16, v58
  v_and_b32 v31, 0xffff0000, v58
  v_pk_fma_f32 v[80:81], v[30:31], v[24:25], v[80:81] op_sel:[0,0,0] op_sel_hi:[1,0,1]
  v_lshlrev_b32 v32, 16, v59
  v_and_b32 v33, 0xffff0000, v59
  v_pk_fma_f32 v[82:83], v[32:33], v[24:25], v[82:83] op_sel:[0,0,0] op_sel_hi:[1,0,1]
  s_waitcnt vmcnt(4)
  v_lshlrev_b32 v30, 16, v60
  v_and_b32 v31, 0xffff0000, v60
  v_pk_fma_f32 v[76:77], v[30:31], v[24:25], v[76:77] op_sel:[0,1,0] op_sel_hi:[1,1,1]
  v_lshlrev_b32 v32, 16, v61
  v_and_b32 v33, 0xffff0000, v61
  v_pk_fma_f32 v[78:79], v[32:33], v[24:25], v[78:79] op_sel:[0,1,0] op_sel_hi:[1,1,1]
  v_lshlrev_b32 v30, 16, v62
  v_and_b32 v31, 0xffff0000, v62
  v_pk_fma_f32 v[80:81], v[30:31], v[24:25], v[80:81] op_sel:[0,1,0] op_sel_hi:[1,1,1]
  v_lshlrev_b32 v32, 16, v63
  v_and_b32 v33, 0xffff0000, v63
  v_pk_fma_f32 v[82:83], v[32:33], v[24:25], v[82:83] op_sel:[0,1,0] op_sel_hi:[1,1,1]
  s_waitcnt vmcnt(3)
  v_lshlrev_b32 v30, 16, v64
  v_and_b32 v31, 0xffff0000, v64
  v_pk_fma_f32 v[76:77], v[30:31], v[26:27], v[76:77] op_sel:[0,0,0] op_sel_hi:[1,0,1]
  v_lshlrev_b32 v32, 16, v65
  v_and_b32 v33, 0xffff0000, v65
  v_pk_fma_f32 v[78:79], v[32:33], v[26:27], v[78:79] op_sel:[0,0,0] op_sel_hi:[1,0,1]
  v_lshlrev_b32 v30, 16, v66
  v_and_b32 v31, 0xffff0000, v66
  v_pk_fma_f32 v[80:81], v[30:31], v[26:27], v[80:81] op_sel:[0,0,0] op_sel_hi:[1,0,1]
  v_lshlrev_b32 v32, 16, v67
  v_and_b32 v33, 0xffff0000, v67
  v_pk_fma_f32 v[82:83], v[32:33], v[26:27], v[82:83] op_sel:[0,0,0] op_sel_hi:[1,0,1]
  s_waitcnt vmcnt(2)
  v_lshlrev_b32 v30, 16, v68
  v_and_b32 v31, 0xffff0000, v68
  v_pk_fma_f32 v[76:77], v[30:31], v[26:27], v[76:77] op_sel:[0,1,0] op_sel_hi:[1,1,1]
  v_lshlrev_b32 v32, 16, v69
  v_and_b32 v33, 0xffff0000, v69
  v_pk_fma_f32 v[78:79], v[32:33], v[26:27], v[78:79] op_sel:[0,1,0] op_sel_hi:[1,1,1]
  v_lshlrev_b32 v30, 16, v70
  v_and_b32 v31, 0xffff0000, v70
  v_pk_fma_f32 v[80:81], v[30:31], v[26:27], v[80:81] op_sel:[0,1,0] op_sel_hi:[1,1,1]
  v_lshlrev_b32 v32, 16, v71
  v_and_b32 v33, 0xffff0000, v71
  v_pk_fma_f32 v[82:83], v[32:33], v[26:27], v[82:83] op_sel:[0,1,0] op_sel_hi:[1,1,1]
  s_waitcnt vmcnt(1)
  v_lshlrev_b32 v30, 16, v72
  v_and_b32 v31, 0xffff0000, v72
  v_pk_fma_f32 v[76:77], v[30:31], v[28:29], v[76:77] op_sel:[0,0,0] op_sel_hi:[1,0,1]
  v_lshlrev_b32 v32, 16, v73
  v_and_b32 v33, 0xffff0000, v73
  v_pk_fma_f32 v[78:79], v[32:33], v[28:29], v[78:79] op_sel:[0,0,0] op_sel_hi:[1,0,1]
  v_lshlrev_b32 v30, 16, v74
  v_and_b32 v31, 0xffff0000, v74
  v_pk_fma_f32 v[80:81], v[30:31], v[28:29], v[80:81] op_sel:[0,0,0] op_sel_hi:[1,0,1]
  v_lshlrev_b32 v32, 16, v75
  v_and_b32 v33, 0xffff0000, v75
  v_pk_fma_f32 v[82:83], v[32:33], v[28:29], v[82:83] op_sel:[0,0,0] op_sel_hi:[1,0,1]
  v_lshlrev_b32 v6, 5, v0
  ds_write_b128 v6, v[76:79] offset:0
  ds_write_b128 v6, v[80:83] offset:16
  v_lshlrev_b32 v6, 2, v2
  s_lshl_b32 s26, s3, 11
  v_add_u32 v6, s26, v6
  s_waitcnt lgkmcnt(0)
  s_barrier
  ds_read_b32 v40, v6 offset:0
  ds_read_b32 v41, v6 offset:256
  ds_read_b32 v42, v6 offset:512
  ds_read_b32 v43, v6 offset:768
  ds_read_b32 v44, v6 offset:1024
  ds_read_b32 v45, v6 offset:1280
  ds_read_b32 v46, v6 offset:1536
  ds_read_b32 v47, v6 offset:1792
  v_lshlrev_b32 v90, 2, v0
  s_waitcnt lgkmcnt(0)
  v_pk_add_f32 v[40:41], v[40:41], v[42:43]
  v_pk_add_f32 v[44:45], v[44:45], v[46:47]
  v_pk_add_f32 v[40:41], v[40:41], v[44:45]
  v_add_f32 v40, v40, v41
  ds_write_b32 v90, v40 offset:8192
  v_lshlrev_b32 v90, 2, v2
  s_waitcnt lgkmcnt(0)
  s_barrier
  ds_read_b32 v40, v90 offset:8192
  ds_read_b32 v41, v90 offset:8448
  ds_read_b32 v42, v90 offset:8704
  ds_read_b32 v43, v90 offset:8960
  s_waitcnt lgkmcnt(0)
  v_pk_add_f32 v[40:41], v[40:41], v[42:43]
  v_add_f32 v40, v40, v41
  buffer_store_dword v40, v91, s[8:11], s100 offen sc1
L_m_nogv2:
  s_cmp_eq_u32 s96, 0
  s_cbranch_scc1 L_m_udone
  s_mov_b32 s26, s101
  s_cmp_eq_u32 s96, 3
  s_cbranch_scc1 L_m_uln
  s_cmp_eq_u32 s96, 2
  s_cbranch_scc1 L_m_uv
  v_add_u32 v92, 16384, v19
  v_lshl_add_u32 v93, v155, 5, v92
  v_lshl_add_u32 v92, v155, 8, v92
  s_add_u32 s26, s26, 73728
  s_waitcnt vmcnt(1)
  ds_read_b64_tr_b16 v[108:109], v92 offset:0
  ds_read_b64_tr_b16 v[110:111], v92 offset:1024
  ds_read_b64_tr_b16 v[112:113], v92 offset:32
  ds_read_b64_tr_b16 v[114:115], v92 offset:1056
  ds_read_b64_tr_b16 v[116:117], v92 offset:64
  ds_read_b64_tr_b16 v[118:119], v92 offset:1088
  ds_read_b64_tr_b16 v[120:121], v92 offset:96
  ds_read_b64_tr_b16 v[122:123], v92 offset:1120
  ds_read_b64_tr_b16 v[124:125], v92 offset:128
  ds_read_b64_tr_b16 v[126:127], v92 offset:1152
  ds_read_b64_tr_b16 v[128:129], v92 offset:160
  ds_read_b64_tr_b16 v[130:131], v92 offset:1184
  ds_read_b64_tr_b16 v[132:133], v92 offset:192
  ds_read_b64_tr_b16 v[134:135], v92 offset:1216
  ds_read_b64_tr_b16 v[136:137], v92 offset:224
  ds_read_b64_tr_b16 v[138:139], v92 offset:1248
  ds_read_b64_tr_b16 v[140:141], v93 offset:8192
  ds_read_b64_tr_b16 v[142:143], v93 offset:8320
  s_waitcnt lgkmcnt(15)
  buffer_store_dwordx4 v[108:111], v4, s[16:19], s26 offen sc1
  s_add_u32 s26, s26, 18432
  s_waitcnt lgkmcnt(14)
  buffer_store_dwordx4 v[112:115], v4, s[16:19], s26 offen sc1
  s_add_u32 s26, s26, 18432
  s_waitcnt lgkmcnt(12)
  buffer_store_dwordx4 v[116:119], v4, s[16:19], s26 offen sc1
  s_add_u32 s26, s26, 18432
  s_waitcnt lgkmcnt(10)
  buffer_store_dwordx4 v[120:123], v4, s[16:19], s26 offen sc1
  s_add_u32 s26, s26, 18432
  s_waitcnt lgkmcnt(8)
  buffer_store_dwordx4 v[124:127], v4, s[16:19], s26 offen sc1
  s_add_u32 s26, s26, 18432
  s_waitcnt lgkmcnt(6)
  buffer_store_dwordx4 v[128:131], v4, s[16:19], s26 offen sc1
  s_add_u32 s26, s26, 18432
  s_waitcnt lgkmcnt(4)
  buffer_store_dwordx4 v[132:135], v4, s[16:19], s26 offen sc1
  s_add_u32 s26, s26, 18432
  s_waitcnt lgkmcnt(2)
  buffer_store_dwordx4 v[136:139], v4, s[16:19], s26 offen sc1
  s_add_u32 s26, s26, 36864
  s_waitcnt lgkmcnt(0)
  buffer_store_dwordx4 v[140:143], v4, s[16:19], s26 offen sc1
  s_add_u32 s26, s26, 18432
  s_branch L_m_udone
L_m_uv:
  v_add_u32 v92, 57344, v19
  v_lshl_add_u32 v93, v155, 4, v92
  v_lshl_add_u32 v92, v155, 7, v92
  v_cmp_gt_u32 vcc, 8, v3
  s_waitcnt vmcnt(1)
  ds_read_b64_tr_b16 v[108:109], v92 offset:0
  ds_read_b64_tr_b16 v[110:111], v92 offset:512
  ds_read_b64_tr_b16 v[112:113], v92 offset:32
  ds_read_b64_tr_b16 v[114:115], v92 offset:544
  ds_read_b64_tr_b16 v[116:117], v92 offset:64
  ds_read_b64_tr_b16 v[118:119], v92 offset:576
  ds_read_b64_tr_b16 v[120:121], v92 offset:96
  ds_read_b64_tr_b16 v[122:123], v92 offset:608
  ds_read_b64_tr_b16 v[124:125], v93 offset:4096
  ds_read_b64_tr_b16 v[126:127], v93 offset:4160
  s_waitcnt lgkmcnt(8)
  buffer_store_dwordx4 v[108:111], v4, s[16:19], s26 offen sc1
  s_add_u32 s26, s26, 18432
  s_waitcnt lgkmcnt(6)
  buffer_store_dwordx4 v[112:115], v4, s[16:19], s26 offen sc1
  s_add_u32 s26, s26, 18432
  s_waitcnt lgkmcnt(4)
  buffer_store_dwordx4 v[116:119], v4, s[16:19], s26 offen sc1
  s_add_u32 s26, s26, 18432
  s_waitcnt lgkmcnt(2)
  buffer_store_dwordx4 v[120:123], v4, s[16:19], s26 offen sc1
  s_add_u32 s26, s26, 165888
  s_waitcnt lgkmcnt(0)
  v_cndmask_b32 v124, 0, v124, vcc
  v_cndmask_b32 v125, 0, v125, vcc
  v_cndmask_b32 v126, 0, v126, vcc
  v_cndmask_b32 v127, 0, v127, vcc
  buffer_store_dwordx4 v[124:127], v4, s[16:19], s26 offen sc1
  s_add_u32 s26, s26, 18432
  s_branch L_m_udone
L_m_uln:
  s_waitcnt vmcnt(1)
  v_lshlrev_b32 v156, 16, v108
  v_and_b32 v157, 0xffff0000, v108
  v_lshlrev_b32 v158, 16, v109
  v_and_b32 v159, 0xffff0000, v109
  v_lshlrev_b32 v160, 16, v110
  v_and_b32 v161, 0xffff0000, v110
  v_lshlrev_b32 v162, 16, v111
  v_and_b32 v163, 0xffff0000, v111
  v_lshlrev_b32 v164, 16, v112
  v_and_b32 v165, 0xffff0000, v112
  v_lshlrev_b32 v166, 16, v113
  v_and_b32 v167, 0xffff0000, v113
  v_lshlrev_b32 v168, 16, v114
  v_and_b32 v169, 0xffff0000, v114
  v_lshlrev_b32 v170, 16, v115
  v_and_b32 v171, 0xffff0000, v115
  v_lshlrev_b32 v172, 16, v116
  v_and_b32 v173, 0xffff0000, v116
  v_lshlrev_b32 v174, 16, v117
  v_and_b32 v175, 0xffff0000, v117
  v_lshlrev_b32 v176, 16, v118
  v_and_b32 v177, 0xffff0000, v118
  v_lshlrev_b32 v178, 16, v119
  v_and_b32 v179, 0xffff0000, v119
  v_lshlrev_b32 v180, 16, v120
  v_and_b32 v181, 0xffff0000, v120
  v_lshlrev_b32 v182, 16, v121
  v_and_b32 v183, 0xffff0000, v121
  v_lshlrev_b32 v184, 16, v122
  v_and_b32 v185, 0xffff0000, v122
  v_lshlrev_b32 v186, 16, v123
  v_and_b32 v187, 0xffff0000, v123
  v_lshlrev_b32 v188, 16, v124
  v_and_b32 v189, 0xffff0000, v124
  v_lshlrev_b32 v190, 16, v125
  v_and_b32 v191, 0xffff0000, v125
  v_lshlrev_b32 v192, 16, v126
  v_and_b32 v193, 0xffff0000, v126
  v_lshlrev_b32 v194, 16, v127
  v_and_b32 v195, 0xffff0000, v127
  v_lshlrev_b32 v196, 16, v128
  v_and_b32 v197, 0xffff0000, v128
  v_lshlrev_b32 v198, 16, v129
  v_and_b32 v199, 0xffff0000, v129
  v_lshlrev_b32 v200, 16, v130
  v_and_b32 v201, 0xffff0000, v130
  v_lshlrev_b32 v202, 16, v131
  v_and_b32 v203, 0xffff0000, v131
  v_lshlrev_b32 v204, 16, v132
  v_and_b32 v205, 0xffff0000, v132
  v_lshlrev_b32 v206, 16, v133
  v_and_b32 v207, 0xffff0000, v133
  v_lshlrev_b32 v208, 16, v134
  v_and_b32 v209, 0xffff0000, v134
  v_lshlrev_b32 v210, 16, v135
  v_and_b32 v211, 0xffff0000, v135
  v_lshlrev_b32 v212, 16, v136
  v_and_b32 v213, 0xffff0000, v136
  v_lshlrev_b32 v214, 16, v137
  v_and_b32 v215, 0xffff0000, v137
  v_lshlrev_b32 v216, 16, v138
  v_and_b32 v217, 0xffff0000, v138
  v_lshlrev_b32 v218, 16, v139
  v_and_b32 v219, 0xffff0000, v139
  v_lshlrev_b32 v220, 16, v140
  v_and_b32 v221, 0xffff0000, v140
  v_lshlrev_b32 v222, 16, v141
  v_and_b32 v223, 0xffff0000, v141
  v_lshlrev_b32 v224, 16, v142
  v_and_b32 v225, 0xffff0000, v142
  v_lshlrev_b32 v226, 16, v143
  v_and_b32 v227, 0xffff0000, v143
  v_pk_add_f32 v[40:41], v[156:157], v[164:165]
  v_pk_add_f32 v[42:43], v[158:159], v[166:167]
  v_pk_add_f32 v[44:45], v[160:161], v[168:169]
  v_pk_add_f32 v[46:47], v[162:163], v[170:171]
  v_pk_add_f32 v[40:41], v[40:41], v[172:173]
  v_pk_add_f32 v[42:43], v[42:43], v[174:175]
  v_pk_add_f32 v[44:45], v[44:45], v[176:177]
  v_pk_add_f32 v[46:47], v[46:47], v[178:179]
  v_pk_add_f32 v[40:41], v[40:41], v[180:181]
  v_pk_add_f32 v[42:43], v[42:43], v[182:183]
  v_pk_add_f32 v[44:45], v[44:45], v[184:185]
  v_pk_add_f32 v[46:47], v[46:47], v[186:187]
  v_pk_add_f32 v[40:41], v[40:41], v[188:189]
  v_pk_add_f32 v[42:43], v[42:43], v[190:191]
  v_pk_add_f32 v[44:45], v[44:45], v[192:193]
  v_pk_add_f32 v[46:47], v[46:47], v[194:195]
  v_pk_add_f32 v[40:41], v[40:41], v[196:197]
  v_pk_add_f32 v[42:43], v[42:43], v[198:199]
  v_pk_add_f32 v[44:45], v[44:45], v[200:201]
  v_pk_add_f32 v[46:47], v[46:47], v[202:203]
  v_pk_add_f32 v[40:41], v[40:41], v[204:205]
  v_pk_add_f32 v[42:43], v[42:43], v[206:207]
  v_pk_add_f32 v[44:45], v[44:45], v[208:209]
  v_pk_add_f32 v[46:47], v[46:47], v[210:211]
  v_pk_add_f32 v[40:41], v[40:41], v[212:213]
  v_pk_add_f32 v[42:43], v[42:43], v[214:215]
  v_pk_add_f32 v[44:45], v[44:45], v[216:217]
  v_pk_add_f32 v[46:47], v[46:47], v[218:219]
  v_pk_add_f32 v[40:41], v[40:41], v[220:221]
  v_pk_add_f32 v[42:43], v[42:43], v[222:223]
  v_pk_add_f32 v[44:45], v[44:45], v[224:225]
  v_pk_add_f32 v[46:47], v[46:47], v[226:227]
  v_pk_add_f32 v[40:41], v[40:41], v[42:43]
  v_pk_add_f32 v[44:45], v[44:45], v[46:47]
  v_pk_add_f32 v[40:41], v[40:41], v[44:45]
  v_add_f32 v40, v40, v41
  s_nop 1
  v_add_f32_dpp v40, v40, v40 quad_perm:[1,0,3,2] row_mask:0xf bank_mask:0xf
  s_nop 1
  v_add_f32_dpp v40, v40, v40 quad_perm:[2,3,0,1] row_mask:0xf bank_mask:0xf
  s_nop 1
  v_add_f32_dpp v40, v40, v40 row_half_mirror row_mask:0xf bank_mask:0xf
  v_mul_f32 v40, 0xbae38e39, v40
  v_pk_add_f32 v[156:157], v[156:157], v[40:41] op_sel_hi:[1,0]
  v_pk_add_f32 v[158:159], v[158:159], v[40:41] op_sel_hi:[1,0]
  v_pk_add_f32 v[160:161], v[160:161], v[40:41] op_sel_hi:[1,0]
  v_pk_add_f32 v[162:163], v[162:163], v[40:41] op_sel_hi:[1,0]
  v_pk_add_f32 v[164:165], v[164:165], v[40:41] op_sel_hi:[1,0]
  v_pk_add_f32 v[166:167], v[166:167], v[40:41] op_sel_hi:[1,0]
  v_pk_add_f32 v[168:169], v[168:169], v[40:41] op_sel_hi:[1,0]
  v_pk_add_f32 v[170:171], v[170:171], v[40:41] op_sel_hi:[1,0]
  v_pk_add_f32 v[172:173], v[172:173], v[40:41] op_sel_hi:[1,0]
  v_pk_add_f32 v[174:175], v[174:175], v[40:41] op_sel_hi:[1,0]
  v_pk_add_f32 v[176:177], v[176:177], v[40:41] op_sel_hi:[1,0]
  v_pk_add_f32 v[178:179], v[178:179], v[40:41] op_sel_hi:[1,0]
  v_pk_add_f32 v[180:181], v[180:181], v[40:41] op_sel_hi:[1,0]
  v_pk_add_f32 v[182:183], v[182:183], v[40:41] op_sel_hi:[1,0]
  v_pk_add_f32 v[184:185], v[184:185], v[40:41] op_sel_hi:[1,0]
  v_pk_add_f32 v[186:187], v[186:187], v[40:41] op_sel_hi:[1,0]
  v_pk_add_f32 v[188:189], v[188:189], v[40:41] op_sel_hi:[1,0]
  v_pk_add_f32 v[190:191], v[190:191], v[40:41] op_sel_hi:[1,0]
  v_pk_add_f32 v[192:193], v[192:193], v[40:41] op_sel_hi:[1,0]
  v_pk_add_f32 v[194:195], v[194:195], v[40:41] op_sel_hi:[1,0]
  v_pk_add_f32 v[196:197], v[196:197], v[40:41] op_sel_hi:[1,0]
  v_pk_add_f32 v[198:199], v[198:199], v[40:41] op_sel_hi:[1,0]
  v_pk_add_f32 v[200:201], v[200:201], v[40:41] op_sel_hi:[1,0]
  v_pk_add_f32 v[202:203], v[202:203], v[40:41] op_sel_hi:[1,0]
  v_pk_add_f32 v[204:205], v[204:205], v[40:41] op_sel_hi:[1,0]
  v_pk_add_f32 v[206:207], v[206:207], v[40:41] op_sel_hi:[1,0]
  v_pk_add_f32 v[208:209], v[208:209], v[40:41] op_sel_hi:[1,0]
  v_pk_add_f32 v[210:211], v[210:211], v[40:41] op_sel_hi:[1,0]
  v_pk_add_f32 v[212:213], v[212:213], v[40:41] op_sel_hi:[1,0]
  v_pk_add_f32 v[214:215], v[214:215], v[40:41] op_sel_hi:[1,0]
  v_pk_add_f32 v[216:217], v[216:217], v[40:41] op_sel_hi:[1,0]
  v_pk_add_f32 v[218:219], v[218:219], v[40:41] op_sel_hi:[1,0]
  v_pk_add_f32 v[220:221], v[220:221], v[40:41] op_sel_hi:[1,0]
  v_pk_add_f32 v[222:223], v[222:223], v[40:41] op_sel_hi:[1,0]
  v_pk_add_f32 v[224:225], v[224:225], v[40:41] op_sel_hi:[1,0]
  v_pk_add_f32 v[226:227], v[226:227], v[40:41] op_sel_hi:[1,0]
  v_pk_mul_f32 v[42:43], v[156:157], v[156:157]
  v_pk_mul_f32 v[44:45], v[158:159], v[158:159]
  v_pk_mul_f32 v[46:47], v[160:161], v[160:161]
  v_pk_mul_f32 v[48:49], v[162:163], v[162:163]
  v_pk_fma_f32 v[42:43], v[164:165], v[164:165], v[42:43]
  v_pk_fma_f32 v[44:45], v[166:167], v[166:167], v[44:45]
  v_pk_fma_f32 v[46:47], v[168:169], v[168:169], v[46:47]
  v_pk_fma_f32 v[48:49], v[170:171], v[170:171], v[48:49]
  v_pk_fma_f32 v[42:43], v[172:173], v[172:173], v[42:43]
  v_pk_fma_f32 v[44:45], v[174:175], v[174:175], v[44:45]
  v_pk_fma_f32 v[46:47], v[176:177], v[176:177], v[46:47]
  v_pk_fma_f32 v[48:49], v[178:179], v[178:179], v[48:49]
  v_pk_fma_f32 v[42:43], v[180:181], v[180:181], v[42:43]
  v_pk_fma_f32 v[44:45], v[182:183], v[182:183], v[44:45]
  v_pk_fma_f32 v[46:47], v[184:185], v[184:185], v[46:47]
  v_pk_fma_f32 v[48:49], v[186:187], v[186:187], v[48:49]
  v_pk_fma_f32 v[42:43], v[188:189], v[188:189], v[42:43]
  v_pk_fma_f32 v[44:45], v[190:191], v[190:191], v[44:45]
  v_pk_fma_f32 v[46:47], v[192:193], v[192:193], v[46:47]
  v_pk_fma_f32 v[48:49], v[194:195], v[194:195], v[48:49]
  v_pk_fma_f32 v[42:43], v[196:197], v[196:197], v[42:43]
  v_pk_fma_f32 v[44:45], v[198:199], v[198:199], v[44:45]
  v_pk_fma_f32 v[46:47], v[200:201], v[200:201], v[46:47]
  v_pk_fma_f32 v[48:49], v[202:203], v[202:203], v[48:49]
  v_pk_fma_f32 v[42:43], v[204:205], v[204:205], v[42:43]
  v_pk_fma_f32 v[44:45], v[206:207], v[206:207], v[44:45]
  v_pk_fma_f32 v[46:47], v[208:209], v[208:209], v[46:47]
  v_pk_fma_f32 v[48:49], v[210:211], v[210:211], v[48:49]
  v_pk_fma_f32 v[42:43], v[212:213], v[212:213], v[42:43]
  v_pk_fma_f32 v[44:45], v[214:215], v[214:215], v[44:45]
  v_pk_fma_f32 v[46:47], v[216:217], v[216:217], v[46:47]
  v_pk_fma_f32 v[48:49], v[218:219], v[218:219], v[48:49]
  v_pk_fma_f32 v[42:43], v[220:221], v[220:221], v[42:43]
  v_pk_fma_f32 v[44:45], v[222:223], v[222:223], v[44:45]
  v_pk_fma_f32 v[46:47], v[224:225], v[224:225], v[46:47]
  v_pk_fma_f32 v[48:49], v[226:227], v[226:227], v[48:49]
  v_pk_add_f32 v[42:43], v[42:43], v[44:45]
  v_pk_add_f32 v[46:47], v[46:47], v[48:49]
  v_pk_add_f32 v[42:43], v[42:43], v[46:47]
  v_add_f32 v42, v42, v43
  s_nop 1
  v_add_f32_dpp v42, v42, v42 quad_perm:[1,0,3,2] row_mask:0xf bank_mask:0xf
  s_nop 1
  v_add_f32_dpp v42, v42, v42 quad_perm:[2,3,0,1] row_mask:0xf bank_mask:0xf
  s_nop 1
  v_add_f32_dpp v42, v42, v42 row_half_mirror row_mask:0xf bank_mask:0xf
  v_mov_b32 v43, 0x3727c5ac
  v_fmac_f32 v43, 0x3ae38e39, v42
  v_rsq_f32 v42, v43
  s_mov_b32 s26, 0
  v_pk_mul_f32 v[156:157], v[156:157], v[42:43] op_sel_hi:[1,0]
  v_cvt_pk_bf16_f32 v108, v156, v157
  v_pk_mul_f32 v[158:159], v[158:159], v[42:43] op_sel_hi:[1,0]
  v_cvt_pk_bf16_f32 v109, v158, v159
  v_pk_mul_f32 v[160:161], v[160:161], v[42:43] op_sel_hi:[1,0]
  v_cvt_pk_bf16_f32 v110, v160, v161
  v_pk_mul_f32 v[162:163], v[162:163], v[42:43] op_sel_hi:[1,0]
  v_cvt_pk_bf16_f32 v111, v162, v163
  buffer_store_dwordx4 v[108:111], v103, s[12:15], s26 offen sc1
  s_add_u32 s26, s26, 2048
  v_pk_mul_f32 v[164:165], v[164:165], v[42:43] op_sel_hi:[1,0]
  v_cvt_pk_bf16_f32 v112, v164, v165
  v_pk_mul_f32 v[166:167], v[166:167], v[42:43] op_sel_hi:[1,0]
  v_cvt_pk_bf16_f32 v113, v166, v167
  v_pk_mul_f32 v[168:169], v[168:169], v[42:43] op_sel_hi:[1,0]
  v_cvt_pk_bf16_f32 v114, v168, v169
  v_pk_mul_f32 v[170:171], v[170:171], v[42:43] op_sel_hi:[1,0]
  v_cvt_pk_bf16_f32 v115, v170, v171
  buffer_store_dwordx4 v[112:115], v103, s[12:15], s26 offen sc1
  s_add_u32 s26, s26, 2048
  v_pk_mul_f32 v[172:173], v[172:173], v[42:43] op_sel_hi:[1,0]
  v_cvt_pk_bf16_f32 v116, v172, v173
  v_pk_mul_f32 v[174:175], v[174:175], v[42:43] op_sel_hi:[1,0]
  v_cvt_pk_bf16_f32 v117, v174, v175
  v_pk_mul_f32 v[176:177], v[176:177], v[42:43] op_sel_hi:[1,0]
  v_cvt_pk_bf16_f32 v118, v176, v177
  v_pk_mul_f32 v[178:179], v[178:179], v[42:43] op_sel_hi:[1,0]
  v_cvt_pk_bf16_f32 v119, v178, v179
  buffer_store_dwordx4 v[116:119], v103, s[12:15], s26 offen sc1
  s_add_u32 s26, s26, 2048
  v_pk_mul_f32 v[180:181], v[180:181], v[42:43] op_sel_hi:[1,0]
  v_cvt_pk_bf16_f32 v120, v180, v181
  v_pk_mul_f32 v[182:183], v[182:183], v[42:43] op_sel_hi:[1,0]
  v_cvt_pk_bf16_f32 v121, v182, v183
  v_pk_mul_f32 v[184:185], v[184:185], v[42:43] op_sel_hi:[1,0]
  v_cvt_pk_bf16_f32 v122, v184, v185
  v_pk_mul_f32 v[186:187], v[186:187], v[42:43] op_sel_hi:[1,0]
  v_cvt_pk_bf16_f32 v123, v186, v187
  buffer_store_dwordx4 v[120:123], v103, s[12:15], s26 offen sc1
  s_add_u32 s26, s26, 2048
  v_pk_mul_f32 v[188:189], v[188:189], v[42:43] op_sel_hi:[1,0]
  v_cvt_pk_bf16_f32 v124, v188, v189
  v_pk_mul_f32 v[190:191], v[190:191], v[42:43] op_sel_hi:[1,0]
  v_cvt_pk_bf16_f32 v125, v190, v191
  v_pk_mul_f32 v[192:193], v[192:193], v[42:43] op_sel_hi:[1,0]
  v_cvt_pk_bf16_f32 v126, v192, v193
  v_pk_mul_f32 v[194:195], v[194:195], v[42:43] op_sel_hi:[1,0]
  v_cvt_pk_bf16_f32 v127, v194, v195
  buffer_store_dwordx4 v[124:127], v103, s[12:15], s26 offen sc1
  s_add_u32 s26, s26, 2048
  v_pk_mul_f32 v[196:197], v[196:197], v[42:43] op_sel_hi:[1,0]
  v_cvt_pk_bf16_f32 v128, v196, v197
  v_pk_mul_f32 v[198:199], v[198:199], v[42:43] op_sel_hi:[1,0]
  v_cvt_pk_bf16_f32 v129, v198, v199
  v_pk_mul_f32 v[200:201], v[200:201], v[42:43] op_sel_hi:[1,0]
  v_cvt_pk_bf16_f32 v130, v200, v201
  v_pk_mul_f32 v[202:203], v[202:203], v[42:43] op_sel_hi:[1,0]
  v_cvt_pk_bf16_f32 v131, v202, v203
  buffer_store_dwordx4 v[128:131], v103, s[12:15], s26 offen sc1
  s_add_u32 s26, s26, 2048
  v_pk_mul_f32 v[204:205], v[204:205], v[42:43] op_sel_hi:[1,0]
  v_cvt_pk_bf16_f32 v132, v204, v205
  v_pk_mul_f32 v[206:207], v[206:207], v[42:43] op_sel_hi:[1,0]
  v_cvt_pk_bf16_f32 v133, v206, v207
  v_pk_mul_f32 v[208:209], v[208:209], v[42:43] op_sel_hi:[1,0]
  v_cvt_pk_bf16_f32 v134, v208, v209
  v_pk_mul_f32 v[210:211], v[210:211], v[42:43] op_sel_hi:[1,0]
  v_cvt_pk_bf16_f32 v135, v210, v211
  buffer_store_dwordx4 v[132:135], v103, s[12:15], s26 offen sc1
  s_add_u32 s26, s26, 2048
  v_pk_mul_f32 v[212:213], v[212:213], v[42:43] op_sel_hi:[1,0]
  v_cvt_pk_bf16_f32 v136, v212, v213
  v_pk_mul_f32 v[214:215], v[214:215], v[42:43] op_sel_hi:[1,0]
  v_cvt_pk_bf16_f32 v137, v214, v215
  v_pk_mul_f32 v[216:217], v[216:217], v[42:43] op_sel_hi:[1,0]
  v_cvt_pk_bf16_f32 v138, v216, v217
  v_pk_mul_f32 v[218:219], v[218:219], v[42:43] op_sel_hi:[1,0]
  v_cvt_pk_bf16_f32 v139, v218, v219
  buffer_store_dwordx4 v[136:139], v103, s[12:15], s26 offen sc1
  s_add_u32 s26, s26, 2048
  v_pk_mul_f32 v[220:221], v[220:221], v[42:43] op_sel_hi:[1,0]
  v_cvt_pk_bf16_f32 v140, v220, v221
  v_pk_mul_f32 v[222:223], v[222:223], v[42:43] op_sel_hi:[1,0]
  v_cvt_pk_bf16_f32 v141, v222, v223
  v_pk_mul_f32 v[224:225], v[224:225], v[42:43] op_sel_hi:[1,0]
  v_cvt_pk_bf16_f32 v142, v224, v225
  v_pk_mul_f32 v[226:227], v[226:227], v[42:43] op_sel_hi:[1,0]
  v_cvt_pk_bf16_f32 v143, v226, v227
  buffer_store_dwordx4 v[140:143], v103, s[12:15], s26 offen sc1
  s_add_u32 s26, s26, 2048
L_m_udone:
  s_mov_b32 s36, s4
  s_mov_b32 s37, s5
  s_mov_b32 s38, 50364416
  s_mov_b32 s39, 0x20000
  v_mov_b32 v84, -1
  v_mov_b32 v85, -1
  v_mov_b32 v86, -1
  v_mov_b32 v87, -1
  s_lshl_b32 s26, s20, 4
  s_add_u32 s26, s26, s21
  s_lshl_b32 s26, s26, 10
  s_lshl_b32 s25, s3, 8
  s_add_u32 s26, s26, s25
  s_add_u32 s26, s26, 196608
  v_lshlrev_b32 v88, 27, v2
  v_lshlrev_b32 v89, 26, v2
  v_or_b32 v88, v88, v89
  v_and_b32 v88, 0x80000000, v88
  v_or_b32 v88, v88, v4
  buffer_store_dwordx4 v[84:87], v88, s[36:39], s26 offen sc1
  s_lshl_b32 s26, s22, 2
  s_add_u32 s26, s26, s3
  s_mul_i32 s26, s26, 18432
  s_mul_i32 s25, s23, 2304
  s_add_u32 s26, s26, s25
  s_add_u32 s26, s26, 13895680
  buffer_store_dwordx4 v[84:87], v88, s[36:39], s26 offen sc1
  s_lshl_b32 s26, s3, 4
  s_sub_u32 s26, s26, 16
  s_add_u32 s26, s26, s20
  s_cmp_lt_u32 s26, 18
  s_cselect_b32 s24, 0, 0x80000000
  s_cselect_b32 s26, s26, 0
  s_mul_i32 s25, s21, 18
  s_add_u32 s26, s26, s25
  s_lshl_b32 s26, s26, 7
  s_add_u32 s26, s26, 147456
  v_lshlrev_b32 v89, 28, v2
  v_and_b32 v89, 0x80000000, v89
  v_or3_b32 v88, v88, v89, s24
  buffer_store_dwordx4 v[84:87], v88, s[36:39], s26 offen sc1
  s_waitcnt vmcnt(0)
L_m_tagchk:
  v_readfirstlane_b32 s97, v98
  s_nop 0
  s_cmp_lg_u32 s97, 0
  s_cbranch_scc1 L_m_tagok
  s_load_dwordx2 s[100:101], s[0:1], 88
  v_mov_b32 v1, 0
  s_waitcnt lgkmcnt(0)
  global_load_dword v98, v1, s[100:101] sc1
  s_waitcnt vmcnt(0)
  s_branch L_m_tagchk
L_m_tagok:
  s_lshl_b32 s26, s2, 2
  s_barrier
  s_cmp_lg_u32 s3, 0
  s_cbranch_scc1 L_sig_1
  s_lshl_b32 s24, s26, 2
  s_add_u32 s24, s24, 229376
  v_mov_b32 v1, 0
  v_mov_b32 v6, s97
  s_mov_b64 exec, 1
  buffer_store_dword v6, v1, s[56:59], s24 offen sc1
  s_mov_b64 exec, -1
L_sig_1:
  s_mov_b32 s36, s54
  s_mov_b32 s37, s55
  s_mov_b32 s38, 5308416
  s_mov_b32 s39, 0x20000
  s_load_dwordx2 s[8:9], s[0:1], 16
  s_mov_b32 s10, 663552
  s_waitcnt lgkmcnt(0)
  s_add_u32 m0, s42, 4096
  s_mov_b32 exec_hi, 0
  buffer_load_dwordx4 v16, s[8:11], s41 offen nt lds
  s_mov_b32 exec_hi, -1
  s_add_u32 m0, s42, 0
  s_nop 0
  buffer_load_dwordx4 v148, s[8:11], s41 offen nt lds
  s_add_u32 m0, s42, 1024
  s_nop 0
  buffer_load_dwordx4 v149, s[8:11], s41 offen nt lds
  s_add_u32 m0, s42, 2048
  s_nop 0
  buffer_load_dwordx4 v150, s[8:11], s41 offen nt lds
  s_add_u32 m0, s42, 3072
  s_nop 0
  buffer_load_dwordx4 v151, s[8:11], s41 offen nt lds
  s_add_u32 m0, s40, 8192
  s_nop 0
  buffer_load_dwordx4 v18, s[36:39], s43 offen nt lds
  s_add_u32 m0, s40, 0
  s_nop 0
  buffer_load_dwordx4 v17, s[36:39], s43 offen nt lds
  s_add_u32 m0, s40, 1024
  s_add_u32 s44, s43, s46
  buffer_load_dwordx4 v17, s[36:39], s44 offen nt lds
  s_add_u32 s43, s43, s45
  s_add_u32 m0, s40, 2048
  s_nop 0
  buffer_load_dwordx4 v17, s[36:39], s43 offen nt lds
  s_add_u32 m0, s40, 3072
  s_add_u32 s44, s43, s46
  buffer_load_dwordx4 v17, s[36:39], s44 offen nt lds
  s_add_u32 s43, s43, s45
  s_add_u32 m0, s40, 4096
  s_nop 0
  buffer_load_dwordx4 v17, s[36:39], s43 offen nt lds
  s_add_u32 m0, s40, 5120
  s_add_u32 s44, s43, s46
  buffer_load_dwordx4 v17, s[36:39], s44 offen nt lds
  s_add_u32 s43, s43, s45
  s_add_u32 m0, s40, 6144
  s_nop 0
  buffer_load_dwordx4 v17, s[36:39], s43 offen nt lds
  s_add_u32 m0, s40, 7168
  s_add_u32 s44, s43, s46
  buffer_load_dwordx4 v17, s[36:39], s44 offen nt lds
  s_add_u32 s43, s43, s45
  s_add_u32 s8, s4, 50331648
  s_addc_u32 s9, s5, 0
  s_mov_b32 s10, 27648
  s_mov_b32 s11, 0x20000
  s_lshl_b32 s96, s3, 5
  s_add_u32 s96, s96, s22
  s_cmp_lt_u32 s96, 18
  s_cselect_b32 s96, 0, 0x80000000
  s_lshl_b32 s26, s3, 4
  v_lshl_add_u32 v120, v5, 2, s26
  v_mul_u32_u24 v121, 720, v3
  s_movk_i32 s24, 384
  v_add_u32 v122, 0, v120
  v_mul_u32_u24 v123, 57, v122
  v_lshrrev_b32 v123, 10, v123
  v_mul_u32_u24 v124, 18, v123
  v_sub_u32 v124, v122, v124
  v_mul_u32_u24 v123, 80, v123
  v_lshl_add_u32 v123, v124, 2, v123
  v_add3_u32 v144, v123, v121, s24
  v_add_u32 v122, 0, v120
  v_mul_u32_u24 v123, 57, v122
  v_lshrrev_b32 v123, 10, v123
  v_mul_u32_u24 v124, 18, v123
  v_sub_u32 v124, v122, v124
  v_mul_u32_u24 v123, 48, v123
  v_lshl_add_u32 v123, v124, 1, v123
  v_add_u32 v146, v123, v121
  v_add_u32 v122, 64, v120
  v_mul_u32_u24 v123, 57, v122
  v_lshrrev_b32 v123, 10, v123
  v_mul_u32_u24 v124, 18, v123
  v_sub_u32 v124, v122, v124
  v_mul_u32_u24 v123, 48, v123
  v_lshl_add_u32 v123, v124, 1, v123
  v_add_u32 v148, v123, v121
  v_add_u32 v122, 64, v120
  v_mul_u32_u24 v123, 57, v122
  v_lshrrev_b32 v123, 10, v123
  v_mul_u32_u24 v124, 18, v123
  v_sub_u32 v124, v122, v124
  v_mul_u32_u24 v123, 80, v123
  v_lshl_add_u32 v123, v124, 2, v123
  v_add3_u32 v150, v123, v121, s24
  v_add_u32 v122, 112, v120
  v_mul_u32_u24 v123, 57, v122
  v_lshrrev_b32 v123, 10, v123
  v_mul_u32_u24 v124, 18, v123
  v_sub_u32 v124, v122, v124
  v_mul_u32_u24 v123, 48, v123
  v_lshl_add_u32 v123, v124, 1, v123
  v_add_u32 v152, v123, v121
  v_add_u32 v122, 2, v120
  v_mul_u32_u24 v123, 57, v122
  v_lshrrev_b32 v123, 10, v123
  v_mul_u32_u24 v124, 18, v123
  v_sub_u32 v124, v122, v124
  v_mul_u32_u24 v123, 80, v123
  v_lshl_add_u32 v123, v124, 2, v123
  v_add3_u32 v145, v123, v121, s24
  v_add_u32 v122, 2, v120
  v_mul_u32_u24 v123, 57, v122
  v_lshrrev_b32 v123, 10, v123
  v_mul_u32_u24 v124, 18, v123
  v_sub_u32 v124, v122, v124
  v_mul_u32_u24 v123, 48, v123
  v_lshl_add_u32 v123, v124, 1, v123
  v_add_u32 v147, v123, v121
  v_add_u32 v122, 66, v120
  v_mul_u32_u24 v123, 57, v122
  v_lshrrev_b32 v123, 10, v123
  v_mul_u32_u24 v124, 18, v123
  v_sub_u32 v124, v122, v124
  v_mul_u32_u24 v123, 48, v123
  v_lshl_add_u32 v123, v124, 1, v123
  v_add_u32 v149, v123, v121
  v_add_u32 v122, 66, v120
  v_mul_u32_u24 v123, 57, v122
  v_lshrrev_b32 v123, 10, v123
  v_mul_u32_u24 v124, 18, v123
  v_sub_u32 v124, v122, v124
  v_mul_u32_u24 v123, 80, v123
  v_lshl_add_u32 v123, v124, 2, v123
  v_add3_u32 v151, v123, v121, s24
  v_add_u32 v122, 114, v120
  v_mul_u32_u24 v123, 57, v122
  v_lshrrev_b32 v123, 10, v123
  v_mul_u32_u24 v124, 18, v123
  v_sub_u32 v124, v122, v124
  v_mul_u32_u24 v123, 48, v123
  v_lshl_add_u32 v123, v124, 1, v123
  v_add_u32 v153, v123, v121
  v_add_u32 v122, 704, v121
  v_cmp_gt_u32 vcc, 8, v120
  s_nop 1
  v_cndmask_b32 v150, v122, v150, vcc
  v_cndmask_b32 v151, v122, v151, vcc
  s_cmp_eq_u32 s3, 1
  s_cselect_b64 vcc, -1, 0
  v_cndmask_b32 v152, v122, v152, vcc
  v_cndmask_b32 v153, v122, v153, vcc
  s_cmp_lg_u32 s3, 0
  s_cbranch_scc1 L_m_p0d
  s_mov_b32 s26, 229376
  s_mov_b32 s25, 230400
  s_mov_b32 s24, 231424
  s_mov_b32 s101, 232448
  v_lshlrev_b32 v59, 4, v2
L_m_p0w:
  buffer_load_dword v60, v59, s[56:59], s26 offen sc1
  buffer_load_dword v61, v59, s[56:59], s25 offen sc1
  buffer_load_dword v62, v59, s[56:59], s24 offen sc1
  buffer_load_dword v63, v59, s[56:59], s101 offen sc1
  s_waitcnt vmcnt(0)
  v_xor_b32 v60, s97, v60
  v_xor_b32 v61, s97, v61
  v_xor_b32 v62, s97, v62
  v_xor_b32 v63, s97, v63
  v_or3_b32 v60, v60, v61, v62
  v_or_b32 v60, v60, v63
  v_cmp_ne_u32 vcc, 0, v60
  s_nop 0
  s_cbranch_vccz L_m_p0d
  s_sleep 2
  s_branch L_m_p0w
L_m_p0d:
  s_barrier
  s_mov_b32 s26, 0
  buffer_load_dwordx4 v[40:43], v99, s[8:11], s26 offen sc1
  s_mov_b32 s26, 13824
  buffer_load_dwordx4 v[44:47], v99, s[8:11], s26 offen sc1
  s_mov_b32 s26, 2304
  buffer_load_dwordx4 v[48:51], v99, s[8:11], s26 offen sc1
  s_mov_b32 s26, 16128
  buffer_load_dwordx4 v[52:55], v99, s[8:11], s26 offen sc1
  s_add_u32 s25, s28, 0
  buffer_load_dwordx4 v[156:159], v7, s[12:15], s25 offen sc1
  s_add_u32 s25, s29, 0
  buffer_load_dwordx4 v[160:163], v4, s[12:15], s25 offen sc1
  s_add_u32 s25, s29, 18432
  buffer_load_dwordx4 v[164:167], v4, s[12:15], s25 offen sc1
  s_add_u32 s25, s29, 36864
  buffer_load_dwordx4 v[168:171], v4, s[12:15], s25 offen sc1
  s_add_u32 s25, s29, 55296
  buffer_load_dwordx4 v[172:175], v4, s[12:15], s25 offen sc1
  buffer_load_dwordx4 a[0:3], v4, s[16:19], s30 offen offset:0 sc1
  buffer_load_dwordx4 a[4:7], v4, s[16:19], s31 offen offset:0 sc1
  buffer_load_dwordx4 a[8:11], v4, s[16:19], s32 offen offset:0 sc1
  buffer_load_dwordx4 a[12:15], v8, s[16:19], s33 offen offset:0 sc1
  s_add_u32 s25, s28, 4096
  buffer_load_dwordx4 v[176:179], v7, s[12:15], s25 offen sc1
  s_add_u32 s25, s29, 4096
  buffer_load_dwordx4 v[180:183], v4, s[12:15], s25 offen sc1
  s_add_u32 s25, s29, 22528
  buffer_load_dwordx4 v[184:187], v4, s[12:15], s25 offen sc1
  s_add_u32 s25, s29, 40960
  buffer_load_dwordx4 v[188:191], v4, s[12:15], s25 offen sc1
  s_add_u32 s25, s29, 59392
  buffer_load_dwordx4 v[192:195], v4, s[12:15], s25 offen sc1
  buffer_load_dwordx4 a[16:19], v4, s[16:19], s30 offen offset:1024 sc1
  buffer_load_dwordx4 a[20:23], v4, s[16:19], s31 offen offset:1024 sc1
  buffer_load_dwordx4 a[24:27], v4, s[16:19], s32 offen offset:1024 sc1
  buffer_load_dwordx4 a[28:31], v8, s[16:19], s33 offen offset:1024 sc1
  s_waitcnt vmcnt(18)
  v_pk_add_f32 v[40:41], v[40:41], v[44:45]
  v_cvt_pk_bf16_f32 v100, v40, v41
  v_lshlrev_b32 v40, 16, v100
  v_and_b32 v41, 0xffff0000, v100
  v_pk_add_f32 v[42:43], v[42:43], v[46:47]
  v_cvt_pk_bf16_f32 v100, v42, v43
  v_lshlrev_b32 v42, 16, v100
  v_and_b32 v43, 0xffff0000, v100
  v_pk_add_f32 v[48:49], v[48:49], v[52:53]
  v_cvt_pk_bf16_f32 v100, v48, v49
  v_lshlrev_b32 v48, 16, v100
  v_and_b32 v49, 0xffff0000, v100
  v_add_f32 v48, 1.0, v48
  v_add_f32 v49, 1.0, v49
  v_cvt_pk_bf16_f32 v100, v48, v49
  v_lshlrev_b32 v48, 16, v100
  v_and_b32 v49, 0xffff0000, v100
  v_pk_add_f32 v[50:51], v[50:51], v[54:55]
  v_cvt_pk_bf16_f32 v100, v50, v51
  v_lshlrev_b32 v50, 16, v100
  v_and_b32 v51, 0xffff0000, v100
  v_add_f32 v50, 1.0, v50
  v_add_f32 v51, 1.0, v51
  v_cvt_pk_bf16_f32 v100, v50, v51
  v_lshlrev_b32 v50, 16, v100
  v_and_b32 v51, 0xffff0000, v100
  v_cmp_gt_u32 vcc, 144, v0
  s_nop 0
  s_and_saveexec_b64 s[24:25], vcc
  ds_write_b128 v228, v[48:51]
  ds_write_b128 v228, v[40:43] offset:2304
  s_mov_b64 exec, s[24:25]
  s_waitcnt lgkmcnt(0)
  s_barrier
  ds_read_b128 v[120:123], v13 offset:0
  ds_read_b128 v[124:127], v13 offset:16
  ds_read_b128 v[128:131], v13 offset:2304
  ds_read_b128 v[132:135], v13 offset:2320
  s_waitcnt lgkmcnt(0)
  s_waitcnt vmcnt(13)
  v_lshlrev_b32 v136, 16, v156
  v_and_b32 v137, 0xffff0000, v156
  v_lshlrev_b32 v138, 16, v157
  v_and_b32 v139, 0xffff0000, v157
  v_lshlrev_b32 v140, 16, v158
  v_and_b32 v141, 0xffff0000, v158
  v_lshlrev_b32 v142, 16, v159
  v_and_b32 v143, 0xffff0000, v159
  v_pk_fma_f32 v[136:137], v[136:137], v[120:121], v[128:129]
  v_pk_fma_f32 v[138:139], v[138:139], v[122:123], v[130:131]
  v_pk_fma_f32 v[140:141], v[140:141], v[124:125], v[132:133]
  v_pk_fma_f32 v[142:143], v[142:143], v[126:127], v[134:135]
  v_cvt_pk_bf16_f32 v156, v136, v137
  buffer_load_dwordx4 a[32:35], v4, s[16:19], s30 offen offset:2048 sc1
  v_cvt_pk_bf16_f32 v157, v138, v139
  v_cvt_pk_bf16_f32 v158, v140, v141
  v_cvt_pk_bf16_f32 v159, v142, v143
  ds_write_b128 v10, v[156:159] offset:0
  v_lshlrev_b32 v136, 16, v160
  v_and_b32 v137, 0xffff0000, v160
  v_lshlrev_b32 v138, 16, v161
  v_and_b32 v139, 0xffff0000, v161
  v_lshlrev_b32 v140, 16, v162
  v_and_b32 v141, 0xffff0000, v162
  v_lshlrev_b32 v142, 16, v163
  v_and_b32 v143, 0xffff0000, v163
  v_pk_fma_f32 v[136:137], v[136:137], v[120:121], v[128:129]
  v_pk_fma_f32 v[138:139], v[138:139], v[122:123], v[130:131]
  buffer_load_dwordx4 a[36:39], v4, s[16:19], s31 offen offset:2048 sc1
  v_pk_fma_f32 v[140:141], v[140:141], v[124:125], v[132:133]
  v_pk_fma_f32 v[142:143], v[142:143], v[126:127], v[134:135]
  v_cvt_pk_bf16_f32 v160, v136, v137
  v_cvt_pk_bf16_f32 v161, v138, v139
  v_cvt_pk_bf16_f32 v162, v140, v141
  v_cvt_pk_bf16_f32 v163, v142, v143
  ds_write_b128 v10, v[160:163] offset:1024
  v_lshlrev_b32 v136, 16, v164
  v_and_b32 v137, 0xffff0000, v164
  v_lshlrev_b32 v138, 16, v165
  v_and_b32 v139, 0xffff0000, v165
  v_lshlrev_b32 v140, 16, v166
  v_and_b32 v141, 0xffff0000, v166
  v_lshlrev_b32 v142, 16, v167
  buffer_load_dwordx4 a[40:43], v4, s[16:19], s32 offen offset:2048 sc1
  v_and_b32 v143, 0xffff0000, v167
  v_pk_fma_f32 v[136:137], v[136:137], v[120:121], v[128:129]
  v_pk_fma_f32 v[138:139], v[138:139], v[122:123], v[130:131]
  v_pk_fma_f32 v[140:141], v[140:141], v[124:125], v[132:133]
  v_pk_fma_f32 v[142:143], v[142:143], v[126:127], v[134:135]
  v_cvt_pk_bf16_f32 v164, v136, v137
  v_cvt_pk_bf16_f32 v165, v138, v139
  v_cvt_pk_bf16_f32 v166, v140, v141
  v_cvt_pk_bf16_f32 v167, v142, v143
  ds_write_b128 v10, v[164:167] offset:2048
  v_lshlrev_b32 v136, 16, v168
  v_and_b32 v137, 0xffff0000, v168
  v_lshlrev_b32 v138, 16, v169
  v_and_b32 v139, 0xffff0000, v169
  buffer_load_dwordx4 a[44:47], v8, s[16:19], s33 offen offset:2048 sc1
  v_lshlrev_b32 v140, 16, v170
  v_and_b32 v141, 0xffff0000, v170
  v_lshlrev_b32 v142, 16, v171
  v_and_b32 v143, 0xffff0000, v171
  v_pk_fma_f32 v[136:137], v[136:137], v[120:121], v[128:129]
  v_pk_fma_f32 v[138:139], v[138:139], v[122:123], v[130:131]
  v_pk_fma_f32 v[140:141], v[140:141], v[124:125], v[132:133]
  v_pk_fma_f32 v[142:143], v[142:143], v[126:127], v[134:135]
  v_cvt_pk_bf16_f32 v168, v136, v137
  v_cvt_pk_bf16_f32 v169, v138, v139
  v_cvt_pk_bf16_f32 v170, v140, v141
  v_cvt_pk_bf16_f32 v171, v142, v143
  ds_write_b128 v10, v[168:171] offset:3072
  v_lshlrev_b32 v136, 16, v172
  buffer_load_dwordx4 a[48:51], v4, s[16:19], s30 offen offset:3072 sc1
  s_add_u32 s30, s30, 4096
  v_and_b32 v137, 0xffff0000, v172
  v_lshlrev_b32 v138, 16, v173
  v_and_b32 v139, 0xffff0000, v173
  v_lshlrev_b32 v140, 16, v174
  v_and_b32 v141, 0xffff0000, v174
  v_lshlrev_b32 v142, 16, v175
  v_and_b32 v143, 0xffff0000, v175
  v_pk_fma_f32 v[136:137], v[136:137], v[120:121], v[128:129]
  v_pk_fma_f32 v[138:139], v[138:139], v[122:123], v[130:131]
  v_pk_fma_f32 v[140:141], v[140:141], v[124:125], v[132:133]
  v_pk_fma_f32 v[142:143], v[142:143], v[126:127], v[134:135]
  v_cvt_pk_bf16_f32 v172, v136, v137
  v_cvt_pk_bf16_f32 v173, v138, v139
  buffer_load_dwordx4 a[52:55], v4, s[16:19], s31 offen offset:3072 sc1
  s_add_u32 s31, s31, 4096
  v_cvt_pk_bf16_f32 v174, v140, v141
  v_cvt_pk_bf16_f32 v175, v142, v143
  ds_write_b128 v10, v[172:175] offset:4096
  v_mov_b32 v1, v99
  v_mov_b32 v6, v230
  v_mov_b32 v16, v231
  s_waitcnt lgkmcnt(0)
  s_barrier
  ds_read_b128 v[20:23], v4 offset:0
  ds_read_b128 v[24:27], v4 offset:1024
  ds_read_b128 v[28:31], v4 offset:2048
  ds_read_b128 v[32:35], v4 offset:3072
  ds_read_b128 v[36:39], v4 offset:4096
  s_waitcnt vmcnt(15)
  s_waitcnt lgkmcnt(3)
  v_mfma_f32_16x16x32_bf16 v[40:43], a[0:3], v[20:23], 0
  buffer_load_dwordx4 a[56:59], v4, s[16:19], s32 offen offset:3072 sc1
  s_add_u32 s32, s32, 4096
  v_mfma_f32_16x16x32_bf16 v[60:63], a[4:7], v[20:23], 0
  ds_read_b128 v[120:123], v13 offset:512
  ds_read_b128 v[124:127], v13 offset:528
  ds_read_b128 v[128:131], v13 offset:2816
  v_mfma_f32_16x16x32_bf16 v[80:83], a[8:11], v[20:23], 0
  ds_read_b128 v[132:135], v13 offset:2832
  s_waitcnt vmcnt(11)
  v_lshlrev_b32 v136, 16, v176
  v_mfma_f32_16x16x32_bf16 v[100:103], a[12:15], v[20:23], 0
  ds_read_b128 v[20:23], v4 offset:5120
  buffer_load_dwordx4 a[60:63], v8, s[16:19], s33 offen offset:3072 sc1
  v_mfma_f32_16x16x32_bf16 v[44:47], a[0:3], v[24:27], 0
  s_add_u32 s33, s33, 4096
  v_and_b32 v137, 0xffff0000, v176
  v_lshlrev_b32 v138, 16, v177
  v_mfma_f32_16x16x32_bf16 v[64:67], a[4:7], v[24:27], 0
  v_and_b32 v139, 0xffff0000, v177
  v_lshlrev_b32 v140, 16, v178
  v_and_b32 v141, 0xffff0000, v178
  v_mfma_f32_16x16x32_bf16 v[84:87], a[8:11], v[24:27], 0
  s_add_u32 s25, s28, 8192
  v_lshlrev_b32 v142, 16, v179
  v_and_b32 v143, 0xffff0000, v179
  v_mfma_f32_16x16x32_bf16 v[104:107], a[12:15], v[24:27], 0
  ds_read_b128 v[24:27], v4 offset:6144
  s_waitcnt lgkmcnt(7)
  v_mfma_f32_16x16x32_bf16 v[48:51], a[0:3], v[28:31], 0
  buffer_load_dwordx4 v[196:199], v7, s[12:15], s25 offen sc1
  v_mfma_f32_16x16x32_bf16 v[68:71], a[4:7], v[28:31], 0
  s_waitcnt lgkmcnt(2)
  v_fma_f32 v136, v136, v120, v128
  v_fma_f32 v137, v137, v121, v129
  v_mfma_f32_16x16x32_bf16 v[88:91], a[8:11], v[28:31], 0
  s_add_u32 s25, s29, 8192
  v_fma_f32 v138, v138, v122, v130
  v_fma_f32 v139, v139, v123, v131
  v_mfma_f32_16x16x32_bf16 v[108:111], a[12:15], v[28:31], 0
  ds_read_b128 v[28:31], v4 offset:7168
  buffer_load_dwordx4 v[200:203], v4, s[12:15], s25 offen sc1
  v_mfma_f32_16x16x32_bf16 v[52:55], a[0:3], v[32:35], 0
  v_fma_f32 v140, v140, v124, v132
  v_fma_f32 v141, v141, v125, v133
  v_fma_f32 v142, v142, v126, v134
  v_mfma_f32_16x16x32_bf16 v[72:75], a[4:7], v[32:35], 0
  v_fma_f32 v143, v143, v127, v135
  v_cvt_pk_bf16_f32 v176, v136, v137
  v_cvt_pk_bf16_f32 v177, v138, v139
  v_mfma_f32_16x16x32_bf16 v[92:95], a[8:11], v[32:35], 0
  s_add_u32 s25, s29, 26624
  v_cvt_pk_bf16_f32 v178, v140, v141
  v_cvt_pk_bf16_f32 v179, v142, v143
  v_mfma_f32_16x16x32_bf16 v[112:115], a[12:15], v[32:35], 0
  ds_read_b128 v[32:35], v4 offset:8192
  ds_write_b128 v10, v[176:179] offset:20480
  v_mfma_f32_16x16x32_bf16 v[56:59], a[0:3], v[36:39], 0
  buffer_load_dwordx4 v[204:207], v4, s[12:15], s25 offen sc1
  v_lshlrev_b32 v136, 16, v180
  v_mfma_f32_16x16x32_bf16 v[76:79], a[4:7], v[36:39], 0
  v_and_b32 v137, 0xffff0000, v180
  v_lshlrev_b32 v138, 16, v181
  v_and_b32 v139, 0xffff0000, v181
  v_mfma_f32_16x16x32_bf16 v[96:99], a[8:11], v[36:39], 0
  s_add_u32 s25, s29, 45056
  v_lshlrev_b32 v140, 16, v182
  v_and_b32 v141, 0xffff0000, v182
  v_mfma_f32_16x16x32_bf16 v[116:119], a[12:15], v[36:39], 0
  ds_read_b128 v[36:39], v4 offset:9216
  v_lshlrev_b32 v142, 16, v183
  s_waitcnt vmcnt(11)
  s_waitcnt lgkmcnt(4)
  v_mfma_f32_16x16x32_bf16 v[40:43], a[16:19], v[20:23], v[40:43]
  buffer_load_dwordx4 v[208:211], v4, s[12:15], s25 offen sc1
  v_and_b32 v143, 0xffff0000, v183
  v_mfma_f32_16x16x32_bf16 v[60:63], a[20:23], v[20:23], v[60:63]
  v_fma_f32 v136, v136, v120, v128
  v_fma_f32 v137, v137, v121, v129
  v_fma_f32 v138, v138, v122, v130
  v_mfma_f32_16x16x32_bf16 v[80:83], a[24:27], v[20:23], v[80:83]
  s_add_u32 s25, s29, 63488
  v_fma_f32 v139, v139, v123, v131
  v_fma_f32 v140, v140, v124, v132
  v_mfma_f32_16x16x32_bf16 v[100:103], a[28:31], v[20:23], v[100:103]
  ds_read_b128 v[20:23], v4 offset:10240
  buffer_load_dwordx4 v[212:215], v4, s[12:15], s25 offen sc1
  v_mfma_f32_16x16x32_bf16 v[44:47], a[16:19], v[24:27], v[44:47]
  v_fma_f32 v141, v141, v125, v133
  v_fma_f32 v142, v142, v126, v134
  v_fma_f32 v143, v143, v127, v135
  v_mfma_f32_16x16x32_bf16 v[64:67], a[20:23], v[24:27], v[64:67]
  v_cvt_pk_bf16_f32 v180, v136, v137
  v_cvt_pk_bf16_f32 v181, v138, v139
  v_cvt_pk_bf16_f32 v182, v140, v141
  v_mfma_f32_16x16x32_bf16 v[84:87], a[24:27], v[24:27], v[84:87]
  buffer_load_dwordx4 a[64:67], v4, s[16:19], s30 offen offset:0 sc1
  v_cvt_pk_bf16_f32 v183, v142, v143
  v_mfma_f32_16x16x32_bf16 v[104:107], a[28:31], v[24:27], v[104:107]
  ds_read_b128 v[24:27], v4 offset:11264
  ds_write_b128 v10, v[180:183] offset:21504
  s_waitcnt lgkmcnt(5)
  v_mfma_f32_16x16x32_bf16 v[48:51], a[16:19], v[28:31], v[48:51]
  v_lshlrev_b32 v136, 16, v184
  v_and_b32 v137, 0xffff0000, v184
  v_lshlrev_b32 v138, 16, v185
  v_mfma_f32_16x16x32_bf16 v[68:71], a[20:23], v[28:31], v[68:71]
  v_and_b32 v139, 0xffff0000, v185
  v_lshlrev_b32 v140, 16, v186
  v_and_b32 v141, 0xffff0000, v186
  v_mfma_f32_16x16x32_bf16 v[88:91], a[24:27], v[28:31], v[88:91]
  buffer_load_dwordx4 a[68:71], v4, s[16:19], s31 offen offset:0 sc1
  v_lshlrev_b32 v142, 16, v187
  v_mfma_f32_16x16x32_bf16 v[108:111], a[28:31], v[28:31], v[108:111]
  ds_read_b128 v[28:31], v4 offset:12288
  v_and_b32 v143, 0xffff0000, v187
  v_fma_f32 v136, v136, v120, v128
  v_mfma_f32_16x16x32_bf16 v[52:55], a[16:19], v[32:35], v[52:55]
  v_fma_f32 v137, v137, v121, v129
  v_fma_f32 v138, v138, v122, v130
  v_fma_f32 v139, v139, v123, v131
  v_mfma_f32_16x16x32_bf16 v[72:75], a[20:23], v[32:35], v[72:75]
  v_fma_f32 v140, v140, v124, v132
  v_fma_f32 v141, v141, v125, v133
  v_fma_f32 v142, v142, v126, v134
  v_mfma_f32_16x16x32_bf16 v[92:95], a[24:27], v[32:35], v[92:95]
  buffer_load_dwordx4 a[72:75], v4, s[16:19], s32 offen offset:0 sc1
  v_fma_f32 v143, v143, v127, v135
  v_mfma_f32_16x16x32_bf16 v[112:115], a[28:31], v[32:35], v[112:115]
  ds_read_b128 v[32:35], v4 offset:13312
  v_cvt_pk_bf16_f32 v184, v136, v137
  s_waitcnt lgkmcnt(5)
  v_mfma_f32_16x16x32_bf16 v[56:59], a[16:19], v[36:39], v[56:59]
  v_cvt_pk_bf16_f32 v185, v138, v139
  v_cvt_pk_bf16_f32 v186, v140, v141
  v_cvt_pk_bf16_f32 v187, v142, v143
  v_mfma_f32_16x16x32_bf16 v[76:79], a[20:23], v[36:39], v[76:79]
  ds_write_b128 v10, v[184:187] offset:22528
  v_lshlrev_b32 v136, 16, v188
  v_and_b32 v137, 0xffff0000, v188
  v_mfma_f32_16x16x32_bf16 v[96:99], a[24:27], v[36:39], v[96:99]
  buffer_load_dwordx4 a[76:79], v8, s[16:19], s33 offen offset:0 sc1
  v_lshlrev_b32 v138, 16, v189
  v_mfma_f32_16x16x32_bf16 v[116:119], a[28:31], v[36:39], v[116:119]
  ds_read_b128 v[36:39], v4 offset:14336
  v_and_b32 v139, 0xffff0000, v189
  s_waitcnt vmcnt(13)
  s_waitcnt lgkmcnt(5)
  v_mfma_f32_16x16x32_bf16 v[40:43], a[32:35], v[20:23], v[40:43]
  v_lshlrev_b32 v140, 16, v190
  v_and_b32 v141, 0xffff0000, v190
  v_lshlrev_b32 v142, 16, v191
  v_mfma_f32_16x16x32_bf16 v[60:63], a[36:39], v[20:23], v[60:63]
  v_and_b32 v143, 0xffff0000, v191
  v_fma_f32 v136, v136, v120, v128
  v_fma_f32 v137, v137, v121, v129
  v_mfma_f32_16x16x32_bf16 v[80:83], a[40:43], v[20:23], v[80:83]
  buffer_load_dwordx4 a[80:83], v4, s[16:19], s30 offen offset:1024 sc1
  v_fma_f32 v138, v138, v122, v130
  v_mfma_f32_16x16x32_bf16 v[100:103], a[44:47], v[20:23], v[100:103]
  ds_read_b128 v[20:23], v4 offset:15360
  v_fma_f32 v139, v139, v123, v131
  v_fma_f32 v140, v140, v124, v132
  v_mfma_f32_16x16x32_bf16 v[44:47], a[32:35], v[24:27], v[44:47]
  v_fma_f32 v141, v141, v125, v133
  v_fma_f32 v142, v142, v126, v134
  v_fma_f32 v143, v143, v127, v135
  v_mfma_f32_16x16x32_bf16 v[64:67], a[36:39], v[24:27], v[64:67]
  v_cvt_pk_bf16_f32 v188, v136, v137
  v_cvt_pk_bf16_f32 v189, v138, v139
  v_cvt_pk_bf16_f32 v190, v140, v141
  v_mfma_f32_16x16x32_bf16 v[84:87], a[40:43], v[24:27], v[84:87]
  buffer_load_dwordx4 a[84:87], v4, s[16:19], s31 offen offset:1024 sc1
  v_cvt_pk_bf16_f32 v191, v142, v143
  v_mfma_f32_16x16x32_bf16 v[104:107], a[44:47], v[24:27], v[104:107]
  ds_read_b128 v[24:27], v4 offset:16384
  ds_write_b128 v10, v[188:191] offset:23552
  s_waitcnt lgkmcnt(5)
  v_mfma_f32_16x16x32_bf16 v[48:51], a[32:35], v[28:31], v[48:51]
  v_lshlrev_b32 v136, 16, v192
  v_and_b32 v137, 0xffff0000, v192
  v_lshlrev_b32 v138, 16, v193
  v_mfma_f32_16x16x32_bf16 v[68:71], a[36:39], v[28:31], v[68:71]
  buffer_load_dwordx4 a[88:91], v4, s[16:19], s32 offen offset:1024 sc1
  v_and_b32 v139, 0xffff0000, v193
  v_mfma_f32_16x16x32_bf16 v[88:91], a[40:43], v[28:31], v[88:91]
  v_lshlrev_b32 v140, 16, v194
  v_and_b32 v141, 0xffff0000, v194
  v_lshlrev_b32 v142, 16, v195
  v_mfma_f32_16x16x32_bf16 v[108:111], a[44:47], v[28:31], v[108:111]
  ds_read_b128 v[28:31], v4 offset:17408
  v_and_b32 v143, 0xffff0000, v195
  v_fma_f32 v136, v136, v120, v128
  v_mfma_f32_16x16x32_bf16 v[52:55], a[32:35], v[32:35], v[52:55]
  v_fma_f32 v137, v137, v121, v129
  v_fma_f32 v138, v138, v122, v130
  v_fma_f32 v139, v139, v123, v131
  v_mfma_f32_16x16x32_bf16 v[72:75], a[36:39], v[32:35], v[72:75]
  buffer_load_dwordx4 a[92:95], v8, s[16:19], s33 offen offset:1024 sc1
  v_fma_f32 v140, v140, v124, v132
  v_mfma_f32_16x16x32_bf16 v[92:95], a[40:43], v[32:35], v[92:95]
  v_fma_f32 v141, v141, v125, v133
  v_fma_f32 v142, v142, v126, v134
  v_fma_f32 v143, v143, v127, v135
  v_mfma_f32_16x16x32_bf16 v[112:115], a[44:47], v[32:35], v[112:115]
  ds_read_b128 v[32:35], v4 offset:18432
  v_cvt_pk_bf16_f32 v192, v136, v137
  s_waitcnt lgkmcnt(5)
  v_mfma_f32_16x16x32_bf16 v[56:59], a[32:35], v[36:39], v[56:59]
  v_cvt_pk_bf16_f32 v193, v138, v139
  v_cvt_pk_bf16_f32 v194, v140, v141
  v_cvt_pk_bf16_f32 v195, v142, v143
  v_mfma_f32_16x16x32_bf16 v[76:79], a[36:39], v[36:39], v[76:79]
  buffer_load_dwordx4 a[96:99], v4, s[16:19], s30 offen offset:2048 sc1
  ds_write_b128 v10, v[192:195] offset:24576
  v_mfma_f32_16x16x32_bf16 v[96:99], a[40:43], v[36:39], v[96:99]
  v_mfma_f32_16x16x32_bf16 v[116:119], a[44:47], v[36:39], v[116:119]
  ds_read_b128 v[36:39], v4 offset:19456
  s_waitcnt lgkmcnt(1)
  s_barrier
  s_waitcnt vmcnt(14)
  v_mfma_f32_16x16x32_bf16 v[40:43], a[48:51], v[20:23], v[40:43]
  v_mfma_f32_16x16x32_bf16 v[60:63], a[52:55], v[20:23], v[60:63]
  buffer_load_dwordx4 a[100:103], v4, s[16:19], s31 offen offset:2048 sc1
  v_mfma_f32_16x16x32_bf16 v[80:83], a[56:59], v[20:23], v[80:83]
  v_mfma_f32_16x16x32_bf16 v[100:103], a[60:63], v[20:23], v[100:103]
  ds_read_b128 v[20:23], v4 offset:20480
  v_mfma_f32_16x16x32_bf16 v[44:47], a[48:51], v[24:27], v[44:47]
  v_mfma_f32_16x16x32_bf16 v[64:67], a[52:55], v[24:27], v[64:67]
  buffer_load_dwordx4 a[104:107], v4, s[16:19], s32 offen offset:2048 sc1
  v_mfma_f32_16x16x32_bf16 v[84:87], a[56:59], v[24:27], v[84:87]
  v_mfma_f32_16x16x32_bf16 v[104:107], a[60:63], v[24:27], v[104:107]
  ds_read_b128 v[24:27], v4 offset:21504
  v_mfma_f32_16x16x32_bf16 v[48:51], a[48:51], v[28:31], v[48:51]
  v_mfma_f32_16x16x32_bf16 v[68:71], a[52:55], v[28:31], v[68:71]
  buffer_load_dwordx4 a[108:111], v8, s[16:19], s33 offen offset:2048 sc1
  v_mfma_f32_16x16x32_bf16 v[88:91], a[56:59], v[28:31], v[88:91]
  v_mfma_f32_16x16x32_bf16 v[108:111], a[60:63], v[28:31], v[108:111]
  ds_read_b128 v[28:31], v4 offset:22528
  v_mfma_f32_16x16x32_bf16 v[52:55], a[48:51], v[32:35], v[52:55]
  buffer_load_dwordx4 a[112:115], v4, s[16:19], s30 offen offset:3072 sc1
  s_add_u32 s30, s30, 4096
  v_mfma_f32_16x16x32_bf16 v[72:75], a[52:55], v[32:35], v[72:75]
  v_mfma_f32_16x16x32_bf16 v[92:95], a[56:59], v[32:35], v[92:95]
  v_mfma_f32_16x16x32_bf16 v[112:115], a[60:63], v[32:35], v[112:115]
  ds_read_b128 v[32:35], v4 offset:23552
  s_waitcnt lgkmcnt(4)
  v_mfma_f32_16x16x32_bf16 v[56:59], a[48:51], v[36:39], v[56:59]
  buffer_load_dwordx4 a[116:119], v4, s[16:19], s31 offen offset:3072 sc1
  s_add_u32 s31, s31, 4096
  v_mfma_f32_16x16x32_bf16 v[76:79], a[52:55], v[36:39], v[76:79]
  v_mfma_f32_16x16x32_bf16 v[96:99], a[56:59], v[36:39], v[96:99]
  v_mfma_f32_16x16x32_bf16 v[116:119], a[60:63], v[36:39], v[116:119]
  ds_read_b128 v[36:39], v4 offset:24576
  s_add_u32 s36, s4, 5636096
  s_addc_u32 s37, s5, 0
  s_mov_b32 s38, 5308416
  s_mov_b32 s39, 0x20000
  s_add_u32 s8, s4, 4898816
  s_addc_u32 s9, s5, 0
  s_mov_b32 s10, 737280
  s_mov_b32 s11, 0x20000
  s_waitcnt vmcnt(10)
  s_waitcnt lgkmcnt(3)
  v_mfma_f32_16x16x32_bf16 v[40:43], a[64:67], v[20:23], v[40:43]
  buffer_load_dwordx4 a[120:123], v4, s[16:19], s32 offen offset:3072 sc1
  s_add_u32 s32, s32, 4096
  v_mfma_f32_16x16x32_bf16 v[60:63], a[68:71], v[20:23], v[60:63]
  ds_read_b128 v[120:123], v13 offset:1024
  ds_read_b128 v[124:127], v13 offset:1040
  ds_read_b128 v[128:131], v13 offset:3328
  v_mfma_f32_16x16x32_bf16 v[80:83], a[72:75], v[20:23], v[80:83]
  ds_read_b128 v[132:135], v13 offset:3344
  v_lshlrev_b32 v136, 16, v196
  v_mfma_f32_16x16x32_bf16 v[100:103], a[76:79], v[20:23], v[100:103]
  ds_read_b128 v[20:23], v4 offset:25600
  v_and_b32 v137, 0xffff0000, v196
  v_lshlrev_b32 v138, 16, v197
  v_mfma_f32_16x16x32_bf16 v[44:47], a[64:67], v[24:27], v[44:47]
  buffer_load_dwordx4 a[124:127], v8, s[16:19], s33 offen offset:3072 sc1
  s_add_u32 s33, s33, 4096
  v_mfma_f32_16x16x32_bf16 v[64:67], a[68:71], v[24:27], v[64:67]
  v_and_b32 v139, 0xffff0000, v197
  v_lshlrev_b32 v140, 16, v198
  v_and_b32 v141, 0xffff0000, v198
  v_mfma_f32_16x16x32_bf16 v[84:87], a[72:75], v[24:27], v[84:87]
  v_lshlrev_b32 v142, 16, v199
  v_and_b32 v143, 0xffff0000, v199
  v_mfma_f32_16x16x32_bf16 v[104:107], a[76:79], v[24:27], v[104:107]
  ds_read_b128 v[24:27], v4 offset:26624
  s_add_u32 s25, s28, 12288
  s_waitcnt lgkmcnt(7)
  v_mfma_f32_16x16x32_bf16 v[48:51], a[64:67], v[28:31], v[48:51]
  buffer_load_dwordx4 v[216:219], v7, s[12:15], s25 offen sc1
  v_mfma_f32_16x16x32_bf16 v[68:71], a[68:71], v[28:31], v[68:71]
  s_waitcnt lgkmcnt(2)
  v_fma_f32 v136, v136, v120, v128
  v_fma_f32 v137, v137, v121, v129
  v_mfma_f32_16x16x32_bf16 v[88:91], a[72:75], v[28:31], v[88:91]
  v_fma_f32 v138, v138, v122, v130
  v_fma_f32 v139, v139, v123, v131
  v_fma_f32 v140, v140, v124, v132
  v_mfma_f32_16x16x32_bf16 v[108:111], a[76:79], v[28:31], v[108:111]
  ds_read_b128 v[28:31], v4 offset:27648
  s_add_u32 s25, s29, 12288
  v_fma_f32 v141, v141, v125, v133
  v_mfma_f32_16x16x32_bf16 v[52:55], a[64:67], v[32:35], v[52:55]
  buffer_load_dwordx4 v[220:223], v4, s[12:15], s25 offen sc1
  v_fma_f32 v142, v142, v126, v134
  v_mfma_f32_16x16x32_bf16 v[72:75], a[68:71], v[32:35], v[72:75]
  v_fma_f32 v143, v143, v127, v135
  v_cvt_pk_bf16_f32 v196, v136, v137
  v_cvt_pk_bf16_f32 v197, v138, v139
  v_mfma_f32_16x16x32_bf16 v[92:95], a[72:75], v[32:35], v[92:95]
  s_add_u32 s25, s29, 30720
  v_cvt_pk_bf16_f32 v198, v140, v141
  v_cvt_pk_bf16_f32 v199, v142, v143
  v_mfma_f32_16x16x32_bf16 v[112:115], a[76:79], v[32:35], v[112:115]
  ds_read_b128 v[32:35], v4 offset:28672
  ds_write_b128 v11, v[196:199] offset:0
  v_mfma_f32_16x16x32_bf16 v[56:59], a[64:67], v[36:39], v[56:59]
  buffer_load_dwordx4 v[224:227], v4, s[12:15], s25 offen sc1
  v_lshlrev_b32 v136, 16, v200
  v_mfma_f32_16x16x32_bf16 v[76:79], a[68:71], v[36:39], v[76:79]
  v_and_b32 v137, 0xffff0000, v200
  v_lshlrev_b32 v138, 16, v201
  v_and_b32 v139, 0xffff0000, v201
  v_mfma_f32_16x16x32_bf16 v[96:99], a[72:75], v[36:39], v[96:99]
  s_add_u32 s25, s29, 49152
  v_lshlrev_b32 v140, 16, v202
  v_and_b32 v141, 0xffff0000, v202
  v_mfma_f32_16x16x32_bf16 v[116:119], a[76:79], v[36:39], v[116:119]
  ds_read_b128 v[36:39], v4 offset:29696
  v_lshlrev_b32 v142, 16, v203
  s_waitcnt vmcnt(11)
  s_waitcnt lgkmcnt(4)
  v_mfma_f32_16x16x32_bf16 v[40:43], a[80:83], v[20:23], v[40:43]
  buffer_load_dwordx4 v[228:231], v4, s[12:15], s25 offen sc1
  v_and_b32 v143, 0xffff0000, v203
  v_mfma_f32_16x16x32_bf16 v[60:63], a[84:87], v[20:23], v[60:63]
  v_fma_f32 v136, v136, v120, v128
  v_fma_f32 v137, v137, v121, v129
  v_fma_f32 v138, v138, v122, v130
  v_mfma_f32_16x16x32_bf16 v[80:83], a[88:91], v[20:23], v[80:83]
  s_add_u32 s25, s29, 67584
  v_fma_f32 v139, v139, v123, v131
  v_fma_f32 v140, v140, v124, v132
  v_mfma_f32_16x16x32_bf16 v[100:103], a[92:95], v[20:23], v[100:103]
  ds_read_b128 v[20:23], v4 offset:30720
  buffer_load_dwordx4 v[232:235], v4, s[12:15], s25 offen sc1
  v_mfma_f32_16x16x32_bf16 v[44:47], a[80:83], v[24:27], v[44:47]
  v_fma_f32 v141, v141, v125, v133
  v_fma_f32 v142, v142, v126, v134
  v_fma_f32 v143, v143, v127, v135
  v_mfma_f32_16x16x32_bf16 v[64:67], a[84:87], v[24:27], v[64:67]
  v_cvt_pk_bf16_f32 v200, v136, v137
  v_cvt_pk_bf16_f32 v201, v138, v139
  v_cvt_pk_bf16_f32 v202, v140, v141
  v_mfma_f32_16x16x32_bf16 v[84:87], a[88:91], v[24:27], v[84:87]
  v_cvt_pk_bf16_f32 v203, v142, v143
  ds_write_b128 v11, v[200:203] offset:1024
  v_lshlrev_b32 v136, 16, v204
  v_mfma_f32_16x16x32_bf16 v[104:107], a[92:95], v[24:27], v[104:107]
  ds_read_b128 v[24:27], v4 offset:31744
  v_and_b32 v137, 0xffff0000, v204
  s_waitcnt lgkmcnt(5)
  v_mfma_f32_16x16x32_bf16 v[48:51], a[80:83], v[28:31], v[48:51]
  buffer_load_dwordx4 a[128:131], v4, s[16:19], s30 offen offset:0 sc1
  v_lshlrev_b32 v138, 16, v205
  v_mfma_f32_16x16x32_bf16 v[68:71], a[84:87], v[28:31], v[68:71]
  v_and_b32 v139, 0xffff0000, v205
  v_lshlrev_b32 v140, 16, v206
  v_and_b32 v141, 0xffff0000, v206
  v_mfma_f32_16x16x32_bf16 v[88:91], a[88:91], v[28:31], v[88:91]
  v_lshlrev_b32 v142, 16, v207
  v_and_b32 v143, 0xffff0000, v207
  v_fma_f32 v136, v136, v120, v128
  v_mfma_f32_16x16x32_bf16 v[108:111], a[92:95], v[28:31], v[108:111]
  ds_read_b128 v[28:31], v4 offset:32768
  buffer_load_dwordx4 a[132:135], v4, s[16:19], s31 offen offset:0 sc1
  v_mfma_f32_16x16x32_bf16 v[52:55], a[80:83], v[32:35], v[52:55]
  v_fma_f32 v137, v137, v121, v129
  v_fma_f32 v138, v138, v122, v130
  v_fma_f32 v139, v139, v123, v131
  v_mfma_f32_16x16x32_bf16 v[72:75], a[84:87], v[32:35], v[72:75]
  v_fma_f32 v140, v140, v124, v132
  v_fma_f32 v141, v141, v125, v133
  v_fma_f32 v142, v142, v126, v134
  v_mfma_f32_16x16x32_bf16 v[92:95], a[88:91], v[32:35], v[92:95]
  v_fma_f32 v143, v143, v127, v135
  v_cvt_pk_bf16_f32 v204, v136, v137
  v_cvt_pk_bf16_f32 v205, v138, v139
  v_mfma_f32_16x16x32_bf16 v[112:115], a[92:95], v[32:35], v[112:115]
  ds_read_b128 v[32:35], v4 offset:33792
  v_cvt_pk_bf16_f32 v206, v140, v141
  s_waitcnt lgkmcnt(5)
  v_mfma_f32_16x16x32_bf16 v[56:59], a[80:83], v[36:39], v[56:59]
  buffer_load_dwordx4 a[136:139], v4, s[16:19], s32 offen offset:0 sc1
  v_cvt_pk_bf16_f32 v207, v142, v143
  v_mfma_f32_16x16x32_bf16 v[76:79], a[84:87], v[36:39], v[76:79]
  ds_write_b128 v11, v[204:207] offset:2048
  v_lshlrev_b32 v136, 16, v208
  v_and_b32 v137, 0xffff0000, v208
  v_mfma_f32_16x16x32_bf16 v[96:99], a[88:91], v[36:39], v[96:99]
  buffer_load_dwordx4 a[140:143], v8, s[16:19], s33 offen offset:0 sc1
  v_lshlrev_b32 v138, 16, v209
  v_mfma_f32_16x16x32_bf16 v[116:119], a[92:95], v[36:39], v[116:119]
  ds_read_b128 v[36:39], v4 offset:34816
  v_and_b32 v139, 0xffff0000, v209
  s_waitcnt vmcnt(13)
  s_waitcnt lgkmcnt(4)
  v_mfma_f32_16x16x32_bf16 v[40:43], a[96:99], v[20:23], v[40:43]
  v_lshlrev_b32 v140, 16, v210
  v_and_b32 v141, 0xffff0000, v210
  v_lshlrev_b32 v142, 16, v211
  v_mfma_f32_16x16x32_bf16 v[60:63], a[100:103], v[20:23], v[60:63]
  v_and_b32 v143, 0xffff0000, v211
  v_fma_f32 v136, v136, v120, v128
  v_fma_f32 v137, v137, v121, v129
  v_mfma_f32_16x16x32_bf16 v[80:83], a[104:107], v[20:23], v[80:83]
  buffer_load_dwordx4 a[144:147], v4, s[16:19], s30 offen offset:1024 sc1
  v_fma_f32 v138, v138, v122, v130
  v_mfma_f32_16x16x32_bf16 v[100:103], a[108:111], v[20:23], v[100:103]
  ds_read_b128 v[20:23], v4 offset:35840
  v_fma_f32 v139, v139, v123, v131
  v_fma_f32 v140, v140, v124, v132
  v_mfma_f32_16x16x32_bf16 v[44:47], a[96:99], v[24:27], v[44:47]
  v_fma_f32 v141, v141, v125, v133
  v_fma_f32 v142, v142, v126, v134
  v_fma_f32 v143, v143, v127, v135
  v_mfma_f32_16x16x32_bf16 v[64:67], a[100:103], v[24:27], v[64:67]
  v_cvt_pk_bf16_f32 v208, v136, v137
  v_cvt_pk_bf16_f32 v209, v138, v139
  v_cvt_pk_bf16_f32 v210, v140, v141
  v_mfma_f32_16x16x32_bf16 v[84:87], a[104:107], v[24:27], v[84:87]
  buffer_load_dwordx4 a[148:151], v4, s[16:19], s31 offen offset:1024 sc1
  v_cvt_pk_bf16_f32 v211, v142, v143
  v_mfma_f32_16x16x32_bf16 v[104:107], a[108:111], v[24:27], v[104:107]
  ds_read_b128 v[24:27], v4 offset:36864
  ds_write_b128 v11, v[208:211] offset:3072
  s_waitcnt lgkmcnt(5)
  v_mfma_f32_16x16x32_bf16 v[48:51], a[96:99], v[28:31], v[48:51]
  v_lshlrev_b32 v136, 16, v212
  v_and_b32 v137, 0xffff0000, v212
  v_lshlrev_b32 v138, 16, v213
  v_mfma_f32_16x16x32_bf16 v[68:71], a[100:103], v[28:31], v[68:71]
  v_and_b32 v139, 0xffff0000, v213
  v_lshlrev_b32 v140, 16, v214
  v_and_b32 v141, 0xffff0000, v214
  v_mfma_f32_16x16x32_bf16 v[88:91], a[104:107], v[28:31], v[88:91]
  buffer_load_dwordx4 a[152:155], v4, s[16:19], s32 offen offset:1024 sc1
  v_lshlrev_b32 v142, 16, v215
  v_mfma_f32_16x16x32_bf16 v[108:111], a[108:111], v[28:31], v[108:111]
  ds_read_b128 v[28:31], v4 offset:37888
  v_and_b32 v143, 0xffff0000, v215
  v_fma_f32 v136, v136, v120, v128
  v_mfma_f32_16x16x32_bf16 v[52:55], a[96:99], v[32:35], v[52:55]
  v_fma_f32 v137, v137, v121, v129
  v_fma_f32 v138, v138, v122, v130
  v_fma_f32 v139, v139, v123, v131
  v_mfma_f32_16x16x32_bf16 v[72:75], a[100:103], v[32:35], v[72:75]
  v_fma_f32 v140, v140, v124, v132
  v_fma_f32 v141, v141, v125, v133
  v_fma_f32 v142, v142, v126, v134
  v_mfma_f32_16x16x32_bf16 v[92:95], a[104:107], v[32:35], v[92:95]
  buffer_load_dwordx4 a[156:159], v8, s[16:19], s33 offen offset:1024 sc1
  v_fma_f32 v143, v143, v127, v135
  v_mfma_f32_16x16x32_bf16 v[112:115], a[108:111], v[32:35], v[112:115]
  ds_read_b128 v[32:35], v4 offset:38912
  v_cvt_pk_bf16_f32 v212, v136, v137
  s_waitcnt lgkmcnt(5)
  v_mfma_f32_16x16x32_bf16 v[56:59], a[96:99], v[36:39], v[56:59]
  v_cvt_pk_bf16_f32 v213, v138, v139
  v_cvt_pk_bf16_f32 v214, v140, v141
  v_cvt_pk_bf16_f32 v215, v142, v143
  v_mfma_f32_16x16x32_bf16 v[76:79], a[100:103], v[36:39], v[76:79]
  ds_write_b128 v11, v[212:215] offset:4096
  v_add_u32 v17, s40, v19
  v_lshl_add_u32 v18, v155, 5, v17
  v_mfma_f32_16x16x32_bf16 v[96:99], a[104:107], v[36:39], v[96:99]
  buffer_load_dwordx4 a[160:163], v4, s[16:19], s30 offen offset:2048 sc1
  v_lshl_add_u32 v17, v155, 8, v17
  v_mfma_f32_16x16x32_bf16 v[116:119], a[108:111], v[36:39], v[116:119]
  ds_read_b128 v[36:39], v4 offset:39936
  s_waitcnt lgkmcnt(1)
  s_barrier
  s_waitcnt vmcnt(14)
  v_mfma_f32_16x16x32_bf16 v[40:43], a[112:115], v[20:23], v[40:43]
  ds_read_b64_tr_b16 v[156:157], v17 offset:0
  ds_read_b64_tr_b16 v[158:159], v17 offset:1024
  v_mfma_f32_16x16x32_bf16 v[60:63], a[116:119], v[20:23], v[60:63]
  buffer_load_dwordx4 a[164:167], v4, s[16:19], s31 offen offset:2048 sc1
  ds_read_b64_tr_b16 v[160:161], v17 offset:32
  v_mfma_f32_16x16x32_bf16 v[80:83], a[120:123], v[20:23], v[80:83]
  ds_read_b64_tr_b16 v[162:163], v17 offset:1056
  ds_read_b64_tr_b16 v[164:165], v17 offset:64
  ds_read_b64_tr_b16 v[166:167], v17 offset:1088
  v_mfma_f32_16x16x32_bf16 v[100:103], a[124:127], v[20:23], v[100:103]
  ds_read_b128 v[20:23], v4 offset:40960
  ds_read_b64_tr_b16 v[168:169], v17 offset:96
  ds_read_b64_tr_b16 v[170:171], v17 offset:1120
  v_mfma_f32_16x16x32_bf16 v[44:47], a[112:115], v[24:27], v[44:47]
  ds_read_b64_tr_b16 v[172:173], v17 offset:128
  ds_read_b64_tr_b16 v[174:175], v17 offset:1152
  ds_read_b64_tr_b16 v[176:177], v17 offset:160
  v_mfma_f32_16x16x32_bf16 v[64:67], a[116:119], v[24:27], v[64:67]
  buffer_load_dwordx4 a[168:171], v4, s[16:19], s32 offen offset:2048 sc1
  ds_read_b64_tr_b16 v[178:179], v17 offset:1184
  v_mfma_f32_16x16x32_bf16 v[84:87], a[120:123], v[24:27], v[84:87]
  ds_read_b64_tr_b16 v[180:181], v17 offset:192
  ds_read_b64_tr_b16 v[182:183], v17 offset:1216
  ds_read_b64_tr_b16 v[184:185], v17 offset:224
  v_mfma_f32_16x16x32_bf16 v[104:107], a[124:127], v[24:27], v[104:107]
  ds_read_b128 v[24:27], v4 offset:41984
  ds_read_b64_tr_b16 v[186:187], v17 offset:1248
  v_mfma_f32_16x16x32_bf16 v[48:51], a[112:115], v[28:31], v[48:51]
  ds_read_b64_tr_b16 v[188:189], v18 offset:8192
  ds_read_b64_tr_b16 v[190:191], v18 offset:8320
  v_mfma_f32_16x16x32_bf16 v[68:71], a[116:119], v[28:31], v[68:71]
  buffer_load_dwordx4 a[172:175], v8, s[16:19], s33 offen offset:2048 sc1
  v_mfma_f32_16x16x32_bf16 v[88:91], a[120:123], v[28:31], v[88:91]
  s_waitcnt lgkmcnt(15)
  buffer_store_dwordx4 v[156:159], v154, s[36:39], s47 offen sc1
  v_mfma_f32_16x16x32_bf16 v[108:111], a[124:127], v[28:31], v[108:111]
  ds_read_b128 v[28:31], v4 offset:43008
  s_add_u32 s47, s47, 18432
  v_mfma_f32_16x16x32_bf16 v[52:55], a[112:115], v[32:35], v[52:55]
  buffer_store_dwordx4 v[160:163], v154, s[36:39], s47 offen sc1
  v_mfma_f32_16x16x32_bf16 v[72:75], a[116:119], v[32:35], v[72:75]
  buffer_load_dwordx4 a[176:179], v4, s[16:19], s30 offen offset:3072 sc1
  s_add_u32 s30, s30, 4096
  v_mfma_f32_16x16x32_bf16 v[92:95], a[120:123], v[32:35], v[92:95]
  s_add_u32 s47, s47, 18432
  v_mfma_f32_16x16x32_bf16 v[112:115], a[124:127], v[32:35], v[112:115]
  ds_read_b128 v[32:35], v4 offset:44032
  v_mfma_f32_16x16x32_bf16 v[56:59], a[112:115], v[36:39], v[56:59]
  s_waitcnt lgkmcnt(15)
  buffer_store_dwordx4 v[164:167], v154, s[36:39], s47 offen sc1
  v_mfma_f32_16x16x32_bf16 v[76:79], a[116:119], v[36:39], v[76:79]
  buffer_load_dwordx4 a[180:183], v4, s[16:19], s31 offen offset:3072 sc1
  s_add_u32 s31, s31, 4096
  v_mfma_f32_16x16x32_bf16 v[96:99], a[120:123], v[36:39], v[96:99]
  s_add_u32 s47, s47, 18432
  v_mfma_f32_16x16x32_bf16 v[116:119], a[124:127], v[36:39], v[116:119]
  ds_read_b128 v[36:39], v4 offset:45056
  s_waitcnt vmcnt(13)
  s_waitcnt lgkmcnt(6)
  v_mfma_f32_16x16x32_bf16 v[40:43], a[128:131], v[20:23], v[40:43]
  ds_read_b128 v[120:123], v13 offset:1536
  ds_read_b128 v[124:127], v13 offset:1552
  ds_read_b128 v[128:131], v13 offset:3840
  v_mfma_f32_16x16x32_bf16 v[60:63], a[132:135], v[20:23], v[60:63]
  buffer_load_dwordx4 a[184:187], v4, s[16:19], s32 offen offset:3072 sc1
  s_add_u32 s32, s32, 4096
  v_mfma_f32_16x16x32_bf16 v[80:83], a[136:139], v[20:23], v[80:83]
  ds_read_b128 v[132:135], v13 offset:3856
  v_lshlrev_b32 v136, 16, v216
  v_mfma_f32_16x16x32_bf16 v[100:103], a[140:143], v[20:23], v[100:103]
  ds_read_b128 v[20:23], v4 offset:46080
  v_and_b32 v137, 0xffff0000, v216
  v_lshlrev_b32 v138, 16, v217
  v_mfma_f32_16x16x32_bf16 v[44:47], a[128:131], v[24:27], v[44:47]
  buffer_load_dwordx4 a[188:191], v8, s[16:19], s33 offen offset:3072 sc1
  s_add_u32 s33, s33, 4096
  v_mfma_f32_16x16x32_bf16 v[64:67], a[132:135], v[24:27], v[64:67]
  v_and_b32 v139, 0xffff0000, v217
  v_lshlrev_b32 v140, 16, v218
  v_and_b32 v141, 0xffff0000, v218
  v_mfma_f32_16x16x32_bf16 v[84:87], a[136:139], v[24:27], v[84:87]
  v_lshlrev_b32 v142, 16, v219
  v_and_b32 v143, 0xffff0000, v219
  v_mfma_f32_16x16x32_bf16 v[104:107], a[140:143], v[24:27], v[104:107]
  ds_read_b128 v[24:27], v4 offset:47104
  s_add_u32 s25, s28, 16384
  s_waitcnt lgkmcnt(7)
  v_mfma_f32_16x16x32_bf16 v[48:51], a[128:131], v[28:31], v[48:51]
  buffer_load_dwordx4 v[236:239], v9, s[12:15], s25 offen sc1
  v_mfma_f32_16x16x32_bf16 v[68:71], a[132:135], v[28:31], v[68:71]
  s_waitcnt lgkmcnt(2)
  v_fma_f32 v136, v136, v120, v128
  v_fma_f32 v137, v137, v121, v129
  v_mfma_f32_16x16x32_bf16 v[88:91], a[136:139], v[28:31], v[88:91]
  v_fma_f32 v138, v138, v122, v130
  v_fma_f32 v139, v139, v123, v131
  v_fma_f32 v140, v140, v124, v132
  v_mfma_f32_16x16x32_bf16 v[108:111], a[140:143], v[28:31], v[108:111]
  ds_read_b128 v[28:31], v4 offset:48128
  s_add_u32 s25, s29, 16384
  v_fma_f32 v141, v141, v125, v133
  v_mfma_f32_16x16x32_bf16 v[52:55], a[128:131], v[32:35], v[52:55]
  buffer_load_dwordx4 v[240:243], v8, s[12:15], s25 offen sc1
  v_fma_f32 v142, v142, v126, v134
  v_mfma_f32_16x16x32_bf16 v[72:75], a[132:135], v[32:35], v[72:75]
  v_fma_f32 v143, v143, v127, v135
  v_cvt_pk_bf16_f32 v216, v136, v137
  v_cvt_pk_bf16_f32 v217, v138, v139
  v_mfma_f32_16x16x32_bf16 v[92:95], a[136:139], v[32:35], v[92:95]
  v_cvt_pk_bf16_f32 v218, v140, v141
  v_cvt_pk_bf16_f32 v219, v142, v143
  ds_write_b128 v11, v[216:219] offset:20480
  v_mfma_f32_16x16x32_bf16 v[112:115], a[140:143], v[32:35], v[112:115]
  ds_read_b128 v[32:35], v4 offset:49152
  s_add_u32 s25, s29, 34816
  v_mfma_f32_16x16x32_bf16 v[56:59], a[128:131], v[36:39], v[56:59]
  buffer_load_dwordx4 v[244:247], v8, s[12:15], s25 offen sc1
  v_lshlrev_b32 v136, 16, v220
  v_mfma_f32_16x16x32_bf16 v[76:79], a[132:135], v[36:39], v[76:79]
  v_and_b32 v137, 0xffff0000, v220
  v_lshlrev_b32 v138, 16, v221
  v_and_b32 v139, 0xffff0000, v221
  v_mfma_f32_16x16x32_bf16 v[96:99], a[136:139], v[36:39], v[96:99]
  v_lshlrev_b32 v140, 16, v222
  v_and_b32 v141, 0xffff0000, v222
  v_lshlrev_b32 v142, 16, v223
  v_mfma_f32_16x16x32_bf16 v[116:119], a[140:143], v[36:39], v[116:119]
  ds_read_b128 v[36:39], v4 offset:50176
  s_add_u32 s25, s29, 53248
  s_waitcnt vmcnt(14)
  s_waitcnt lgkmcnt(4)
  v_mfma_f32_16x16x32_bf16 v[40:43], a[144:147], v[20:23], v[40:43]
  buffer_load_dwordx4 v[248:251], v8, s[12:15], s25 offen sc1
  v_and_b32 v143, 0xffff0000, v223
  v_mfma_f32_16x16x32_bf16 v[60:63], a[148:151], v[20:23], v[60:63]
  v_fma_f32 v136, v136, v120, v128
  v_fma_f32 v137, v137, v121, v129
  v_fma_f32 v138, v138, v122, v130
  v_mfma_f32_16x16x32_bf16 v[80:83], a[152:155], v[20:23], v[80:83]
  v_fma_f32 v139, v139, v123, v131
  v_fma_f32 v140, v140, v124, v132
  v_fma_f32 v141, v141, v125, v133
  v_mfma_f32_16x16x32_bf16 v[100:103], a[156:159], v[20:23], v[100:103]
  ds_read_b128 v[20:23], v4 offset:51200
  s_add_u32 s25, s29, 71680
  v_fma_f32 v142, v142, v126, v134
  v_mfma_f32_16x16x32_bf16 v[44:47], a[144:147], v[24:27], v[44:47]
  buffer_load_dwordx4 v[252:255], v8, s[12:15], s25 offen sc1
  v_fma_f32 v143, v143, v127, v135
  v_mfma_f32_16x16x32_bf16 v[64:67], a[148:151], v[24:27], v[64:67]
  v_cvt_pk_bf16_f32 v220, v136, v137
  v_cvt_pk_bf16_f32 v221, v138, v139
  v_cvt_pk_bf16_f32 v222, v140, v141
  v_mfma_f32_16x16x32_bf16 v[84:87], a[152:155], v[24:27], v[84:87]
  v_cvt_pk_bf16_f32 v223, v142, v143
  ds_write_b128 v11, v[220:223] offset:21504
  v_lshlrev_b32 v136, 16, v224
  v_mfma_f32_16x16x32_bf16 v[104:107], a[156:159], v[24:27], v[104:107]
  ds_read_b128 v[24:27], v4 offset:52224
  v_and_b32 v137, 0xffff0000, v224
  s_waitcnt lgkmcnt(4)
  v_mfma_f32_16x16x32_bf16 v[48:51], a[144:147], v[28:31], v[48:51]
  buffer_load_dwordx4 a[192:195], v4, s[16:19], s30 offen offset:0 sc1
  v_lshlrev_b32 v138, 16, v225
  v_mfma_f32_16x16x32_bf16 v[68:71], a[148:151], v[28:31], v[68:71]
  v_and_b32 v139, 0xffff0000, v225
  v_lshlrev_b32 v140, 16, v226
  v_and_b32 v141, 0xffff0000, v226
  v_mfma_f32_16x16x32_bf16 v[88:91], a[152:155], v[28:31], v[88:91]
  v_lshlrev_b32 v142, 16, v227
  v_and_b32 v143, 0xffff0000, v227
  v_fma_f32 v136, v136, v120, v128
  v_mfma_f32_16x16x32_bf16 v[108:111], a[156:159], v[28:31], v[108:111]
  ds_read_b128 v[28:31], v4 offset:53248
  buffer_load_dwordx4 a[196:199], v4, s[16:19], s31 offen offset:0 sc1
  v_mfma_f32_16x16x32_bf16 v[52:55], a[144:147], v[32:35], v[52:55]
  v_fma_f32 v137, v137, v121, v129
  v_fma_f32 v138, v138, v122, v130
  v_fma_f32 v139, v139, v123, v131
  v_mfma_f32_16x16x32_bf16 v[72:75], a[148:151], v[32:35], v[72:75]
  v_fma_f32 v140, v140, v124, v132
  v_fma_f32 v141, v141, v125, v133
  v_fma_f32 v142, v142, v126, v134
  v_mfma_f32_16x16x32_bf16 v[92:95], a[152:155], v[32:35], v[92:95]
  v_fma_f32 v143, v143, v127, v135
  v_cvt_pk_bf16_f32 v224, v136, v137
  v_cvt_pk_bf16_f32 v225, v138, v139
  v_mfma_f32_16x16x32_bf16 v[112:115], a[156:159], v[32:35], v[112:115]
  ds_read_b128 v[32:35], v4 offset:54272
  v_cvt_pk_bf16_f32 v226, v140, v141
  s_waitcnt lgkmcnt(5)
  v_mfma_f32_16x16x32_bf16 v[56:59], a[144:147], v[36:39], v[56:59]
  buffer_load_dwordx4 a[200:203], v4, s[16:19], s32 offen offset:0 sc1
  v_cvt_pk_bf16_f32 v227, v142, v143
  v_mfma_f32_16x16x32_bf16 v[76:79], a[148:151], v[36:39], v[76:79]
  ds_write_b128 v11, v[224:227] offset:22528
  v_lshlrev_b32 v136, 16, v228
  v_and_b32 v137, 0xffff0000, v228
  v_mfma_f32_16x16x32_bf16 v[96:99], a[152:155], v[36:39], v[96:99]
  v_lshlrev_b32 v138, 16, v229
  v_and_b32 v139, 0xffff0000, v229
  v_lshlrev_b32 v140, 16, v230
  v_mfma_f32_16x16x32_bf16 v[116:119], a[156:159], v[36:39], v[116:119]
  ds_read_b128 v[36:39], v4 offset:55296
  v_and_b32 v141, 0xffff0000, v230
  s_waitcnt vmcnt(15)
  s_waitcnt lgkmcnt(4)
  v_mfma_f32_16x16x32_bf16 v[40:43], a[160:163], v[20:23], v[40:43]
  buffer_load_dwordx4 a[204:207], v8, s[16:19], s33 offen offset:0 sc1
  v_lshlrev_b32 v142, 16, v231
  v_mfma_f32_16x16x32_bf16 v[60:63], a[164:167], v[20:23], v[60:63]
  v_and_b32 v143, 0xffff0000, v231
  v_fma_f32 v136, v136, v120, v128
  v_fma_f32 v137, v137, v121, v129
  v_mfma_f32_16x16x32_bf16 v[80:83], a[168:171], v[20:23], v[80:83]
  v_fma_f32 v138, v138, v122, v130
  v_fma_f32 v139, v139, v123, v131
  v_fma_f32 v140, v140, v124, v132
  v_mfma_f32_16x16x32_bf16 v[100:103], a[172:175], v[20:23], v[100:103]
  ds_read_b128 v[20:23], v4 offset:56320
  buffer_load_dwordx4 a[208:211], v4, s[16:19], s30 offen offset:1024 sc1
  v_mfma_f32_16x16x32_bf16 v[44:47], a[160:163], v[24:27], v[44:47]
  v_fma_f32 v141, v141, v125, v133
  v_fma_f32 v142, v142, v126, v134
  v_fma_f32 v143, v143, v127, v135
  v_mfma_f32_16x16x32_bf16 v[64:67], a[164:167], v[24:27], v[64:67]
  v_cvt_pk_bf16_f32 v228, v136, v137
  v_cvt_pk_bf16_f32 v229, v138, v139
  v_cvt_pk_bf16_f32 v230, v140, v141
  v_mfma_f32_16x16x32_bf16 v[84:87], a[168:171], v[24:27], v[84:87]
  v_cvt_pk_bf16_f32 v231, v142, v143
  ds_write_b128 v11, v[228:231] offset:23552
  v_lshlrev_b32 v136, 16, v232
  v_mfma_f32_16x16x32_bf16 v[104:107], a[172:175], v[24:27], v[104:107]
  ds_read_b128 v[24:27], v4 offset:57344
  v_and_b32 v137, 0xffff0000, v232
  s_waitcnt lgkmcnt(5)
  v_mfma_f32_16x16x32_bf16 v[48:51], a[160:163], v[28:31], v[48:51]
  buffer_load_dwordx4 a[212:215], v4, s[16:19], s31 offen offset:1024 sc1
  v_lshlrev_b32 v138, 16, v233
  v_mfma_f32_16x16x32_bf16 v[68:71], a[164:167], v[28:31], v[68:71]
  v_and_b32 v139, 0xffff0000, v233
  v_lshlrev_b32 v140, 16, v234
  v_and_b32 v141, 0xffff0000, v234
  v_mfma_f32_16x16x32_bf16 v[88:91], a[168:171], v[28:31], v[88:91]
  buffer_load_dwordx4 a[216:219], v4, s[16:19], s32 offen offset:1024 sc1
  v_lshlrev_b32 v142, 16, v235
  v_mfma_f32_16x16x32_bf16 v[108:111], a[172:175], v[28:31], v[108:111]
  ds_read_b128 v[28:31], v4 offset:58368
  v_and_b32 v143, 0xffff0000, v235
  v_fma_f32 v136, v136, v120, v128
  v_mfma_f32_16x16x32_bf16 v[52:55], a[160:163], v[32:35], v[52:55]
  v_fma_f32 v137, v137, v121, v129
  v_fma_f32 v138, v138, v122, v130
  v_fma_f32 v139, v139, v123, v131
  v_mfma_f32_16x16x32_bf16 v[72:75], a[164:167], v[32:35], v[72:75]
  v_fma_f32 v140, v140, v124, v132
  v_fma_f32 v141, v141, v125, v133
  v_fma_f32 v142, v142, v126, v134
  v_mfma_f32_16x16x32_bf16 v[92:95], a[168:171], v[32:35], v[92:95]
  buffer_load_dwordx4 a[220:223], v8, s[16:19], s33 offen offset:1024 sc1
  v_fma_f32 v143, v143, v127, v135
  v_mfma_f32_16x16x32_bf16 v[112:115], a[172:175], v[32:35], v[112:115]
  ds_read_b128 v[32:35], v4 offset:59392
  v_cvt_pk_bf16_f32 v232, v136, v137
  s_waitcnt lgkmcnt(5)
  v_mfma_f32_16x16x32_bf16 v[56:59], a[160:163], v[36:39], v[56:59]
  v_cvt_pk_bf16_f32 v233, v138, v139
  v_cvt_pk_bf16_f32 v234, v140, v141
  v_cvt_pk_bf16_f32 v235, v142, v143
  v_mfma_f32_16x16x32_bf16 v[76:79], a[164:167], v[36:39], v[76:79]
  ds_write_b128 v11, v[232:235] offset:24576
  v_mfma_f32_16x16x32_bf16 v[96:99], a[168:171], v[36:39], v[96:99]
  buffer_load_dwordx4 a[224:227], v4, s[16:19], s30 offen offset:2048 sc1
  v_mfma_f32_16x16x32_bf16 v[116:119], a[172:175], v[36:39], v[116:119]
  ds_read_b128 v[36:39], v4 offset:60416
  s_waitcnt lgkmcnt(1)
  s_barrier
  s_waitcnt vmcnt(14)
  v_mfma_f32_16x16x32_bf16 v[40:43], a[176:179], v[20:23], v[40:43]
  buffer_store_dwordx4 v[168:171], v154, s[36:39], s47 offen sc1
  v_mfma_f32_16x16x32_bf16 v[60:63], a[180:183], v[20:23], v[60:63]
  s_add_u32 s47, s47, 18432
  v_mfma_f32_16x16x32_bf16 v[80:83], a[184:187], v[20:23], v[80:83]
  buffer_load_dwordx4 a[228:231], v4, s[16:19], s31 offen offset:2048 sc1
  v_mfma_f32_16x16x32_bf16 v[100:103], a[188:191], v[20:23], v[100:103]
  ds_read_b128 v[20:23], v14 offset:0
  v_mfma_f32_16x16x32_bf16 v[44:47], a[176:179], v[24:27], v[44:47]
  buffer_store_dwordx4 v[172:175], v154, s[36:39], s47 offen sc1
  v_mfma_f32_16x16x32_bf16 v[64:67], a[180:183], v[24:27], v[64:67]
  s_add_u32 s47, s47, 18432
  v_mfma_f32_16x16x32_bf16 v[84:87], a[184:187], v[24:27], v[84:87]
  buffer_load_dwordx4 a[232:235], v4, s[16:19], s32 offen offset:2048 sc1
  v_mfma_f32_16x16x32_bf16 v[104:107], a[188:191], v[24:27], v[104:107]
  ds_read_b128 v[24:27], v14 offset:1024
  v_mfma_f32_16x16x32_bf16 v[48:51], a[176:179], v[28:31], v[48:51]
  buffer_store_dwordx4 v[176:179], v154, s[36:39], s47 offen sc1
  v_mfma_f32_16x16x32_bf16 v[68:71], a[180:183], v[28:31], v[68:71]
  s_add_u32 s47, s47, 18432
  v_mfma_f32_16x16x32_bf16 v[88:91], a[184:187], v[28:31], v[88:91]
  buffer_load_dwordx4 a[236:239], v8, s[16:19], s33 offen offset:2048 sc1
  v_mfma_f32_16x16x32_bf16 v[108:111], a[188:191], v[28:31], v[108:111]
  ds_read_b128 v[28:31], v14 offset:2048
  v_mfma_f32_16x16x32_bf16 v[52:55], a[176:179], v[32:35], v[52:55]
  buffer_store_dwordx4 v[180:183], v154, s[36:39], s47 offen sc1
  v_mfma_f32_16x16x32_bf16 v[72:75], a[180:183], v[32:35], v[72:75]
  buffer_load_dwordx4 a[240:243], v4, s[16:19], s30 offen offset:3072 sc1
  s_add_u32 s30, s30, 4096
  v_mfma_f32_16x16x32_bf16 v[92:95], a[184:187], v[32:35], v[92:95]
  s_add_u32 s47, s47, 18432
  v_mfma_f32_16x16x32_bf16 v[112:115], a[188:191], v[32:35], v[112:115]
  ds_read_b128 v[32:35], v14 offset:3072
  s_waitcnt lgkmcnt(4)
  v_mfma_f32_16x16x32_bf16 v[56:59], a[176:179], v[36:39], v[56:59]
  buffer_store_dwordx4 v[184:187], v154, s[36:39], s47 offen sc1
  v_mfma_f32_16x16x32_bf16 v[76:79], a[180:183], v[36:39], v[76:79]
  buffer_load_dwordx4 a[244:247], v4, s[16:19], s31 offen offset:3072 sc1
  s_add_u32 s31, s31, 4096
  v_mfma_f32_16x16x32_bf16 v[96:99], a[184:187], v[36:39], v[96:99]
  s_add_u32 s47, s47, 18432
  v_mfma_f32_16x16x32_bf16 v[116:119], a[188:191], v[36:39], v[116:119]
  ds_read_b128 v[36:39], v14 offset:4096
  s_waitcnt vmcnt(15)
  s_waitcnt lgkmcnt(3)
  v_mfma_f32_16x16x32_bf16 v[40:43], a[192:195], v[20:23], v[40:43]
  ds_read_b128 v[120:123], v13 offset:2048
  ds_read_b128 v[124:127], v13 offset:2064
  ds_read_b128 v[128:131], v13 offset:4352
  v_mfma_f32_16x16x32_bf16 v[60:63], a[196:199], v[20:23], v[60:63]
  buffer_load_dwordx4 a[248:251], v4, s[16:19], s32 offen offset:3072 sc1
  s_add_u32 s32, s32, 4096
  v_mfma_f32_16x16x32_bf16 v[80:83], a[200:203], v[20:23], v[80:83]
  ds_read_b128 v[132:135], v13 offset:4368
  v_lshlrev_b32 v136, 16, v236
  v_mfma_f32_16x16x32_bf16 v[100:103], a[204:207], v[20:23], v[100:103]
  ds_read_b128 v[20:23], v14 offset:5120
  v_and_b32 v137, 0xffff0000, v236
  v_lshlrev_b32 v138, 16, v237
  v_mfma_f32_16x16x32_bf16 v[44:47], a[192:195], v[24:27], v[44:47]
  v_and_b32 v139, 0xffff0000, v237
  v_lshlrev_b32 v140, 16, v238
  v_and_b32 v141, 0xffff0000, v238
  v_mfma_f32_16x16x32_bf16 v[64:67], a[196:199], v[24:27], v[64:67]
  buffer_load_dwordx4 a[252:255], v8, s[16:19], s33 offen offset:3072 sc1
  s_add_u32 s33, s33, 4096
  v_mfma_f32_16x16x32_bf16 v[84:87], a[200:203], v[24:27], v[84:87]
  v_lshlrev_b32 v142, 16, v239
  v_and_b32 v143, 0xffff0000, v239
  v_mfma_f32_16x16x32_bf16 v[104:107], a[204:207], v[24:27], v[104:107]
  ds_read_b128 v[24:27], v14 offset:6144
  s_waitcnt lgkmcnt(7)
  v_mfma_f32_16x16x32_bf16 v[48:51], a[192:195], v[28:31], v[48:51]
  s_waitcnt lgkmcnt(2)
  v_fma_f32 v136, v136, v120, v128
  v_fma_f32 v137, v137, v121, v129
  v_mfma_f32_16x16x32_bf16 v[68:71], a[196:199], v[28:31], v[68:71]
  buffer_load_dwordx4 a[0:3], v4, s[16:19], s30 offen offset:0 sc1
  v_fma_f32 v138, v138, v122, v130
  v_mfma_f32_16x16x32_bf16 v[88:91], a[200:203], v[28:31], v[88:91]
  v_fma_f32 v139, v139, v123, v131
  v_fma_f32 v140, v140, v124, v132
  v_fma_f32 v141, v141, v125, v133
  v_mfma_f32_16x16x32_bf16 v[108:111], a[204:207], v[28:31], v[108:111]
  ds_read_b128 v[28:31], v14 offset:7168
  v_fma_f32 v142, v142, v126, v134
  v_fma_f32 v143, v143, v127, v135
  v_mfma_f32_16x16x32_bf16 v[52:55], a[192:195], v[32:35], v[52:55]
  v_cvt_pk_bf16_f32 v236, v136, v137
  v_cvt_pk_bf16_f32 v237, v138, v139
  v_cvt_pk_bf16_f32 v238, v140, v141
  v_mfma_f32_16x16x32_bf16 v[72:75], a[196:199], v[32:35], v[72:75]
  buffer_load_dwordx4 a[4:7], v4, s[16:19], s31 offen offset:0 sc1
  v_cvt_pk_bf16_f32 v239, v142, v143
  v_mfma_f32_16x16x32_bf16 v[92:95], a[200:203], v[32:35], v[92:95]
  ds_write_b128 v12, v[236:239] offset:0
  v_lshlrev_b32 v136, 16, v240
  v_and_b32 v137, 0xffff0000, v240
  v_mfma_f32_16x16x32_bf16 v[112:115], a[204:207], v[32:35], v[112:115]
  ds_read_b128 v[32:35], v14 offset:8192
  v_lshlrev_b32 v138, 16, v241
  v_mfma_f32_16x16x32_bf16 v[56:59], a[192:195], v[36:39], v[56:59]
  buffer_load_dwordx4 a[8:11], v4, s[16:19], s32 offen offset:0 sc1
  v_and_b32 v139, 0xffff0000, v241
  v_mfma_f32_16x16x32_bf16 v[76:79], a[196:199], v[36:39], v[76:79]
  v_lshlrev_b32 v140, 16, v242
  v_and_b32 v141, 0xffff0000, v242
  v_lshlrev_b32 v142, 16, v243
  v_mfma_f32_16x16x32_bf16 v[96:99], a[200:203], v[36:39], v[96:99]
  v_and_b32 v143, 0xffff0000, v243
  v_fma_f32 v136, v136, v120, v128
  v_fma_f32 v137, v137, v121, v129
  v_mfma_f32_16x16x32_bf16 v[116:119], a[204:207], v[36:39], v[116:119]
  ds_read_b128 v[36:39], v14 offset:9216
  v_fma_f32 v138, v138, v122, v130
  s_waitcnt vmcnt(16)
  s_waitcnt lgkmcnt(4)
  v_mfma_f32_16x16x32_bf16 v[40:43], a[208:211], v[20:23], v[40:43]
  buffer_load_dwordx4 a[12:15], v8, s[16:19], s33 offen offset:0 sc1
  v_fma_f32 v139, v139, v123, v131
  v_mfma_f32_16x16x32_bf16 v[60:63], a[212:215], v[20:23], v[60:63]
  v_fma_f32 v140, v140, v124, v132
  v_fma_f32 v141, v141, v125, v133
  v_fma_f32 v142, v142, v126, v134
  v_mfma_f32_16x16x32_bf16 v[80:83], a[216:219], v[20:23], v[80:83]
  v_fma_f32 v143, v143, v127, v135
  v_cvt_pk_bf16_f32 v240, v136, v137
  v_cvt_pk_bf16_f32 v241, v138, v139
  v_mfma_f32_16x16x32_bf16 v[100:103], a[220:223], v[20:23], v[100:103]
  ds_read_b128 v[20:23], v14 offset:10240
  v_cvt_pk_bf16_f32 v242, v140, v141
  v_cvt_pk_bf16_f32 v243, v142, v143
  v_mfma_f32_16x16x32_bf16 v[44:47], a[208:211], v[24:27], v[44:47]
  buffer_load_dwordx4 a[16:19], v4, s[16:19], s30 offen offset:1024 sc1
  ds_write_b128 v12, v[240:243] offset:1024
  v_mfma_f32_16x16x32_bf16 v[64:67], a[212:215], v[24:27], v[64:67]
  v_lshlrev_b32 v136, 16, v244
  v_and_b32 v137, 0xffff0000, v244
  v_lshlrev_b32 v138, 16, v245
  v_mfma_f32_16x16x32_bf16 v[84:87], a[216:219], v[24:27], v[84:87]
  v_and_b32 v139, 0xffff0000, v245
  v_lshlrev_b32 v140, 16, v246
  v_and_b32 v141, 0xffff0000, v246
  v_mfma_f32_16x16x32_bf16 v[104:107], a[220:223], v[24:27], v[104:107]
  ds_read_b128 v[24:27], v14 offset:11264
  v_lshlrev_b32 v142, 16, v247
  s_waitcnt lgkmcnt(4)
  v_mfma_f32_16x16x32_bf16 v[48:51], a[208:211], v[28:31], v[48:51]
  buffer_load_dwordx4 a[20:23], v4, s[16:19], s31 offen offset:1024 sc1
  v_and_b32 v143, 0xffff0000, v247
  v_mfma_f32_16x16x32_bf16 v[68:71], a[212:215], v[28:31], v[68:71]
  v_fma_f32 v136, v136, v120, v128
  v_fma_f32 v137, v137, v121, v129
  v_fma_f32 v138, v138, v122, v130
  v_mfma_f32_16x16x32_bf16 v[88:91], a[216:219], v[28:31], v[88:91]
  v_fma_f32 v139, v139, v123, v131
  v_fma_f32 v140, v140, v124, v132
  v_fma_f32 v141, v141, v125, v133
  v_mfma_f32_16x16x32_bf16 v[108:111], a[220:223], v[28:31], v[108:111]
  ds_read_b128 v[28:31], v14 offset:12288
  v_fma_f32 v142, v142, v126, v134
  v_fma_f32 v143, v143, v127, v135
  v_mfma_f32_16x16x32_bf16 v[52:55], a[208:211], v[32:35], v[52:55]
  buffer_load_dwordx4 a[24:27], v4, s[16:19], s32 offen offset:1024 sc1
  v_cvt_pk_bf16_f32 v244, v136, v137
  v_mfma_f32_16x16x32_bf16 v[72:75], a[212:215], v[32:35], v[72:75]
  v_cvt_pk_bf16_f32 v245, v138, v139
  v_cvt_pk_bf16_f32 v246, v140, v141
  v_cvt_pk_bf16_f32 v247, v142, v143
  v_mfma_f32_16x16x32_bf16 v[92:95], a[216:219], v[32:35], v[92:95]
  ds_write_b128 v12, v[244:247] offset:2048
  v_lshlrev_b32 v136, 16, v248
  v_and_b32 v137, 0xffff0000, v248
  v_mfma_f32_16x16x32_bf16 v[112:115], a[220:223], v[32:35], v[112:115]
  ds_read_b128 v[32:35], v14 offset:13312
  v_lshlrev_b32 v138, 16, v249
  s_waitcnt lgkmcnt(6)
  v_mfma_f32_16x16x32_bf16 v[56:59], a[208:211], v[36:39], v[56:59]
  buffer_load_dwordx4 a[28:31], v8, s[16:19], s33 offen offset:1024 sc1
  v_and_b32 v139, 0xffff0000, v249
  v_mfma_f32_16x16x32_bf16 v[76:79], a[212:215], v[36:39], v[76:79]
  v_lshlrev_b32 v140, 16, v250
  v_and_b32 v141, 0xffff0000, v250
  v_lshlrev_b32 v142, 16, v251
  v_mfma_f32_16x16x32_bf16 v[96:99], a[216:219], v[36:39], v[96:99]
  v_and_b32 v143, 0xffff0000, v251
  v_fma_f32 v136, v136, v120, v128
  v_fma_f32 v137, v137, v121, v129
  v_mfma_f32_16x16x32_bf16 v[116:119], a[220:223], v[36:39], v[116:119]
  ds_read_b128 v[36:39], v14 offset:14336
  v_fma_f32 v138, v138, v122, v130
  v_fma_f32 v139, v139, v123, v131
  v_fma_f32 v140, v140, v124, v132
  v_fma_f32 v141, v141, v125, v133
  v_fma_f32 v142, v142, v126, v134
  v_fma_f32 v143, v143, v127, v135
  v_cvt_pk_bf16_f32 v248, v136, v137
  v_cvt_pk_bf16_f32 v249, v138, v139
  v_cvt_pk_bf16_f32 v250, v140, v141
  v_cvt_pk_bf16_f32 v251, v142, v143
  ds_write_b128 v12, v[248:251] offset:3072
  v_lshlrev_b32 v136, 16, v252
  v_and_b32 v137, 0xffff0000, v252
  v_lshlrev_b32 v138, 16, v253
  v_and_b32 v139, 0xffff0000, v253
  v_lshlrev_b32 v140, 16, v254
  v_and_b32 v141, 0xffff0000, v254
  v_lshlrev_b32 v142, 16, v255
  v_and_b32 v143, 0xffff0000, v255
  v_fma_f32 v136, v136, v120, v128
  v_fma_f32 v137, v137, v121, v129
  v_fma_f32 v138, v138, v122, v130
  v_fma_f32 v139, v139, v123, v131
  v_fma_f32 v140, v140, v124, v132
  v_fma_f32 v141, v141, v125, v133
  v_fma_f32 v142, v142, v126, v134
  v_fma_f32 v143, v143, v127, v135
  v_cvt_pk_bf16_f32 v252, v136, v137
  v_cvt_pk_bf16_f32 v253, v138, v139
  v_cvt_pk_bf16_f32 v254, v140, v141
  v_cvt_pk_bf16_f32 v255, v142, v143
  ds_write_b128 v12, v[252:255] offset:4096
  buffer_store_dwordx4 v[188:191], v154, s[36:39], s47 offen sc1
  s_add_u32 s47, s47, 18432
  v_mov_b32 v192, v1
  v_mov_b32 v193, v6
  v_mov_b32 v194, v16
  v_add_u32 v15, 110592, v19
  v_lshl_add_u32 v16, v155, 4, v15
  v_lshl_add_u32 v15, v155, 7, v15
  s_add_u32 s42, s27, 4096
  v_add_u32 v195, s96, v4
  ds_read_b64_tr_b16 v[196:197], v15 offset:0
  ds_read_b64_tr_b16 v[198:199], v15 offset:512
  ds_read_b64_tr_b16 v[200:201], v15 offset:32
  ds_read_b64_tr_b16 v[202:203], v15 offset:544
  ds_read_b64_tr_b16 v[204:205], v15 offset:64
  ds_read_b64_tr_b16 v[206:207], v15 offset:576
  ds_read_b64_tr_b16 v[208:209], v15 offset:96
  ds_read_b64_tr_b16 v[210:211], v15 offset:608
  ds_read_b64_tr_b16 v[212:213], v16 offset:4096
  ds_read_b64_tr_b16 v[214:215], v16 offset:4160
  v_cmp_gt_u32 vcc, 8, v3
  s_waitcnt lgkmcnt(8)
  buffer_store_dwordx4 v[196:199], v195, s[8:11], s27 offen offset:0 sc1
  s_waitcnt lgkmcnt(6)
  buffer_store_dwordx4 v[200:203], v195, s[8:11], s27 offen offset:1024 sc1
  s_waitcnt lgkmcnt(4)
  buffer_store_dwordx4 v[204:207], v195, s[8:11], s27 offen offset:2048 sc1
  s_waitcnt lgkmcnt(2)
  buffer_store_dwordx4 v[208:211], v195, s[8:11], s27 offen offset:3072 sc1
  s_waitcnt lgkmcnt(0)
  v_cndmask_b32 v212, 0, v212, vcc
  v_cndmask_b32 v213, 0, v213, vcc
  v_cndmask_b32 v214, 0, v214, vcc
  v_cndmask_b32 v215, 0, v215, vcc
  buffer_store_dwordx4 v[212:215], v195, s[8:11], s42 offen offset:0 sc1
  s_add_u32 s8, s4, 50331648
  s_addc_u32 s9, s5, 0
  s_mov_b32 s10, 27648
  s_mov_b32 s11, 0x20000
  s_mov_b32 s26, 4608
  buffer_load_dwordx4 v[156:159], v192, s[8:11], s26 offen sc1
  s_mov_b32 s26, 18432
  buffer_load_dwordx4 v[160:163], v192, s[8:11], s26 offen sc1
  s_mov_b32 s26, 6912
  buffer_load_dwordx4 v[164:167], v192, s[8:11], s26 offen sc1
  s_mov_b32 s26, 20736
  buffer_load_dwordx4 v[168:171], v192, s[8:11], s26 offen sc1
  s_mov_b32 s26, 9216
  buffer_load_dwordx4 v[172:175], v192, s[8:11], s26 offen sc1
  s_mov_b32 s26, 23040
  buffer_load_dwordx4 v[176:179], v192, s[8:11], s26 offen sc1
  s_mov_b32 s26, 11520
  buffer_load_dwordx4 v[180:183], v192, s[8:11], s26 offen sc1
  s_mov_b32 s26, 25344
  buffer_load_dwordx4 v[184:187], v192, s[8:11], s26 offen sc1
  s_waitcnt vmcnt(28)
  v_mfma_f32_16x16x32_bf16 v[40:43], a[224:227], v[20:23], v[40:43]
  v_mfma_f32_16x16x32_bf16 v[60:63], a[228:231], v[20:23], v[60:63]
  v_mfma_f32_16x16x32_bf16 v[80:83], a[232:235], v[20:23], v[80:83]
  v_mfma_f32_16x16x32_bf16 v[100:103], a[236:239], v[20:23], v[100:103]
  ds_read_b128 v[20:23], v14 offset:15360
  v_mfma_f32_16x16x32_bf16 v[44:47], a[224:227], v[24:27], v[44:47]
  v_mfma_f32_16x16x32_bf16 v[64:67], a[228:231], v[24:27], v[64:67]
  v_mfma_f32_16x16x32_bf16 v[84:87], a[232:235], v[24:27], v[84:87]
  v_mfma_f32_16x16x32_bf16 v[104:107], a[236:239], v[24:27], v[104:107]
  ds_read_b128 v[24:27], v14 offset:16384
  v_mfma_f32_16x16x32_bf16 v[48:51], a[224:227], v[28:31], v[48:51]
  v_mfma_f32_16x16x32_bf16 v[68:71], a[228:231], v[28:31], v[68:71]
  v_mfma_f32_16x16x32_bf16 v[88:91], a[232:235], v[28:31], v[88:91]
  v_mfma_f32_16x16x32_bf16 v[108:111], a[236:239], v[28:31], v[108:111]
  ds_read_b128 v[28:31], v14 offset:17408
  v_mfma_f32_16x16x32_bf16 v[52:55], a[224:227], v[32:35], v[52:55]
  v_mfma_f32_16x16x32_bf16 v[72:75], a[228:231], v[32:35], v[72:75]
  v_mfma_f32_16x16x32_bf16 v[92:95], a[232:235], v[32:35], v[92:95]
  v_mfma_f32_16x16x32_bf16 v[112:115], a[236:239], v[32:35], v[112:115]
  ds_read_b128 v[32:35], v14 offset:18432
  v_mfma_f32_16x16x32_bf16 v[56:59], a[224:227], v[36:39], v[56:59]
  v_mfma_f32_16x16x32_bf16 v[76:79], a[228:231], v[36:39], v[76:79]
  v_mfma_f32_16x16x32_bf16 v[96:99], a[232:235], v[36:39], v[96:99]
  v_mfma_f32_16x16x32_bf16 v[116:119], a[236:239], v[36:39], v[116:119]
  ds_read_b128 v[36:39], v14 offset:19456
  s_waitcnt vmcnt(8)
  s_barrier
  s_lshl_b32 s46, s23, 5
  s_add_u32 s46, s46, s22
  s_cmp_lg_u32 s3, 0
  s_cbranch_scc1 L_sig_2
  s_lshl_b32 s24, s46, 6
  s_add_u32 s24, s24, 131072
  v_mov_b32 v1, 0
  v_mov_b32 v6, s97
  s_mov_b64 exec, 1
  buffer_store_dword v6, v1, s[56:59], s24 offen sc1
  s_mov_b64 exec, -1
L_sig_2:
  s_lshl_b32 s46, s21, 4
  s_add_u32 s46, s46, s20
  s_cmp_lg_u32 s3, 0
  s_cbranch_scc1 L_sig_3
  s_lshl_b32 s24, s46, 6
  s_add_u32 s24, s24, 163840
  v_mov_b32 v1, 0
  v_mov_b32 v6, s97
  s_mov_b64 exec, 1
  buffer_store_dword v6, v1, s[56:59], s24 offen sc1
  s_mov_b64 exec, -1
L_sig_3:
  s_waitcnt lgkmcnt(3)
  v_mfma_f32_16x16x32_bf16 v[40:43], a[240:243], v[20:23], v[40:43]
  v_mfma_f32_16x16x32_bf16 v[60:63], a[244:247], v[20:23], v[60:63]
  v_mfma_f32_16x16x32_bf16 v[80:83], a[248:251], v[20:23], v[80:83]
  v_mfma_f32_16x16x32_bf16 v[100:103], a[252:255], v[20:23], v[100:103]
  ds_read_b128 v[20:23], v14 offset:20480
  v_mfma_f32_16x16x32_bf16 v[44:47], a[240:243], v[24:27], v[44:47]
  v_mfma_f32_16x16x32_bf16 v[64:67], a[244:247], v[24:27], v[64:67]
  v_mfma_f32_16x16x32_bf16 v[84:87], a[248:251], v[24:27], v[84:87]
  v_mfma_f32_16x16x32_bf16 v[104:107], a[252:255], v[24:27], v[104:107]
  ds_read_b128 v[24:27], v14 offset:21504
  s_waitcnt lgkmcnt(3)
  v_mfma_f32_16x16x32_bf16 v[48:51], a[240:243], v[28:31], v[48:51]
  v_mfma_f32_16x16x32_bf16 v[68:71], a[244:247], v[28:31], v[68:71]
  v_mfma_f32_16x16x32_bf16 v[88:91], a[248:251], v[28:31], v[88:91]
  v_mfma_f32_16x16x32_bf16 v[108:111], a[252:255], v[28:31], v[108:111]
  ds_read_b128 v[28:31], v14 offset:22528
  v_mfma_f32_16x16x32_bf16 v[52:55], a[240:243], v[32:35], v[52:55]
  v_mfma_f32_16x16x32_bf16 v[72:75], a[244:247], v[32:35], v[72:75]
  v_mfma_f32_16x16x32_bf16 v[92:95], a[248:251], v[32:35], v[92:95]
  v_mfma_f32_16x16x32_bf16 v[112:115], a[252:255], v[32:35], v[112:115]
  ds_read_b128 v[32:35], v14 offset:23552
  s_waitcnt lgkmcnt(4)
  v_mfma_f32_16x16x32_bf16 v[56:59], a[240:243], v[36:39], v[56:59]
  v_mfma_f32_16x16x32_bf16 v[76:79], a[244:247], v[36:39], v[76:79]
  v_mfma_f32_16x16x32_bf16 v[96:99], a[248:251], v[36:39], v[96:99]
  v_mfma_f32_16x16x32_bf16 v[116:119], a[252:255], v[36:39], v[116:119]
  ds_read_b128 v[36:39], v14 offset:24576
  s_lshl_b32 s33, s23, 11
  s_lshl_b32 s24, s21, 10
  s_add_u32 s24, s24, 32768
  v_and_b32 v12, 31, v2
  v_lshl_add_u32 v12, v12, 6, s33
  v_lshl_add_u32 v13, v3, 6, s24
  v_cmp_gt_u32 vcc, 32, v2
  s_nop 1
  v_cndmask_b32 v12, v13, v12, vcc
  s_mov_b32 s33, 131072
  s_waitcnt lgkmcnt(3)
  v_mfma_f32_16x16x32_bf16 v[40:43], a[0:3], v[20:23], v[40:43]
  s_waitcnt vmcnt(0)
  s_nop 0
  v_pk_add_f32 v[156:157], v[156:157], v[160:161]
  v_mfma_f32_16x16x32_bf16 v[60:63], a[4:7], v[20:23], v[60:63]
  v_cvt_pk_bf16_f32 v195, v156, v157
  v_lshlrev_b32 v156, 16, v195
  v_and_b32 v157, 0xffff0000, v195
  v_mfma_f32_16x16x32_bf16 v[80:83], a[8:11], v[20:23], v[80:83]
  v_pk_add_f32 v[158:159], v[158:159], v[162:163]
  v_cvt_pk_bf16_f32 v195, v158, v159
  v_lshlrev_b32 v158, 16, v195
  v_mfma_f32_16x16x32_bf16 v[100:103], a[12:15], v[20:23], v[100:103]
  ds_read_b128 v[20:23], v14 offset:25600
  v_and_b32 v159, 0xffff0000, v195
  v_pk_add_f32 v[164:165], v[164:165], v[168:169]
  v_mfma_f32_16x16x32_bf16 v[44:47], a[0:3], v[24:27], v[44:47]
  v_cvt_pk_bf16_f32 v195, v164, v165
  v_lshlrev_b32 v164, 16, v195
  v_and_b32 v165, 0xffff0000, v195
  v_mfma_f32_16x16x32_bf16 v[64:67], a[4:7], v[24:27], v[64:67]
  v_pk_add_f32 v[166:167], v[166:167], v[170:171]
  v_cvt_pk_bf16_f32 v195, v166, v167
  v_lshlrev_b32 v166, 16, v195
  v_mfma_f32_16x16x32_bf16 v[84:87], a[8:11], v[24:27], v[84:87]
  v_and_b32 v167, 0xffff0000, v195
  v_pk_add_f32 v[172:173], v[172:173], v[176:177]
  v_cvt_pk_bf16_f32 v195, v172, v173
  v_mfma_f32_16x16x32_bf16 v[104:107], a[12:15], v[24:27], v[104:107]
  ds_read_b128 v[24:27], v14 offset:26624
  v_lshlrev_b32 v172, 16, v195
  s_waitcnt lgkmcnt(3)
  v_mfma_f32_16x16x32_bf16 v[48:51], a[0:3], v[28:31], v[48:51]
  v_and_b32 v173, 0xffff0000, v195
  v_add_f32 v172, 1.0, v172
  v_add_f32 v173, 1.0, v173
  v_mfma_f32_16x16x32_bf16 v[68:71], a[4:7], v[28:31], v[68:71]
  v_cvt_pk_bf16_f32 v195, v172, v173
  v_lshlrev_b32 v172, 16, v195
  v_and_b32 v173, 0xffff0000, v195
  v_mfma_f32_16x16x32_bf16 v[88:91], a[8:11], v[28:31], v[88:91]
  v_pk_add_f32 v[174:175], v[174:175], v[178:179]
  v_cvt_pk_bf16_f32 v195, v174, v175
  v_lshlrev_b32 v174, 16, v195
  v_mfma_f32_16x16x32_bf16 v[108:111], a[12:15], v[28:31], v[108:111]
  ds_read_b128 v[28:31], v14 offset:27648
  v_and_b32 v175, 0xffff0000, v195
  v_add_f32 v174, 1.0, v174
  v_mfma_f32_16x16x32_bf16 v[52:55], a[0:3], v[32:35], v[52:55]
  v_add_f32 v175, 1.0, v175
  v_cvt_pk_bf16_f32 v195, v174, v175
  v_lshlrev_b32 v174, 16, v195
  v_mfma_f32_16x16x32_bf16 v[72:75], a[4:7], v[32:35], v[72:75]
  v_and_b32 v175, 0xffff0000, v195
  v_pk_add_f32 v[180:181], v[180:181], v[184:185]
  v_cvt_pk_bf16_f32 v195, v180, v181
  v_mfma_f32_16x16x32_bf16 v[92:95], a[8:11], v[32:35], v[92:95]
  v_lshlrev_b32 v180, 16, v195
  v_and_b32 v181, 0xffff0000, v195
  v_pk_add_f32 v[182:183], v[182:183], v[186:187]
  v_mfma_f32_16x16x32_bf16 v[112:115], a[12:15], v[32:35], v[112:115]
  ds_read_b128 v[32:35], v14 offset:28672
  v_cvt_pk_bf16_f32 v195, v182, v183
  s_waitcnt lgkmcnt(4)
  v_mfma_f32_16x16x32_bf16 v[56:59], a[0:3], v[36:39], v[56:59]
  v_lshlrev_b32 v182, 16, v195
  v_and_b32 v183, 0xffff0000, v195
  v_cvt_pk_bf16_f32 v188, v172, v173
  v_mfma_f32_16x16x32_bf16 v[76:79], a[4:7], v[36:39], v[76:79]
  v_cvt_pk_bf16_f32 v189, v174, v175
  v_cvt_pk_bf16_f32 v190, v164, v165
  v_cvt_pk_bf16_f32 v191, v166, v167
  v_mfma_f32_16x16x32_bf16 v[96:99], a[8:11], v[36:39], v[96:99]
  v_cmp_gt_u32 vcc, 144, v0
  s_nop 0
  s_and_saveexec_b64 s[100:101], vcc
  ds_write_b128 v194, v[156:159]
  ds_write_b128 v194, v[172:175] offset:2304
  ds_write_b128 v194, v[180:183] offset:7168
  ds_write_b64 v193, v[188:189]
  ds_write_b64 v193, v[190:191] offset:1280
  s_mov_b64 exec, s[100:101]
  v_mfma_f32_16x16x32_bf16 v[116:119], a[12:15], v[36:39], v[116:119]
  ds_read_b128 v[36:39], v14 offset:29696
  v_add_u32 v6, 2, v2
  s_waitcnt lgkmcnt(8)
  v_mfma_f32_16x16x32_bf16 v[40:43], a[16:19], v[20:23], v[40:43]
  v_mul_u32_u24 v6, 720, v6
  s_mul_i32 s26, s3, 48
  v_add_u32 v7, s26, v6
  v_mfma_f32_16x16x32_bf16 v[60:63], a[20:23], v[20:23], v[60:63]
  s_mul_i32 s26, s3, 80
  s_add_u32 s26, s26, 384
  v_add_u32 v9, s26, v6
  v_mfma_f32_16x16x32_bf16 v[80:83], a[24:27], v[20:23], v[80:83]
  s_lshl_b32 s26, s22, 6
  s_lshl_b32 s27, s3, 4
  s_add_u32 s26, s26, s27
  v_mfma_f32_16x16x32_bf16 v[100:103], a[28:31], v[20:23], v[100:103]
  v_add_u32 v255, s26, v3
  s_movk_i32 s27, 1152
  v_lshlrev_b32 v253, 3, v5
  v_mfma_f32_16x16x32_bf16 v[44:47], a[16:19], v[24:27], v[44:47]
  v_mad_u32_u24 v253, v255, s27, v253
  v_lshlrev_b32 v254, 30, v5
  v_and_b32 v254, 0x80000000, v254
  v_mfma_f32_16x16x32_bf16 v[64:67], a[20:23], v[24:27], v[64:67]
  v_add_u32 v254, v254, v253
  s_mul_i32 s45, s23, 144
  s_lshl_b32 s40, s3, 13
  v_mfma_f32_16x16x32_bf16 v[84:87], a[24:27], v[24:27], v[84:87]
  s_add_u32 s40, s40, 59392
  s_mul_i32 s41, s23, 92160
  s_add_u32 s41, s41, s40
  v_mfma_f32_16x16x32_bf16 v[104:107], a[28:31], v[24:27], v[104:107]
  s_add_u32 s12, s4, 4898816
  s_addc_u32 s13, s5, 0
  s_waitcnt lgkmcnt(6)
  v_mfma_f32_16x16x32_bf16 v[48:51], a[16:19], v[28:31], v[48:51]
  s_mov_b32 s14, 737280
  s_mov_b32 s15, 0x20000
  v_mfma_f32_16x16x32_bf16 v[68:71], a[20:23], v[28:31], v[68:71]
  s_add_u32 s8, s4, 5636096
  s_addc_u32 s9, s5, 0
  s_mov_b32 s10, 5308416
  v_mfma_f32_16x16x32_bf16 v[88:91], a[24:27], v[28:31], v[88:91]
  s_mov_b32 s11, 0x20000
  s_add_u32 s36, s4, 13893632
  s_addc_u32 s37, s5, 0
  v_mfma_f32_16x16x32_bf16 v[108:111], a[28:31], v[28:31], v[108:111]
  s_mov_b32 s38, 2359296
  s_mov_b32 s39, 0x20000
  s_and_b32 s54, s2, 7
  v_mfma_f32_16x16x32_bf16 v[52:55], a[16:19], v[32:35], v[52:55]
  s_lshl_b32 s54, s54, 5
  s_lshr_b32 s42, s2, 3
  s_add_u32 s54, s54, s42
  v_mfma_f32_16x16x32_bf16 v[72:75], a[20:23], v[32:35], v[72:75]
  s_lshl_b32 s42, s3, 8
  s_add_u32 s54, s54, s42
  v_mfma_f32_16x16x32_bf16 v[92:95], a[24:27], v[32:35], v[92:95]
  s_cmp_lt_u32 s54, 576
  s_cselect_b32 s55, 0, 0x80000000
  s_cselect_b32 s54, s54, 0
  s_and_b32 s42, s54, 7
  v_mfma_f32_16x16x32_bf16 v[112:115], a[28:31], v[32:35], v[112:115]
  s_lshr_b32 s54, s54, 3
  s_mul_i32 s29, s54, 57
  s_waitcnt lgkmcnt(0)
  v_mfma_f32_16x16x32_bf16 v[56:59], a[16:19], v[36:39], v[56:59]
  s_lshr_b32 s29, s29, 9
  s_mul_i32 s24, s29, 9
  s_sub_u32 s24, s54, s24
  v_mfma_f32_16x16x32_bf16 v[76:79], a[20:23], v[36:39], v[76:79]
  s_lshl_b32 s26, s29, 8
  s_lshl_b32 s27, s24, 5
  s_add_u32 s26, s26, s27
  v_mfma_f32_16x16x32_bf16 v[96:99], a[24:27], v[36:39], v[96:99]
  s_lshl_b32 s29, s29, 5
  s_add_u32 s29, s29, 2048
  v_mfma_f32_16x16x32_bf16 v[116:119], a[28:31], v[36:39], v[116:119]
  s_cmp_lt_u32 s24, 8
  s_cselect_b32 s29, s26, s29
  s_mov_b32 s24, 16
  s_mul_i32 s29, s29, 1152
  s_mul_i32 s26, s42, 144
  s_add_u32 s29, s29, s26
  s_mul_i32 s43, s42, 72
  s_add_u32 s43, s43, s54
  s_mul_i32 s43, s43, 5120
  s_mul_i32 s54, s3, 4608
  s_add_u32 s54, s54, 110592
  v_lshrrev_b32 v15, 5, v2
  v_mul_u32_u24 v15, s24, v15
  v_bfe_u32 v126, v2, 3, 2
  v_add_u32 v15, v15, v126
  v_mul_u32_u24 v15, 1152, v15
  v_and_b32 v127, 7, v2
  v_lshl_add_u32 v15, v127, 4, v15
  v_add_u32 v15, s55, v15
  v_bfe_u32 v16, v2, 2, 1
  v_mul_u32_u24 v16, s24, v16
  v_lshl_add_u32 v16, v126, 2, v16
  v_and_b32 v127, 3, v2
  v_add_u32 v16, v16, v127
  v_mul_u32_u24 v16, 1152, v16
  v_add_u32 v16, 128, v16
  v_add_u32 v16, s55, v16
  s_nop 0
  s_mov_b32 s16, s48
  s_mov_b32 s17, s49
  s_mov_b32 s18, 2654208
  s_mov_b32 s19, 0x20000
  s_mul_i32 s48, s21, 331776
  s_mul_i32 s26, s3, 36864
  s_add_u32 s48, s48, s26
  s_add_u32 s49, s48, 18432
  s_add_u32 s46, s48, 165888
  s_add_u32 s47, s48, 184320
  s_barrier
  ds_write_b64 v144, v[40:41] offset:0
  ds_write_b64 v145, v[42:43] offset:0
  ds_write_b64 v150, v[100:101] offset:0
  ds_write_b64 v151, v[102:103] offset:0
  v_cvt_pk_bf16_f32 v122, v60, v61
  v_cvt_pk_bf16_f32 v123, v62, v63
  ds_write_b32 v146, v122 offset:0
  ds_write_b32 v147, v123 offset:0
  v_cvt_pk_bf16_f32 v124, v80, v81
  v_cvt_pk_bf16_f32 v125, v82, v83
  buffer_load_dword v13, v12, s[56:59], s33 offen sc1
  ds_write_b32 v148, v124 offset:0
  ds_write_b32 v149, v125 offset:0
  v_cvt_pk_bf16_f32 v126, v100, v101
  v_cvt_pk_bf16_f32 v127, v102, v103
  s_add_u32 m0, s54, 4096
  s_mov_b32 exec_hi, 0
  buffer_load_dwordx4 v16, s[16:19], s29 offen nt lds
  s_mov_b32 exec_hi, -1
  ds_write_b32 v152, v126 offset:0
  ds_write_b32 v153, v127 offset:0
  ds_write_b64 v144, v[44:45] offset:11520
  ds_write_b64 v145, v[46:47] offset:11520
  s_add_u32 m0, s54, 0
  s_nop 0
  buffer_load_dwordx4 v15, s[16:19], s29 offen nt lds
  s_add_u32 s29, s29, 4608
  ds_write_b64 v150, v[104:105] offset:11520
  ds_write_b64 v151, v[106:107] offset:11520
  v_cvt_pk_bf16_f32 v122, v64, v65
  v_cvt_pk_bf16_f32 v123, v66, v67
  s_add_u32 m0, s54, 1024
  s_nop 0
  buffer_load_dwordx4 v15, s[16:19], s29 offen nt lds
  s_add_u32 s29, s29, 4608
  ds_write_b32 v146, v122 offset:11520
  ds_write_b32 v147, v123 offset:11520
  v_cvt_pk_bf16_f32 v124, v84, v85
  v_cvt_pk_bf16_f32 v125, v86, v87
  s_add_u32 m0, s54, 2048
  s_nop 0
  buffer_load_dwordx4 v15, s[16:19], s29 offen nt lds
  s_add_u32 s29, s29, 4608
  ds_write_b32 v148, v124 offset:11520
  ds_write_b32 v149, v125 offset:11520
  v_cvt_pk_bf16_f32 v126, v104, v105
  v_cvt_pk_bf16_f32 v127, v106, v107
  s_add_u32 m0, s54, 3072
  s_nop 0
  buffer_load_dwordx4 v15, s[16:19], s29 offen nt lds
  s_add_u32 s29, s29, 4608
  ds_write_b32 v152, v126 offset:11520
  ds_write_b32 v153, v127 offset:11520
  ds_write_b64 v144, v[48:49] offset:23040
  ds_write_b64 v145, v[50:51] offset:23040
  ds_write_b64 v150, v[108:109] offset:23040
  ds_write_b64 v151, v[110:111] offset:23040
  v_cvt_pk_bf16_f32 v122, v68, v69
  v_cvt_pk_bf16_f32 v123, v70, v71
  ds_write_b32 v146, v122 offset:23040
  ds_write_b32 v147, v123 offset:23040
  v_cvt_pk_bf16_f32 v124, v88, v89
  v_cvt_pk_bf16_f32 v125, v90, v91
  ds_write_b32 v148, v124 offset:23040
  ds_write_b32 v149, v125 offset:23040
  v_cvt_pk_bf16_f32 v126, v108, v109
  v_cvt_pk_bf16_f32 v127, v110, v111
  ds_write_b32 v152, v126 offset:23040
  ds_write_b32 v153, v127 offset:23040
  ds_write_b64 v144, v[52:53] offset:34560
  ds_write_b64 v145, v[54:55] offset:34560
  ds_write_b64 v150, v[112:113] offset:34560
  ds_write_b64 v151, v[114:115] offset:34560
  v_cvt_pk_bf16_f32 v122, v72, v73
  v_cvt_pk_bf16_f32 v123, v74, v75
  ds_write_b32 v146, v122 offset:34560
  ds_write_b32 v147, v123 offset:34560
  v_cvt_pk_bf16_f32 v124, v92, v93
  v_cvt_pk_bf16_f32 v125, v94, v95
  ds_write_b32 v148, v124 offset:34560
  ds_write_b32 v149, v125 offset:34560
  v_cvt_pk_bf16_f32 v126, v112, v113
  v_cvt_pk_bf16_f32 v127, v114, v115
  ds_write_b32 v152, v126 offset:34560
  ds_write_b32 v153, v127 offset:34560
  ds_write_b64 v144, v[56:57] offset:46080
  ds_write_b64 v145, v[58:59] offset:46080
  ds_write_b64 v150, v[116:117] offset:46080
  ds_write_b64 v151, v[118:119] offset:46080
  v_cvt_pk_bf16_f32 v122, v76, v77
  v_cvt_pk_bf16_f32 v123, v78, v79
  ds_write_b32 v146, v122 offset:46080
  ds_write_b32 v147, v123 offset:46080
  v_cvt_pk_bf16_f32 v124, v96, v97
  v_cvt_pk_bf16_f32 v125, v98, v99
  ds_write_b32 v148, v124 offset:46080
  ds_write_b32 v149, v125 offset:46080
  v_cvt_pk_bf16_f32 v126, v116, v117
  v_cvt_pk_bf16_f32 v127, v118, v119
  ds_write_b32 v152, v126 offset:46080
  ds_write_b32 v153, v127 offset:46080
  s_waitcnt vmcnt(5)
L_m_wchk:
  v_cmp_ne_u32 vcc, s97, v13
  s_nop 0
  s_cbranch_vccz L_m_wok
  buffer_load_dword v13, v12, s[56:59], s33 offen sc1
  s_waitcnt vmcnt(0)
  s_branch L_m_wchk
L_m_wok:
  s_waitcnt lgkmcnt(0)
  s_barrier
  ds_read_b128 v[232:235], v7 offset:10272
  ds_read_b128 v[236:239], v7 offset:10288
  ds_read_b32 v240, v7 offset:10304
  ds_read_b128 v[20:23], v7 offset:10080
  ds_read_b128 v[24:27], v7 offset:10096
  ds_read_b32 v28, v7 offset:10112
  ds_read_b128 v[30:33], v7 offset:8640
  ds_read_b128 v[34:37], v7 offset:8656
  ds_read_b32 v38, v7 offset:8672
  ds_read_b128 v[40:43], v7 offset:7200
  s_add_u32 m0, s40, 0
  s_nop 0
  buffer_load_dwordx4 v4, s[12:15], s41 offen offset:0 sc1 lds
  ds_read_b128 v[44:47], v7 offset:7216
  ds_read_b32 v48, v7 offset:7232
  ds_read_b128 v[50:53], v7 offset:5760
  ds_read_b128 v[54:57], v7 offset:5776
  ds_read_b32 v58, v7 offset:5792
  ds_read_b128 v[60:63], v7 offset:4320
  ds_read_b128 v[64:67], v7 offset:4336
  ds_read_b32 v68, v7 offset:4352
  ds_read_b128 v[70:73], v7 offset:2880
  ds_read_b128 v[74:77], v7 offset:2896
  buffer_load_dwordx4 v4, s[12:15], s41 offen offset:1024 sc1 lds
  ds_read_b32 v78, v7 offset:2912
  ds_read_b128 v[80:83], v7 offset:1440
  ds_read_b128 v[84:87], v7 offset:1456
  ds_read_b32 v88, v7 offset:1472
  ds_read_b128 v[90:93], v7 offset:0
  ds_read_b128 v[94:97], v7 offset:16
  ds_read_b32 v98, v7 offset:32
  s_waitcnt lgkmcnt(12)
  v_dot2_f32_bf16 v244, v232, v20, 0
  v_dot2_f32_bf16 v245, v232, v30, 0
  v_dot2_f32_bf16 v246, v232, v40, 0
  buffer_load_dwordx4 v4, s[12:15], s41 offen offset:2048 sc1 lds
  v_dot2_f32_bf16 v247, v232, v50, 0
  ds_read_b128 v[100:103], v9 offset:10080
  ds_read_b128 v[104:107], v9 offset:10096
  ds_read_b128 v[108:111], v9 offset:10112
  ds_read_b128 v[112:115], v9 offset:10128
  ds_read_b64 v[116:117], v9 offset:10144
  v_dot2_f32_bf16 v244, v233, v21, v244
  v_dot2_f32_bf16 v245, v233, v31, v245
  v_dot2_f32_bf16 v246, v233, v41, v246
  v_dot2_f32_bf16 v247, v233, v51, v247
  buffer_load_dwordx4 v4, s[12:15], s41 offen offset:3072 sc1 lds
  v_dot2_f32_bf16 v244, v234, v22, v244
  v_dot2_f32_bf16 v245, v234, v32, v245
  v_dot2_f32_bf16 v246, v234, v42, v246
  v_dot2_f32_bf16 v247, v234, v52, v247
  ds_read_b128 v[118:121], v9 offset:8640
  ds_read_b128 v[122:125], v9 offset:8656
  ds_read_b128 v[126:129], v9 offset:8672
  ds_read_b128 v[130:133], v9 offset:8688
  ds_read_b64 v[134:135], v9 offset:8704
  v_dot2_f32_bf16 v244, v235, v23, v244
  s_add_u32 m0, s40, 4096
  s_add_u32 s41, s41, 4096
  buffer_load_dwordx4 v4, s[12:15], s41 offen offset:0 sc1 lds
  v_dot2_f32_bf16 v245, v235, v33, v245
  v_dot2_f32_bf16 v246, v235, v43, v246
  v_dot2_f32_bf16 v247, v235, v53, v247
  v_dot2_f32_bf16 v244, v236, v24, v244
  v_dot2_f32_bf16 v245, v236, v34, v245
  v_dot2_f32_bf16 v246, v236, v44, v246
  v_dot2_f32_bf16 v247, v236, v54, v247
  ds_read_b128 v[136:139], v9 offset:7200
  ds_read_b128 v[140:143], v9 offset:7216
  ds_read_b128 v[144:147], v9 offset:7232
  buffer_load_dwordx4 v4, s[12:15], s41 offen offset:1024 sc1 lds
  ds_read_b128 v[148:151], v9 offset:7248
  ds_read_b64 v[152:153], v9 offset:7264
  v_dot2_f32_bf16 v244, v237, v25, v244
  v_dot2_f32_bf16 v245, v237, v35, v245
  v_dot2_f32_bf16 v246, v237, v45, v246
  v_dot2_f32_bf16 v247, v237, v55, v247
  v_dot2_f32_bf16 v244, v238, v26, v244
  v_dot2_f32_bf16 v245, v238, v36, v245
  v_dot2_f32_bf16 v246, v238, v46, v246
  v_dot2_f32_bf16 v247, v238, v56, v247
  buffer_load_dwordx4 v4, s[12:15], s41 offen offset:2048 sc1 lds
  ds_read_b128 v[154:157], v9 offset:5760
  ds_read_b128 v[158:161], v9 offset:5776
  ds_read_b128 v[162:165], v9 offset:5792
  ds_read_b128 v[166:169], v9 offset:5808
  ds_read_b64 v[170:171], v9 offset:5824
  v_dot2_f32_bf16 v244, v239, v27, v244
  v_dot2_f32_bf16 v245, v239, v37, v245
  v_dot2_f32_bf16 v246, v239, v47, v246
  v_dot2_f32_bf16 v247, v239, v57, v247
  v_dot2_f32_bf16 v244, v240, v28, v244
  buffer_load_dwordx4 v4, s[12:15], s41 offen offset:3072 sc1 lds
  v_dot2_f32_bf16 v245, v240, v38, v245
  v_dot2_f32_bf16 v246, v240, v48, v246
  v_dot2_f32_bf16 v247, v240, v58, v247
  s_waitcnt lgkmcnt(15)
  v_dot2_f32_bf16 v248, v232, v60, 0
  v_dot2_f32_bf16 v249, v232, v70, 0
  v_dot2_f32_bf16 v250, v232, v80, 0
  v_dot2_f32_bf16 v251, v232, v90, 0
  ds_read_b128 v[172:175], v9 offset:4320
  ds_read_b128 v[176:179], v9 offset:4336
  ds_read_b128 v[180:183], v9 offset:4352
  ds_read_b128 v[184:187], v9 offset:4368
  ds_read_b64 v[188:189], v9 offset:4384
  buffer_load_dwordx4 a[144:147], v4, s[8:11], s46 offen offset:0 sc1
  v_dot2_f32_bf16 v248, v233, v61, v248
  v_dot2_f32_bf16 v249, v233, v71, v249
  v_dot2_f32_bf16 v250, v233, v81, v250
  v_dot2_f32_bf16 v251, v233, v91, v251
  v_dot2_f32_bf16 v248, v234, v62, v248
  v_dot2_f32_bf16 v249, v234, v72, v249
  v_dot2_f32_bf16 v250, v234, v82, v250
  v_dot2_f32_bf16 v251, v234, v92, v251
  ds_read_b128 v[190:193], v9 offset:2880
  ds_read_b128 v[194:197], v9 offset:2896
  ds_read_b128 v[198:201], v9 offset:2912
  buffer_load_dwordx4 a[148:151], v4, s[8:11], s47 offen offset:0 sc1
  ds_read_b128 v[202:205], v9 offset:2928
  ds_read_b64 v[206:207], v9 offset:2944
  v_dot2_f32_bf16 v248, v235, v63, v248
  v_dot2_f32_bf16 v249, v235, v73, v249
  v_dot2_f32_bf16 v250, v235, v83, v250
  v_dot2_f32_bf16 v251, v235, v93, v251
  v_dot2_f32_bf16 v248, v236, v64, v248
  v_dot2_f32_bf16 v249, v236, v74, v249
  v_dot2_f32_bf16 v250, v236, v84, v250
  v_dot2_f32_bf16 v251, v236, v94, v251
  ds_read_b128 v[208:211], v9 offset:1440
  ds_read_b128 v[212:215], v9 offset:1456
  buffer_load_dwordx4 a[152:155], v4, s[8:11], s46 offen offset:1024 sc1
  ds_read_b128 v[216:219], v9 offset:1472
  ds_read_b128 v[220:223], v9 offset:1488
  ds_read_b64 v[224:225], v9 offset:1504
  v_dot2_f32_bf16 v248, v237, v65, v248
  v_dot2_f32_bf16 v249, v237, v75, v249
  v_dot2_f32_bf16 v250, v237, v85, v250
  v_dot2_f32_bf16 v251, v237, v95, v251
  v_dot2_f32_bf16 v248, v238, v66, v248
  v_dot2_f32_bf16 v249, v238, v76, v249
  v_dot2_f32_bf16 v250, v238, v86, v250
  v_dot2_f32_bf16 v251, v238, v96, v251
  buffer_load_dwordx4 a[156:159], v4, s[8:11], s47 offen offset:1024 sc1
  v_dot2_f32_bf16 v248, v239, v67, v248
  v_dot2_f32_bf16 v249, v239, v77, v249
  v_dot2_f32_bf16 v250, v239, v87, v250
  v_dot2_f32_bf16 v251, v239, v97, v251
  v_dot2_f32_bf16 v248, v240, v68, v248
  v_dot2_f32_bf16 v249, v240, v78, v249
  v_dot2_f32_bf16 v250, v240, v88, v250
  v_dot2_f32_bf16 v251, v240, v98, v251
  ds_read_b128 v[60:63], v9 offset:0
  ds_read_b128 v[64:67], v9 offset:16
  ds_read_b128 v[68:71], v9 offset:32
  ds_read_b128 v[72:75], v9 offset:48
  buffer_load_dwordx4 a[160:163], v4, s[8:11], s46 offen offset:2048 sc1
  ds_read_b64 v[76:77], v9 offset:64
  s_mov_b32 s26, 0x3eae1a93
  v_mul_f32 v244, s26, v244
  v_mul_f32 v245, s26, v245
  v_mul_f32 v246, s26, v246
  v_mul_f32 v247, s26, v247
  v_mul_f32 v248, s26, v248
  v_mul_f32 v249, s26, v249
  v_mul_f32 v250, s26, v250
  v_mul_f32 v251, s26, v251
  s_cmp_lg_u32 s22, 0
  s_cbranch_scc1 L_m_nomask
  v_mov_b32 v20, 0xf149f2ca
  v_cmp_gt_u32 vcc, 2, v2
  s_nop 1
  v_cndmask_b32 v245, v245, v20, vcc
  v_cmp_gt_u32 vcc, 4, v2
  s_nop 1
  v_cndmask_b32 v246, v246, v20, vcc
  v_cmp_gt_u32 vcc, 6, v2
  s_nop 1
  v_cndmask_b32 v247, v247, v20, vcc
  v_cmp_gt_u32 vcc, 8, v2
  s_nop 1
  v_cndmask_b32 v248, v248, v20, vcc
  v_cmp_gt_u32 vcc, 10, v2
  s_nop 1
  v_cndmask_b32 v249, v249, v20, vcc
  v_cmp_gt_u32 vcc, 12, v2
  s_nop 1
  v_cndmask_b32 v250, v250, v20, vcc
  v_cmp_gt_u32 vcc, 14, v2
  s_nop 1
  v_cndmask_b32 v251, v251, v20, vcc
  s_nop 1
L_m_nomask:
  v_max3_f32 v20, v244, v245, v246
  v_max3_f32 v21, v247, v248, v249
  buffer_load_dwordx4 a[164:167], v4, s[8:11], s47 offen offset:2048 sc1
  v_max3_f32 v20, v20, v250, v251
  v_max_f32 v20, v20, v21
  v_sub_f32 v244, v244, v20
  v_sub_f32 v245, v245, v20
  v_sub_f32 v246, v246, v20
  v_sub_f32 v247, v247, v20
  v_sub_f32 v248, v248, v20
  v_sub_f32 v249, v249, v20
  v_sub_f32 v250, v250, v20
  v_sub_f32 v251, v251, v20
  v_exp_f32 v244, v244
  v_exp_f32 v245, v245
  buffer_load_dwordx4 a[168:171], v4, s[8:11], s46 offen offset:3072 sc1
  s_add_u32 s46, s46, 4096
  v_exp_f32 v246, v246
  v_exp_f32 v247, v247
  v_exp_f32 v248, v248
  v_exp_f32 v249, v249
  v_exp_f32 v250, v250
  v_exp_f32 v251, v251
  v_pk_add_f32 v[20:21], v[244:245], v[246:247]
  v_pk_add_f32 v[22:23], v[248:249], v[250:251]
  v_pk_add_f32 v[20:21], v[20:21], v[22:23]
  v_add_f32 v20, v20, v21
  v_rcp_f32 v20, v20
  buffer_load_dwordx4 a[172:175], v4, s[8:11], s47 offen offset:3072 sc1
  s_add_u32 s47, s47, 4096
  v_pk_mul_f32 v[30:31], v[244:245], v[100:101] op_sel:[0,0] op_sel_hi:[0,1]
  v_pk_mul_f32 v[32:33], v[244:245], v[102:103] op_sel:[0,0] op_sel_hi:[0,1]
  v_pk_mul_f32 v[34:35], v[244:245], v[104:105] op_sel:[0,0] op_sel_hi:[0,1]
  v_pk_mul_f32 v[36:37], v[244:245], v[106:107] op_sel:[0,0] op_sel_hi:[0,1]
  v_pk_mul_f32 v[38:39], v[244:245], v[108:109] op_sel:[0,0] op_sel_hi:[0,1]
  v_pk_mul_f32 v[40:41], v[244:245], v[110:111] op_sel:[0,0] op_sel_hi:[0,1]
  v_pk_mul_f32 v[42:43], v[244:245], v[112:113] op_sel:[0,0] op_sel_hi:[0,1]
  v_pk_mul_f32 v[44:45], v[244:245], v[114:115] op_sel:[0,0] op_sel_hi:[0,1]
  v_pk_mul_f32 v[46:47], v[244:245], v[116:117] op_sel:[0,0] op_sel_hi:[0,1]
  s_waitcnt lgkmcnt(15)
  v_pk_fma_f32 v[30:31], v[244:245], v[118:119], v[30:31] op_sel:[1,0,0] op_sel_hi:[1,1,1]
  v_pk_fma_f32 v[32:33], v[244:245], v[120:121], v[32:33] op_sel:[1,0,0] op_sel_hi:[1,1,1]
  v_pk_fma_f32 v[34:35], v[244:245], v[122:123], v[34:35] op_sel:[1,0,0] op_sel_hi:[1,1,1]
  buffer_load_dwordx4 a[176:179], v4, s[8:11], s46 offen offset:0 sc1
  v_pk_fma_f32 v[36:37], v[244:245], v[124:125], v[36:37] op_sel:[1,0,0] op_sel_hi:[1,1,1]
  v_pk_fma_f32 v[38:39], v[244:245], v[126:127], v[38:39] op_sel:[1,0,0] op_sel_hi:[1,1,1]
  v_pk_fma_f32 v[40:41], v[244:245], v[128:129], v[40:41] op_sel:[1,0,0] op_sel_hi:[1,1,1]
  v_pk_fma_f32 v[42:43], v[244:245], v[130:131], v[42:43] op_sel:[1,0,0] op_sel_hi:[1,1,1]
  v_pk_fma_f32 v[44:45], v[244:245], v[132:133], v[44:45] op_sel:[1,0,0] op_sel_hi:[1,1,1]
  v_pk_fma_f32 v[46:47], v[244:245], v[134:135], v[46:47] op_sel:[1,0,0] op_sel_hi:[1,1,1]
  v_pk_fma_f32 v[30:31], v[246:247], v[136:137], v[30:31] op_sel:[0,0,0] op_sel_hi:[0,1,1]
  v_pk_fma_f32 v[32:33], v[246:247], v[138:139], v[32:33] op_sel:[0,0,0] op_sel_hi:[0,1,1]
  v_pk_fma_f32 v[34:35], v[246:247], v[140:141], v[34:35] op_sel:[0,0,0] op_sel_hi:[0,1,1]
  v_pk_fma_f32 v[36:37], v[246:247], v[142:143], v[36:37] op_sel:[0,0,0] op_sel_hi:[0,1,1]
  v_pk_fma_f32 v[38:39], v[246:247], v[144:145], v[38:39] op_sel:[0,0,0] op_sel_hi:[0,1,1]
  buffer_load_dwordx4 a[180:183], v4, s[8:11], s47 offen offset:0 sc1
  v_pk_fma_f32 v[40:41], v[246:247], v[146:147], v[40:41] op_sel:[0,0,0] op_sel_hi:[0,1,1]
  v_pk_fma_f32 v[42:43], v[246:247], v[148:149], v[42:43] op_sel:[0,0,0] op_sel_hi:[0,1,1]
  v_pk_fma_f32 v[44:45], v[246:247], v[150:151], v[44:45] op_sel:[0,0,0] op_sel_hi:[0,1,1]
  v_pk_fma_f32 v[46:47], v[246:247], v[152:153], v[46:47] op_sel:[0,0,0] op_sel_hi:[0,1,1]
  v_pk_fma_f32 v[30:31], v[246:247], v[154:155], v[30:31] op_sel:[1,0,0] op_sel_hi:[1,1,1]
  v_pk_fma_f32 v[32:33], v[246:247], v[156:157], v[32:33] op_sel:[1,0,0] op_sel_hi:[1,1,1]
  v_pk_fma_f32 v[34:35], v[246:247], v[158:159], v[34:35] op_sel:[1,0,0] op_sel_hi:[1,1,1]
  v_pk_fma_f32 v[36:37], v[246:247], v[160:161], v[36:37] op_sel:[1,0,0] op_sel_hi:[1,1,1]
  v_pk_fma_f32 v[38:39], v[246:247], v[162:163], v[38:39] op_sel:[1,0,0] op_sel_hi:[1,1,1]
  v_pk_fma_f32 v[40:41], v[246:247], v[164:165], v[40:41] op_sel:[1,0,0] op_sel_hi:[1,1,1]
  v_pk_fma_f32 v[42:43], v[246:247], v[166:167], v[42:43] op_sel:[1,0,0] op_sel_hi:[1,1,1]
  v_pk_fma_f32 v[44:45], v[246:247], v[168:169], v[44:45] op_sel:[1,0,0] op_sel_hi:[1,1,1]
  buffer_load_dwordx4 a[184:187], v4, s[8:11], s46 offen offset:1024 sc1
  v_pk_fma_f32 v[46:47], v[246:247], v[170:171], v[46:47] op_sel:[1,0,0] op_sel_hi:[1,1,1]
  v_pk_fma_f32 v[30:31], v[248:249], v[172:173], v[30:31] op_sel:[0,0,0] op_sel_hi:[0,1,1]
  v_pk_fma_f32 v[32:33], v[248:249], v[174:175], v[32:33] op_sel:[0,0,0] op_sel_hi:[0,1,1]
  v_pk_fma_f32 v[34:35], v[248:249], v[176:177], v[34:35] op_sel:[0,0,0] op_sel_hi:[0,1,1]
  v_pk_fma_f32 v[36:37], v[248:249], v[178:179], v[36:37] op_sel:[0,0,0] op_sel_hi:[0,1,1]
  v_pk_fma_f32 v[38:39], v[248:249], v[180:181], v[38:39] op_sel:[0,0,0] op_sel_hi:[0,1,1]
  v_pk_fma_f32 v[40:41], v[248:249], v[182:183], v[40:41] op_sel:[0,0,0] op_sel_hi:[0,1,1]
  v_pk_fma_f32 v[42:43], v[248:249], v[184:185], v[42:43] op_sel:[0,0,0] op_sel_hi:[0,1,1]
  v_pk_fma_f32 v[44:45], v[248:249], v[186:187], v[44:45] op_sel:[0,0,0] op_sel_hi:[0,1,1]
  v_pk_fma_f32 v[46:47], v[248:249], v[188:189], v[46:47] op_sel:[0,0,0] op_sel_hi:[0,1,1]
  s_waitcnt lgkmcnt(10)
  v_pk_fma_f32 v[30:31], v[248:249], v[190:191], v[30:31] op_sel:[1,0,0] op_sel_hi:[1,1,1]
  buffer_load_dwordx4 a[188:191], v4, s[8:11], s47 offen offset:1024 sc1
  v_pk_fma_f32 v[32:33], v[248:249], v[192:193], v[32:33] op_sel:[1,0,0] op_sel_hi:[1,1,1]
  v_pk_fma_f32 v[34:35], v[248:249], v[194:195], v[34:35] op_sel:[1,0,0] op_sel_hi:[1,1,1]
  v_pk_fma_f32 v[36:37], v[248:249], v[196:197], v[36:37] op_sel:[1,0,0] op_sel_hi:[1,1,1]
  v_pk_fma_f32 v[38:39], v[248:249], v[198:199], v[38:39] op_sel:[1,0,0] op_sel_hi:[1,1,1]
  v_pk_fma_f32 v[40:41], v[248:249], v[200:201], v[40:41] op_sel:[1,0,0] op_sel_hi:[1,1,1]
  v_pk_fma_f32 v[42:43], v[248:249], v[202:203], v[42:43] op_sel:[1,0,0] op_sel_hi:[1,1,1]
  v_pk_fma_f32 v[44:45], v[248:249], v[204:205], v[44:45] op_sel:[1,0,0] op_sel_hi:[1,1,1]
  v_pk_fma_f32 v[46:47], v[248:249], v[206:207], v[46:47] op_sel:[1,0,0] op_sel_hi:[1,1,1]
  s_waitcnt lgkmcnt(5)
  v_pk_fma_f32 v[30:31], v[250:251], v[208:209], v[30:31] op_sel:[0,0,0] op_sel_hi:[0,1,1]
  v_pk_fma_f32 v[32:33], v[250:251], v[210:211], v[32:33] op_sel:[0,0,0] op_sel_hi:[0,1,1]
  v_pk_fma_f32 v[34:35], v[250:251], v[212:213], v[34:35] op_sel:[0,0,0] op_sel_hi:[0,1,1]
  v_pk_fma_f32 v[36:37], v[250:251], v[214:215], v[36:37] op_sel:[0,0,0] op_sel_hi:[0,1,1]
  buffer_load_dwordx4 a[192:195], v4, s[8:11], s46 offen offset:2048 sc1
  v_pk_fma_f32 v[38:39], v[250:251], v[216:217], v[38:39] op_sel:[0,0,0] op_sel_hi:[0,1,1]
  v_pk_fma_f32 v[40:41], v[250:251], v[218:219], v[40:41] op_sel:[0,0,0] op_sel_hi:[0,1,1]
  v_pk_fma_f32 v[42:43], v[250:251], v[220:221], v[42:43] op_sel:[0,0,0] op_sel_hi:[0,1,1]
  v_pk_fma_f32 v[44:45], v[250:251], v[222:223], v[44:45] op_sel:[0,0,0] op_sel_hi:[0,1,1]
  v_pk_fma_f32 v[46:47], v[250:251], v[224:225], v[46:47] op_sel:[0,0,0] op_sel_hi:[0,1,1]
  s_waitcnt lgkmcnt(0)
  v_pk_fma_f32 v[30:31], v[250:251], v[60:61], v[30:31] op_sel:[1,0,0] op_sel_hi:[1,1,1]
  v_pk_fma_f32 v[32:33], v[250:251], v[62:63], v[32:33] op_sel:[1,0,0] op_sel_hi:[1,1,1]
  v_pk_fma_f32 v[34:35], v[250:251], v[64:65], v[34:35] op_sel:[1,0,0] op_sel_hi:[1,1,1]
  v_pk_fma_f32 v[36:37], v[250:251], v[66:67], v[36:37] op_sel:[1,0,0] op_sel_hi:[1,1,1]
  v_pk_fma_f32 v[38:39], v[250:251], v[68:69], v[38:39] op_sel:[1,0,0] op_sel_hi:[1,1,1]
  v_pk_fma_f32 v[40:41], v[250:251], v[70:71], v[40:41] op_sel:[1,0,0] op_sel_hi:[1,1,1]
  buffer_load_dwordx4 a[196:199], v4, s[8:11], s47 offen offset:2048 sc1
  v_pk_fma_f32 v[42:43], v[250:251], v[72:73], v[42:43] op_sel:[1,0,0] op_sel_hi:[1,1,1]
  v_pk_fma_f32 v[44:45], v[250:251], v[74:75], v[44:45] op_sel:[1,0,0] op_sel_hi:[1,1,1]
  v_pk_fma_f32 v[46:47], v[250:251], v[76:77], v[46:47] op_sel:[1,0,0] op_sel_hi:[1,1,1]
  v_pk_mul_f32 v[30:31], v[20:21], v[30:31] op_sel:[0,0] op_sel_hi:[0,1]
  v_cvt_pk_bf16_f32 v80, v30, v31
  v_pk_mul_f32 v[32:33], v[20:21], v[32:33] op_sel:[0,0] op_sel_hi:[0,1]
  v_cvt_pk_bf16_f32 v81, v32, v33
  v_pk_mul_f32 v[34:35], v[20:21], v[34:35] op_sel:[0,0] op_sel_hi:[0,1]
  v_cvt_pk_bf16_f32 v82, v34, v35
  v_pk_mul_f32 v[36:37], v[20:21], v[36:37] op_sel:[0,0] op_sel_hi:[0,1]
  v_cvt_pk_bf16_f32 v83, v36, v37
  v_pk_mul_f32 v[38:39], v[20:21], v[38:39] op_sel:[0,0] op_sel_hi:[0,1]
  buffer_load_dwordx4 a[200:203], v4, s[8:11], s46 offen offset:3072 sc1
  s_add_u32 s46, s46, 4096
  v_cvt_pk_bf16_f32 v84, v38, v39
  v_pk_mul_f32 v[40:41], v[20:21], v[40:41] op_sel:[0,0] op_sel_hi:[0,1]
  v_cvt_pk_bf16_f32 v85, v40, v41
  v_pk_mul_f32 v[42:43], v[20:21], v[42:43] op_sel:[0,0] op_sel_hi:[0,1]
  v_cvt_pk_bf16_f32 v86, v42, v43
  v_pk_mul_f32 v[44:45], v[20:21], v[44:45] op_sel:[0,0] op_sel_hi:[0,1]
  v_cvt_pk_bf16_f32 v87, v44, v45
  v_pk_mul_f32 v[46:47], v[20:21], v[46:47] op_sel:[0,0] op_sel_hi:[0,1]
  v_cvt_pk_bf16_f32 v88, v46, v47
  buffer_load_dwordx4 a[204:207], v4, s[8:11], s47 offen offset:3072 sc1
  s_add_u32 s47, s47, 4096
  buffer_load_dwordx4 a[208:211], v4, s[8:11], s46 offen offset:0 sc1
  buffer_load_dwordx4 a[212:215], v4, s[8:11], s47 offen offset:0 sc1
  buffer_load_dwordx4 a[216:219], v4, s[8:11], s46 offen offset:1024 sc1
  buffer_load_dwordx4 a[72:75], v4, s[8:11], s47 offen offset:1024 sc1
  buffer_load_dwordx4 a[76:79], v4, s[8:11], s46 offen offset:2048 sc1
  buffer_load_dwordx4 a[80:83], v4, s[8:11], s47 offen offset:2048 sc1
  s_getpc_b64 s[100:101]
L_pc_4:
  s_add_u32 s100, s100, L_code_p0+30720-L_pc_4
  s_addc_u32 s101, s101, 0
  s_sub_u32 s24, s2, 112
  s_cmp_lt_u32 s24, 16
  s_cselect_b32 s24, 128, 0
  v_mul_u32_u24 v1, s24, v0
  global_load_dword a251, v1, s[100:101]
  s_getpc_b64 s[100:101]
L_pc_5:
  s_add_u32 s100, s100, L_code_p0+61440-L_pc_5
  s_addc_u32 s101, s101, 0
  s_sub_u32 s24, s2, 112
  s_cmp_lt_u32 s24, 16
  s_cselect_b32 s24, 128, 0
  v_mul_u32_u24 v1, s24, v0
  global_load_dword a251, v1, s[100:101]
  v_mul_u32_u24 v6, 18432, v5
  v_lshl_add_u32 v6, v3, 4, v6
  s_mul_i32 s26, s22, 73728
  s_mul_i32 s27, s23, 2304
  s_add_u32 s26, s26, s27
  s_lshl_b32 s27, s3, 9
  s_add_u32 s27, s27, s26
  s_lshl_b32 s25, s3, 2
  s_add_u32 s25, s25, s26
  buffer_store_dwordx4 v[80:83], v6, s[36:39], s27 offen sc1
  buffer_store_dwordx4 v[84:87], v6, s[36:39], s27 offen offset:256 sc1
  buffer_store_dword v88, v6, s[36:39], s25 offen offset:2048 sc1
  s_mov_b32 s8, s6
  s_mov_b32 s9, s7
  s_mov_b32 s10, 2359296
  s_mov_b32 s11, 0x20000
  buffer_load_dwordx2 v[150:151], v253, s[8:11], s45 offen offset:0
  buffer_load_dwordx2 v[152:153], v253, s[8:11], s45 offen offset:32
  buffer_load_dwordx2 v[154:155], v253, s[8:11], s45 offen offset:64
  buffer_load_dwordx2 v[156:157], v253, s[8:11], s45 offen offset:96
  buffer_load_dwordx2 v[158:159], v254, s[8:11], s45 offen offset:128
  s_add_u32 s16, s4, 10944512
  s_addc_u32 s17, s5, 0
  s_mov_b32 s18, 2949120
  s_mov_b32 s19, 0x20000
  v_lshrrev_b32 v10, 2, v3
  v_lshl_add_u32 v10, v5, 3, v10
  v_and_b32 v11, 3, v3
  v_lshlrev_b32 v11, 3, v11
  v_add_u32 v11, s54, v11
  v_lshl_add_u32 v12, v10, 4, v11
  v_lshl_add_u32 v10, v10, 7, v11
  v_add_u32 v13, s55, v4
  s_add_u32 s44, s43, 4096
  s_waitcnt vmcnt(40)
  ds_read_b64_tr_b16 v[20:21], v10 offset:0
  ds_read_b64_tr_b16 v[22:23], v10 offset:512
  ds_read_b64_tr_b16 v[24:25], v10 offset:32
  ds_read_b64_tr_b16 v[26:27], v10 offset:544
  ds_read_b64_tr_b16 v[28:29], v10 offset:64
  ds_read_b64_tr_b16 v[30:31], v10 offset:576
  ds_read_b64_tr_b16 v[32:33], v10 offset:96
  ds_read_b64_tr_b16 v[34:35], v10 offset:608
  ds_read_b64_tr_b16 v[36:37], v12 offset:4096
  ds_read_b64_tr_b16 v[38:39], v12 offset:4160
  v_mov_b32 v14, v255
  v_lshlrev_b32 v16, 30, v5
  v_and_b32 v16, 0x80000000, v16
  s_lshl_b32 s25, s22, 3
  s_add_u32 s33, s25, s23
  s_waitcnt lgkmcnt(0)
  s_waitcnt vmcnt(5)
  s_barrier
  s_cmp_lg_u32 s3, 0
  s_cbranch_scc1 L_sig_6
  s_lshl_b32 s24, s33, 6
  s_add_u32 s24, s24, 0
  v_mov_b32 v1, 0
  v_mov_b32 v6, s97
  s_mov_b64 exec, 1
  buffer_store_dword v6, v1, s[56:59], s24 offen sc1
  s_mov_b64 exec, -1
L_sig_6:
  s_mul_i32 s26, s23, 288
  v_lshl_add_u32 v7, v5, 4, s26
  v_add_u32 v6, 153600, v7
  ds_read_b128 v[100:103], v6 offset:7168
  ds_read_b128 v[160:163], v6 offset:0
  ds_read_b128 v[180:183], v6 offset:2304
  ds_read_b128 v[104:107], v6 offset:7232
  ds_read_b128 v[164:167], v6 offset:64
  ds_read_b128 v[184:187], v6 offset:2368
  ds_read_b128 v[108:111], v6 offset:7296
  ds_read_b128 v[168:171], v6 offset:128
  ds_read_b128 v[188:191], v6 offset:2432
  ds_read_b128 v[112:115], v6 offset:7360
  ds_read_b128 v[172:175], v6 offset:192
  ds_read_b128 v[192:195], v6 offset:2496
  ds_read_b128 v[116:119], v6 offset:7424
  ds_read_b128 v[176:179], v6 offset:256
  ds_read_b128 v[196:199], v6 offset:2560
  s_add_u32 s12, s4, 5636096
  s_addc_u32 s13, s5, 0
  s_mov_b32 s14, 5308416
  s_mov_b32 s15, 0x20000
  s_mul_i32 s42, s21, 331776
  s_add_u32 s8, s4, 4898816
  s_addc_u32 s9, s5, 0
  s_mov_b32 s10, 737280
  s_mov_b32 s11, 0x20000
  s_mul_i32 s27, s3, 15360
  s_min_u32 s27, s27, 44032
  s_mul_i32 s40, s23, 92160
  s_add_u32 s40, s40, s27
  s_add_u32 m0, s27, 0
  s_nop 0
  buffer_load_dwordx4 v4, s[8:11], s40 offen offset:0 sc1 lds
  buffer_load_dwordx4 v4, s[8:11], s40 offen offset:1024 sc1 lds
  buffer_load_dwordx4 v4, s[8:11], s40 offen offset:2048 sc1 lds
  buffer_load_dwordx4 v4, s[8:11], s40 offen offset:3072 sc1 lds
  s_add_u32 m0, s27, 4096
  s_add_u32 s40, s40, 4096
  buffer_load_dwordx4 v4, s[8:11], s40 offen offset:0 sc1 lds
  buffer_load_dwordx4 v4, s[8:11], s40 offen offset:1024 sc1 lds
  buffer_load_dwordx4 v4, s[8:11], s40 offen offset:2048 sc1 lds
  buffer_load_dwordx4 v4, s[8:11], s40 offen offset:3072 sc1 lds
  s_add_u32 m0, s27, 8192
  s_add_u32 s40, s40, 4096
  buffer_load_dwordx4 v4, s[8:11], s40 offen offset:0 sc1 lds
  buffer_load_dwordx4 v4, s[8:11], s40 offen offset:1024 sc1 lds
  buffer_load_dwordx4 v4, s[8:11], s40 offen offset:2048 sc1 lds
  buffer_load_dwordx4 v4, s[8:11], s40 offen offset:3072 sc1 lds
  s_add_u32 m0, s27, 12288
  s_add_u32 s40, s40, 4096
  buffer_load_dwordx4 v4, s[8:11], s40 offen offset:0 sc1 lds
  buffer_load_dwordx4 v4, s[8:11], s40 offen offset:1024 sc1 lds
  buffer_load_dwordx4 v4, s[8:11], s40 offen offset:2048 sc1 lds
  buffer_store_dwordx4 v[20:23], v13, s[16:19], s43 offen offset:0 sc1
  buffer_store_dwordx4 v[24:27], v13, s[16:19], s43 offen offset:1024 sc1
  buffer_store_dwordx4 v[28:31], v13, s[16:19], s43 offen offset:2048 sc1
  buffer_store_dwordx4 v[32:35], v13, s[16:19], s43 offen offset:3072 sc1
  buffer_store_dwordx4 v[36:39], v13, s[16:19], s44 offen offset:0 sc1
  s_add_u32 s16, s4, 40632320
  s_addc_u32 s17, s5, 0
  s_mov_b32 s18, 9437184
  s_mov_b32 s19, 0x20000
  s_lshl_b32 s26, s2, 2
  s_add_u32 s26, s26, s3
  s_mul_i32 s26, s26, 9216
  s_add_u32 s26, s26, 8192
  buffer_store_dwordx4 v[80:83], v4, s[16:19], s26 offen sc1
  s_lshl_b32 s30, s3, 4
  s_sub_u32 s30, s30, 16
  s_add_u32 s30, s30, s20
  s_cmp_lt_u32 s30, 18
  s_cselect_b32 s29, 0, 0x80000000
  s_cselect_b32 s30, s30, 0
  v_add_u32 v215, s29, v4
  s_mov_b32 s55, s29
  s_mul_i32 s31, s21, 18
  s_add_u32 s30, s30, s31
  s_lshl_b32 s54, s30, 7
  s_mul_i32 s32, s30, 18432
  s_waitcnt lgkmcnt(0)
  v_accvgpr_write_b32 a220, v100
  v_accvgpr_write_b32 a221, v101
  v_accvgpr_write_b32 a222, v102
  v_accvgpr_write_b32 a223, v103
  v_accvgpr_write_b32 a224, v104
  v_accvgpr_write_b32 a225, v105
  v_accvgpr_write_b32 a226, v106
  v_accvgpr_write_b32 a227, v107
  v_accvgpr_write_b32 a228, v108
  v_accvgpr_write_b32 a229, v109
  v_accvgpr_write_b32 a230, v110
  v_accvgpr_write_b32 a231, v111
  v_accvgpr_write_b32 a232, v112
  v_accvgpr_write_b32 a233, v113
  v_accvgpr_write_b32 a234, v114
  v_accvgpr_write_b32 a235, v115
  v_accvgpr_write_b32 a236, v116
  v_accvgpr_write_b32 a237, v117
  v_accvgpr_write_b32 a238, v118
  v_accvgpr_write_b32 a239, v119
  s_getpc_b64 s[100:101]
L_pc_7:
  s_add_u32 s100, s100, L_code_p3-L_pc_7
  s_addc_u32 s101, s101, 0
  s_sub_u32 s24, s2, 112
  s_cmp_lt_u32 s24, 16
  s_cselect_b32 s24, 128, 0
  v_mul_u32_u24 v1, s24, v0
  global_load_dword a251, v1, s[100:101]
  s_waitcnt vmcnt(7)
  s_cmp_lg_u32 s3, 0
  s_cbranch_scc1 L_aw_8_d
  s_lshl_b32 s24, s25, 6
  s_add_u32 s24, s24, 0
  v_lshlrev_b32 v1, 6, v2
  s_mov_b64 exec, 0xff
L_aw_8:
  buffer_load_dword v6, v1, s[56:59], s24 offen sc1
  s_waitcnt vmcnt(0)
  v_cmp_ne_u32 vcc, s97, v6
  s_nop 0
  s_cbranch_vccz L_aw_8_g
  s_branch L_aw_8
L_aw_8_g:
  s_mov_b64 exec, -1
L_aw_8_d:
  s_barrier
  s_lshl_b32 s26, s22, 2
  s_add_u32 s26, s26, s3
  s_mul_i32 s26, s26, 18432
  buffer_load_dwordx4 a[0:3], v4, s[36:39], s26 offen offset:0 sc1
  buffer_load_dwordx4 a[4:7], v4, s[36:39], s26 offen offset:1024 sc1
  buffer_load_dwordx4 a[8:11], v4, s[36:39], s26 offen offset:2048 sc1
  buffer_load_dwordx4 a[12:15], v4, s[36:39], s26 offen offset:3072 sc1
  s_add_u32 s26, s26, 4096
  buffer_load_dwordx4 a[16:19], v4, s[36:39], s26 offen offset:0 sc1
  buffer_load_dwordx4 a[20:23], v4, s[36:39], s26 offen offset:1024 sc1
  buffer_load_dwordx4 a[24:27], v4, s[36:39], s26 offen offset:2048 sc1
  buffer_load_dwordx4 a[28:31], v4, s[36:39], s26 offen offset:3072 sc1
  s_add_u32 s26, s26, 4096
  buffer_load_dwordx4 a[32:35], v4, s[36:39], s26 offen offset:0 sc1
  buffer_load_dwordx4 a[36:39], v4, s[36:39], s26 offen offset:1024 sc1
  buffer_load_dwordx4 a[40:43], v4, s[36:39], s26 offen offset:2048 sc1
  buffer_load_dwordx4 a[44:47], v4, s[36:39], s26 offen offset:3072 sc1
  s_add_u32 s26, s26, 4096
  buffer_load_dwordx4 a[48:51], v4, s[36:39], s26 offen offset:0 sc1
  buffer_load_dwordx4 a[52:55], v4, s[36:39], s26 offen offset:1024 sc1
  buffer_load_dwordx4 a[56:59], v4, s[36:39], s26 offen offset:2048 sc1
  buffer_load_dwordx4 a[60:63], v4, s[36:39], s26 offen offset:3072 sc1
  s_add_u32 s26, s26, 4096
  buffer_load_dwordx4 a[64:67], v4, s[36:39], s26 offen offset:0 sc1
  buffer_load_dwordx4 a[68:71], v4, s[36:39], s26 offen offset:1024 sc1
  v_add_u32 v18, 0, v4
  v_add_u32 v19, 61440, v18
  ds_read_b128 v[20:23], v18 offset:0
  ds_read_b128 v[24:27], v18 offset:1024
  ds_read_b128 v[28:31], v18 offset:2048
  ds_read_b128 v[32:35], v18 offset:3072
  ds_read_b128 v[36:39], v18 offset:4096
  ds_read_b128 v[40:43], v18 offset:5120
  ds_read_b128 v[44:47], v18 offset:6144
  ds_read_b128 v[48:51], v18 offset:7168
  ds_read_b128 v[52:55], v18 offset:8192
  ds_read_b128 v[56:59], v18 offset:9216
  s_add_u32 s8, s4, 16252928
  s_addc_u32 s9, s5, 0
  s_mov_b32 s10, 2359296
  s_mov_b32 s11, 0x20000
  s_add_u32 s16, s4, 16384
  s_addc_u32 s17, s5, 0
  s_mov_b32 s18, 131072
  s_mov_b32 s19, 0x20000
  s_waitcnt vmcnt(17)
  s_waitcnt lgkmcnt(5)
  v_mfma_f32_16x16x32_bf16 v[60:63], v[20:23], a[0:3], 0
  ds_read_b128 v[20:23], v18 offset:10240
  v_mfma_f32_16x16x32_bf16 v[64:67], v[24:27], a[0:3], 0
  ds_read_b128 v[24:27], v18 offset:11264
  v_mfma_f32_16x16x32_bf16 v[68:71], v[28:31], a[0:3], 0
  ds_read_b128 v[28:31], v18 offset:12288
  v_mfma_f32_16x16x32_bf16 v[72:75], v[32:35], a[0:3], 0
  ds_read_b128 v[32:35], v18 offset:13312
  v_mfma_f32_16x16x32_bf16 v[76:79], v[36:39], a[0:3], 0
  s_waitcnt vmcnt(16)
  s_waitcnt lgkmcnt(4)
  v_mfma_f32_16x16x32_bf16 v[60:63], v[40:43], a[4:7], v[60:63]
  ds_read_b128 v[36:39], v18 offset:14336
  ds_read_b128 v[40:43], v18 offset:15360
  v_mfma_f32_16x16x32_bf16 v[64:67], v[44:47], a[4:7], v[64:67]
  ds_read_b128 v[44:47], v18 offset:16384
  v_mfma_f32_16x16x32_bf16 v[68:71], v[48:51], a[4:7], v[68:71]
  ds_read_b128 v[48:51], v18 offset:17408
  v_mfma_f32_16x16x32_bf16 v[72:75], v[52:55], a[4:7], v[72:75]
  ds_read_b128 v[52:55], v18 offset:18432
  v_mfma_f32_16x16x32_bf16 v[76:79], v[56:59], a[4:7], v[76:79]
  s_waitcnt vmcnt(15)
  s_waitcnt lgkmcnt(4)
  v_mfma_f32_16x16x32_bf16 v[60:63], v[20:23], a[8:11], v[60:63]
  ds_read_b128 v[56:59], v18 offset:19456
  ds_read_b128 v[20:23], v18 offset:20480
  v_mfma_f32_16x16x32_bf16 v[64:67], v[24:27], a[8:11], v[64:67]
  ds_read_b128 v[24:27], v18 offset:21504
  v_mfma_f32_16x16x32_bf16 v[68:71], v[28:31], a[8:11], v[68:71]
  ds_read_b128 v[28:31], v18 offset:22528
  v_mfma_f32_16x16x32_bf16 v[72:75], v[32:35], a[8:11], v[72:75]
  ds_read_b128 v[32:35], v18 offset:23552
  v_mfma_f32_16x16x32_bf16 v[76:79], v[36:39], a[8:11], v[76:79]
  s_waitcnt vmcnt(14)
  s_waitcnt lgkmcnt(4)
  v_mfma_f32_16x16x32_bf16 v[60:63], v[40:43], a[12:15], v[60:63]
  ds_read_b128 v[36:39], v18 offset:24576
  ds_read_b128 v[40:43], v18 offset:25600
  v_mfma_f32_16x16x32_bf16 v[64:67], v[44:47], a[12:15], v[64:67]
  ds_read_b128 v[44:47], v18 offset:26624
  v_mfma_f32_16x16x32_bf16 v[68:71], v[48:51], a[12:15], v[68:71]
  ds_read_b128 v[48:51], v18 offset:27648
  v_mfma_f32_16x16x32_bf16 v[72:75], v[52:55], a[12:15], v[72:75]
  ds_read_b128 v[52:55], v18 offset:28672
  v_mfma_f32_16x16x32_bf16 v[76:79], v[56:59], a[12:15], v[76:79]
  s_waitcnt vmcnt(13)
  s_waitcnt lgkmcnt(4)
  v_mfma_f32_16x16x32_bf16 v[60:63], v[20:23], a[16:19], v[60:63]
  ds_read_b128 v[56:59], v18 offset:29696
  ds_read_b128 v[20:23], v18 offset:30720
  v_mfma_f32_16x16x32_bf16 v[64:67], v[24:27], a[16:19], v[64:67]
  ds_read_b128 v[24:27], v18 offset:31744
  v_mfma_f32_16x16x32_bf16 v[68:71], v[28:31], a[16:19], v[68:71]
  ds_read_b128 v[28:31], v18 offset:32768
  v_mfma_f32_16x16x32_bf16 v[72:75], v[32:35], a[16:19], v[72:75]
  ds_read_b128 v[32:35], v18 offset:33792
  buffer_load_dwordx4 a[84:87], v4, s[12:15], s46 offen offset:3072 sc1
  v_mfma_f32_16x16x32_bf16 v[76:79], v[36:39], a[16:19], v[76:79]
  s_waitcnt vmcnt(13)
  s_waitcnt lgkmcnt(4)
  v_mfma_f32_16x16x32_bf16 v[60:63], v[40:43], a[20:23], v[60:63]
  ds_read_b128 v[36:39], v18 offset:34816
  ds_read_b128 v[40:43], v18 offset:35840
  v_mfma_f32_16x16x32_bf16 v[64:67], v[44:47], a[20:23], v[64:67]
  ds_read_b128 v[44:47], v18 offset:36864
  s_add_u32 s46, s46, 4096
  v_mfma_f32_16x16x32_bf16 v[68:71], v[48:51], a[20:23], v[68:71]
  ds_read_b128 v[48:51], v18 offset:37888
  buffer_load_dwordx4 a[88:91], v4, s[12:15], s47 offen offset:3072 sc1
  v_mfma_f32_16x16x32_bf16 v[72:75], v[52:55], a[20:23], v[72:75]
  ds_read_b128 v[52:55], v18 offset:38912
  s_add_u32 s47, s47, 4096
  v_mfma_f32_16x16x32_bf16 v[76:79], v[56:59], a[20:23], v[76:79]
  s_waitcnt vmcnt(13)
  s_waitcnt lgkmcnt(4)
  v_mfma_f32_16x16x32_bf16 v[60:63], v[20:23], a[24:27], v[60:63]
  ds_read_b128 v[56:59], v18 offset:39936
  ds_read_b128 v[20:23], v18 offset:40960
  v_mfma_f32_16x16x32_bf16 v[64:67], v[24:27], a[24:27], v[64:67]
  ds_read_b128 v[24:27], v18 offset:41984
  v_mfma_f32_16x16x32_bf16 v[68:71], v[28:31], a[24:27], v[68:71]
  ds_read_b128 v[28:31], v18 offset:43008
  buffer_load_dwordx4 a[92:95], v4, s[12:15], s46 offen offset:0 sc1
  v_mfma_f32_16x16x32_bf16 v[72:75], v[32:35], a[24:27], v[72:75]
  ds_read_b128 v[32:35], v18 offset:44032
  v_mfma_f32_16x16x32_bf16 v[76:79], v[36:39], a[24:27], v[76:79]
  s_waitcnt vmcnt(13)
  s_waitcnt lgkmcnt(4)
  v_mfma_f32_16x16x32_bf16 v[60:63], v[40:43], a[28:31], v[60:63]
  ds_read_b128 v[36:39], v18 offset:45056
  ds_read_b128 v[40:43], v18 offset:46080
  v_mfma_f32_16x16x32_bf16 v[64:67], v[44:47], a[28:31], v[64:67]
  ds_read_b128 v[44:47], v18 offset:47104
  v_mfma_f32_16x16x32_bf16 v[68:71], v[48:51], a[28:31], v[68:71]
  ds_read_b128 v[48:51], v18 offset:48128
  buffer_load_dwordx4 a[96:99], v4, s[12:15], s47 offen offset:0 sc1
  v_mfma_f32_16x16x32_bf16 v[72:75], v[52:55], a[28:31], v[72:75]
  ds_read_b128 v[52:55], v18 offset:49152
  v_mfma_f32_16x16x32_bf16 v[76:79], v[56:59], a[28:31], v[76:79]
  s_waitcnt vmcnt(13)
  s_waitcnt lgkmcnt(4)
  v_mfma_f32_16x16x32_bf16 v[60:63], v[20:23], a[32:35], v[60:63]
  ds_read_b128 v[56:59], v18 offset:50176
  ds_read_b128 v[20:23], v18 offset:51200
  v_mfma_f32_16x16x32_bf16 v[64:67], v[24:27], a[32:35], v[64:67]
  ds_read_b128 v[24:27], v18 offset:52224
  v_mfma_f32_16x16x32_bf16 v[68:71], v[28:31], a[32:35], v[68:71]
  ds_read_b128 v[28:31], v18 offset:53248
  buffer_load_dwordx4 a[100:103], v4, s[12:15], s46 offen offset:1024 sc1
  v_mfma_f32_16x16x32_bf16 v[72:75], v[32:35], a[32:35], v[72:75]
  ds_read_b128 v[32:35], v18 offset:54272
  v_mfma_f32_16x16x32_bf16 v[76:79], v[36:39], a[32:35], v[76:79]
  s_waitcnt vmcnt(13)
  s_waitcnt lgkmcnt(4)
  v_mfma_f32_16x16x32_bf16 v[60:63], v[40:43], a[36:39], v[60:63]
  ds_read_b128 v[36:39], v18 offset:55296
  ds_read_b128 v[40:43], v18 offset:56320
  v_mfma_f32_16x16x32_bf16 v[64:67], v[44:47], a[36:39], v[64:67]
  ds_read_b128 v[44:47], v18 offset:57344
  v_mfma_f32_16x16x32_bf16 v[68:71], v[48:51], a[36:39], v[68:71]
  ds_read_b128 v[48:51], v18 offset:58368
  buffer_load_dwordx4 a[104:107], v4, s[12:15], s47 offen offset:1024 sc1
  v_mfma_f32_16x16x32_bf16 v[72:75], v[52:55], a[36:39], v[72:75]
  ds_read_b128 v[52:55], v18 offset:59392
  v_mfma_f32_16x16x32_bf16 v[76:79], v[56:59], a[36:39], v[76:79]
  s_waitcnt vmcnt(13)
  s_waitcnt lgkmcnt(4)
  v_mfma_f32_16x16x32_bf16 v[60:63], v[20:23], a[40:43], v[60:63]
  ds_read_b128 v[56:59], v18 offset:60416
  ds_read_b128 v[20:23], v19 offset:0
  v_mfma_f32_16x16x32_bf16 v[64:67], v[24:27], a[40:43], v[64:67]
  ds_read_b128 v[24:27], v19 offset:1024
  v_mfma_f32_16x16x32_bf16 v[68:71], v[28:31], a[40:43], v[68:71]
  ds_read_b128 v[28:31], v19 offset:2048
  buffer_load_dwordx4 a[108:111], v4, s[12:15], s46 offen offset:2048 sc1
  v_mfma_f32_16x16x32_bf16 v[72:75], v[32:35], a[40:43], v[72:75]
  ds_read_b128 v[32:35], v19 offset:3072
  v_mfma_f32_16x16x32_bf16 v[76:79], v[36:39], a[40:43], v[76:79]
  s_waitcnt vmcnt(13)
  s_waitcnt lgkmcnt(4)
  v_mfma_f32_16x16x32_bf16 v[60:63], v[40:43], a[44:47], v[60:63]
  ds_read_b128 v[36:39], v19 offset:4096
  ds_read_b128 v[40:43], v19 offset:5120
  v_mfma_f32_16x16x32_bf16 v[64:67], v[44:47], a[44:47], v[64:67]
  ds_read_b128 v[44:47], v19 offset:6144
  v_mfma_f32_16x16x32_bf16 v[68:71], v[48:51], a[44:47], v[68:71]
  ds_read_b128 v[48:51], v19 offset:7168
  buffer_load_dwordx4 a[112:115], v4, s[12:15], s47 offen offset:2048 sc1
  v_mfma_f32_16x16x32_bf16 v[72:75], v[52:55], a[44:47], v[72:75]
  ds_read_b128 v[52:55], v19 offset:8192
  v_mfma_f32_16x16x32_bf16 v[76:79], v[56:59], a[44:47], v[76:79]
  s_waitcnt vmcnt(13)
  s_waitcnt lgkmcnt(4)
  v_mfma_f32_16x16x32_bf16 v[60:63], v[20:23], a[48:51], v[60:63]
  ds_read_b128 v[56:59], v19 offset:9216
  ds_read_b128 v[20:23], v19 offset:10240
  v_mfma_f32_16x16x32_bf16 v[64:67], v[24:27], a[48:51], v[64:67]
  ds_read_b128 v[24:27], v19 offset:11264
  buffer_load_dwordx4 a[116:119], v4, s[12:15], s46 offen offset:3072 sc1
  v_mfma_f32_16x16x32_bf16 v[68:71], v[28:31], a[48:51], v[68:71]
  ds_read_b128 v[28:31], v19 offset:12288
  s_add_u32 s46, s46, 4096
  v_mfma_f32_16x16x32_bf16 v[72:75], v[32:35], a[48:51], v[72:75]
  ds_read_b128 v[32:35], v19 offset:13312
  v_mfma_f32_16x16x32_bf16 v[76:79], v[36:39], a[48:51], v[76:79]
  s_waitcnt vmcnt(13)
  s_waitcnt lgkmcnt(4)
  v_mfma_f32_16x16x32_bf16 v[60:63], v[40:43], a[52:55], v[60:63]
  ds_read_b128 v[36:39], v19 offset:14336
  ds_read_b128 v[40:43], v19 offset:15360
  v_mfma_f32_16x16x32_bf16 v[64:67], v[44:47], a[52:55], v[64:67]
  ds_read_b128 v[44:47], v19 offset:16384
  buffer_load_dwordx4 a[120:123], v4, s[12:15], s47 offen offset:3072 sc1
  v_mfma_f32_16x16x32_bf16 v[68:71], v[48:51], a[52:55], v[68:71]
  ds_read_b128 v[48:51], v19 offset:17408
  s_add_u32 s47, s47, 4096
  v_mfma_f32_16x16x32_bf16 v[72:75], v[52:55], a[52:55], v[72:75]
  ds_read_b128 v[52:55], v19 offset:18432
  v_mfma_f32_16x16x32_bf16 v[76:79], v[56:59], a[52:55], v[76:79]
  s_waitcnt vmcnt(13)
  s_waitcnt lgkmcnt(4)
  v_mfma_f32_16x16x32_bf16 v[60:63], v[20:23], a[56:59], v[60:63]
  ds_read_b128 v[56:59], v19 offset:19456
  ds_read_b128 v[20:23], v19 offset:20480
  v_mfma_f32_16x16x32_bf16 v[64:67], v[24:27], a[56:59], v[64:67]
  ds_read_b128 v[24:27], v19 offset:21504
  buffer_load_dwordx4 a[124:127], v4, s[12:15], s46 offen offset:0 sc1
  v_mfma_f32_16x16x32_bf16 v[68:71], v[28:31], a[56:59], v[68:71]
  ds_read_b128 v[28:31], v19 offset:22528
  v_mfma_f32_16x16x32_bf16 v[72:75], v[32:35], a[56:59], v[72:75]
  ds_read_b128 v[32:35], v19 offset:23552
  v_mfma_f32_16x16x32_bf16 v[76:79], v[36:39], a[56:59], v[76:79]
  s_waitcnt vmcnt(13)
  s_waitcnt lgkmcnt(4)
  v_mfma_f32_16x16x32_bf16 v[60:63], v[40:43], a[60:63], v[60:63]
  ds_read_b128 v[36:39], v19 offset:24576
  ds_read_b128 v[40:43], v19 offset:25600
  v_mfma_f32_16x16x32_bf16 v[64:67], v[44:47], a[60:63], v[64:67]
  ds_read_b128 v[44:47], v19 offset:26624
  buffer_load_dwordx4 a[128:131], v4, s[12:15], s47 offen offset:0 sc1
  v_mfma_f32_16x16x32_bf16 v[68:71], v[48:51], a[60:63], v[68:71]
  ds_read_b128 v[48:51], v19 offset:27648
  v_mfma_f32_16x16x32_bf16 v[72:75], v[52:55], a[60:63], v[72:75]
  ds_read_b128 v[52:55], v19 offset:28672
  v_mfma_f32_16x16x32_bf16 v[76:79], v[56:59], a[60:63], v[76:79]
  s_waitcnt vmcnt(13)
  s_waitcnt lgkmcnt(4)
  v_mfma_f32_16x16x32_bf16 v[60:63], v[20:23], a[64:67], v[60:63]
  ds_read_b128 v[56:59], v19 offset:29696
  v_mfma_f32_16x16x32_bf16 v[64:67], v[24:27], a[64:67], v[64:67]
  buffer_load_dwordx4 a[132:135], v4, s[12:15], s46 offen offset:1024 sc1
  v_mfma_f32_16x16x32_bf16 v[68:71], v[28:31], a[64:67], v[68:71]
  v_mfma_f32_16x16x32_bf16 v[72:75], v[32:35], a[64:67], v[72:75]
  buffer_load_dwordx4 a[136:139], v4, s[12:15], s47 offen offset:1024 sc1
  v_mfma_f32_16x16x32_bf16 v[76:79], v[36:39], a[64:67], v[76:79]
  s_waitcnt vmcnt(14)
  s_waitcnt lgkmcnt(0)
  v_mfma_f32_16x16x32_bf16 v[60:63], v[40:43], a[68:71], v[60:63]
  v_mfma_f32_16x16x32_bf16 v[64:67], v[44:47], a[68:71], v[64:67]
  v_mfma_f32_16x16x32_bf16 v[68:71], v[48:51], a[68:71], v[68:71]
  v_mfma_f32_16x16x32_bf16 v[72:75], v[52:55], a[68:71], v[72:75]
  v_mfma_f32_16x16x32_bf16 v[76:79], v[56:59], a[68:71], v[76:79]
  v_lshlrev_b32 v80, 16, v150
  v_lshlrev_b32 v82, 16, v151
  v_and_b32 v81, 0xffff0000, v150
  v_and_b32 v83, 0xffff0000, v151
  v_pk_fma_f32 v[60:61], v[60:61], v[160:161], v[80:81]
  v_pk_fma_f32 v[62:63], v[62:63], v[162:163], v[82:83]
  v_cvt_pk_bf16_f32 v112, v60, v61
  v_cvt_pk_bf16_f32 v113, v62, v63
  v_lshlrev_b32 v60, 16, v112
  v_lshlrev_b32 v62, 16, v113
  v_and_b32 v61, 0xffff0000, v112
  v_and_b32 v63, 0xffff0000, v113
  v_pk_mul_f32 v[86:87], v[60:61], v[60:61]
  v_pk_mul_f32 v[90:91], v[62:63], v[62:63]
  v_pk_mul_f32 v[84:85], v[60:61], 1.0 op_sel_hi:[1,0]
  v_pk_mul_f32 v[88:89], v[62:63], 1.0 op_sel_hi:[1,0]
  v_pk_mul_f32 v[60:61], v[60:61], v[180:181]
  v_pk_mul_f32 v[62:63], v[62:63], v[182:183]
  v_cvt_pk_bf16_f32 v124, v60, v61
  v_cvt_pk_bf16_f32 v125, v62, v63
  v_lshlrev_b32 v80, 16, v152
  v_lshlrev_b32 v82, 16, v153
  v_and_b32 v81, 0xffff0000, v152
  v_and_b32 v83, 0xffff0000, v153
  v_pk_fma_f32 v[64:65], v[64:65], v[164:165], v[80:81]
  v_pk_fma_f32 v[66:67], v[66:67], v[166:167], v[82:83]
  v_cvt_pk_bf16_f32 v114, v64, v65
  v_cvt_pk_bf16_f32 v115, v66, v67
  v_lshlrev_b32 v64, 16, v114
  v_lshlrev_b32 v66, 16, v115
  v_and_b32 v65, 0xffff0000, v114
  v_and_b32 v67, 0xffff0000, v115
  v_pk_fma_f32 v[86:87], v[64:65], v[64:65], v[86:87]
  v_pk_fma_f32 v[90:91], v[66:67], v[66:67], v[90:91]
  v_pk_add_f32 v[84:85], v[84:85], v[64:65]
  v_pk_add_f32 v[88:89], v[88:89], v[66:67]
  v_pk_mul_f32 v[64:65], v[64:65], v[184:185]
  v_pk_mul_f32 v[66:67], v[66:67], v[186:187]
  v_cvt_pk_bf16_f32 v126, v64, v65
  v_cvt_pk_bf16_f32 v127, v66, v67
  v_lshlrev_b32 v80, 16, v154
  v_lshlrev_b32 v82, 16, v155
  v_and_b32 v81, 0xffff0000, v154
  v_and_b32 v83, 0xffff0000, v155
  v_pk_fma_f32 v[68:69], v[68:69], v[168:169], v[80:81]
  v_pk_fma_f32 v[70:71], v[70:71], v[170:171], v[82:83]
  v_cvt_pk_bf16_f32 v116, v68, v69
  v_cvt_pk_bf16_f32 v117, v70, v71
  v_lshlrev_b32 v68, 16, v116
  v_lshlrev_b32 v70, 16, v117
  v_and_b32 v69, 0xffff0000, v116
  v_and_b32 v71, 0xffff0000, v117
  v_pk_fma_f32 v[86:87], v[68:69], v[68:69], v[86:87]
  v_pk_fma_f32 v[90:91], v[70:71], v[70:71], v[90:91]
  v_pk_add_f32 v[84:85], v[84:85], v[68:69]
  v_pk_add_f32 v[88:89], v[88:89], v[70:71]
  v_pk_mul_f32 v[68:69], v[68:69], v[188:189]
  v_pk_mul_f32 v[70:71], v[70:71], v[190:191]
  v_cvt_pk_bf16_f32 v128, v68, v69
  v_cvt_pk_bf16_f32 v129, v70, v71
  v_lshlrev_b32 v80, 16, v156
  v_lshlrev_b32 v82, 16, v157
  v_and_b32 v81, 0xffff0000, v156
  v_and_b32 v83, 0xffff0000, v157
  v_pk_fma_f32 v[72:73], v[72:73], v[172:173], v[80:81]
  v_pk_fma_f32 v[74:75], v[74:75], v[174:175], v[82:83]
  v_cvt_pk_bf16_f32 v118, v72, v73
  v_cvt_pk_bf16_f32 v119, v74, v75
  v_lshlrev_b32 v72, 16, v118
  v_lshlrev_b32 v74, 16, v119
  v_and_b32 v73, 0xffff0000, v118
  v_and_b32 v75, 0xffff0000, v119
  v_pk_fma_f32 v[86:87], v[72:73], v[72:73], v[86:87]
  v_pk_fma_f32 v[90:91], v[74:75], v[74:75], v[90:91]
  v_pk_add_f32 v[84:85], v[84:85], v[72:73]
  v_pk_add_f32 v[88:89], v[88:89], v[74:75]
  v_pk_mul_f32 v[72:73], v[72:73], v[192:193]
  v_pk_mul_f32 v[74:75], v[74:75], v[194:195]
  v_cvt_pk_bf16_f32 v130, v72, v73
  v_cvt_pk_bf16_f32 v131, v74, v75
  v_lshlrev_b32 v80, 16, v158
  v_lshlrev_b32 v82, 16, v159
  v_and_b32 v81, 0xffff0000, v158
  v_and_b32 v83, 0xffff0000, v159
  v_pk_fma_f32 v[76:77], v[76:77], v[176:177], v[80:81]
  v_pk_fma_f32 v[78:79], v[78:79], v[178:179], v[82:83]
  v_cvt_pk_bf16_f32 v120, v76, v77
  v_cvt_pk_bf16_f32 v121, v78, v79
  v_lshlrev_b32 v76, 16, v120
  v_lshlrev_b32 v78, 16, v121
  v_and_b32 v77, 0xffff0000, v120
  v_and_b32 v79, 0xffff0000, v121
  v_pk_fma_f32 v[86:87], v[76:77], v[76:77], v[86:87]
  v_pk_fma_f32 v[90:91], v[78:79], v[78:79], v[90:91]
  v_pk_add_f32 v[84:85], v[84:85], v[76:77]
  v_pk_add_f32 v[88:89], v[88:89], v[78:79]
  v_pk_mul_f32 v[76:77], v[76:77], v[196:197]
  v_pk_mul_f32 v[78:79], v[78:79], v[198:199]
  v_cvt_pk_bf16_f32 v132, v76, v77
  v_cvt_pk_bf16_f32 v133, v78, v79
  s_lshr_b32 s26, s22, 1
  s_mul_i32 s26, s26, 147456
  s_and_b32 s27, s22, 1
  s_lshl_b32 s27, s27, 2
  s_add_u32 s27, s27, s3
  s_lshl_b32 s27, s27, 10
  s_add_u32 s26, s26, s27
  s_lshl_b32 s27, s23, 14
  s_add_u32 s27, s27, s26
  buffer_store_dwordx4 v[124:127], v4, s[8:11], s27 offen sc1
  s_add_u32 s27, s27, 8192
  buffer_store_dwordx4 v[128:131], v4, s[8:11], s27 offen sc1
  s_lshr_b32 s27, s23, 2
  s_add_u32 s27, s27, 16
  s_lshl_b32 s27, s27, 13
  s_add_u32 s27, s27, s26
  s_and_b32 s33, s23, 3
  s_lshl_b32 s33, s33, 8
  s_add_u32 s27, s27, s33
  v_lshlrev_b32 v6, 4, v3
  v_lshl_add_u32 v6, v5, 3, v6
  v_add_u32 v6, v6, v16
  buffer_store_dwordx2 v[132:133], v6, s[8:11], s27 offen sc1
  v_pk_add_f32 v[84:85], v[84:85], v[88:89]
  v_pk_add_f32 v[86:87], v[86:87], v[90:91]
  v_add_f32 v84, v84, v85
  v_add_f32 v86, v86, v87
  s_nop 1
  v_permlane32_swap_b32 v84, v86
  v_add_f32 v84, v84, v86
  v_mov_b32 v86, v84
  s_nop 1
  v_permlane16_swap_b32 v84, v86
  v_add_f32 v84, v84, v86
  v_lshlrev_b32 v6, 3, v3
  v_lshl_add_u32 v6, v5, 1, v6
  v_and_b32 v7, 1, v5
  v_lshlrev_b32 v7, 31, v7
  v_add_u32 v6, v6, v7
  s_lshl_b32 s26, s22, 2
  s_add_u32 s26, s26, s3
  s_lshl_b32 s26, s26, 3
  s_add_u32 s26, s26, s23
  s_lshl_b32 s26, s26, 7
  buffer_store_dword v84, v6, s[16:19], s26 offen sc1
  v_accvgpr_write_b32 a240, v112
  v_accvgpr_write_b32 a241, v113
  v_accvgpr_write_b32 a242, v114
  v_accvgpr_write_b32 a243, v115
  v_accvgpr_write_b32 a244, v116
  v_accvgpr_write_b32 a245, v117
  v_accvgpr_write_b32 a246, v118
  v_accvgpr_write_b32 a247, v119
  v_accvgpr_write_b32 a248, v120
  v_accvgpr_write_b32 a249, v121
  s_lshl_b32 s26, s50, 10
  v_add_u32 v10, s26, v4
  v_add_u32 v14, 65536, v10
  s_lshl_b32 s26, s51, 10
  v_add_u32 v11, s26, v4
  v_add_u32 v15, 65536, v11
  s_lshl_b32 s26, s52, 10
  v_add_u32 v12, s26, v4
  v_add_u32 v16, 65536, v12
  s_lshl_b32 s26, s53, 10
  v_add_u32 v13, s26, v4
  v_add_u32 v17, 65536, v13
  s_add_u32 s36, s4, 147456
  s_addc_u32 s37, s5, 0
  s_mov_b32 s38, 36864
  s_mov_b32 s39, 0x20000
  v_add_u32 v18, 110592, v4
  v_and_b32 v8, 127, v0
  v_lshrrev_b32 v7, 4, v8
  v_lshlrev_b32 v7, 10, v7
  v_lshl_add_u32 v7, v3, 3, v7
  v_lshlrev_b32 v8, 3, v8
  v_add_u32 v8, 147456, v8
  v_lshlrev_b32 v19, 4, v0
  v_cmp_lt_u32 vcc, 143, v0
  v_mov_b32 v20, 0x80000000
  s_nop 0
  v_cndmask_b32 v9, v19, v20, vcc
  v_add_u32 v19, 148480, v19
  s_mul_i32 s45, s21, 2304
  s_mul_i32 s43, s20, 147456
  s_lshl_b32 s41, s3, 12
  s_add_u32 s43, s43, s41
  s_mov_b32 s40, s43
  s_add_u32 s30, s48, 9216
  s_add_u32 s31, s49, 9216
  s_lshr_b32 s26, s3, 1
  s_mul_i32 s26, s26, 165888
  s_and_b32 s27, s3, 1
  s_mul_i32 s27, s27, 9216
  s_sub_u32 s28, s27, s26
  s_add_u32 s28, s28, s42
  s_add_u32 s28, s28, 313344
  s_mul_i32 s29, s3, 9216
  s_add_u32 s29, s29, 110592
  s_lshl_b32 s25, s20, 4
  s_lshl_b32 s33, s22, 3
  s_add_u32 s33, s33, s23
  s_waitcnt vmcnt(0)
  s_barrier
  s_cmp_lg_u32 s3, 0
  s_cbranch_scc1 L_sig_9
  s_lshl_b32 s24, s33, 6
  s_add_u32 s24, s24, 32768
  v_mov_b32 v1, 0
  v_mov_b32 v6, s97
  s_mov_b64 exec, 1
  buffer_store_dword v6, v1, s[56:59], s24 offen sc1
  s_mov_b64 exec, -1
L_sig_9:
  buffer_load_dwordx4 a[0:3], v215, s[12:15], s32 offen offset:0 sc1
  buffer_load_dwordx4 a[4:7], v215, s[12:15], s32 offen offset:1024 sc1
  buffer_load_dwordx4 a[8:11], v215, s[12:15], s32 offen offset:2048 sc1
  buffer_load_dwordx4 a[12:15], v215, s[12:15], s32 offen offset:3072 sc1
  s_add_u32 s32, s32, 4096
  buffer_load_dwordx4 a[16:19], v215, s[12:15], s32 offen offset:0 sc1
  buffer_load_dwordx4 a[20:23], v215, s[12:15], s32 offen offset:1024 sc1
  buffer_load_dwordx4 a[24:27], v215, s[12:15], s32 offen offset:2048 sc1
  buffer_load_dwordx4 a[28:31], v215, s[12:15], s32 offen offset:3072 sc1
  s_add_u32 s32, s32, 4096
  buffer_load_dwordx4 a[32:35], v215, s[12:15], s32 offen offset:0 sc1
  buffer_load_dwordx4 a[36:39], v215, s[12:15], s32 offen offset:1024 sc1
  buffer_load_dwordx4 a[40:43], v215, s[12:15], s32 offen offset:2048 sc1
  buffer_load_dwordx4 a[44:47], v215, s[12:15], s32 offen offset:3072 sc1
  s_add_u32 s32, s32, 4096
  buffer_load_dwordx4 a[48:51], v215, s[12:15], s32 offen offset:0 sc1
  buffer_load_dwordx4 a[52:55], v215, s[12:15], s32 offen offset:1024 sc1
  buffer_load_dwordx4 a[56:59], v215, s[12:15], s32 offen offset:2048 sc1
  buffer_load_dwordx4 a[60:63], v215, s[12:15], s32 offen offset:3072 sc1
  s_add_u32 s32, s32, 4096
  buffer_load_dwordx4 a[64:67], v215, s[12:15], s32 offen offset:0 sc1
  buffer_load_dwordx4 a[68:71], v215, s[12:15], s32 offen offset:1024 sc1
  s_add_u32 m0, s29, 0
  s_nop 0
  buffer_load_dwordx4 v4, s[12:15], s28 offen offset:0 sc1 lds
  buffer_load_dwordx4 v4, s[12:15], s28 offen offset:1024 sc1 lds
  buffer_load_dwordx4 v4, s[12:15], s28 offen offset:2048 sc1 lds
  buffer_load_dwordx4 v4, s[12:15], s28 offen offset:3072 sc1 lds
  s_add_u32 m0, s29, 4096
  s_add_u32 s28, s28, 4096
  buffer_load_dwordx4 v4, s[12:15], s28 offen offset:0 sc1 lds
  buffer_load_dwordx4 v4, s[12:15], s28 offen offset:1024 sc1 lds
  buffer_load_dwordx4 v4, s[12:15], s28 offen offset:2048 sc1 lds
  buffer_load_dwordx4 v4, s[12:15], s28 offen offset:3072 sc1 lds
  s_add_u32 m0, s29, 8192
  s_add_u32 s28, s28, 4096
  buffer_load_dwordx4 v4, s[12:15], s28 offen offset:0 sc1 lds
  s_waitcnt vmcnt(9)
  v_and_b32 v214, 1, v3
  v_mul_u32_u24 v214, 1280, v214
  v_lshl_add_u32 v214, v5, 4, v214
  v_add_u32 v214, 158208, v214
  v_lshlrev_b32 v213, 6, v3
  v_lshl_add_u32 v213, v5, 4, v213
  v_cmp_gt_u32 vcc, 2, v3
  v_mov_b32 v212, 0x80000000
  s_nop 0
  v_cndmask_b32 v213, v212, v213, vcc
  v_or_b32 v213, s55, v213
  v_mov_b32 v212, 0x7fc00000
  ds_read_b128 v[176:179], v214 offset:0
  ds_read_b128 v[180:183], v214 offset:64
  ds_read_b128 v[184:187], v214 offset:128
  ds_read_b128 v[188:191], v214 offset:192
  ds_read_b128 v[192:195], v214 offset:256
  ds_read_b128 v[196:199], v214 offset:320
  s_waitcnt lgkmcnt(0)
  v_mfma_f32_16x16x32_bf16 v[208:211], a[0:3], v[176:179], 0
  v_mfma_f32_16x16x32_bf16 v[208:211], a[4:7], v[180:183], v[208:211]
  v_mfma_f32_16x16x32_bf16 v[208:211], a[8:11], v[184:187], v[208:211]
  v_mfma_f32_16x16x32_bf16 v[208:211], a[12:15], v[188:191], v[208:211]
  v_mfma_f32_16x16x32_bf16 v[208:211], a[16:19], v[192:195], v[208:211]
  v_mfma_f32_16x16x32_bf16 v[208:211], a[20:23], v[196:199], v[208:211]
  ds_read_b128 v[176:179], v214 offset:384
  ds_read_b128 v[180:183], v214 offset:448
  ds_read_b128 v[184:187], v214 offset:512
  ds_read_b128 v[188:191], v214 offset:576
  ds_read_b128 v[192:195], v214 offset:640
  ds_read_b128 v[196:199], v214 offset:704
  s_waitcnt lgkmcnt(0)
  v_mfma_f32_16x16x32_bf16 v[208:211], a[24:27], v[176:179], v[208:211]
  v_mfma_f32_16x16x32_bf16 v[208:211], a[28:31], v[180:183], v[208:211]
  v_mfma_f32_16x16x32_bf16 v[208:211], a[32:35], v[184:187], v[208:211]
  v_mfma_f32_16x16x32_bf16 v[208:211], a[36:39], v[188:191], v[208:211]
  v_mfma_f32_16x16x32_bf16 v[208:211], a[40:43], v[192:195], v[208:211]
  v_mfma_f32_16x16x32_bf16 v[208:211], a[44:47], v[196:199], v[208:211]
  ds_read_b128 v[176:179], v214 offset:768
  ds_read_b128 v[180:183], v214 offset:832
  ds_read_b128 v[184:187], v214 offset:896
  ds_read_b128 v[188:191], v214 offset:960
  ds_read_b128 v[192:195], v214 offset:1024
  ds_read_b128 v[196:199], v214 offset:1088
  s_waitcnt lgkmcnt(0)
  v_mfma_f32_16x16x32_bf16 v[208:211], a[48:51], v[176:179], v[208:211]
  v_mfma_f32_16x16x32_bf16 v[208:211], a[52:55], v[180:183], v[208:211]
  v_mfma_f32_16x16x32_bf16 v[208:211], a[56:59], v[184:187], v[208:211]
  v_mfma_f32_16x16x32_bf16 v[208:211], a[60:63], v[188:191], v[208:211]
  v_mfma_f32_16x16x32_bf16 v[208:211], a[64:67], v[192:195], v[208:211]
  v_mfma_f32_16x16x32_bf16 v[208:211], a[68:71], v[196:199], v[208:211]
  s_nop 7
  v_cmp_eq_u32 vcc, -1, v208
  s_nop 1
  v_cndmask_b32 v208, v208, v212, vcc
  v_cmp_eq_u32 vcc, -1, v209
  s_nop 1
  v_cndmask_b32 v209, v209, v212, vcc
  v_cmp_eq_u32 vcc, -1, v210
  s_nop 1
  v_cndmask_b32 v210, v210, v212, vcc
  v_cmp_eq_u32 vcc, -1, v211
  s_nop 1
  v_cndmask_b32 v211, v211, v212, vcc
  buffer_store_dwordx4 v[208:211], v213, s[36:39], s54 offen sc1
  buffer_load_dwordx4 a[0:3], v4, s[12:15], s30 offen offset:0 sc1
  buffer_load_dwordx4 a[4:7], v4, s[12:15], s31 offen offset:0 sc1
  buffer_load_dwordx4 a[8:11], v4, s[12:15], s30 offen offset:1024 sc1
  buffer_load_dwordx4 a[12:15], v4, s[12:15], s31 offen offset:1024 sc1
  buffer_load_dwordx4 a[16:19], v4, s[12:15], s30 offen offset:2048 sc1
  buffer_load_dwordx4 a[20:23], v4, s[12:15], s31 offen offset:2048 sc1
  buffer_load_dwordx4 a[24:27], v4, s[12:15], s30 offen offset:3072 sc1
  s_add_u32 s30, s30, 4096
  buffer_load_dwordx4 a[28:31], v4, s[12:15], s31 offen offset:3072 sc1
  s_add_u32 s31, s31, 4096
  s_lshl_b32 s26, s20, 13
  s_cmp_lg_u32 s3, 0
  s_cbranch_scc1 L_aw_10_d
  s_lshl_b32 s24, s25, 6
  s_add_u32 s24, s24, 32768
  v_lshlrev_b32 v1, 6, v2
  s_mov_b64 exec, 0xffff
L_aw_10:
  buffer_load_dword v6, v1, s[56:59], s24 offen sc1
  s_waitcnt vmcnt(0)
  v_cmp_ne_u32 vcc, s97, v6
  s_nop 0
  s_cbranch_vccz L_aw_10_g
  s_branch L_aw_10
L_aw_10_g:
  s_mov_b64 exec, -1
L_aw_10_d:
  s_barrier
L_code_p3:
  s_add_u32 m0, s41, 0
  s_nop 0
  buffer_load_dwordx4 v4, s[8:11], s40 offen offset:0 sc1 lds
  buffer_load_dwordx4 v4, s[8:11], s40 offen offset:1024 sc1 lds
  buffer_load_dwordx4 v4, s[8:11], s40 offen offset:2048 sc1 lds
  buffer_load_dwordx4 v4, s[8:11], s40 offen offset:3072 sc1 lds
  s_add_u32 s40, s40, 16384
  buffer_load_dwordx2 v[152:153], v7, s[16:19], s26 offen offset:0 sc1
  buffer_load_dwordx2 v[154:155], v7, s[16:19], s26 offen offset:128 sc1
  buffer_load_dwordx2 v[156:157], v7, s[16:19], s26 offen offset:256 sc1
  buffer_load_dwordx2 v[158:159], v7, s[16:19], s26 offen offset:384 sc1
  buffer_load_dwordx2 v[160:161], v7, s[16:19], s26 offen offset:512 sc1
  buffer_load_dwordx2 v[162:163], v7, s[16:19], s26 offen offset:640 sc1
  buffer_load_dwordx2 v[164:165], v7, s[16:19], s26 offen offset:768 sc1
  buffer_load_dwordx2 v[166:167], v7, s[16:19], s26 offen offset:896 sc1
  s_add_u32 m0, s41, 16384
  s_nop 0
  buffer_load_dwordx4 v4, s[8:11], s40 offen offset:0 sc1 lds
  buffer_load_dwordx4 v4, s[8:11], s40 offen offset:1024 sc1 lds
  buffer_load_dwordx4 v4, s[8:11], s40 offen offset:2048 sc1 lds
  buffer_load_dwordx4 v4, s[8:11], s40 offen offset:3072 sc1 lds
  s_add_u32 s40, s40, 16384
  s_waitcnt vmcnt(12)
  s_barrier
  ds_read_b128 v[20:23], v10 offset:0
  ds_read_b128 v[24:27], v10 offset:1024
  ds_read_b128 v[52:55], v18 offset:0
  ds_read_b128 v[28:31], v11 offset:0
  ds_read_b128 v[32:35], v11 offset:1024
  ds_read_b128 v[36:39], v12 offset:0
  ds_read_b128 v[40:43], v12 offset:1024
  ds_read_b128 v[44:47], v13 offset:0
  ds_read_b128 v[48:51], v13 offset:1024
  s_waitcnt lgkmcnt(6)
  v_mfma_f32_16x16x32_bf16 v[72:75], a[144:147], v[20:23], 0
  s_add_u32 m0, s41, 32768
  v_mfma_f32_16x16x32_bf16 v[104:107], a[148:151], v[20:23], 0
  buffer_load_dwordx4 v4, s[8:11], s40 offen offset:0 sc1 lds
  v_mfma_f32_16x16x32_bf16 v[136:139], v[52:55], v[20:23], 0
  ds_read_b128 v[20:23], v10 offset:8192
  v_mfma_f32_16x16x32_bf16 v[76:79], a[144:147], v[24:27], 0
  buffer_load_dwordx4 v4, s[8:11], s40 offen offset:1024 sc1 lds
  v_mfma_f32_16x16x32_bf16 v[108:111], a[148:151], v[24:27], 0
  v_mfma_f32_16x16x32_bf16 v[140:143], v[52:55], v[24:27], 0
  ds_read_b128 v[24:27], v10 offset:9216
  s_waitcnt lgkmcnt(6)
  v_mfma_f32_16x16x32_bf16 v[80:83], a[144:147], v[28:31], 0
  ds_read_b128 v[52:55], v18 offset:1024
  v_mfma_f32_16x16x32_bf16 v[112:115], a[148:151], v[28:31], 0
  ds_read_b128 v[28:31], v11 offset:8192
  v_mfma_f32_16x16x32_bf16 v[84:87], a[144:147], v[32:35], 0
  buffer_load_dwordx4 v4, s[8:11], s40 offen offset:2048 sc1 lds
  v_mfma_f32_16x16x32_bf16 v[116:119], a[148:151], v[32:35], 0
  ds_read_b128 v[32:35], v11 offset:9216
  s_waitcnt lgkmcnt(7)
  v_mfma_f32_16x16x32_bf16 v[88:91], a[144:147], v[36:39], 0
  buffer_load_dwordx4 v4, s[8:11], s40 offen offset:3072 sc1 lds
  v_mfma_f32_16x16x32_bf16 v[120:123], a[148:151], v[36:39], 0
  ds_read_b128 v[36:39], v12 offset:8192
  s_add_u32 s40, s40, 16384
  v_mfma_f32_16x16x32_bf16 v[92:95], a[144:147], v[40:43], 0
  s_add_u32 m0, s41, 49152
  v_mfma_f32_16x16x32_bf16 v[124:127], a[148:151], v[40:43], 0
  ds_read_b128 v[40:43], v12 offset:9216
  s_waitcnt lgkmcnt(7)
  v_mfma_f32_16x16x32_bf16 v[96:99], a[144:147], v[44:47], 0
  buffer_load_dwordx4 v4, s[8:11], s40 offen offset:0 sc1 lds
  v_mfma_f32_16x16x32_bf16 v[128:131], a[148:151], v[44:47], 0
  ds_read_b128 v[44:47], v13 offset:8192
  v_mfma_f32_16x16x32_bf16 v[100:103], a[144:147], v[48:51], 0
  buffer_load_dwordx4 v4, s[8:11], s40 offen offset:1024 sc1 lds
  v_mfma_f32_16x16x32_bf16 v[132:135], a[148:151], v[48:51], 0
  s_waitcnt vmcnt(6)
  s_barrier
  s_waitcnt lgkmcnt(5)
  v_mfma_f32_16x16x32_bf16 v[72:75], a[152:155], v[20:23], v[72:75]
  ds_read_b128 v[48:51], v13 offset:9216
  v_mfma_f32_16x16x32_bf16 v[104:107], a[156:159], v[20:23], v[104:107]
  buffer_load_dwordx4 v4, s[8:11], s40 offen offset:2048 sc1 lds
  v_mfma_f32_16x16x32_bf16 v[136:139], v[52:55], v[20:23], v[136:139]
  ds_read_b128 v[20:23], v10 offset:16384
  v_mfma_f32_16x16x32_bf16 v[76:79], a[152:155], v[24:27], v[76:79]
  buffer_load_dwordx4 v4, s[8:11], s40 offen offset:3072 sc1 lds
  v_mfma_f32_16x16x32_bf16 v[108:111], a[156:159], v[24:27], v[108:111]
  s_add_u32 s40, s40, 16384
  v_mfma_f32_16x16x32_bf16 v[140:143], v[52:55], v[24:27], v[140:143]
  ds_read_b128 v[24:27], v10 offset:17408
  s_waitcnt lgkmcnt(6)
  v_mfma_f32_16x16x32_bf16 v[80:83], a[152:155], v[28:31], v[80:83]
  ds_read_b128 v[52:55], v18 offset:2048
  s_add_u32 m0, s41, 65536
  v_mfma_f32_16x16x32_bf16 v[112:115], a[156:159], v[28:31], v[112:115]
  ds_read_b128 v[28:31], v11 offset:16384
  v_mfma_f32_16x16x32_bf16 v[84:87], a[152:155], v[32:35], v[84:87]
  buffer_load_dwordx4 v4, s[8:11], s40 offen offset:0 sc1 lds
  v_mfma_f32_16x16x32_bf16 v[116:119], a[156:159], v[32:35], v[116:119]
  ds_read_b128 v[32:35], v11 offset:17408
  s_waitcnt lgkmcnt(7)
  v_mfma_f32_16x16x32_bf16 v[88:91], a[152:155], v[36:39], v[88:91]
  buffer_load_dwordx4 v4, s[8:11], s40 offen offset:1024 sc1 lds
  v_mfma_f32_16x16x32_bf16 v[120:123], a[156:159], v[36:39], v[120:123]
  ds_read_b128 v[36:39], v12 offset:16384
  v_mfma_f32_16x16x32_bf16 v[92:95], a[152:155], v[40:43], v[92:95]
  v_mfma_f32_16x16x32_bf16 v[124:127], a[156:159], v[40:43], v[124:127]
  ds_read_b128 v[40:43], v12 offset:17408
  s_waitcnt lgkmcnt(7)
  v_mfma_f32_16x16x32_bf16 v[96:99], a[152:155], v[44:47], v[96:99]
  buffer_load_dwordx4 v4, s[8:11], s40 offen offset:2048 sc1 lds
  v_mfma_f32_16x16x32_bf16 v[128:131], a[156:159], v[44:47], v[128:131]
  ds_read_b128 v[44:47], v13 offset:16384
  v_mfma_f32_16x16x32_bf16 v[100:103], a[152:155], v[48:51], v[100:103]
  buffer_load_dwordx4 v4, s[8:11], s40 offen offset:3072 sc1 lds
  v_mfma_f32_16x16x32_bf16 v[132:135], a[156:159], v[48:51], v[132:135]
  ds_read_b128 v[48:51], v13 offset:17408
  s_waitcnt lgkmcnt(6)
  v_mfma_f32_16x16x32_bf16 v[72:75], a[160:163], v[20:23], v[72:75]
  s_add_u32 s40, s40, 16384
  s_add_u32 m0, s41, 81920
  v_mfma_f32_16x16x32_bf16 v[104:107], a[164:167], v[20:23], v[104:107]
  buffer_load_dwordx4 v4, s[8:11], s40 offen offset:0 sc1 lds
  v_mfma_f32_16x16x32_bf16 v[136:139], v[52:55], v[20:23], v[136:139]
  ds_read_b128 v[20:23], v10 offset:24576
  v_mfma_f32_16x16x32_bf16 v[76:79], a[160:163], v[24:27], v[76:79]
  v_mfma_f32_16x16x32_bf16 v[108:111], a[164:167], v[24:27], v[108:111]
  buffer_load_dwordx4 v4, s[8:11], s40 offen offset:1024 sc1 lds
  v_mfma_f32_16x16x32_bf16 v[140:143], v[52:55], v[24:27], v[140:143]
  ds_read_b128 v[24:27], v10 offset:25600
  s_waitcnt lgkmcnt(6)
  v_mfma_f32_16x16x32_bf16 v[80:83], a[160:163], v[28:31], v[80:83]
  ds_read_b128 v[52:55], v18 offset:3072
  v_mfma_f32_16x16x32_bf16 v[112:115], a[164:167], v[28:31], v[112:115]
  ds_read_b128 v[28:31], v11 offset:24576
  v_mfma_f32_16x16x32_bf16 v[84:87], a[160:163], v[32:35], v[84:87]
  buffer_load_dwordx4 v4, s[8:11], s40 offen offset:2048 sc1 lds
  v_mfma_f32_16x16x32_bf16 v[116:119], a[164:167], v[32:35], v[116:119]
  ds_read_b128 v[32:35], v11 offset:25600
  s_waitcnt lgkmcnt(7)
  v_mfma_f32_16x16x32_bf16 v[88:91], a[160:163], v[36:39], v[88:91]
  buffer_load_dwordx4 v4, s[8:11], s40 offen offset:3072 sc1 lds
  v_mfma_f32_16x16x32_bf16 v[120:123], a[164:167], v[36:39], v[120:123]
  ds_read_b128 v[36:39], v12 offset:24576
  s_add_u32 s40, s40, 16384
  v_mfma_f32_16x16x32_bf16 v[92:95], a[160:163], v[40:43], v[92:95]
  v_mfma_f32_16x16x32_bf16 v[124:127], a[164:167], v[40:43], v[124:127]
  ds_read_b128 v[40:43], v12 offset:25600
  s_waitcnt lgkmcnt(7)
  v_mfma_f32_16x16x32_bf16 v[96:99], a[160:163], v[44:47], v[96:99]
  v_mfma_f32_16x16x32_bf16 v[128:131], a[164:167], v[44:47], v[128:131]
  ds_read_b128 v[44:47], v13 offset:24576
  v_mfma_f32_16x16x32_bf16 v[100:103], a[160:163], v[48:51], v[100:103]
  v_mfma_f32_16x16x32_bf16 v[132:135], a[164:167], v[48:51], v[132:135]
  s_waitcnt vmcnt(12)
  s_barrier
  s_waitcnt lgkmcnt(5)
  v_mfma_f32_16x16x32_bf16 v[72:75], a[168:171], v[20:23], v[72:75]
  ds_read_b128 v[48:51], v13 offset:25600
  s_add_u32 m0, s41, 0
  v_mfma_f32_16x16x32_bf16 v[104:107], a[172:175], v[20:23], v[104:107]
  buffer_load_dwordx4 v4, s[8:11], s40 offen offset:0 sc1 lds
  v_mfma_f32_16x16x32_bf16 v[136:139], v[52:55], v[20:23], v[136:139]
  ds_read_b128 v[20:23], v10 offset:32768
  v_mfma_f32_16x16x32_bf16 v[76:79], a[168:171], v[24:27], v[76:79]
  v_mfma_f32_16x16x32_bf16 v[108:111], a[172:175], v[24:27], v[108:111]
  v_mfma_f32_16x16x32_bf16 v[140:143], v[52:55], v[24:27], v[140:143]
  ds_read_b128 v[24:27], v10 offset:33792
  s_waitcnt lgkmcnt(6)
  v_mfma_f32_16x16x32_bf16 v[80:83], a[168:171], v[28:31], v[80:83]
  ds_read_b128 v[52:55], v18 offset:4096
  v_mfma_f32_16x16x32_bf16 v[112:115], a[172:175], v[28:31], v[112:115]
  ds_read_b128 v[28:31], v11 offset:32768
  v_mfma_f32_16x16x32_bf16 v[84:87], a[168:171], v[32:35], v[84:87]
  v_mfma_f32_16x16x32_bf16 v[116:119], a[172:175], v[32:35], v[116:119]
  ds_read_b128 v[32:35], v11 offset:33792
  s_waitcnt lgkmcnt(7)
  v_mfma_f32_16x16x32_bf16 v[88:91], a[168:171], v[36:39], v[88:91]
  buffer_load_dwordx4 v4, s[8:11], s40 offen offset:1024 sc1 lds
  v_mfma_f32_16x16x32_bf16 v[120:123], a[172:175], v[36:39], v[120:123]
  ds_read_b128 v[36:39], v12 offset:32768
  v_mfma_f32_16x16x32_bf16 v[92:95], a[168:171], v[40:43], v[92:95]
  v_mfma_f32_16x16x32_bf16 v[124:127], a[172:175], v[40:43], v[124:127]
  ds_read_b128 v[40:43], v12 offset:33792
  s_waitcnt lgkmcnt(7)
  v_mfma_f32_16x16x32_bf16 v[96:99], a[168:171], v[44:47], v[96:99]
  v_mfma_f32_16x16x32_bf16 v[128:131], a[172:175], v[44:47], v[128:131]
  ds_read_b128 v[44:47], v13 offset:32768
  v_mfma_f32_16x16x32_bf16 v[100:103], a[168:171], v[48:51], v[100:103]
  v_mfma_f32_16x16x32_bf16 v[132:135], a[172:175], v[48:51], v[132:135]
  ds_read_b128 v[48:51], v13 offset:33792
  s_waitcnt lgkmcnt(6)
  v_mfma_f32_16x16x32_bf16 v[72:75], a[176:179], v[20:23], v[72:75]
  buffer_load_dwordx4 v4, s[8:11], s40 offen offset:2048 sc1 lds
  v_mfma_f32_16x16x32_bf16 v[104:107], a[180:183], v[20:23], v[104:107]
  v_mfma_f32_16x16x32_bf16 v[136:139], v[52:55], v[20:23], v[136:139]
  ds_read_b128 v[20:23], v10 offset:40960
  v_mfma_f32_16x16x32_bf16 v[76:79], a[176:179], v[24:27], v[76:79]
  v_mfma_f32_16x16x32_bf16 v[108:111], a[180:183], v[24:27], v[108:111]
  v_mfma_f32_16x16x32_bf16 v[140:143], v[52:55], v[24:27], v[140:143]
  ds_read_b128 v[24:27], v10 offset:41984
  s_waitcnt lgkmcnt(6)
  v_mfma_f32_16x16x32_bf16 v[80:83], a[176:179], v[28:31], v[80:83]
  ds_read_b128 v[52:55], v18 offset:5120
  v_mfma_f32_16x16x32_bf16 v[112:115], a[180:183], v[28:31], v[112:115]
  ds_read_b128 v[28:31], v11 offset:40960
  v_mfma_f32_16x16x32_bf16 v[84:87], a[176:179], v[32:35], v[84:87]
  buffer_load_dwordx4 v4, s[8:11], s40 offen offset:3072 sc1 lds
  v_mfma_f32_16x16x32_bf16 v[116:119], a[180:183], v[32:35], v[116:119]
  ds_read_b128 v[32:35], v11 offset:41984
  s_waitcnt lgkmcnt(7)
  v_mfma_f32_16x16x32_bf16 v[88:91], a[176:179], v[36:39], v[88:91]
  s_add_u32 s40, s40, 16384
  buffer_load_dwordx4 a[32:35], v4, s[12:15], s30 offen offset:0 sc1
  v_mfma_f32_16x16x32_bf16 v[120:123], a[180:183], v[36:39], v[120:123]
  ds_read_b128 v[36:39], v12 offset:40960
  v_mfma_f32_16x16x32_bf16 v[92:95], a[176:179], v[40:43], v[92:95]
  buffer_load_dwordx4 a[36:39], v4, s[12:15], s31 offen offset:0 sc1
  v_mfma_f32_16x16x32_bf16 v[124:127], a[180:183], v[40:43], v[124:127]
  ds_read_b128 v[40:43], v12 offset:41984
  s_waitcnt lgkmcnt(7)
  v_mfma_f32_16x16x32_bf16 v[96:99], a[176:179], v[44:47], v[96:99]
  v_mfma_f32_16x16x32_bf16 v[128:131], a[180:183], v[44:47], v[128:131]
  ds_read_b128 v[44:47], v13 offset:40960
  v_mfma_f32_16x16x32_bf16 v[100:103], a[176:179], v[48:51], v[100:103]
  v_mfma_f32_16x16x32_bf16 v[132:135], a[180:183], v[48:51], v[132:135]
  s_waitcnt vmcnt(14)
  s_barrier
  s_waitcnt lgkmcnt(5)
  v_mfma_f32_16x16x32_bf16 v[72:75], a[184:187], v[20:23], v[72:75]
  ds_read_b128 v[48:51], v13 offset:41984
  v_mfma_f32_16x16x32_bf16 v[104:107], a[188:191], v[20:23], v[104:107]
  v_mfma_f32_16x16x32_bf16 v[136:139], v[52:55], v[20:23], v[136:139]
  ds_read_b128 v[20:23], v10 offset:49152
  v_mfma_f32_16x16x32_bf16 v[76:79], a[184:187], v[24:27], v[76:79]
  buffer_load_dwordx4 a[40:43], v4, s[12:15], s30 offen offset:1024 sc1
  v_mfma_f32_16x16x32_bf16 v[108:111], a[188:191], v[24:27], v[108:111]
  v_mfma_f32_16x16x32_bf16 v[140:143], v[52:55], v[24:27], v[140:143]
  ds_read_b128 v[24:27], v10 offset:50176
  s_waitcnt lgkmcnt(6)
  v_mfma_f32_16x16x32_bf16 v[80:83], a[184:187], v[28:31], v[80:83]
  ds_read_b128 v[52:55], v18 offset:6144
  v_mfma_f32_16x16x32_bf16 v[112:115], a[188:191], v[28:31], v[112:115]
  ds_read_b128 v[28:31], v11 offset:49152
  v_mfma_f32_16x16x32_bf16 v[84:87], a[184:187], v[32:35], v[84:87]
  v_mfma_f32_16x16x32_bf16 v[116:119], a[188:191], v[32:35], v[116:119]
  ds_read_b128 v[32:35], v11 offset:50176
  s_waitcnt lgkmcnt(7)
  v_mfma_f32_16x16x32_bf16 v[88:91], a[184:187], v[36:39], v[88:91]
  v_mfma_f32_16x16x32_bf16 v[120:123], a[188:191], v[36:39], v[120:123]
  ds_read_b128 v[36:39], v12 offset:49152
  v_mfma_f32_16x16x32_bf16 v[92:95], a[184:187], v[40:43], v[92:95]
  buffer_load_dwordx4 a[44:47], v4, s[12:15], s31 offen offset:1024 sc1
  v_mfma_f32_16x16x32_bf16 v[124:127], a[188:191], v[40:43], v[124:127]
  ds_read_b128 v[40:43], v12 offset:50176
  s_waitcnt lgkmcnt(7)
  v_mfma_f32_16x16x32_bf16 v[96:99], a[184:187], v[44:47], v[96:99]
  v_mfma_f32_16x16x32_bf16 v[128:131], a[188:191], v[44:47], v[128:131]
  ds_read_b128 v[44:47], v13 offset:49152
  v_mfma_f32_16x16x32_bf16 v[100:103], a[184:187], v[48:51], v[100:103]
  v_mfma_f32_16x16x32_bf16 v[132:135], a[188:191], v[48:51], v[132:135]
  ds_read_b128 v[48:51], v13 offset:50176
  s_waitcnt lgkmcnt(6)
  v_mfma_f32_16x16x32_bf16 v[72:75], a[192:195], v[20:23], v[72:75]
  v_mfma_f32_16x16x32_bf16 v[104:107], a[196:199], v[20:23], v[104:107]
  v_mfma_f32_16x16x32_bf16 v[136:139], v[52:55], v[20:23], v[136:139]
  ds_read_b128 v[20:23], v10 offset:57344
  v_mfma_f32_16x16x32_bf16 v[76:79], a[192:195], v[24:27], v[76:79]
  buffer_load_dwordx4 a[48:51], v4, s[12:15], s30 offen offset:2048 sc1
  v_mfma_f32_16x16x32_bf16 v[108:111], a[196:199], v[24:27], v[108:111]
  v_mfma_f32_16x16x32_bf16 v[140:143], v[52:55], v[24:27], v[140:143]
  ds_read_b128 v[24:27], v10 offset:58368
  s_waitcnt lgkmcnt(6)
  v_mfma_f32_16x16x32_bf16 v[80:83], a[192:195], v[28:31], v[80:83]
  ds_read_b128 v[52:55], v18 offset:7168
  v_mfma_f32_16x16x32_bf16 v[112:115], a[196:199], v[28:31], v[112:115]
  ds_read_b128 v[28:31], v11 offset:57344
  v_mfma_f32_16x16x32_bf16 v[84:87], a[192:195], v[32:35], v[84:87]
  v_mfma_f32_16x16x32_bf16 v[116:119], a[196:199], v[32:35], v[116:119]
  ds_read_b128 v[32:35], v11 offset:58368
  s_waitcnt lgkmcnt(7)
  v_mfma_f32_16x16x32_bf16 v[88:91], a[192:195], v[36:39], v[88:91]
  v_mfma_f32_16x16x32_bf16 v[120:123], a[196:199], v[36:39], v[120:123]
  ds_read_b128 v[36:39], v12 offset:57344
  v_mfma_f32_16x16x32_bf16 v[92:95], a[192:195], v[40:43], v[92:95]
  buffer_load_dwordx4 a[52:55], v4, s[12:15], s31 offen offset:2048 sc1
  v_mfma_f32_16x16x32_bf16 v[124:127], a[196:199], v[40:43], v[124:127]
  ds_read_b128 v[40:43], v12 offset:58368
  s_waitcnt lgkmcnt(7)
  v_mfma_f32_16x16x32_bf16 v[96:99], a[192:195], v[44:47], v[96:99]
  v_mfma_f32_16x16x32_bf16 v[128:131], a[196:199], v[44:47], v[128:131]
  ds_read_b128 v[44:47], v13 offset:57344
  v_mfma_f32_16x16x32_bf16 v[100:103], a[192:195], v[48:51], v[100:103]
  v_mfma_f32_16x16x32_bf16 v[132:135], a[196:199], v[48:51], v[132:135]
  s_waitcnt vmcnt(14)
  s_barrier
  s_waitcnt lgkmcnt(5)
  v_mfma_f32_16x16x32_bf16 v[72:75], a[200:203], v[20:23], v[72:75]
  ds_read_b128 v[48:51], v13 offset:58368
  v_mfma_f32_16x16x32_bf16 v[104:107], a[204:207], v[20:23], v[104:107]
  buffer_load_dwordx4 a[56:59], v4, s[12:15], s30 offen offset:3072 sc1
  v_mfma_f32_16x16x32_bf16 v[136:139], v[52:55], v[20:23], v[136:139]
  ds_read_b128 v[20:23], v14 offset:0
  s_add_u32 s30, s30, 4096
  v_mfma_f32_16x16x32_bf16 v[76:79], a[200:203], v[24:27], v[76:79]
  v_mfma_f32_16x16x32_bf16 v[108:111], a[204:207], v[24:27], v[108:111]
  v_mfma_f32_16x16x32_bf16 v[140:143], v[52:55], v[24:27], v[140:143]
  ds_read_b128 v[24:27], v14 offset:1024
  s_waitcnt lgkmcnt(6)
  v_mfma_f32_16x16x32_bf16 v[80:83], a[200:203], v[28:31], v[80:83]
  ds_read_b128 v[52:55], v18 offset:8192
  v_mfma_f32_16x16x32_bf16 v[112:115], a[204:207], v[28:31], v[112:115]
  ds_read_b128 v[28:31], v15 offset:0
  v_mfma_f32_16x16x32_bf16 v[84:87], a[200:203], v[32:35], v[84:87]
  v_mfma_f32_16x16x32_bf16 v[116:119], a[204:207], v[32:35], v[116:119]
  ds_read_b128 v[32:35], v15 offset:1024
  s_waitcnt lgkmcnt(7)
  v_mfma_f32_16x16x32_bf16 v[88:91], a[200:203], v[36:39], v[88:91]
  buffer_load_dwordx4 a[60:63], v4, s[12:15], s31 offen offset:3072 sc1
  v_mfma_f32_16x16x32_bf16 v[120:123], a[204:207], v[36:39], v[120:123]
  ds_read_b128 v[36:39], v16 offset:0
  s_add_u32 s31, s31, 4096
  v_mfma_f32_16x16x32_bf16 v[92:95], a[200:203], v[40:43], v[92:95]
  v_mfma_f32_16x16x32_bf16 v[124:127], a[204:207], v[40:43], v[124:127]
  ds_read_b128 v[40:43], v16 offset:1024
  s_waitcnt lgkmcnt(7)
  v_mfma_f32_16x16x32_bf16 v[96:99], a[200:203], v[44:47], v[96:99]
  v_mfma_f32_16x16x32_bf16 v[128:131], a[204:207], v[44:47], v[128:131]
  ds_read_b128 v[44:47], v17 offset:0
  v_mfma_f32_16x16x32_bf16 v[100:103], a[200:203], v[48:51], v[100:103]
  v_mfma_f32_16x16x32_bf16 v[132:135], a[204:207], v[48:51], v[132:135]
  ds_read_b128 v[48:51], v17 offset:1024
  s_waitcnt lgkmcnt(6)
  v_mfma_f32_16x16x32_bf16 v[72:75], a[208:211], v[20:23], v[72:75]
  buffer_load_dwordx4 a[64:67], v4, s[12:15], s30 offen offset:0 sc1
  v_mfma_f32_16x16x32_bf16 v[104:107], a[212:215], v[20:23], v[104:107]
  v_mfma_f32_16x16x32_bf16 v[136:139], v[52:55], v[20:23], v[136:139]
  ds_read_b128 v[20:23], v14 offset:8192
  v_mfma_f32_16x16x32_bf16 v[76:79], a[208:211], v[24:27], v[76:79]
  v_mfma_f32_16x16x32_bf16 v[108:111], a[212:215], v[24:27], v[108:111]
  v_mfma_f32_16x16x32_bf16 v[140:143], v[52:55], v[24:27], v[140:143]
  ds_read_b128 v[24:27], v14 offset:9216
  s_waitcnt lgkmcnt(6)
  v_mfma_f32_16x16x32_bf16 v[80:83], a[208:211], v[28:31], v[80:83]
  ds_read_b128 v[52:55], v18 offset:9216
  v_mfma_f32_16x16x32_bf16 v[112:115], a[212:215], v[28:31], v[112:115]
  ds_read_b128 v[28:31], v15 offset:8192
  v_mfma_f32_16x16x32_bf16 v[84:87], a[208:211], v[32:35], v[84:87]
  v_mfma_f32_16x16x32_bf16 v[116:119], a[212:215], v[32:35], v[116:119]
  ds_read_b128 v[32:35], v15 offset:9216
  s_waitcnt lgkmcnt(7)
  v_mfma_f32_16x16x32_bf16 v[88:91], a[208:211], v[36:39], v[88:91]
  buffer_load_dwordx4 a[68:71], v4, s[12:15], s31 offen offset:0 sc1
  v_mfma_f32_16x16x32_bf16 v[120:123], a[212:215], v[36:39], v[120:123]
  ds_read_b128 v[36:39], v16 offset:8192
  s_add_u32 m0, s41, 16384
  v_mfma_f32_16x16x32_bf16 v[92:95], a[208:211], v[40:43], v[92:95]
  buffer_load_dwordx4 v4, s[8:11], s40 offen offset:0 sc1 lds
  v_mfma_f32_16x16x32_bf16 v[124:127], a[212:215], v[40:43], v[124:127]
  ds_read_b128 v[40:43], v16 offset:9216
  s_waitcnt lgkmcnt(7)
  v_mfma_f32_16x16x32_bf16 v[96:99], a[208:211], v[44:47], v[96:99]
  buffer_load_dwordx4 v4, s[8:11], s40 offen offset:1024 sc1 lds
  v_mfma_f32_16x16x32_bf16 v[128:131], a[212:215], v[44:47], v[128:131]
  ds_read_b128 v[44:47], v17 offset:8192
  buffer_load_dwordx4 v4, s[8:11], s40 offen offset:2048 sc1 lds
  v_mfma_f32_16x16x32_bf16 v[100:103], a[208:211], v[48:51], v[100:103]
  buffer_load_dwordx4 v4, s[8:11], s40 offen offset:3072 sc1 lds
  v_mfma_f32_16x16x32_bf16 v[132:135], a[212:215], v[48:51], v[132:135]
  s_waitcnt vmcnt(18)
  s_barrier
  s_waitcnt lgkmcnt(5)
  v_mfma_f32_16x16x32_bf16 v[72:75], a[216:219], v[20:23], v[72:75]
  ds_read_b128 v[48:51], v17 offset:9216
  s_add_u32 s40, s40, 16384
  v_mfma_f32_16x16x32_bf16 v[104:107], a[72:75], v[20:23], v[104:107]
  s_add_u32 m0, s41, 32768
  s_nop 0
  buffer_load_dwordx4 v4, s[8:11], s40 offen offset:0 sc1 lds
  v_mfma_f32_16x16x32_bf16 v[136:139], v[52:55], v[20:23], v[136:139]
  ds_read_b128 v[20:23], v14 offset:16384
  buffer_load_dwordx4 v4, s[8:11], s40 offen offset:1024 sc1 lds
  v_mfma_f32_16x16x32_bf16 v[76:79], a[216:219], v[24:27], v[76:79]
  buffer_load_dwordx4 v4, s[8:11], s40 offen offset:2048 sc1 lds
  v_mfma_f32_16x16x32_bf16 v[108:111], a[72:75], v[24:27], v[108:111]
  buffer_load_dwordx4 v4, s[8:11], s40 offen offset:3072 sc1 lds
  v_mfma_f32_16x16x32_bf16 v[140:143], v[52:55], v[24:27], v[140:143]
  ds_read_b128 v[24:27], v14 offset:17408
  s_waitcnt lgkmcnt(6)
  v_mfma_f32_16x16x32_bf16 v[80:83], a[216:219], v[28:31], v[80:83]
  ds_read_b128 v[52:55], v18 offset:10240
  s_add_u32 s40, s40, 16384
  v_mfma_f32_16x16x32_bf16 v[112:115], a[72:75], v[28:31], v[112:115]
  ds_read_b128 v[28:31], v15 offset:16384
  v_mfma_f32_16x16x32_bf16 v[84:87], a[216:219], v[32:35], v[84:87]
  v_mfma_f32_16x16x32_bf16 v[116:119], a[72:75], v[32:35], v[116:119]
  ds_read_b128 v[32:35], v15 offset:17408
  s_waitcnt lgkmcnt(7)
  v_mfma_f32_16x16x32_bf16 v[88:91], a[216:219], v[36:39], v[88:91]
  v_mfma_f32_16x16x32_bf16 v[120:123], a[72:75], v[36:39], v[120:123]
  ds_read_b128 v[36:39], v16 offset:16384
  v_mfma_f32_16x16x32_bf16 v[92:95], a[216:219], v[40:43], v[92:95]
  v_mfma_f32_16x16x32_bf16 v[124:127], a[72:75], v[40:43], v[124:127]
  ds_read_b128 v[40:43], v16 offset:17408
  s_waitcnt lgkmcnt(7)
  v_mfma_f32_16x16x32_bf16 v[96:99], a[216:219], v[44:47], v[96:99]
  v_mfma_f32_16x16x32_bf16 v[128:131], a[72:75], v[44:47], v[128:131]
  ds_read_b128 v[44:47], v17 offset:16384
  v_mfma_f32_16x16x32_bf16 v[100:103], a[216:219], v[48:51], v[100:103]
  v_mfma_f32_16x16x32_bf16 v[132:135], a[72:75], v[48:51], v[132:135]
  ds_read_b128 v[48:51], v17 offset:17408
  s_waitcnt lgkmcnt(6)
  v_mfma_f32_16x16x32_bf16 v[72:75], a[76:79], v[20:23], v[72:75]
  buffer_load_dwordx4 v[144:147], v9, s[36:39], s45 offen sc1
  v_mfma_f32_16x16x32_bf16 v[104:107], a[80:83], v[20:23], v[104:107]
  s_add_u32 s46, s48, 4096
  v_mfma_f32_16x16x32_bf16 v[136:139], v[52:55], v[20:23], v[136:139]
  ds_read_b128 v[20:23], v14 offset:24576
  v_mfma_f32_16x16x32_bf16 v[76:79], a[76:79], v[24:27], v[76:79]
  buffer_load_dwordx4 a[192:195], v4, s[12:15], s46 offen offset:2048 sc1
  v_mfma_f32_16x16x32_bf16 v[108:111], a[80:83], v[24:27], v[108:111]
  v_mfma_f32_16x16x32_bf16 v[140:143], v[52:55], v[24:27], v[140:143]
  ds_read_b128 v[24:27], v14 offset:25600
  s_waitcnt lgkmcnt(6)
  v_mfma_f32_16x16x32_bf16 v[80:83], a[76:79], v[28:31], v[80:83]
  ds_read_b128 v[52:55], v18 offset:11264
  s_add_u32 s47, s49, 4096
  v_mfma_f32_16x16x32_bf16 v[112:115], a[80:83], v[28:31], v[112:115]
  ds_read_b128 v[28:31], v15 offset:24576
  v_mfma_f32_16x16x32_bf16 v[84:87], a[76:79], v[32:35], v[84:87]
  buffer_load_dwordx4 a[196:199], v4, s[12:15], s47 offen offset:2048 sc1
  v_mfma_f32_16x16x32_bf16 v[116:119], a[80:83], v[32:35], v[116:119]
  ds_read_b128 v[32:35], v15 offset:25600
  s_waitcnt lgkmcnt(7)
  v_mfma_f32_16x16x32_bf16 v[88:91], a[76:79], v[36:39], v[88:91]
  v_mfma_f32_16x16x32_bf16 v[120:123], a[80:83], v[36:39], v[120:123]
  ds_read_b128 v[36:39], v16 offset:24576
  v_mfma_f32_16x16x32_bf16 v[92:95], a[76:79], v[40:43], v[92:95]
  buffer_load_dwordx4 a[200:203], v4, s[12:15], s46 offen offset:3072 sc1
  v_mfma_f32_16x16x32_bf16 v[124:127], a[80:83], v[40:43], v[124:127]
  ds_read_b128 v[40:43], v16 offset:25600
  s_waitcnt lgkmcnt(7)
  v_mfma_f32_16x16x32_bf16 v[96:99], a[76:79], v[44:47], v[96:99]
  s_add_u32 s46, s46, 4096
  v_mfma_f32_16x16x32_bf16 v[128:131], a[80:83], v[44:47], v[128:131]
  ds_read_b128 v[44:47], v17 offset:24576
  v_mfma_f32_16x16x32_bf16 v[100:103], a[76:79], v[48:51], v[100:103]
  v_mfma_f32_16x16x32_bf16 v[132:135], a[80:83], v[48:51], v[132:135]
  s_waitcnt vmcnt(22)
  s_barrier
  s_waitcnt lgkmcnt(5)
  v_mfma_f32_16x16x32_bf16 v[72:75], a[84:87], v[20:23], v[72:75]
  ds_read_b128 v[48:51], v17 offset:25600
  v_mfma_f32_16x16x32_bf16 v[104:107], a[88:91], v[20:23], v[104:107]
  buffer_load_dwordx4 a[204:207], v4, s[12:15], s47 offen offset:3072 sc1
  v_mfma_f32_16x16x32_bf16 v[136:139], v[52:55], v[20:23], v[136:139]
  ds_read_b128 v[20:23], v10 offset:0
  s_add_u32 s47, s47, 4096
  v_mfma_f32_16x16x32_bf16 v[76:79], a[84:87], v[24:27], v[76:79]
  v_mfma_f32_16x16x32_bf16 v[108:111], a[88:91], v[24:27], v[108:111]
  v_mfma_f32_16x16x32_bf16 v[140:143], v[52:55], v[24:27], v[140:143]
  ds_read_b128 v[24:27], v10 offset:1024
  s_waitcnt lgkmcnt(6)
  v_mfma_f32_16x16x32_bf16 v[80:83], a[84:87], v[28:31], v[80:83]
  ds_read_b128 v[52:55], v18 offset:12288
  v_mfma_f32_16x16x32_bf16 v[112:115], a[88:91], v[28:31], v[112:115]
  ds_read_b128 v[28:31], v11 offset:0
  v_mfma_f32_16x16x32_bf16 v[84:87], a[84:87], v[32:35], v[84:87]
  buffer_load_dwordx4 a[208:211], v4, s[12:15], s46 offen offset:0 sc1
  v_mfma_f32_16x16x32_bf16 v[116:119], a[88:91], v[32:35], v[116:119]
  ds_read_b128 v[32:35], v11 offset:1024
  s_waitcnt lgkmcnt(7)
  v_mfma_f32_16x16x32_bf16 v[88:91], a[84:87], v[36:39], v[88:91]
  v_mfma_f32_16x16x32_bf16 v[120:123], a[88:91], v[36:39], v[120:123]
  ds_read_b128 v[36:39], v12 offset:0
  v_mfma_f32_16x16x32_bf16 v[92:95], a[84:87], v[40:43], v[92:95]
  buffer_load_dwordx4 a[212:215], v4, s[12:15], s47 offen offset:0 sc1
  v_mfma_f32_16x16x32_bf16 v[124:127], a[88:91], v[40:43], v[124:127]
  ds_read_b128 v[40:43], v12 offset:1024
  s_waitcnt lgkmcnt(7)
  v_mfma_f32_16x16x32_bf16 v[96:99], a[84:87], v[44:47], v[96:99]
  v_mfma_f32_16x16x32_bf16 v[128:131], a[88:91], v[44:47], v[128:131]
  ds_read_b128 v[44:47], v13 offset:0
  v_mfma_f32_16x16x32_bf16 v[100:103], a[84:87], v[48:51], v[100:103]
  v_mfma_f32_16x16x32_bf16 v[132:135], a[88:91], v[48:51], v[132:135]
  ds_read_b128 v[48:51], v13 offset:1024
  s_waitcnt vmcnt(6)
L_m_uvchk:
  v_max_u32 v148, v144, v145
  v_max3_u32 v148, v148, v146, v147
  v_cmp_eq_u32 vcc, -1, v148
  s_nop 0
  s_cbranch_vccz L_m_uvok
  buffer_load_dwordx4 v[144:147], v9, s[36:39], s45 offen sc1
  s_waitcnt vmcnt(0)
  s_branch L_m_uvchk
L_m_uvok:
  ds_write_b128 v19, v[144:147]
  s_waitcnt lgkmcnt(7)
  v_mfma_f32_16x16x32_bf16 v[72:75], a[92:95], v[20:23], v[72:75]
  s_lshl_b32 s100, s2, 2
  s_add_u32 s100, s100, s3
  s_lshl_b32 s100, s100, 13
  s_add_u32 s100, s100, 0
  v_add_u32 v1, s100, v4
  global_load_dwordx4 a[252:255], v1, s[34:35]
  v_mfma_f32_16x16x32_bf16 v[104:107], a[96:99], v[20:23], v[104:107]
  v_add_f32 v152, v152, v154
  v_add_f32 v153, v153, v155
  v_mfma_f32_16x16x32_bf16 v[136:139], v[52:55], v[20:23], v[136:139]
  ds_read_b128 v[20:23], v10 offset:8192
  v_add_f32 v156, v156, v158
  v_mfma_f32_16x16x32_bf16 v[76:79], a[92:95], v[24:27], v[76:79]
  v_add_f32 v157, v157, v159
  v_add_f32 v160, v160, v162
  v_mfma_f32_16x16x32_bf16 v[108:111], a[96:99], v[24:27], v[108:111]
  v_add_f32 v161, v161, v163
  v_add_f32 v164, v164, v166
  v_mfma_f32_16x16x32_bf16 v[140:143], v[52:55], v[24:27], v[140:143]
  ds_read_b128 v[24:27], v10 offset:9216
  s_waitcnt lgkmcnt(7)
  v_mfma_f32_16x16x32_bf16 v[80:83], a[92:95], v[28:31], v[80:83]
  ds_read_b128 v[52:55], v18 offset:13312
  v_add_f32 v165, v165, v167
  v_mfma_f32_16x16x32_bf16 v[112:115], a[96:99], v[28:31], v[112:115]
  ds_read_b128 v[28:31], v11 offset:8192
  v_add_f32 v152, v152, v156
  v_mfma_f32_16x16x32_bf16 v[84:87], a[92:95], v[32:35], v[84:87]
  s_lshl_b32 s100, s2, 2
  s_add_u32 s100, s100, s3
  s_lshl_b32 s100, s100, 13
  s_add_u32 s100, s100, 1024
  v_add_u32 v1, s100, v4
  global_load_dwordx4 a[252:255], v1, s[34:35]
  v_mfma_f32_16x16x32_bf16 v[116:119], a[96:99], v[32:35], v[116:119]
  ds_read_b128 v[32:35], v11 offset:9216
  s_waitcnt lgkmcnt(8)
  v_mfma_f32_16x16x32_bf16 v[88:91], a[92:95], v[36:39], v[88:91]
  v_add_f32 v153, v153, v157
  v_add_f32 v160, v160, v164
  v_mfma_f32_16x16x32_bf16 v[120:123], a[96:99], v[36:39], v[120:123]
  ds_read_b128 v[36:39], v12 offset:8192
  v_add_f32 v161, v161, v165
  v_mfma_f32_16x16x32_bf16 v[92:95], a[92:95], v[40:43], v[92:95]
  v_add_f32 v152, v152, v160
  v_add_f32 v153, v153, v161
  v_mfma_f32_16x16x32_bf16 v[124:127], a[96:99], v[40:43], v[124:127]
  ds_read_b128 v[40:43], v12 offset:9216
  s_waitcnt lgkmcnt(8)
  v_mfma_f32_16x16x32_bf16 v[96:99], a[92:95], v[44:47], v[96:99]
  v_mul_f32 v152, 0x3ae38e39, v152
  v_mul_f32 v153, 0x3ae38e39, v153
  v_mfma_f32_16x16x32_bf16 v[128:131], a[96:99], v[44:47], v[128:131]
  ds_read_b128 v[44:47], v13 offset:8192
  v_fma_f32 v153, -v152, v152, v153
  v_mfma_f32_16x16x32_bf16 v[100:103], a[92:95], v[48:51], v[100:103]
  v_max_f32 v153, 0, v153
  v_add_f32 v153, 0x3727c5ac, v153
  v_mfma_f32_16x16x32_bf16 v[132:135], a[96:99], v[48:51], v[132:135]
  s_barrier
  s_waitcnt lgkmcnt(5)
  v_mfma_f32_16x16x32_bf16 v[72:75], a[100:103], v[20:23], v[72:75]
  ds_read_b128 v[48:51], v13 offset:9216
  v_mfma_f32_16x16x32_bf16 v[104:107], a[104:107], v[20:23], v[104:107]
  s_lshl_b32 s100, s2, 2
  s_add_u32 s100, s100, s3
  s_lshl_b32 s100, s100, 13
  s_add_u32 s100, s100, 2048
  v_add_u32 v1, s100, v4
  global_load_dwordx4 a[252:255], v1, s[34:35]
  v_mfma_f32_16x16x32_bf16 v[136:139], v[52:55], v[20:23], v[136:139]
  ds_read_b128 v[20:23], v10 offset:16384
  v_mfma_f32_16x16x32_bf16 v[76:79], a[100:103], v[24:27], v[76:79]
  v_rsq_f32 v153, v153
  v_mfma_f32_16x16x32_bf16 v[108:111], a[104:107], v[24:27], v[108:111]
  v_mul_f32 v152, v152, v153
  v_sub_f32 v152, 0, v152
  v_mfma_f32_16x16x32_bf16 v[140:143], v[52:55], v[24:27], v[140:143]
  ds_read_b128 v[24:27], v10 offset:17408
  s_waitcnt lgkmcnt(6)
  v_mfma_f32_16x16x32_bf16 v[80:83], a[100:103], v[28:31], v[80:83]
  ds_read_b128 v[52:55], v18 offset:14336
  ds_write_b64 v8, v[152:153]
  v_mfma_f32_16x16x32_bf16 v[112:115], a[104:107], v[28:31], v[112:115]
  ds_read_b128 v[28:31], v11 offset:16384
  v_mfma_f32_16x16x32_bf16 v[84:87], a[100:103], v[32:35], v[84:87]
  s_lshl_b32 s100, s2, 2
  s_add_u32 s100, s100, s3
  s_lshl_b32 s100, s100, 13
  s_add_u32 s100, s100, 3072
  v_add_u32 v1, s100, v4
  global_load_dwordx4 a[252:255], v1, s[34:35]
  v_mfma_f32_16x16x32_bf16 v[116:119], a[104:107], v[32:35], v[116:119]
  ds_read_b128 v[32:35], v11 offset:17408
  s_waitcnt lgkmcnt(8)
  v_mfma_f32_16x16x32_bf16 v[88:91], a[100:103], v[36:39], v[88:91]
  v_mfma_f32_16x16x32_bf16 v[120:123], a[104:107], v[36:39], v[120:123]
  ds_read_b128 v[36:39], v12 offset:16384
  v_mfma_f32_16x16x32_bf16 v[92:95], a[100:103], v[40:43], v[92:95]
  v_mfma_f32_16x16x32_bf16 v[124:127], a[104:107], v[40:43], v[124:127]
  ds_read_b128 v[40:43], v12 offset:17408
  s_waitcnt lgkmcnt(8)
  v_mfma_f32_16x16x32_bf16 v[96:99], a[100:103], v[44:47], v[96:99]
  v_mfma_f32_16x16x32_bf16 v[128:131], a[104:107], v[44:47], v[128:131]
  ds_read_b128 v[44:47], v13 offset:16384
  v_mfma_f32_16x16x32_bf16 v[100:103], a[100:103], v[48:51], v[100:103]
  s_lshl_b32 s100, s2, 2
  s_add_u32 s100, s100, s3
  s_lshl_b32 s100, s100, 13
  s_add_u32 s100, s100, 4096
  v_add_u32 v1, s100, v4
  global_load_dwordx4 a[252:255], v1, s[34:35]
  v_mfma_f32_16x16x32_bf16 v[132:135], a[104:107], v[48:51], v[132:135]
  ds_read_b128 v[48:51], v13 offset:17408
  s_waitcnt lgkmcnt(7)
  v_mfma_f32_16x16x32_bf16 v[72:75], a[108:111], v[20:23], v[72:75]
  v_mfma_f32_16x16x32_bf16 v[104:107], a[112:115], v[20:23], v[104:107]
  v_mfma_f32_16x16x32_bf16 v[136:139], v[52:55], v[20:23], v[136:139]
  ds_read_b128 v[20:23], v10 offset:24576
  v_mfma_f32_16x16x32_bf16 v[76:79], a[108:111], v[24:27], v[76:79]
  v_mfma_f32_16x16x32_bf16 v[108:111], a[112:115], v[24:27], v[108:111]
  v_mfma_f32_16x16x32_bf16 v[140:143], v[52:55], v[24:27], v[140:143]
  ds_read_b128 v[24:27], v10 offset:25600
  s_waitcnt lgkmcnt(6)
  v_mfma_f32_16x16x32_bf16 v[80:83], a[108:111], v[28:31], v[80:83]
  ds_read_b128 v[52:55], v18 offset:15360
  v_mfma_f32_16x16x32_bf16 v[112:115], a[112:115], v[28:31], v[112:115]
  ds_read_b128 v[28:31], v11 offset:24576
  v_mfma_f32_16x16x32_bf16 v[84:87], a[108:111], v[32:35], v[84:87]
  s_lshl_b32 s100, s2, 2
  s_add_u32 s100, s100, s3
  s_lshl_b32 s100, s100, 13
  s_add_u32 s100, s100, 5120
  v_add_u32 v1, s100, v4
  global_load_dwordx4 a[252:255], v1, s[34:35]
  v_mfma_f32_16x16x32_bf16 v[116:119], a[112:115], v[32:35], v[116:119]
  ds_read_b128 v[32:35], v11 offset:25600
  s_waitcnt lgkmcnt(7)
  v_mfma_f32_16x16x32_bf16 v[88:91], a[108:111], v[36:39], v[88:91]
  v_mfma_f32_16x16x32_bf16 v[120:123], a[112:115], v[36:39], v[120:123]
  ds_read_b128 v[36:39], v12 offset:24576
  v_mfma_f32_16x16x32_bf16 v[92:95], a[108:111], v[40:43], v[92:95]
  v_mfma_f32_16x16x32_bf16 v[124:127], a[112:115], v[40:43], v[124:127]
  ds_read_b128 v[40:43], v12 offset:25600
  s_waitcnt lgkmcnt(7)
  v_mfma_f32_16x16x32_bf16 v[96:99], a[108:111], v[44:47], v[96:99]
  v_mfma_f32_16x16x32_bf16 v[128:131], a[112:115], v[44:47], v[128:131]
  ds_read_b128 v[44:47], v13 offset:24576
  v_mfma_f32_16x16x32_bf16 v[100:103], a[108:111], v[48:51], v[100:103]
  s_lshl_b32 s100, s2, 2
  s_add_u32 s100, s100, s3
  s_lshl_b32 s100, s100, 13
  s_add_u32 s100, s100, 6144
  v_add_u32 v1, s100, v4
  global_load_dwordx4 a[252:255], v1, s[34:35]
  v_mfma_f32_16x16x32_bf16 v[132:135], a[112:115], v[48:51], v[132:135]
  s_barrier
  s_waitcnt lgkmcnt(5)
  v_mfma_f32_16x16x32_bf16 v[72:75], a[116:119], v[20:23], v[72:75]
  ds_read_b128 v[48:51], v13 offset:25600
  v_mfma_f32_16x16x32_bf16 v[104:107], a[120:123], v[20:23], v[104:107]
  v_mfma_f32_16x16x32_bf16 v[136:139], v[52:55], v[20:23], v[136:139]
  ds_read_b128 v[20:23], v10 offset:32768
  v_mfma_f32_16x16x32_bf16 v[76:79], a[116:119], v[24:27], v[76:79]
  v_mfma_f32_16x16x32_bf16 v[108:111], a[120:123], v[24:27], v[108:111]
  v_mfma_f32_16x16x32_bf16 v[140:143], v[52:55], v[24:27], v[140:143]
  ds_read_b128 v[24:27], v10 offset:33792
  s_waitcnt lgkmcnt(6)
  v_mfma_f32_16x16x32_bf16 v[80:83], a[116:119], v[28:31], v[80:83]
  ds_read_b128 v[52:55], v18 offset:16384
  v_mfma_f32_16x16x32_bf16 v[112:115], a[120:123], v[28:31], v[112:115]
  ds_read_b128 v[28:31], v11 offset:32768
  v_mfma_f32_16x16x32_bf16 v[84:87], a[116:119], v[32:35], v[84:87]
  s_lshl_b32 s100, s2, 2
  s_add_u32 s100, s100, s3
  s_lshl_b32 s100, s100, 13
  s_add_u32 s100, s100, 7168
  v_add_u32 v1, s100, v4
  global_load_dwordx4 a[252:255], v1, s[34:35]
  v_mfma_f32_16x16x32_bf16 v[116:119], a[120:123], v[32:35], v[116:119]
  ds_read_b128 v[32:35], v11 offset:33792
  s_waitcnt lgkmcnt(7)
  v_mfma_f32_16x16x32_bf16 v[88:91], a[116:119], v[36:39], v[88:91]
  v_mfma_f32_16x16x32_bf16 v[120:123], a[120:123], v[36:39], v[120:123]
  ds_read_b128 v[36:39], v12 offset:32768
  v_mfma_f32_16x16x32_bf16 v[92:95], a[116:119], v[40:43], v[92:95]
  v_mfma_f32_16x16x32_bf16 v[124:127], a[120:123], v[40:43], v[124:127]
  ds_read_b128 v[40:43], v12 offset:33792
  s_waitcnt lgkmcnt(7)
  v_mfma_f32_16x16x32_bf16 v[96:99], a[116:119], v[44:47], v[96:99]
  v_mfma_f32_16x16x32_bf16 v[128:131], a[120:123], v[44:47], v[128:131]
  ds_read_b128 v[44:47], v13 offset:32768
  v_mfma_f32_16x16x32_bf16 v[100:103], a[116:119], v[48:51], v[100:103]
  v_mfma_f32_16x16x32_bf16 v[132:135], a[120:123], v[48:51], v[132:135]
  ds_read_b128 v[48:51], v13 offset:33792
  s_waitcnt lgkmcnt(6)
  v_mfma_f32_16x16x32_bf16 v[72:75], a[124:127], v[20:23], v[72:75]
  v_mfma_f32_16x16x32_bf16 v[104:107], a[128:131], v[20:23], v[104:107]
  v_mfma_f32_16x16x32_bf16 v[136:139], v[52:55], v[20:23], v[136:139]
  ds_read_b128 v[20:23], v10 offset:40960
  v_mfma_f32_16x16x32_bf16 v[76:79], a[124:127], v[24:27], v[76:79]
  v_mfma_f32_16x16x32_bf16 v[108:111], a[128:131], v[24:27], v[108:111]
  v_mfma_f32_16x16x32_bf16 v[140:143], v[52:55], v[24:27], v[140:143]
  ds_read_b128 v[24:27], v10 offset:41984
  s_waitcnt lgkmcnt(6)
  v_mfma_f32_16x16x32_bf16 v[80:83], a[124:127], v[28:31], v[80:83]
  ds_read_b128 v[52:55], v18 offset:17408
  v_mfma_f32_16x16x32_bf16 v[112:115], a[128:131], v[28:31], v[112:115]
  ds_read_b128 v[28:31], v11 offset:40960
  v_mfma_f32_16x16x32_bf16 v[84:87], a[124:127], v[32:35], v[84:87]
  v_mfma_f32_16x16x32_bf16 v[116:119], a[128:131], v[32:35], v[116:119]
  ds_read_b128 v[32:35], v11 offset:41984
  s_waitcnt lgkmcnt(7)
  v_mfma_f32_16x16x32_bf16 v[88:91], a[124:127], v[36:39], v[88:91]
  v_mfma_f32_16x16x32_bf16 v[120:123], a[128:131], v[36:39], v[120:123]
  ds_read_b128 v[36:39], v12 offset:40960
  v_mfma_f32_16x16x32_bf16 v[92:95], a[124:127], v[40:43], v[92:95]
  v_mfma_f32_16x16x32_bf16 v[124:127], a[128:131], v[40:43], v[124:127]
  ds_read_b128 v[40:43], v12 offset:41984
  s_waitcnt lgkmcnt(7)
  v_mfma_f32_16x16x32_bf16 v[96:99], a[124:127], v[44:47], v[96:99]
  v_mfma_f32_16x16x32_bf16 v[128:131], a[128:131], v[44:47], v[128:131]
  ds_read_b128 v[44:47], v13 offset:40960
  v_mfma_f32_16x16x32_bf16 v[100:103], a[124:127], v[48:51], v[100:103]
  v_mfma_f32_16x16x32_bf16 v[132:135], a[128:131], v[48:51], v[132:135]
  ds_read_b128 v[48:51], v13 offset:41984
  s_waitcnt lgkmcnt(6)
  v_mfma_f32_16x16x32_bf16 v[72:75], a[132:135], v[20:23], v[72:75]
  v_mfma_f32_16x16x32_bf16 v[104:107], a[136:139], v[20:23], v[104:107]
  v_mfma_f32_16x16x32_bf16 v[136:139], v[52:55], v[20:23], v[136:139]
  v_mfma_f32_16x16x32_bf16 v[76:79], a[132:135], v[24:27], v[76:79]
  v_mfma_f32_16x16x32_bf16 v[108:111], a[136:139], v[24:27], v[108:111]
  v_mfma_f32_16x16x32_bf16 v[140:143], v[52:55], v[24:27], v[140:143]
  s_waitcnt lgkmcnt(4)
  v_mfma_f32_16x16x32_bf16 v[80:83], a[132:135], v[28:31], v[80:83]
  v_mfma_f32_16x16x32_bf16 v[112:115], a[136:139], v[28:31], v[112:115]
  v_mfma_f32_16x16x32_bf16 v[84:87], a[132:135], v[32:35], v[84:87]
  v_mfma_f32_16x16x32_bf16 v[116:119], a[136:139], v[32:35], v[116:119]
  s_waitcnt lgkmcnt(2)
  v_mfma_f32_16x16x32_bf16 v[88:91], a[132:135], v[36:39], v[88:91]
  v_mfma_f32_16x16x32_bf16 v[120:123], a[136:139], v[36:39], v[120:123]
  v_mfma_f32_16x16x32_bf16 v[92:95], a[132:135], v[40:43], v[92:95]
  v_mfma_f32_16x16x32_bf16 v[124:127], a[136:139], v[40:43], v[124:127]
  s_waitcnt lgkmcnt(0)
  v_mfma_f32_16x16x32_bf16 v[96:99], a[132:135], v[44:47], v[96:99]
  v_mfma_f32_16x16x32_bf16 v[128:131], a[136:139], v[44:47], v[128:131]
  v_mfma_f32_16x16x32_bf16 v[100:103], a[132:135], v[48:51], v[100:103]
  v_mfma_f32_16x16x32_bf16 v[132:135], a[136:139], v[48:51], v[132:135]
  v_lshlrev_b32 v6, 3, v3
  v_add_u32 v6, 147456, v6
  s_lshl_b32 s26, s50, 7
  v_add_u32 v7, s26, v6
  ds_read_b64 v[216:217], v7
  ds_read_b64 v[218:219], v7 offset:128
  s_lshl_b32 s26, s51, 7
  v_add_u32 v7, s26, v6
  ds_read_b64 v[220:221], v7
  ds_read_b64 v[222:223], v7 offset:128
  s_lshl_b32 s26, s52, 7
  v_add_u32 v7, s26, v6
  ds_read_b64 v[224:225], v7
  ds_read_b64 v[226:227], v7 offset:128
  s_lshl_b32 s26, s53, 7
  v_add_u32 v7, s26, v6
  ds_read_b64 v[228:229], v7
  ds_read_b64 v[230:231], v7 offset:128
  v_lshlrev_b32 v8, 4, v5
  v_add_u32 v8, 148480, v8
  s_lshl_b32 s26, s3, 8
  v_add_u32 v9, s26, v8
  v_mov_b32 v64, 0xc0135761
  v_mov_b32 v65, 0xc0135761
  v_mov_b32 v66, 0xbdd2d3e8
  v_mov_b32 v67, 0xbdd2d3e8
  ds_read_b128 v[144:147], v9 offset:1152
  ds_read_b128 v[148:151], v9 offset:1216
  ds_read_b128 v[152:155], v9 offset:1280
  ds_read_b128 v[156:159], v9 offset:1344
  ds_read_b128 v[160:163], v8 offset:2176
  ds_read_b128 v[164:167], v8 offset:2240
  s_waitcnt lgkmcnt(0)
  v_pk_fma_f32 v[56:57], v[216:217], v[144:145], v[148:149] op_sel:[0,0,0] op_sel_hi:[0,1,1]
  v_pk_fma_f32 v[58:59], v[216:217], v[146:147], v[150:151] op_sel:[0,0,0] op_sel_hi:[0,1,1]
  v_pk_fma_f32 v[72:73], v[216:217], v[72:73], v[56:57] op_sel:[1,0,0] op_sel_hi:[1,1,1]
  v_pk_fma_f32 v[74:75], v[216:217], v[74:75], v[58:59] op_sel:[1,0,0] op_sel_hi:[1,1,1]
  v_pk_mul_f32 v[56:57], v[72:73], v[72:73]
  v_pk_mul_f32 v[58:59], v[74:75], v[74:75]
  v_pk_fma_f32 v[56:57], v[56:57], v[66:67], v[64:65]
  v_pk_fma_f32 v[58:59], v[58:59], v[66:67], v[64:65]
  v_pk_mul_f32 v[56:57], v[56:57], v[72:73]
  v_pk_mul_f32 v[58:59], v[58:59], v[74:75]
  v_exp_f32 v56, v56
  v_exp_f32 v58, v58
  v_exp_f32 v57, v57
  v_exp_f32 v59, v59
  v_pk_add_f32 v[56:57], v[56:57], 1.0 op_sel_hi:[1,0]
  v_pk_add_f32 v[58:59], v[58:59], 1.0 op_sel_hi:[1,0]
  v_rcp_f32 v56, v56
  v_rcp_f32 v58, v58
  v_rcp_f32 v57, v57
  v_rcp_f32 v59, v59
  v_pk_mul_f32 v[72:73], v[72:73], v[56:57]
  v_pk_mul_f32 v[74:75], v[74:75], v[58:59]
  v_pk_add_f32 v[20:21], v[72:73], v[74:75]
  v_pk_mul_f32 v[36:37], v[72:73], v[72:73]
  v_pk_fma_f32 v[36:37], v[74:75], v[74:75], v[36:37]
  v_pk_fma_f32 v[60:61], v[218:219], v[144:145], v[148:149] op_sel:[0,0,0] op_sel_hi:[0,1,1]
  v_pk_fma_f32 v[62:63], v[218:219], v[146:147], v[150:151] op_sel:[0,0,0] op_sel_hi:[0,1,1]
  v_pk_fma_f32 v[76:77], v[218:219], v[76:77], v[60:61] op_sel:[1,0,0] op_sel_hi:[1,1,1]
  v_pk_fma_f32 v[78:79], v[218:219], v[78:79], v[62:63] op_sel:[1,0,0] op_sel_hi:[1,1,1]
  v_pk_mul_f32 v[60:61], v[76:77], v[76:77]
  v_pk_mul_f32 v[62:63], v[78:79], v[78:79]
  v_pk_fma_f32 v[60:61], v[60:61], v[66:67], v[64:65]
  v_pk_fma_f32 v[62:63], v[62:63], v[66:67], v[64:65]
  v_pk_mul_f32 v[60:61], v[60:61], v[76:77]
  v_pk_mul_f32 v[62:63], v[62:63], v[78:79]
  v_exp_f32 v60, v60
  v_exp_f32 v62, v62
  v_exp_f32 v61, v61
  v_exp_f32 v63, v63
  v_pk_add_f32 v[60:61], v[60:61], 1.0 op_sel_hi:[1,0]
  v_pk_add_f32 v[62:63], v[62:63], 1.0 op_sel_hi:[1,0]
  v_rcp_f32 v60, v60
  v_rcp_f32 v62, v62
  v_rcp_f32 v61, v61
  v_rcp_f32 v63, v63
  v_pk_mul_f32 v[76:77], v[76:77], v[60:61]
  v_pk_mul_f32 v[78:79], v[78:79], v[62:63]
  v_pk_add_f32 v[22:23], v[76:77], v[78:79]
  v_pk_mul_f32 v[38:39], v[76:77], v[76:77]
  v_pk_fma_f32 v[38:39], v[78:79], v[78:79], v[38:39]
  v_pk_fma_f32 v[56:57], v[220:221], v[144:145], v[148:149] op_sel:[0,0,0] op_sel_hi:[0,1,1]
  v_pk_fma_f32 v[58:59], v[220:221], v[146:147], v[150:151] op_sel:[0,0,0] op_sel_hi:[0,1,1]
  v_pk_fma_f32 v[80:81], v[220:221], v[80:81], v[56:57] op_sel:[1,0,0] op_sel_hi:[1,1,1]
  v_pk_fma_f32 v[82:83], v[220:221], v[82:83], v[58:59] op_sel:[1,0,0] op_sel_hi:[1,1,1]
  v_pk_mul_f32 v[56:57], v[80:81], v[80:81]
  v_pk_mul_f32 v[58:59], v[82:83], v[82:83]
  v_pk_fma_f32 v[56:57], v[56:57], v[66:67], v[64:65]
  v_pk_fma_f32 v[58:59], v[58:59], v[66:67], v[64:65]
  v_pk_mul_f32 v[56:57], v[56:57], v[80:81]
  v_pk_mul_f32 v[58:59], v[58:59], v[82:83]
  v_exp_f32 v56, v56
  v_exp_f32 v58, v58
  v_exp_f32 v57, v57
  v_exp_f32 v59, v59
  v_pk_add_f32 v[56:57], v[56:57], 1.0 op_sel_hi:[1,0]
  v_pk_add_f32 v[58:59], v[58:59], 1.0 op_sel_hi:[1,0]
  v_rcp_f32 v56, v56
  v_rcp_f32 v58, v58
  v_rcp_f32 v57, v57
  v_rcp_f32 v59, v59
  v_pk_mul_f32 v[80:81], v[80:81], v[56:57]
  v_pk_mul_f32 v[82:83], v[82:83], v[58:59]
  v_pk_add_f32 v[24:25], v[80:81], v[82:83]
  v_pk_mul_f32 v[40:41], v[80:81], v[80:81]
  v_pk_fma_f32 v[40:41], v[82:83], v[82:83], v[40:41]
  v_pk_fma_f32 v[60:61], v[222:223], v[144:145], v[148:149] op_sel:[0,0,0] op_sel_hi:[0,1,1]
  v_pk_fma_f32 v[62:63], v[222:223], v[146:147], v[150:151] op_sel:[0,0,0] op_sel_hi:[0,1,1]
  v_pk_fma_f32 v[84:85], v[222:223], v[84:85], v[60:61] op_sel:[1,0,0] op_sel_hi:[1,1,1]
  v_pk_fma_f32 v[86:87], v[222:223], v[86:87], v[62:63] op_sel:[1,0,0] op_sel_hi:[1,1,1]
  v_pk_mul_f32 v[60:61], v[84:85], v[84:85]
  v_pk_mul_f32 v[62:63], v[86:87], v[86:87]
  v_pk_fma_f32 v[60:61], v[60:61], v[66:67], v[64:65]
  v_pk_fma_f32 v[62:63], v[62:63], v[66:67], v[64:65]
  v_pk_mul_f32 v[60:61], v[60:61], v[84:85]
  v_pk_mul_f32 v[62:63], v[62:63], v[86:87]
  v_exp_f32 v60, v60
  v_exp_f32 v62, v62
  v_exp_f32 v61, v61
  v_exp_f32 v63, v63
  v_pk_add_f32 v[60:61], v[60:61], 1.0 op_sel_hi:[1,0]
  v_pk_add_f32 v[62:63], v[62:63], 1.0 op_sel_hi:[1,0]
  v_rcp_f32 v60, v60
  v_rcp_f32 v62, v62
  v_rcp_f32 v61, v61
  v_rcp_f32 v63, v63
  v_pk_mul_f32 v[84:85], v[84:85], v[60:61]
  v_pk_mul_f32 v[86:87], v[86:87], v[62:63]
  v_pk_add_f32 v[26:27], v[84:85], v[86:87]
  v_pk_mul_f32 v[42:43], v[84:85], v[84:85]
  v_pk_fma_f32 v[42:43], v[86:87], v[86:87], v[42:43]
  v_pk_fma_f32 v[56:57], v[224:225], v[144:145], v[148:149] op_sel:[0,0,0] op_sel_hi:[0,1,1]
  v_pk_fma_f32 v[58:59], v[224:225], v[146:147], v[150:151] op_sel:[0,0,0] op_sel_hi:[0,1,1]
  v_pk_fma_f32 v[88:89], v[224:225], v[88:89], v[56:57] op_sel:[1,0,0] op_sel_hi:[1,1,1]
  v_pk_fma_f32 v[90:91], v[224:225], v[90:91], v[58:59] op_sel:[1,0,0] op_sel_hi:[1,1,1]
  v_pk_mul_f32 v[56:57], v[88:89], v[88:89]
  v_pk_mul_f32 v[58:59], v[90:91], v[90:91]
  v_pk_fma_f32 v[56:57], v[56:57], v[66:67], v[64:65]
  v_pk_fma_f32 v[58:59], v[58:59], v[66:67], v[64:65]
  v_pk_mul_f32 v[56:57], v[56:57], v[88:89]
  v_pk_mul_f32 v[58:59], v[58:59], v[90:91]
  v_exp_f32 v56, v56
  v_exp_f32 v58, v58
  v_exp_f32 v57, v57
  v_exp_f32 v59, v59
  v_pk_add_f32 v[56:57], v[56:57], 1.0 op_sel_hi:[1,0]
  v_pk_add_f32 v[58:59], v[58:59], 1.0 op_sel_hi:[1,0]
  v_rcp_f32 v56, v56
  v_rcp_f32 v58, v58
  v_rcp_f32 v57, v57
  v_rcp_f32 v59, v59
  v_pk_mul_f32 v[88:89], v[88:89], v[56:57]
  v_pk_mul_f32 v[90:91], v[90:91], v[58:59]
  v_pk_add_f32 v[28:29], v[88:89], v[90:91]
  v_pk_mul_f32 v[44:45], v[88:89], v[88:89]
  v_pk_fma_f32 v[44:45], v[90:91], v[90:91], v[44:45]
  v_pk_fma_f32 v[60:61], v[226:227], v[144:145], v[148:149] op_sel:[0,0,0] op_sel_hi:[0,1,1]
  v_pk_fma_f32 v[62:63], v[226:227], v[146:147], v[150:151] op_sel:[0,0,0] op_sel_hi:[0,1,1]
  v_pk_fma_f32 v[92:93], v[226:227], v[92:93], v[60:61] op_sel:[1,0,0] op_sel_hi:[1,1,1]
  v_pk_fma_f32 v[94:95], v[226:227], v[94:95], v[62:63] op_sel:[1,0,0] op_sel_hi:[1,1,1]
  v_pk_mul_f32 v[60:61], v[92:93], v[92:93]
  v_pk_mul_f32 v[62:63], v[94:95], v[94:95]
  v_pk_fma_f32 v[60:61], v[60:61], v[66:67], v[64:65]
  v_pk_fma_f32 v[62:63], v[62:63], v[66:67], v[64:65]
  v_pk_mul_f32 v[60:61], v[60:61], v[92:93]
  v_pk_mul_f32 v[62:63], v[62:63], v[94:95]
  v_exp_f32 v60, v60
  v_exp_f32 v62, v62
  v_exp_f32 v61, v61
  v_exp_f32 v63, v63
  v_pk_add_f32 v[60:61], v[60:61], 1.0 op_sel_hi:[1,0]
  v_pk_add_f32 v[62:63], v[62:63], 1.0 op_sel_hi:[1,0]
  v_rcp_f32 v60, v60
  v_rcp_f32 v62, v62
  v_rcp_f32 v61, v61
  v_rcp_f32 v63, v63
  v_pk_mul_f32 v[92:93], v[92:93], v[60:61]
  v_pk_mul_f32 v[94:95], v[94:95], v[62:63]
  v_pk_add_f32 v[30:31], v[92:93], v[94:95]
  v_pk_mul_f32 v[46:47], v[92:93], v[92:93]
  v_pk_fma_f32 v[46:47], v[94:95], v[94:95], v[46:47]
  v_pk_fma_f32 v[56:57], v[228:229], v[144:145], v[148:149] op_sel:[0,0,0] op_sel_hi:[0,1,1]
  v_pk_fma_f32 v[58:59], v[228:229], v[146:147], v[150:151] op_sel:[0,0,0] op_sel_hi:[0,1,1]
  v_pk_fma_f32 v[96:97], v[228:229], v[96:97], v[56:57] op_sel:[1,0,0] op_sel_hi:[1,1,1]
  v_pk_fma_f32 v[98:99], v[228:229], v[98:99], v[58:59] op_sel:[1,0,0] op_sel_hi:[1,1,1]
  v_pk_mul_f32 v[56:57], v[96:97], v[96:97]
  v_pk_mul_f32 v[58:59], v[98:99], v[98:99]
  v_pk_fma_f32 v[56:57], v[56:57], v[66:67], v[64:65]
  v_pk_fma_f32 v[58:59], v[58:59], v[66:67], v[64:65]
  v_pk_mul_f32 v[56:57], v[56:57], v[96:97]
  v_pk_mul_f32 v[58:59], v[58:59], v[98:99]
  v_exp_f32 v56, v56
  v_exp_f32 v58, v58
  v_exp_f32 v57, v57
  v_exp_f32 v59, v59
  v_pk_add_f32 v[56:57], v[56:57], 1.0 op_sel_hi:[1,0]
  v_pk_add_f32 v[58:59], v[58:59], 1.0 op_sel_hi:[1,0]
  v_rcp_f32 v56, v56
  v_rcp_f32 v58, v58
  v_rcp_f32 v57, v57
  v_rcp_f32 v59, v59
  v_pk_mul_f32 v[96:97], v[96:97], v[56:57]
  v_pk_mul_f32 v[98:99], v[98:99], v[58:59]
  v_pk_add_f32 v[32:33], v[96:97], v[98:99]
  v_pk_mul_f32 v[48:49], v[96:97], v[96:97]
  v_pk_fma_f32 v[48:49], v[98:99], v[98:99], v[48:49]
  v_pk_fma_f32 v[60:61], v[230:231], v[144:145], v[148:149] op_sel:[0,0,0] op_sel_hi:[0,1,1]
  v_pk_fma_f32 v[62:63], v[230:231], v[146:147], v[150:151] op_sel:[0,0,0] op_sel_hi:[0,1,1]
  v_pk_fma_f32 v[100:101], v[230:231], v[100:101], v[60:61] op_sel:[1,0,0] op_sel_hi:[1,1,1]
  v_pk_fma_f32 v[102:103], v[230:231], v[102:103], v[62:63] op_sel:[1,0,0] op_sel_hi:[1,1,1]
  v_pk_mul_f32 v[60:61], v[100:101], v[100:101]
  v_pk_mul_f32 v[62:63], v[102:103], v[102:103]
  v_pk_fma_f32 v[60:61], v[60:61], v[66:67], v[64:65]
  v_pk_fma_f32 v[62:63], v[62:63], v[66:67], v[64:65]
  v_pk_mul_f32 v[60:61], v[60:61], v[100:101]
  v_pk_mul_f32 v[62:63], v[62:63], v[102:103]
  v_exp_f32 v60, v60
  v_exp_f32 v62, v62
  v_exp_f32 v61, v61
  v_exp_f32 v63, v63
  v_pk_add_f32 v[60:61], v[60:61], 1.0 op_sel_hi:[1,0]
  v_pk_add_f32 v[62:63], v[62:63], 1.0 op_sel_hi:[1,0]
  v_rcp_f32 v60, v60
  v_rcp_f32 v62, v62
  v_rcp_f32 v61, v61
  v_rcp_f32 v63, v63
  v_pk_mul_f32 v[100:101], v[100:101], v[60:61]
  v_pk_mul_f32 v[102:103], v[102:103], v[62:63]
  v_pk_add_f32 v[34:35], v[100:101], v[102:103]
  v_pk_mul_f32 v[50:51], v[100:101], v[100:101]
  v_pk_fma_f32 v[50:51], v[102:103], v[102:103], v[50:51]
  v_pk_fma_f32 v[56:57], v[216:217], v[152:153], v[156:157] op_sel:[0,0,0] op_sel_hi:[0,1,1]
  v_pk_fma_f32 v[58:59], v[216:217], v[154:155], v[158:159] op_sel:[0,0,0] op_sel_hi:[0,1,1]
  v_pk_fma_f32 v[104:105], v[216:217], v[104:105], v[56:57] op_sel:[1,0,0] op_sel_hi:[1,1,1]
  v_pk_fma_f32 v[106:107], v[216:217], v[106:107], v[58:59] op_sel:[1,0,0] op_sel_hi:[1,1,1]
  v_pk_mul_f32 v[56:57], v[104:105], v[104:105]
  v_pk_mul_f32 v[58:59], v[106:107], v[106:107]
  v_pk_fma_f32 v[56:57], v[56:57], v[66:67], v[64:65]
  v_pk_fma_f32 v[58:59], v[58:59], v[66:67], v[64:65]
  v_pk_mul_f32 v[56:57], v[56:57], v[104:105]
  v_pk_mul_f32 v[58:59], v[58:59], v[106:107]
  v_exp_f32 v56, v56
  v_exp_f32 v58, v58
  v_exp_f32 v57, v57
  v_exp_f32 v59, v59
  v_pk_add_f32 v[56:57], v[56:57], 1.0 op_sel_hi:[1,0]
  v_pk_add_f32 v[58:59], v[58:59], 1.0 op_sel_hi:[1,0]
  v_rcp_f32 v56, v56
  v_rcp_f32 v58, v58
  v_rcp_f32 v57, v57
  v_rcp_f32 v59, v59
  buffer_load_dwordx4 a[144:147], v4, s[12:15], s48 offen offset:0 sc1
  v_pk_mul_f32 v[104:105], v[104:105], v[56:57]
  v_pk_mul_f32 v[106:107], v[106:107], v[58:59]
  v_pk_add_f32 v[20:21], v[20:21], v[104:105]
  v_pk_fma_f32 v[36:37], v[104:105], v[104:105], v[36:37]
  v_pk_add_f32 v[20:21], v[20:21], v[106:107]
  v_pk_fma_f32 v[36:37], v[106:107], v[106:107], v[36:37]
  v_pk_fma_f32 v[60:61], v[218:219], v[152:153], v[156:157] op_sel:[0,0,0] op_sel_hi:[0,1,1]
  v_pk_fma_f32 v[62:63], v[218:219], v[154:155], v[158:159] op_sel:[0,0,0] op_sel_hi:[0,1,1]
  v_pk_fma_f32 v[108:109], v[218:219], v[108:109], v[60:61] op_sel:[1,0,0] op_sel_hi:[1,1,1]
  v_pk_fma_f32 v[110:111], v[218:219], v[110:111], v[62:63] op_sel:[1,0,0] op_sel_hi:[1,1,1]
  v_pk_mul_f32 v[60:61], v[108:109], v[108:109]
  v_pk_mul_f32 v[62:63], v[110:111], v[110:111]
  v_pk_fma_f32 v[60:61], v[60:61], v[66:67], v[64:65]
  v_pk_fma_f32 v[62:63], v[62:63], v[66:67], v[64:65]
  v_pk_mul_f32 v[60:61], v[60:61], v[108:109]
  v_pk_mul_f32 v[62:63], v[62:63], v[110:111]
  v_exp_f32 v60, v60
  v_exp_f32 v62, v62
  v_exp_f32 v61, v61
  v_exp_f32 v63, v63
  v_pk_add_f32 v[60:61], v[60:61], 1.0 op_sel_hi:[1,0]
  v_pk_add_f32 v[62:63], v[62:63], 1.0 op_sel_hi:[1,0]
  v_rcp_f32 v60, v60
  v_rcp_f32 v62, v62
  buffer_load_dwordx4 a[148:151], v4, s[12:15], s49 offen offset:0 sc1
  v_rcp_f32 v61, v61
  v_rcp_f32 v63, v63
  v_pk_mul_f32 v[108:109], v[108:109], v[60:61]
  v_pk_mul_f32 v[110:111], v[110:111], v[62:63]
  v_pk_add_f32 v[22:23], v[22:23], v[108:109]
  v_pk_fma_f32 v[38:39], v[108:109], v[108:109], v[38:39]
  v_pk_add_f32 v[22:23], v[22:23], v[110:111]
  v_pk_fma_f32 v[38:39], v[110:111], v[110:111], v[38:39]
  v_pk_fma_f32 v[56:57], v[220:221], v[152:153], v[156:157] op_sel:[0,0,0] op_sel_hi:[0,1,1]
  v_pk_fma_f32 v[58:59], v[220:221], v[154:155], v[158:159] op_sel:[0,0,0] op_sel_hi:[0,1,1]
  v_pk_fma_f32 v[112:113], v[220:221], v[112:113], v[56:57] op_sel:[1,0,0] op_sel_hi:[1,1,1]
  v_pk_fma_f32 v[114:115], v[220:221], v[114:115], v[58:59] op_sel:[1,0,0] op_sel_hi:[1,1,1]
  v_pk_mul_f32 v[56:57], v[112:113], v[112:113]
  v_pk_mul_f32 v[58:59], v[114:115], v[114:115]
  v_pk_fma_f32 v[56:57], v[56:57], v[66:67], v[64:65]
  v_pk_fma_f32 v[58:59], v[58:59], v[66:67], v[64:65]
  v_pk_mul_f32 v[56:57], v[56:57], v[112:113]
  v_pk_mul_f32 v[58:59], v[58:59], v[114:115]
  v_exp_f32 v56, v56
  v_exp_f32 v58, v58
  v_exp_f32 v57, v57
  v_exp_f32 v59, v59
  v_pk_add_f32 v[56:57], v[56:57], 1.0 op_sel_hi:[1,0]
  v_pk_add_f32 v[58:59], v[58:59], 1.0 op_sel_hi:[1,0]
  buffer_load_dwordx4 a[152:155], v4, s[12:15], s48 offen offset:1024 sc1
  v_rcp_f32 v56, v56
  v_rcp_f32 v58, v58
  v_rcp_f32 v57, v57
  v_rcp_f32 v59, v59
  v_pk_mul_f32 v[112:113], v[112:113], v[56:57]
  v_pk_mul_f32 v[114:115], v[114:115], v[58:59]
  v_pk_add_f32 v[24:25], v[24:25], v[112:113]
  v_pk_fma_f32 v[40:41], v[112:113], v[112:113], v[40:41]
  v_pk_add_f32 v[24:25], v[24:25], v[114:115]
  v_pk_fma_f32 v[40:41], v[114:115], v[114:115], v[40:41]
  v_pk_fma_f32 v[60:61], v[222:223], v[152:153], v[156:157] op_sel:[0,0,0] op_sel_hi:[0,1,1]
  v_pk_fma_f32 v[62:63], v[222:223], v[154:155], v[158:159] op_sel:[0,0,0] op_sel_hi:[0,1,1]
  v_pk_fma_f32 v[116:117], v[222:223], v[116:117], v[60:61] op_sel:[1,0,0] op_sel_hi:[1,1,1]
  v_pk_fma_f32 v[118:119], v[222:223], v[118:119], v[62:63] op_sel:[1,0,0] op_sel_hi:[1,1,1]
  v_pk_mul_f32 v[60:61], v[116:117], v[116:117]
  v_pk_mul_f32 v[62:63], v[118:119], v[118:119]
  v_pk_fma_f32 v[60:61], v[60:61], v[66:67], v[64:65]
  v_pk_fma_f32 v[62:63], v[62:63], v[66:67], v[64:65]
  v_pk_mul_f32 v[60:61], v[60:61], v[116:117]
  v_pk_mul_f32 v[62:63], v[62:63], v[118:119]
  v_exp_f32 v60, v60
  v_exp_f32 v62, v62
  v_exp_f32 v61, v61
  v_exp_f32 v63, v63
  buffer_load_dwordx4 a[156:159], v4, s[12:15], s49 offen offset:1024 sc1
  v_pk_add_f32 v[60:61], v[60:61], 1.0 op_sel_hi:[1,0]
  v_pk_add_f32 v[62:63], v[62:63], 1.0 op_sel_hi:[1,0]
  v_rcp_f32 v60, v60
  v_rcp_f32 v62, v62
  v_rcp_f32 v61, v61
  v_rcp_f32 v63, v63
  v_pk_mul_f32 v[116:117], v[116:117], v[60:61]
  v_pk_mul_f32 v[118:119], v[118:119], v[62:63]
  v_pk_add_f32 v[26:27], v[26:27], v[116:117]
  v_pk_fma_f32 v[42:43], v[116:117], v[116:117], v[42:43]
  v_pk_add_f32 v[26:27], v[26:27], v[118:119]
  v_pk_fma_f32 v[42:43], v[118:119], v[118:119], v[42:43]
  v_pk_fma_f32 v[56:57], v[224:225], v[152:153], v[156:157] op_sel:[0,0,0] op_sel_hi:[0,1,1]
  v_pk_fma_f32 v[58:59], v[224:225], v[154:155], v[158:159] op_sel:[0,0,0] op_sel_hi:[0,1,1]
  v_pk_fma_f32 v[120:121], v[224:225], v[120:121], v[56:57] op_sel:[1,0,0] op_sel_hi:[1,1,1]
  v_pk_fma_f32 v[122:123], v[224:225], v[122:123], v[58:59] op_sel:[1,0,0] op_sel_hi:[1,1,1]
  v_pk_mul_f32 v[56:57], v[120:121], v[120:121]
  v_pk_mul_f32 v[58:59], v[122:123], v[122:123]
  v_pk_fma_f32 v[56:57], v[56:57], v[66:67], v[64:65]
  v_pk_fma_f32 v[58:59], v[58:59], v[66:67], v[64:65]
  v_pk_mul_f32 v[56:57], v[56:57], v[120:121]
  v_pk_mul_f32 v[58:59], v[58:59], v[122:123]
  v_exp_f32 v56, v56
  v_exp_f32 v58, v58
  buffer_load_dwordx4 a[160:163], v4, s[12:15], s48 offen offset:2048 sc1
  v_exp_f32 v57, v57
  v_exp_f32 v59, v59
  v_pk_add_f32 v[56:57], v[56:57], 1.0 op_sel_hi:[1,0]
  v_pk_add_f32 v[58:59], v[58:59], 1.0 op_sel_hi:[1,0]
  v_rcp_f32 v56, v56
  v_rcp_f32 v58, v58
  v_rcp_f32 v57, v57
  v_rcp_f32 v59, v59
  v_pk_mul_f32 v[120:121], v[120:121], v[56:57]
  v_pk_mul_f32 v[122:123], v[122:123], v[58:59]
  v_pk_add_f32 v[28:29], v[28:29], v[120:121]
  v_pk_fma_f32 v[44:45], v[120:121], v[120:121], v[44:45]
  v_pk_add_f32 v[28:29], v[28:29], v[122:123]
  v_pk_fma_f32 v[44:45], v[122:123], v[122:123], v[44:45]
  v_pk_fma_f32 v[60:61], v[226:227], v[152:153], v[156:157] op_sel:[0,0,0] op_sel_hi:[0,1,1]
  v_pk_fma_f32 v[62:63], v[226:227], v[154:155], v[158:159] op_sel:[0,0,0] op_sel_hi:[0,1,1]
  v_pk_fma_f32 v[124:125], v[226:227], v[124:125], v[60:61] op_sel:[1,0,0] op_sel_hi:[1,1,1]
  v_pk_fma_f32 v[126:127], v[226:227], v[126:127], v[62:63] op_sel:[1,0,0] op_sel_hi:[1,1,1]
  v_pk_mul_f32 v[60:61], v[124:125], v[124:125]
  v_pk_mul_f32 v[62:63], v[126:127], v[126:127]
  v_pk_fma_f32 v[60:61], v[60:61], v[66:67], v[64:65]
  v_pk_fma_f32 v[62:63], v[62:63], v[66:67], v[64:65]
  v_pk_mul_f32 v[60:61], v[60:61], v[124:125]
  v_pk_mul_f32 v[62:63], v[62:63], v[126:127]
  buffer_load_dwordx4 a[164:167], v4, s[12:15], s49 offen offset:2048 sc1
  v_exp_f32 v60, v60
  v_exp_f32 v62, v62
  v_exp_f32 v61, v61
  v_exp_f32 v63, v63
  v_pk_add_f32 v[60:61], v[60:61], 1.0 op_sel_hi:[1,0]
  v_pk_add_f32 v[62:63], v[62:63], 1.0 op_sel_hi:[1,0]
  v_rcp_f32 v60, v60
  v_rcp_f32 v62, v62
  v_rcp_f32 v61, v61
  v_rcp_f32 v63, v63
  v_pk_mul_f32 v[124:125], v[124:125], v[60:61]
  v_pk_mul_f32 v[126:127], v[126:127], v[62:63]
  v_pk_add_f32 v[30:31], v[30:31], v[124:125]
  v_pk_fma_f32 v[46:47], v[124:125], v[124:125], v[46:47]
  v_pk_add_f32 v[30:31], v[30:31], v[126:127]
  v_pk_fma_f32 v[46:47], v[126:127], v[126:127], v[46:47]
  v_pk_fma_f32 v[56:57], v[228:229], v[152:153], v[156:157] op_sel:[0,0,0] op_sel_hi:[0,1,1]
  v_pk_fma_f32 v[58:59], v[228:229], v[154:155], v[158:159] op_sel:[0,0,0] op_sel_hi:[0,1,1]
  v_pk_fma_f32 v[128:129], v[228:229], v[128:129], v[56:57] op_sel:[1,0,0] op_sel_hi:[1,1,1]
  v_pk_fma_f32 v[130:131], v[228:229], v[130:131], v[58:59] op_sel:[1,0,0] op_sel_hi:[1,1,1]
  v_pk_mul_f32 v[56:57], v[128:129], v[128:129]
  v_pk_mul_f32 v[58:59], v[130:131], v[130:131]
  v_pk_fma_f32 v[56:57], v[56:57], v[66:67], v[64:65]
  v_pk_fma_f32 v[58:59], v[58:59], v[66:67], v[64:65]
  buffer_load_dwordx4 a[168:171], v4, s[12:15], s48 offen offset:3072 sc1
  s_add_u32 s48, s48, 4096
  v_pk_mul_f32 v[56:57], v[56:57], v[128:129]
  v_pk_mul_f32 v[58:59], v[58:59], v[130:131]
  v_exp_f32 v56, v56
  v_exp_f32 v58, v58
  v_exp_f32 v57, v57
  v_exp_f32 v59, v59
  v_pk_add_f32 v[56:57], v[56:57], 1.0 op_sel_hi:[1,0]
  v_pk_add_f32 v[58:59], v[58:59], 1.0 op_sel_hi:[1,0]
  v_rcp_f32 v56, v56
  v_rcp_f32 v58, v58
  v_rcp_f32 v57, v57
  v_rcp_f32 v59, v59
  v_pk_mul_f32 v[128:129], v[128:129], v[56:57]
  v_pk_mul_f32 v[130:131], v[130:131], v[58:59]
  v_pk_add_f32 v[32:33], v[32:33], v[128:129]
  v_pk_fma_f32 v[48:49], v[128:129], v[128:129], v[48:49]
  v_pk_add_f32 v[32:33], v[32:33], v[130:131]
  v_pk_fma_f32 v[48:49], v[130:131], v[130:131], v[48:49]
  v_pk_fma_f32 v[60:61], v[230:231], v[152:153], v[156:157] op_sel:[0,0,0] op_sel_hi:[0,1,1]
  v_pk_fma_f32 v[62:63], v[230:231], v[154:155], v[158:159] op_sel:[0,0,0] op_sel_hi:[0,1,1]
  v_pk_fma_f32 v[132:133], v[230:231], v[132:133], v[60:61] op_sel:[1,0,0] op_sel_hi:[1,1,1]
  v_pk_fma_f32 v[134:135], v[230:231], v[134:135], v[62:63] op_sel:[1,0,0] op_sel_hi:[1,1,1]
  v_pk_mul_f32 v[60:61], v[132:133], v[132:133]
  v_pk_mul_f32 v[62:63], v[134:135], v[134:135]
  buffer_load_dwordx4 a[172:175], v4, s[12:15], s49 offen offset:3072 sc1
  s_add_u32 s49, s49, 4096
  v_pk_fma_f32 v[60:61], v[60:61], v[66:67], v[64:65]
  v_pk_fma_f32 v[62:63], v[62:63], v[66:67], v[64:65]
  v_pk_mul_f32 v[60:61], v[60:61], v[132:133]
  v_pk_mul_f32 v[62:63], v[62:63], v[134:135]
  v_exp_f32 v60, v60
  v_exp_f32 v62, v62
  v_exp_f32 v61, v61
  v_exp_f32 v63, v63
  v_pk_add_f32 v[60:61], v[60:61], 1.0 op_sel_hi:[1,0]
  v_pk_add_f32 v[62:63], v[62:63], 1.0 op_sel_hi:[1,0]
  v_rcp_f32 v60, v60
  v_rcp_f32 v62, v62
  v_rcp_f32 v61, v61
  v_rcp_f32 v63, v63
  v_pk_mul_f32 v[132:133], v[132:133], v[60:61]
  v_pk_mul_f32 v[134:135], v[134:135], v[62:63]
  v_pk_add_f32 v[34:35], v[34:35], v[132:133]
  v_pk_fma_f32 v[50:51], v[132:133], v[132:133], v[50:51]
  v_pk_add_f32 v[34:35], v[34:35], v[134:135]
  v_pk_fma_f32 v[50:51], v[134:135], v[134:135], v[50:51]
  v_pk_fma_f32 v[56:57], v[216:217], v[160:161], v[164:165] op_sel:[0,0,0] op_sel_hi:[0,1,1]
  v_pk_fma_f32 v[58:59], v[216:217], v[162:163], v[166:167] op_sel:[0,0,0] op_sel_hi:[0,1,1]
  v_pk_fma_f32 v[136:137], v[216:217], v[136:137], v[56:57] op_sel:[1,0,0] op_sel_hi:[1,1,1]
  v_pk_fma_f32 v[138:139], v[216:217], v[138:139], v[58:59] op_sel:[1,0,0] op_sel_hi:[1,1,1]
  buffer_load_dwordx4 a[176:179], v4, s[12:15], s48 offen offset:0 sc1
  v_pk_mul_f32 v[56:57], v[136:137], v[136:137]
  v_pk_mul_f32 v[58:59], v[138:139], v[138:139]
  v_pk_fma_f32 v[56:57], v[56:57], v[66:67], v[64:65]
  v_pk_fma_f32 v[58:59], v[58:59], v[66:67], v[64:65]
  v_pk_mul_f32 v[56:57], v[56:57], v[136:137]
  v_pk_mul_f32 v[58:59], v[58:59], v[138:139]
  v_exp_f32 v56, v56
  v_exp_f32 v58, v58
  v_exp_f32 v57, v57
  v_exp_f32 v59, v59
  v_pk_add_f32 v[56:57], v[56:57], 1.0 op_sel_hi:[1,0]
  v_pk_add_f32 v[58:59], v[58:59], 1.0 op_sel_hi:[1,0]
  v_rcp_f32 v56, v56
  v_rcp_f32 v58, v58
  v_rcp_f32 v57, v57
  v_rcp_f32 v59, v59
  v_pk_mul_f32 v[136:137], v[136:137], v[56:57]
  v_pk_mul_f32 v[138:139], v[138:139], v[58:59]
  v_pk_add_f32 v[20:21], v[20:21], v[136:137]
  v_pk_fma_f32 v[36:37], v[136:137], v[136:137], v[36:37]
  v_pk_add_f32 v[20:21], v[20:21], v[138:139]
  v_pk_fma_f32 v[36:37], v[138:139], v[138:139], v[36:37]
  v_pk_fma_f32 v[60:61], v[218:219], v[160:161], v[164:165] op_sel:[0,0,0] op_sel_hi:[0,1,1]
  v_pk_fma_f32 v[62:63], v[218:219], v[162:163], v[166:167] op_sel:[0,0,0] op_sel_hi:[0,1,1]
  buffer_load_dwordx4 a[180:183], v4, s[12:15], s49 offen offset:0 sc1
  v_pk_fma_f32 v[140:141], v[218:219], v[140:141], v[60:61] op_sel:[1,0,0] op_sel_hi:[1,1,1]
  v_pk_fma_f32 v[142:143], v[218:219], v[142:143], v[62:63] op_sel:[1,0,0] op_sel_hi:[1,1,1]
  v_pk_mul_f32 v[60:61], v[140:141], v[140:141]
  v_pk_mul_f32 v[62:63], v[142:143], v[142:143]
  v_pk_fma_f32 v[60:61], v[60:61], v[66:67], v[64:65]
  v_pk_fma_f32 v[62:63], v[62:63], v[66:67], v[64:65]
  v_pk_mul_f32 v[60:61], v[60:61], v[140:141]
  v_pk_mul_f32 v[62:63], v[62:63], v[142:143]
  v_exp_f32 v60, v60
  v_exp_f32 v62, v62
  v_exp_f32 v61, v61
  v_exp_f32 v63, v63
  v_pk_add_f32 v[60:61], v[60:61], 1.0 op_sel_hi:[1,0]
  v_pk_add_f32 v[62:63], v[62:63], 1.0 op_sel_hi:[1,0]
  v_rcp_f32 v60, v60
  v_rcp_f32 v62, v62
  v_rcp_f32 v61, v61
  v_rcp_f32 v63, v63
  v_pk_mul_f32 v[140:141], v[140:141], v[60:61]
  v_pk_mul_f32 v[142:143], v[142:143], v[62:63]
  buffer_load_dwordx4 a[184:187], v4, s[12:15], s48 offen offset:1024 sc1
  v_pk_add_f32 v[22:23], v[22:23], v[140:141]
  v_pk_fma_f32 v[38:39], v[140:141], v[140:141], v[38:39]
  v_pk_add_f32 v[22:23], v[22:23], v[142:143]
  v_pk_fma_f32 v[38:39], v[142:143], v[142:143], v[38:39]
  buffer_load_dwordx4 a[188:191], v4, s[12:15], s49 offen offset:1024 sc1
  v_and_b32 v6, 1, v5
  v_lshlrev_b32 v6, 10, v6
  v_lshrrev_b32 v7, 1, v5
  v_lshl_add_u32 v6, v7, 2, v6
  v_lshl_add_u32 v6, v3, 3, v6
  s_lshl_b32 s26, s3, 11
  s_add_u32 s26, s26, 152576
  v_add_u32 v6, s26, v6
  v_add_f32 v20, v20, v21
  v_add_f32 v36, v36, v37
  v_add_f32 v22, v22, v23
  v_add_f32 v38, v38, v39
  v_add_f32 v24, v24, v25
  v_add_f32 v40, v40, v41
  v_add_f32 v26, v26, v27
  v_add_f32 v42, v42, v43
  v_add_f32 v28, v28, v29
  v_add_f32 v44, v44, v45
  v_add_f32 v30, v30, v31
  v_add_f32 v46, v46, v47
  v_add_f32 v32, v32, v33
  v_add_f32 v48, v48, v49
  v_add_f32 v34, v34, v35
  v_add_f32 v50, v50, v51
  v_permlane32_swap_b32 v20, v36
  v_permlane32_swap_b32 v22, v38
  v_permlane32_swap_b32 v24, v40
  v_permlane32_swap_b32 v26, v42
  v_permlane32_swap_b32 v28, v44
  v_permlane32_swap_b32 v30, v46
  v_permlane32_swap_b32 v32, v48
  v_permlane32_swap_b32 v34, v50
  s_lshl_b32 s26, s50, 7
  v_add_u32 v7, s26, v6
  v_add_f32 v20, v20, v36
  ds_write_b32 v7, v20 offset:0
  v_add_f32 v22, v22, v38
  ds_write_b32 v7, v22 offset:128
  s_lshl_b32 s26, s51, 7
  v_add_u32 v7, s26, v6
  v_add_f32 v24, v24, v40
  ds_write_b32 v7, v24 offset:0
  v_add_f32 v26, v26, v42
  ds_write_b32 v7, v26 offset:128
  s_lshl_b32 s26, s52, 7
  v_add_u32 v7, s26, v6
  v_add_f32 v28, v28, v44
  ds_write_b32 v7, v28 offset:0
  v_add_f32 v30, v30, v46
  ds_write_b32 v7, v30 offset:128
  s_lshl_b32 s26, s53, 7
  v_add_u32 v7, s26, v6
  v_add_f32 v32, v32, v48
  ds_write_b32 v7, v32 offset:0
  v_add_f32 v34, v34, v50
  ds_write_b32 v7, v34 offset:128
  s_add_u32 s16, s4, 196608
  s_addc_u32 s17, s5, 0
  s_mov_b32 s18, 262144
  s_mov_b32 s19, 0x20000
  v_and_b32 v245, 127, v0
  v_lshlrev_b32 v245, 3, v245
  v_add_u32 v7, 152576, v245
  v_mov_b32 v232, 0x7fc00000
  s_lshl_b32 s28, s20, 14
  s_lshl_b32 s26, s21, 10
  s_add_u32 s26, s26, s28
  s_waitcnt lgkmcnt(0)
  s_barrier
  ds_read_b64 v[216:217], v7 offset:0
  ds_read_b64 v[218:219], v7 offset:1024
  ds_read_b64 v[220:221], v7 offset:2048
  ds_read_b64 v[222:223], v7 offset:3072
  ds_read_b64 v[224:225], v7 offset:4096
  ds_read_b64 v[226:227], v7 offset:5120
  ds_read_b64 v[228:229], v7 offset:6144
  ds_read_b64 v[230:231], v7 offset:7168
  s_waitcnt lgkmcnt(0)
  v_pk_add_f32 v[216:217], v[216:217], v[224:225]
  v_pk_add_f32 v[218:219], v[218:219], v[226:227]
  v_pk_add_f32 v[220:221], v[220:221], v[228:229]
  v_pk_add_f32 v[222:223], v[222:223], v[230:231]
  v_pk_add_f32 v[216:217], v[216:217], v[220:221]
  v_pk_add_f32 v[218:219], v[218:219], v[222:223]
  v_pk_add_f32 v[216:217], v[216:217], v[218:219]
  v_cmp_eq_u32 vcc, -1, v216
  v_cmp_eq_u32 s[30:31], -1, v217
  s_nop 0
  v_cndmask_b32 v216, v216, v232, vcc
  v_cndmask_b32 v217, v217, v232, s[30:31]
  buffer_store_dwordx2 v[216:217], v245, s[16:19], s26 offen sc1
  ds_read_b128 v[20:23], v14 offset:0
  ds_read_b128 v[24:27], v14 offset:1024
  ds_read_b128 v[52:55], v18 offset:26624
  ds_read_b128 v[28:31], v15 offset:0
  ds_read_b128 v[32:35], v15 offset:1024
  ds_read_b128 v[36:39], v16 offset:0
  ds_read_b128 v[40:43], v16 offset:1024
  ds_read_b128 v[44:47], v17 offset:0
  ds_read_b128 v[48:51], v17 offset:1024
  s_waitcnt vmcnt(21)
  s_waitcnt lgkmcnt(6)
  v_mfma_f32_16x16x32_bf16 v[144:147], a[208:211], v[20:23], 0
  v_lshrrev_b32 v6, 3, v2
  v_and_b32 v68, 7, v2
  v_mfma_f32_16x16x32_bf16 v[176:179], a[212:215], v[20:23], 0
  v_lshrrev_b32 v69, 1, v6
  v_xor_b32 v68, v68, v69
  v_mfma_f32_16x16x32_bf16 v[208:211], v[52:55], v[20:23], 0
  ds_read_b128 v[20:23], v14 offset:8192
  v_lshlrev_b32 v68, 4, v68
  v_mfma_f32_16x16x32_bf16 v[148:151], a[208:211], v[24:27], 0
  v_lshl_add_u32 v68, v6, 12, v68
  v_xor_b32 v69, 64, v68
  v_mfma_f32_16x16x32_bf16 v[180:183], a[212:215], v[24:27], 0
  v_add_u32 v69, 31744, v69
  v_add_u32 v70, 63488, v68
  v_mfma_f32_16x16x32_bf16 v[212:215], v[52:55], v[24:27], 0
  ds_read_b128 v[24:27], v14 offset:9216
  s_waitcnt lgkmcnt(6)
  v_mfma_f32_16x16x32_bf16 v[152:155], a[208:211], v[28:31], 0
  ds_read_b128 v[52:55], v18 offset:27648
  v_add_u32 v71, 63488, v69
  v_mfma_f32_16x16x32_bf16 v[184:187], a[212:215], v[28:31], 0
  ds_read_b128 v[28:31], v15 offset:8192
  v_lshlrev_b32 v246, 1, v3
  v_mfma_f32_16x16x32_bf16 v[156:159], a[208:211], v[32:35], 0
  v_mul_u32_u24 v247, 40, v3
  v_lshl_add_u32 v247, v5, 3, v247
  v_mfma_f32_16x16x32_bf16 v[188:191], a[212:215], v[32:35], 0
  ds_read_b128 v[32:35], v15 offset:9216
  s_waitcnt lgkmcnt(7)
  v_mfma_f32_16x16x32_bf16 v[160:163], a[208:211], v[36:39], 0
  s_mul_i32 s26, s3, 5120
  s_add_u32 s26, s26, 73728
  v_mfma_f32_16x16x32_bf16 v[192:195], a[212:215], v[36:39], 0
  ds_read_b128 v[36:39], v16 offset:8192
  v_add_u32 v247, s26, v247
  v_mfma_f32_16x16x32_bf16 v[164:167], a[208:211], v[40:43], 0
  v_lshrrev_b32 v64, 2, v3
  v_lshl_add_u32 v64, v5, 3, v64
  v_mfma_f32_16x16x32_bf16 v[196:199], a[212:215], v[40:43], 0
  ds_read_b128 v[40:43], v16 offset:9216
  s_waitcnt lgkmcnt(7)
  v_mfma_f32_16x16x32_bf16 v[168:171], a[208:211], v[44:47], 0
  v_mul_u32_u24 v64, 40, v64
  v_and_b32 v65, 3, v3
  v_mfma_f32_16x16x32_bf16 v[200:203], a[212:215], v[44:47], 0
  ds_read_b128 v[44:47], v17 offset:8192
  v_lshl_add_u32 v64, v65, 3, v64
  v_mfma_f32_16x16x32_bf16 v[172:175], a[208:211], v[48:51], 0
  v_add_u32 v19, s26, v64
  s_mul_i32 s42, s21, 589824
  v_mfma_f32_16x16x32_bf16 v[204:207], a[212:215], v[48:51], 0
  s_waitcnt lgkmcnt(5)
  v_mfma_f32_16x16x32_bf16 v[144:147], a[0:3], v[20:23], v[144:147]
  ds_read_b128 v[48:51], v17 offset:9216
  s_mul_i32 s27, s20, 36864
  v_mfma_f32_16x16x32_bf16 v[176:179], a[4:7], v[20:23], v[176:179]
  s_add_u32 s26, s42, s27
  s_mul_i32 s47, s3, 9216
  v_mfma_f32_16x16x32_bf16 v[208:211], v[52:55], v[20:23], v[208:211]
  ds_read_b128 v[20:23], v14 offset:16384
  s_add_u32 s47, s47, s26
  v_mfma_f32_16x16x32_bf16 v[148:151], a[0:3], v[24:27], v[148:151]
  s_add_u32 s47, s47, 8192
  s_lshl_b32 s27, s3, 11
  v_mfma_f32_16x16x32_bf16 v[180:183], a[4:7], v[24:27], v[180:183]
  s_add_u32 s27, s27, s26
  s_mul_i32 s29, s50, 4608
  v_mfma_f32_16x16x32_bf16 v[212:215], v[52:55], v[24:27], v[212:215]
  ds_read_b128 v[24:27], v14 offset:17408
  s_waitcnt lgkmcnt(6)
  v_mfma_f32_16x16x32_bf16 v[152:155], a[0:3], v[28:31], v[152:155]
  ds_read_b128 v[52:55], v18 offset:28672
  s_add_u32 s29, s29, s27
  v_mfma_f32_16x16x32_bf16 v[184:187], a[4:7], v[28:31], v[184:187]
  ds_read_b128 v[28:31], v15 offset:16384
  s_mul_i32 s30, s51, 4608
  v_mfma_f32_16x16x32_bf16 v[156:159], a[0:3], v[32:35], v[156:159]
  s_add_u32 s30, s30, s27
  s_mul_i32 s31, s52, 4608
  v_mfma_f32_16x16x32_bf16 v[188:191], a[4:7], v[32:35], v[188:191]
  ds_read_b128 v[32:35], v15 offset:17408
  s_waitcnt lgkmcnt(7)
  v_mfma_f32_16x16x32_bf16 v[160:163], a[0:3], v[36:39], v[160:163]
  s_add_u32 s31, s31, s27
  s_mul_i32 s32, s53, 4608
  v_mfma_f32_16x16x32_bf16 v[192:195], a[4:7], v[36:39], v[192:195]
  ds_read_b128 v[36:39], v16 offset:16384
  s_add_u32 s32, s32, s27
  v_mfma_f32_16x16x32_bf16 v[164:167], a[0:3], v[40:43], v[164:167]
  s_mov_b32 s36, s60
  s_mov_b32 s37, s61
  v_mfma_f32_16x16x32_bf16 v[196:199], a[4:7], v[40:43], v[196:199]
  ds_read_b128 v[40:43], v16 offset:17408
  s_waitcnt lgkmcnt(7)
  v_mfma_f32_16x16x32_bf16 v[168:171], a[0:3], v[44:47], v[168:171]
  s_mov_b32 s38, 4096
  s_mov_b32 s39, 0x20000
  v_mfma_f32_16x16x32_bf16 v[200:203], a[4:7], v[44:47], v[200:203]
  ds_read_b128 v[44:47], v17 offset:16384
  v_mfma_f32_16x16x32_bf16 v[172:175], a[0:3], v[48:51], v[172:175]
  v_mfma_f32_16x16x32_bf16 v[204:207], a[4:7], v[48:51], v[204:207]
  ds_read_b128 v[48:51], v17 offset:17408
  s_waitcnt lgkmcnt(6)
  v_mfma_f32_16x16x32_bf16 v[144:147], a[8:11], v[20:23], v[144:147]
  v_mfma_f32_16x16x32_bf16 v[176:179], a[12:15], v[20:23], v[176:179]
  v_mfma_f32_16x16x32_bf16 v[208:211], v[52:55], v[20:23], v[208:211]
  ds_read_b128 v[20:23], v14 offset:24576
  v_mfma_f32_16x16x32_bf16 v[148:151], a[8:11], v[24:27], v[148:151]
  v_mfma_f32_16x16x32_bf16 v[180:183], a[12:15], v[24:27], v[180:183]
  v_mfma_f32_16x16x32_bf16 v[212:215], v[52:55], v[24:27], v[212:215]
  ds_read_b128 v[24:27], v14 offset:25600
  s_waitcnt lgkmcnt(6)
  v_mfma_f32_16x16x32_bf16 v[152:155], a[8:11], v[28:31], v[152:155]
  ds_read_b128 v[52:55], v18 offset:29696
  v_mfma_f32_16x16x32_bf16 v[184:187], a[12:15], v[28:31], v[184:187]
  ds_read_b128 v[28:31], v15 offset:24576
  v_mfma_f32_16x16x32_bf16 v[156:159], a[8:11], v[32:35], v[156:159]
  v_mfma_f32_16x16x32_bf16 v[188:191], a[12:15], v[32:35], v[188:191]
  ds_read_b128 v[32:35], v15 offset:25600
  s_waitcnt lgkmcnt(7)
  v_mfma_f32_16x16x32_bf16 v[160:163], a[8:11], v[36:39], v[160:163]
  v_mfma_f32_16x16x32_bf16 v[192:195], a[12:15], v[36:39], v[192:195]
  ds_read_b128 v[36:39], v16 offset:24576
  v_mfma_f32_16x16x32_bf16 v[164:167], a[8:11], v[40:43], v[164:167]
  v_mfma_f32_16x16x32_bf16 v[196:199], a[12:15], v[40:43], v[196:199]
  ds_read_b128 v[40:43], v16 offset:25600
  s_waitcnt lgkmcnt(7)
  v_mfma_f32_16x16x32_bf16 v[168:171], a[8:11], v[44:47], v[168:171]
  v_mfma_f32_16x16x32_bf16 v[200:203], a[12:15], v[44:47], v[200:203]
  ds_read_b128 v[44:47], v17 offset:24576
  v_mfma_f32_16x16x32_bf16 v[172:175], a[8:11], v[48:51], v[172:175]
  v_mfma_f32_16x16x32_bf16 v[204:207], a[12:15], v[48:51], v[204:207]
  s_waitcnt lgkmcnt(5)
  v_mfma_f32_16x16x32_bf16 v[144:147], a[16:19], v[20:23], v[144:147]
  ds_read_b128 v[48:51], v17 offset:25600
  v_mfma_f32_16x16x32_bf16 v[176:179], a[20:23], v[20:23], v[176:179]
  v_mfma_f32_16x16x32_bf16 v[208:211], v[52:55], v[20:23], v[208:211]
  ds_read_b128 v[20:23], v10 offset:49152
  v_mfma_f32_16x16x32_bf16 v[148:151], a[16:19], v[24:27], v[148:151]
  v_mfma_f32_16x16x32_bf16 v[180:183], a[20:23], v[24:27], v[180:183]
  v_mfma_f32_16x16x32_bf16 v[212:215], v[52:55], v[24:27], v[212:215]
  ds_read_b128 v[24:27], v10 offset:50176
  s_waitcnt lgkmcnt(6)
  v_mfma_f32_16x16x32_bf16 v[152:155], a[16:19], v[28:31], v[152:155]
  ds_read_b128 v[52:55], v18 offset:24576
  v_mfma_f32_16x16x32_bf16 v[184:187], a[20:23], v[28:31], v[184:187]
  ds_read_b128 v[28:31], v11 offset:49152
  v_mfma_f32_16x16x32_bf16 v[156:159], a[16:19], v[32:35], v[156:159]
  v_mfma_f32_16x16x32_bf16 v[188:191], a[20:23], v[32:35], v[188:191]
  ds_read_b128 v[32:35], v11 offset:50176
  s_waitcnt lgkmcnt(7)
  v_mfma_f32_16x16x32_bf16 v[160:163], a[16:19], v[36:39], v[160:163]
  v_mfma_f32_16x16x32_bf16 v[192:195], a[20:23], v[36:39], v[192:195]
  ds_read_b128 v[36:39], v12 offset:49152
  v_mfma_f32_16x16x32_bf16 v[164:167], a[16:19], v[40:43], v[164:167]
  v_mfma_f32_16x16x32_bf16 v[196:199], a[20:23], v[40:43], v[196:199]
  ds_read_b128 v[40:43], v12 offset:50176
  s_waitcnt lgkmcnt(7)
  v_mfma_f32_16x16x32_bf16 v[168:171], a[16:19], v[44:47], v[168:171]
  v_mfma_f32_16x16x32_bf16 v[200:203], a[20:23], v[44:47], v[200:203]
  ds_read_b128 v[44:47], v13 offset:49152
  v_mfma_f32_16x16x32_bf16 v[172:175], a[16:19], v[48:51], v[172:175]
  v_mfma_f32_16x16x32_bf16 v[204:207], a[20:23], v[48:51], v[204:207]
  ds_read_b128 v[48:51], v13 offset:50176
  s_waitcnt lgkmcnt(6)
  v_mfma_f32_16x16x32_bf16 v[144:147], a[192:195], v[20:23], v[144:147]
  v_mfma_f32_16x16x32_bf16 v[176:179], a[196:199], v[20:23], v[176:179]
  v_mfma_f32_16x16x32_bf16 v[208:211], v[52:55], v[20:23], v[208:211]
  ds_read_b128 v[20:23], v10 offset:57344
  v_mfma_f32_16x16x32_bf16 v[148:151], a[192:195], v[24:27], v[148:151]
  v_mfma_f32_16x16x32_bf16 v[180:183], a[196:199], v[24:27], v[180:183]
  v_mfma_f32_16x16x32_bf16 v[212:215], v[52:55], v[24:27], v[212:215]
  ds_read_b128 v[24:27], v10 offset:58368
  s_waitcnt lgkmcnt(6)
  v_mfma_f32_16x16x32_bf16 v[152:155], a[192:195], v[28:31], v[152:155]
  ds_read_b128 v[52:55], v18 offset:25600
  v_mfma_f32_16x16x32_bf16 v[184:187], a[196:199], v[28:31], v[184:187]
  ds_read_b128 v[28:31], v11 offset:57344
  v_mfma_f32_16x16x32_bf16 v[156:159], a[192:195], v[32:35], v[156:159]
  s_getpc_b64 s[100:101]
L_pc_11:
  s_add_u32 s100, s100, L_code_p4-L_pc_11
  s_addc_u32 s101, s101, 0
  s_sub_u32 s24, s2, 112
  s_cmp_lt_u32 s24, 16
  s_cselect_b32 s24, 128, 0
  v_mul_u32_u24 v1, s24, v0
  global_load_dword a251, v1, s[100:101]
  v_mfma_f32_16x16x32_bf16 v[188:191], a[196:199], v[32:35], v[188:191]
  ds_read_b128 v[32:35], v11 offset:58368
  s_waitcnt lgkmcnt(7)
  v_mfma_f32_16x16x32_bf16 v[160:163], a[192:195], v[36:39], v[160:163]
  v_mfma_f32_16x16x32_bf16 v[192:195], a[196:199], v[36:39], v[192:195]
  ds_read_b128 v[36:39], v12 offset:57344
  v_mfma_f32_16x16x32_bf16 v[164:167], a[192:195], v[40:43], v[164:167]
  v_mfma_f32_16x16x32_bf16 v[196:199], a[196:199], v[40:43], v[196:199]
  ds_read_b128 v[40:43], v12 offset:58368
  s_waitcnt lgkmcnt(7)
  v_mfma_f32_16x16x32_bf16 v[168:171], a[192:195], v[44:47], v[168:171]
  v_mfma_f32_16x16x32_bf16 v[200:203], a[196:199], v[44:47], v[200:203]
  ds_read_b128 v[44:47], v13 offset:57344
  v_mfma_f32_16x16x32_bf16 v[172:175], a[192:195], v[48:51], v[172:175]
  v_mfma_f32_16x16x32_bf16 v[204:207], a[196:199], v[48:51], v[204:207]
  s_waitcnt lgkmcnt(5)
  v_mfma_f32_16x16x32_bf16 v[144:147], a[200:203], v[20:23], v[144:147]
  ds_read_b128 v[48:51], v13 offset:58368
  v_mfma_f32_16x16x32_bf16 v[176:179], a[204:207], v[20:23], v[176:179]
  v_mfma_f32_16x16x32_bf16 v[208:211], v[52:55], v[20:23], v[208:211]
  ds_read_b128 v[20:23], v10 offset:0
  v_mfma_f32_16x16x32_bf16 v[148:151], a[200:203], v[24:27], v[148:151]
  v_mfma_f32_16x16x32_bf16 v[180:183], a[204:207], v[24:27], v[180:183]
  v_mfma_f32_16x16x32_bf16 v[212:215], v[52:55], v[24:27], v[212:215]
  ds_read_b128 v[24:27], v10 offset:1024
  s_waitcnt lgkmcnt(6)
  v_mfma_f32_16x16x32_bf16 v[152:155], a[200:203], v[28:31], v[152:155]
  ds_read_b128 v[52:55], v18 offset:30720
  v_mfma_f32_16x16x32_bf16 v[184:187], a[204:207], v[28:31], v[184:187]
  ds_read_b128 v[28:31], v11 offset:0
  v_mfma_f32_16x16x32_bf16 v[156:159], a[200:203], v[32:35], v[156:159]
  v_mfma_f32_16x16x32_bf16 v[188:191], a[204:207], v[32:35], v[188:191]
  ds_read_b128 v[32:35], v11 offset:1024
  s_waitcnt lgkmcnt(7)
  v_mfma_f32_16x16x32_bf16 v[160:163], a[200:203], v[36:39], v[160:163]
  v_mfma_f32_16x16x32_bf16 v[192:195], a[204:207], v[36:39], v[192:195]
  ds_read_b128 v[36:39], v12 offset:0
  v_mfma_f32_16x16x32_bf16 v[164:167], a[200:203], v[40:43], v[164:167]
  v_mfma_f32_16x16x32_bf16 v[196:199], a[204:207], v[40:43], v[196:199]
  ds_read_b128 v[40:43], v12 offset:1024
  s_waitcnt lgkmcnt(7)
  v_mfma_f32_16x16x32_bf16 v[168:171], a[200:203], v[44:47], v[168:171]
  v_mfma_f32_16x16x32_bf16 v[200:203], a[204:207], v[44:47], v[200:203]
  ds_read_b128 v[44:47], v13 offset:0
  v_mfma_f32_16x16x32_bf16 v[172:175], a[200:203], v[48:51], v[172:175]
  v_mfma_f32_16x16x32_bf16 v[204:207], a[204:207], v[48:51], v[204:207]
  ds_read_b128 v[48:51], v13 offset:1024
  s_waitcnt lgkmcnt(6)
  v_mfma_f32_16x16x32_bf16 v[144:147], a[24:27], v[20:23], v[144:147]
  v_mfma_f32_16x16x32_bf16 v[176:179], a[28:31], v[20:23], v[176:179]
  v_mfma_f32_16x16x32_bf16 v[208:211], v[52:55], v[20:23], v[208:211]
  ds_read_b128 v[20:23], v10 offset:8192
  v_mfma_f32_16x16x32_bf16 v[148:151], a[24:27], v[24:27], v[148:151]
  v_mfma_f32_16x16x32_bf16 v[180:183], a[28:31], v[24:27], v[180:183]
  v_mfma_f32_16x16x32_bf16 v[212:215], v[52:55], v[24:27], v[212:215]
  ds_read_b128 v[24:27], v10 offset:9216
  s_waitcnt lgkmcnt(6)
  v_mfma_f32_16x16x32_bf16 v[152:155], a[24:27], v[28:31], v[152:155]
  ds_read_b128 v[52:55], v18 offset:31744
  v_mfma_f32_16x16x32_bf16 v[184:187], a[28:31], v[28:31], v[184:187]
  ds_read_b128 v[28:31], v11 offset:8192
  v_mfma_f32_16x16x32_bf16 v[156:159], a[24:27], v[32:35], v[156:159]
  v_mfma_f32_16x16x32_bf16 v[188:191], a[28:31], v[32:35], v[188:191]
  ds_read_b128 v[32:35], v11 offset:9216
  s_waitcnt lgkmcnt(7)
  v_mfma_f32_16x16x32_bf16 v[160:163], a[24:27], v[36:39], v[160:163]
  s_add_u32 s33, s28, 0
  v_mfma_f32_16x16x32_bf16 v[192:195], a[28:31], v[36:39], v[192:195]
  ds_read_b128 v[36:39], v12 offset:8192
  v_mfma_f32_16x16x32_bf16 v[164:167], a[24:27], v[40:43], v[164:167]
  buffer_load_dwordx2 v[216:217], v245, s[16:19], s33 offen offset:0 sc1
  v_mfma_f32_16x16x32_bf16 v[196:199], a[28:31], v[40:43], v[196:199]
  ds_read_b128 v[40:43], v12 offset:9216
  s_waitcnt lgkmcnt(7)
  v_mfma_f32_16x16x32_bf16 v[168:171], a[24:27], v[44:47], v[168:171]
  buffer_load_dwordx2 v[218:219], v245, s[16:19], s33 offen offset:1024 sc1
  v_mfma_f32_16x16x32_bf16 v[200:203], a[28:31], v[44:47], v[200:203]
  ds_read_b128 v[44:47], v13 offset:8192
  buffer_load_dwordx2 v[220:221], v245, s[16:19], s33 offen offset:2048 sc1
  v_mfma_f32_16x16x32_bf16 v[172:175], a[24:27], v[48:51], v[172:175]
  buffer_load_dwordx2 v[222:223], v245, s[16:19], s33 offen offset:3072 sc1
  v_mfma_f32_16x16x32_bf16 v[204:207], a[28:31], v[48:51], v[204:207]
  s_waitcnt lgkmcnt(5)
  v_mfma_f32_16x16x32_bf16 v[144:147], a[32:35], v[20:23], v[144:147]
  ds_read_b128 v[48:51], v13 offset:9216
  s_add_u32 s33, s28, 4096
  v_mfma_f32_16x16x32_bf16 v[176:179], a[36:39], v[20:23], v[176:179]
  buffer_load_dwordx2 v[224:225], v245, s[16:19], s33 offen offset:0 sc1
  v_mfma_f32_16x16x32_bf16 v[208:211], v[52:55], v[20:23], v[208:211]
  ds_read_b128 v[20:23], v10 offset:16384
  buffer_load_dwordx2 v[226:227], v245, s[16:19], s33 offen offset:1024 sc1
  v_mfma_f32_16x16x32_bf16 v[148:151], a[32:35], v[24:27], v[148:151]
  buffer_load_dwordx2 v[228:229], v245, s[16:19], s33 offen offset:2048 sc1
  v_mfma_f32_16x16x32_bf16 v[180:183], a[36:39], v[24:27], v[180:183]
  buffer_load_dwordx2 v[230:231], v245, s[16:19], s33 offen offset:3072 sc1
  v_mfma_f32_16x16x32_bf16 v[212:215], v[52:55], v[24:27], v[212:215]
  ds_read_b128 v[24:27], v10 offset:17408
  s_waitcnt lgkmcnt(6)
  v_mfma_f32_16x16x32_bf16 v[152:155], a[32:35], v[28:31], v[152:155]
  ds_read_b128 v[52:55], v18 offset:32768
  s_add_u32 s33, s28, 8192
  v_mfma_f32_16x16x32_bf16 v[184:187], a[36:39], v[28:31], v[184:187]
  ds_read_b128 v[28:31], v11 offset:16384
  buffer_load_dwordx2 v[232:233], v245, s[16:19], s33 offen offset:0 sc1
  v_mfma_f32_16x16x32_bf16 v[156:159], a[32:35], v[32:35], v[156:159]
  buffer_load_dwordx2 v[234:235], v245, s[16:19], s33 offen offset:1024 sc1
  v_mfma_f32_16x16x32_bf16 v[188:191], a[36:39], v[32:35], v[188:191]
  ds_read_b128 v[32:35], v11 offset:17408
  s_waitcnt lgkmcnt(7)
  v_mfma_f32_16x16x32_bf16 v[160:163], a[32:35], v[36:39], v[160:163]
  buffer_load_dwordx2 v[236:237], v245, s[16:19], s33 offen offset:2048 sc1
  v_mfma_f32_16x16x32_bf16 v[192:195], a[36:39], v[36:39], v[192:195]
  ds_read_b128 v[36:39], v12 offset:16384
  buffer_load_dwordx2 v[238:239], v245, s[16:19], s33 offen offset:3072 sc1
  v_mfma_f32_16x16x32_bf16 v[164:167], a[32:35], v[40:43], v[164:167]
  s_add_u32 s33, s28, 12288
  buffer_load_dwordx2 v[56:57], v245, s[16:19], s33 offen offset:0 sc1
  v_mfma_f32_16x16x32_bf16 v[196:199], a[36:39], v[40:43], v[196:199]
  ds_read_b128 v[40:43], v12 offset:17408
  s_waitcnt lgkmcnt(7)
  v_mfma_f32_16x16x32_bf16 v[168:171], a[32:35], v[44:47], v[168:171]
  buffer_load_dwordx2 v[58:59], v245, s[16:19], s33 offen offset:1024 sc1
  v_mfma_f32_16x16x32_bf16 v[200:203], a[36:39], v[44:47], v[200:203]
  ds_read_b128 v[44:47], v13 offset:16384
  buffer_load_dwordx2 v[60:61], v245, s[16:19], s33 offen offset:2048 sc1
  v_mfma_f32_16x16x32_bf16 v[172:175], a[32:35], v[48:51], v[172:175]
  buffer_load_dwordx2 v[62:63], v245, s[16:19], s33 offen offset:3072 sc1
  v_mfma_f32_16x16x32_bf16 v[204:207], a[36:39], v[48:51], v[204:207]
  ds_read_b128 v[48:51], v13 offset:17408
  s_waitcnt vmcnt(0)
L_m_poll:
  v_max3_u32 v6, v216, v217, v218
  v_max3_u32 v7, v219, v220, v221
  v_max3_u32 v6, v6, v222, v223
  v_max3_u32 v7, v7, v224, v225
  v_max3_u32 v6, v6, v226, v227
  v_max3_u32 v7, v7, v228, v229
  v_max3_u32 v6, v6, v230, v231
  v_max3_u32 v7, v7, v232, v233
  v_max3_u32 v6, v6, v234, v235
  v_max3_u32 v7, v7, v236, v237
  v_max3_u32 v6, v6, v238, v239
  v_max3_u32 v7, v7, v56, v57
  v_max3_u32 v6, v6, v58, v59
  v_max3_u32 v7, v7, v60, v61
  v_max3_u32 v6, v6, v62, v63
  v_max_u32 v6, v6, v7
  v_cmp_eq_u32 vcc, -1, v6
  s_nop 0
  s_cbranch_vccz L_m_got
  s_add_u32 s33, s28, 0
  buffer_load_dwordx2 v[216:217], v245, s[16:19], s33 offen offset:0 sc1
  buffer_load_dwordx2 v[218:219], v245, s[16:19], s33 offen offset:1024 sc1
  buffer_load_dwordx2 v[220:221], v245, s[16:19], s33 offen offset:2048 sc1
  buffer_load_dwordx2 v[222:223], v245, s[16:19], s33 offen offset:3072 sc1
  s_add_u32 s33, s28, 4096
  buffer_load_dwordx2 v[224:225], v245, s[16:19], s33 offen offset:0 sc1
  buffer_load_dwordx2 v[226:227], v245, s[16:19], s33 offen offset:1024 sc1
  buffer_load_dwordx2 v[228:229], v245, s[16:19], s33 offen offset:2048 sc1
  buffer_load_dwordx2 v[230:231], v245, s[16:19], s33 offen offset:3072 sc1
  s_add_u32 s33, s28, 8192
  buffer_load_dwordx2 v[232:233], v245, s[16:19], s33 offen offset:0 sc1
  buffer_load_dwordx2 v[234:235], v245, s[16:19], s33 offen offset:1024 sc1
  buffer_load_dwordx2 v[236:237], v245, s[16:19], s33 offen offset:2048 sc1
  buffer_load_dwordx2 v[238:239], v245, s[16:19], s33 offen offset:3072 sc1
  s_add_u32 s33, s28, 12288
  buffer_load_dwordx2 v[56:57], v245, s[16:19], s33 offen offset:0 sc1
  buffer_load_dwordx2 v[58:59], v245, s[16:19], s33 offen offset:1024 sc1
  buffer_load_dwordx2 v[60:61], v245, s[16:19], s33 offen offset:2048 sc1
  buffer_load_dwordx2 v[62:63], v245, s[16:19], s33 offen offset:3072 sc1
  s_waitcnt vmcnt(0)
  s_branch L_m_poll
L_m_got:
  v_pk_add_f32 v[216:217], v[216:217], v[232:233]
  v_pk_add_f32 v[218:219], v[218:219], v[234:235]
  v_pk_add_f32 v[220:221], v[220:221], v[236:237]
  v_pk_add_f32 v[222:223], v[222:223], v[238:239]
  v_pk_add_f32 v[224:225], v[224:225], v[56:57]
  v_pk_add_f32 v[226:227], v[226:227], v[58:59]
  v_pk_add_f32 v[228:229], v[228:229], v[60:61]
  v_pk_add_f32 v[230:231], v[230:231], v[62:63]
  v_pk_add_f32 v[216:217], v[216:217], v[224:225]
  v_pk_add_f32 v[218:219], v[218:219], v[226:227]
  v_pk_add_f32 v[220:221], v[220:221], v[228:229]
  v_pk_add_f32 v[222:223], v[222:223], v[230:231]
  v_pk_add_f32 v[216:217], v[216:217], v[220:221]
  v_pk_add_f32 v[218:219], v[218:219], v[222:223]
  v_pk_add_f32 v[216:217], v[216:217], v[218:219]
  v_mul_f32 v216, 0x39e38e39, v216
  v_mul_f32 v217, 0x39e38e39, v217
  v_add_u32 v7, 160768, v245
  v_fma_f32 v217, -v216, v216, v217
  v_max_f32 v217, 0, v217
  v_add_f32 v217, 0x3727c5ac, v217
  v_rsq_f32 v217, v217
  v_lshlrev_b32 v6, 3, v3
  v_mul_f32 v216, v216, v217
  v_sub_f32 v216, 0, v216
  ds_write_b64 v7, v[216:217]
  v_add_u32 v6, 160768, v6
  s_waitcnt lgkmcnt(0)
  s_barrier
  s_lshl_b32 s26, s50, 7
  v_add_u32 v7, s26, v6
  ds_read_b64 v[216:217], v7
  ds_read_b64 v[218:219], v7 offset:128
  s_lshl_b32 s26, s51, 7
  v_add_u32 v7, s26, v6
  ds_read_b64 v[220:221], v7
  ds_read_b64 v[222:223], v7 offset:128
  s_lshl_b32 s26, s52, 7
  v_add_u32 v7, s26, v6
  ds_read_b64 v[224:225], v7
  ds_read_b64 v[226:227], v7 offset:128
  s_lshl_b32 s26, s53, 7
  v_add_u32 v7, s26, v6
  ds_read_b64 v[228:229], v7
  ds_read_b64 v[230:231], v7 offset:128
  s_mov_b32 s40, s43
  s_add_u32 m0, s41, 49152
  s_nop 0
  buffer_load_dwordx4 v4, s[8:11], s40 offen offset:0 sc1 lds
  buffer_load_dwordx4 v4, s[8:11], s40 offen offset:1024 sc1 lds
  buffer_load_dwordx4 v4, s[8:11], s40 offen offset:2048 sc1 lds
  buffer_load_dwordx4 v4, s[8:11], s40 offen offset:3072 sc1 lds
  s_add_u32 s40, s40, 16384
  s_add_u32 m0, s41, 0
  s_nop 0
  buffer_load_dwordx4 v4, s[8:11], s40 offen offset:0 sc1 lds
  buffer_load_dwordx4 v4, s[8:11], s40 offen offset:1024 sc1 lds
  buffer_load_dwordx4 v4, s[8:11], s40 offen offset:2048 sc1 lds
  buffer_load_dwordx4 v4, s[8:11], s40 offen offset:3072 sc1 lds
  s_add_u32 s40, s40, 16384
  s_add_u32 m0, s41, 110592
  s_nop 0
  buffer_load_dwordx4 v4, s[8:11], s40 offen offset:0 sc1 lds
  buffer_load_dwordx4 v4, s[8:11], s40 offen offset:1024 sc1 lds
  buffer_load_dwordx4 v4, s[8:11], s40 offen offset:2048 sc1 lds
  buffer_load_dwordx4 v4, s[8:11], s40 offen offset:3072 sc1 lds
  s_add_u32 s40, s40, 16384
  s_add_u32 s16, s4, 31195136
  s_addc_u32 s17, s5, 0
  s_mov_b32 s18, 9437184
  s_mov_b32 s19, 0x20000
  s_waitcnt lgkmcnt(0)
  v_pk_fma_f32 v[72:73], v[216:217], v[72:73], v[216:217] op_sel:[1,0,0] op_sel_hi:[1,1,0]
  v_pk_fma_f32 v[74:75], v[216:217], v[74:75], v[216:217] op_sel:[1,0,0] op_sel_hi:[1,1,0]
  v_cvt_pk_bf16_f32 v56, v72, v73
  v_cvt_pk_bf16_f32 v57, v74, v75
  ds_write_b64 v247, v[56:57] offset:0
  v_pk_fma_f32 v[76:77], v[218:219], v[76:77], v[218:219] op_sel:[1,0,0] op_sel_hi:[1,1,0]
  v_pk_fma_f32 v[78:79], v[218:219], v[78:79], v[218:219] op_sel:[1,0,0] op_sel_hi:[1,1,0]
  v_cvt_pk_bf16_f32 v58, v76, v77
  v_cvt_pk_bf16_f32 v59, v78, v79
  ds_write_b64 v247, v[58:59] offset:640
  v_pk_fma_f32 v[80:81], v[220:221], v[80:81], v[220:221] op_sel:[1,0,0] op_sel_hi:[1,1,0]
  v_pk_fma_f32 v[82:83], v[220:221], v[82:83], v[220:221] op_sel:[1,0,0] op_sel_hi:[1,1,0]
  v_cvt_pk_bf16_f32 v60, v80, v81
  v_cvt_pk_bf16_f32 v61, v82, v83
  ds_write_b64 v247, v[60:61] offset:1280
  v_pk_fma_f32 v[84:85], v[222:223], v[84:85], v[222:223] op_sel:[1,0,0] op_sel_hi:[1,1,0]
  v_pk_fma_f32 v[86:87], v[222:223], v[86:87], v[222:223] op_sel:[1,0,0] op_sel_hi:[1,1,0]
  v_cvt_pk_bf16_f32 v62, v84, v85
  v_cvt_pk_bf16_f32 v63, v86, v87
  ds_write_b64 v247, v[62:63] offset:1920
  s_waitcnt lgkmcnt(2)
  ds_read_b64_tr_b16 v[72:73], v19 offset:0
  ds_read_b64_tr_b16 v[74:75], v19 offset:160
  s_lshl_b32 s26, s50, 5
  s_lshl_b32 s27, s20, 8
  s_add_u32 s26, s26, s27
  buffer_load_ushort v248, v246, s[36:39], s26 offen offset:0
  buffer_load_ushort v249, v246, s[36:39], s26 offen offset:32
  s_lshl_b32 s26, s51, 5
  s_lshl_b32 s27, s20, 8
  s_add_u32 s26, s26, s27
  buffer_load_ushort v250, v246, s[36:39], s26 offen offset:0
  buffer_load_ushort v251, v246, s[36:39], s26 offen offset:32
  s_lshl_b32 s26, s52, 5
  s_lshl_b32 s27, s20, 8
  s_add_u32 s26, s26, s27
  buffer_load_ushort v252, v246, s[36:39], s26 offen offset:0
  buffer_load_ushort v253, v246, s[36:39], s26 offen offset:32
  s_lshl_b32 s26, s53, 5
  s_lshl_b32 s27, s20, 8
  s_add_u32 s26, s26, s27
  buffer_load_ushort v254, v246, s[36:39], s26 offen offset:0
  buffer_load_ushort v255, v246, s[36:39], s26 offen offset:32
  s_mov_b32 s36, s62
  s_mov_b32 s37, s63
  s_mov_b32 s60, s34
  s_mov_b32 s61, s35
  s_mov_b32 s62, 8388608
  s_mov_b32 s63, 0x20000
  s_lshl_b32 s54, s20, 19
  s_lshl_b32 s26, s3, 17
  s_add_u32 s54, s54, s26
  s_lshl_b32 s44, s3, 10
  s_add_u32 s44, s44, 32768
  s_mov_b32 s46, s42
  s_mov_b32 s55, s42
  s_lshl_b32 s25, s21, 4
  s_add_u32 s33, s25, s20
  v_mfma_f32_16x16x32_bf16 v[144:147], a[40:43], v[20:23], v[144:147]
  v_fma_f32 v88, v225, v88, v224
  v_fma_f32 v89, v225, v89, v224
  v_fma_f32 v90, v225, v90, v224
  v_fma_f32 v91, v225, v91, v224
  v_mfma_f32_16x16x32_bf16 v[176:179], a[44:47], v[20:23], v[176:179]
  v_cvt_pk_bf16_f32 v56, v88, v89
  v_cvt_pk_bf16_f32 v57, v90, v91
  ds_write_b64 v247, v[56:57] offset:2560
  v_fma_f32 v92, v227, v92, v226
  v_mfma_f32_16x16x32_bf16 v[208:211], v[52:55], v[20:23], v[208:211]
  ds_read_b128 v[20:23], v10 offset:24576
  v_fma_f32 v93, v227, v93, v226
  v_fma_f32 v94, v227, v94, v226
  v_fma_f32 v95, v227, v95, v226
  v_mfma_f32_16x16x32_bf16 v[148:151], a[40:43], v[24:27], v[148:151]
  v_cvt_pk_bf16_f32 v58, v92, v93
  v_cvt_pk_bf16_f32 v59, v94, v95
  ds_write_b64 v247, v[58:59] offset:3200
  v_mfma_f32_16x16x32_bf16 v[180:183], a[44:47], v[24:27], v[180:183]
  s_waitcnt lgkmcnt(5)
  ds_read_b64_tr_b16 v[80:81], v19 offset:1280
  ds_read_b64_tr_b16 v[82:83], v19 offset:1440
  v_mfma_f32_16x16x32_bf16 v[212:215], v[52:55], v[24:27], v[212:215]
  ds_read_b128 v[24:27], v10 offset:25600
  ds_read_b128 v[52:55], v18 offset:33792
  v_mfma_f32_16x16x32_bf16 v[152:155], a[40:43], v[28:31], v[152:155]
  s_waitcnt lgkmcnt(7)
  buffer_store_dwordx4 v[72:75], v4, s[16:19], s29 offen offset:0 sc1
  v_fma_f32 v96, v229, v96, v228
  v_mfma_f32_16x16x32_bf16 v[184:187], a[44:47], v[28:31], v[184:187]
  ds_read_b128 v[28:31], v11 offset:24576
  v_fma_f32 v97, v229, v97, v228
  v_fma_f32 v98, v229, v98, v228
  v_fma_f32 v99, v229, v99, v228
  v_mfma_f32_16x16x32_bf16 v[156:159], a[40:43], v[32:35], v[156:159]
  v_cvt_pk_bf16_f32 v60, v96, v97
  v_cvt_pk_bf16_f32 v61, v98, v99
  ds_write_b64 v247, v[60:61] offset:3840
  v_fma_f32 v100, v231, v100, v230
  v_mfma_f32_16x16x32_bf16 v[188:191], a[44:47], v[32:35], v[188:191]
  ds_read_b128 v[32:35], v11 offset:25600
  v_fma_f32 v101, v231, v101, v230
  v_fma_f32 v102, v231, v102, v230
  v_mfma_f32_16x16x32_bf16 v[160:163], a[40:43], v[36:39], v[160:163]
  v_fma_f32 v103, v231, v103, v230
  v_cvt_pk_bf16_f32 v62, v100, v101
  v_cvt_pk_bf16_f32 v63, v102, v103
  ds_write_b64 v247, v[62:63] offset:4480
  v_mfma_f32_16x16x32_bf16 v[192:195], a[44:47], v[36:39], v[192:195]
  ds_read_b128 v[36:39], v12 offset:24576
  s_waitcnt lgkmcnt(9)
  ds_read_b64_tr_b16 v[88:89], v19 offset:2560
  ds_read_b64_tr_b16 v[90:91], v19 offset:2720
  v_mfma_f32_16x16x32_bf16 v[164:167], a[40:43], v[40:43], v[164:167]
  s_waitcnt lgkmcnt(9)
  buffer_store_dwordx4 v[80:83], v4, s[16:19], s30 offen offset:0 sc1
  v_fma_f32 v104, v217, v104, v216
  v_mfma_f32_16x16x32_bf16 v[196:199], a[44:47], v[40:43], v[196:199]
  ds_read_b128 v[40:43], v12 offset:25600
  v_fma_f32 v105, v217, v105, v216
  v_fma_f32 v106, v217, v106, v216
  v_mfma_f32_16x16x32_bf16 v[168:171], a[40:43], v[44:47], v[168:171]
  v_fma_f32 v107, v217, v107, v216
  v_cvt_pk_bf16_f32 v56, v104, v105
  v_cvt_pk_bf16_f32 v57, v106, v107
  ds_write_b64 v247, v[56:57] offset:0
  v_mfma_f32_16x16x32_bf16 v[200:203], a[44:47], v[44:47], v[200:203]
  ds_read_b128 v[44:47], v13 offset:24576
  v_fma_f32 v108, v219, v108, v218
  v_fma_f32 v109, v219, v109, v218
  v_fma_f32 v110, v219, v110, v218
  v_mfma_f32_16x16x32_bf16 v[172:175], a[40:43], v[48:51], v[172:175]
  v_fma_f32 v111, v219, v111, v218
  v_cvt_pk_bf16_f32 v58, v108, v109
  v_cvt_pk_bf16_f32 v59, v110, v111
  ds_write_b64 v247, v[58:59] offset:640
  v_mfma_f32_16x16x32_bf16 v[204:207], a[44:47], v[48:51], v[204:207]
  ds_read_b128 v[48:51], v13 offset:25600
  s_waitcnt lgkmcnt(12)
  v_mfma_f32_16x16x32_bf16 v[144:147], a[48:51], v[20:23], v[144:147]
  s_waitcnt lgkmcnt(8)
  ds_read_b64_tr_b16 v[96:97], v19 offset:3840
  ds_read_b64_tr_b16 v[98:99], v19 offset:4000
  v_mfma_f32_16x16x32_bf16 v[176:179], a[52:55], v[20:23], v[176:179]
  s_waitcnt lgkmcnt(7)
  buffer_store_dwordx4 v[88:91], v4, s[16:19], s31 offen offset:0 sc1
  v_fma_f32 v112, v221, v112, v220
  v_mfma_f32_16x16x32_bf16 v[208:211], v[52:55], v[20:23], v[208:211]
  ds_read_b128 v[20:23], v10 offset:32768
  v_fma_f32 v113, v221, v113, v220
  v_fma_f32 v114, v221, v114, v220
  v_fma_f32 v115, v221, v115, v220
  v_mfma_f32_16x16x32_bf16 v[148:151], a[48:51], v[24:27], v[148:151]
  v_cvt_pk_bf16_f32 v60, v112, v113
  v_cvt_pk_bf16_f32 v61, v114, v115
  ds_write_b64 v247, v[60:61] offset:1280
  v_fma_f32 v116, v223, v116, v222
  v_mfma_f32_16x16x32_bf16 v[180:183], a[52:55], v[24:27], v[180:183]
  v_fma_f32 v117, v223, v117, v222
  v_fma_f32 v118, v223, v118, v222
  v_fma_f32 v119, v223, v119, v222
  v_cvt_pk_bf16_f32 v62, v116, v117
  v_mfma_f32_16x16x32_bf16 v[212:215], v[52:55], v[24:27], v[212:215]
  ds_read_b128 v[24:27], v10 offset:33792
  ds_read_b128 v[52:55], v18 offset:34816
  v_cvt_pk_bf16_f32 v63, v118, v119
  v_mfma_f32_16x16x32_bf16 v[152:155], a[48:51], v[28:31], v[152:155]
  ds_write_b64 v247, v[62:63] offset:1920
  s_waitcnt lgkmcnt(8)
  ds_read_b64_tr_b16 v[104:105], v19 offset:0
  ds_read_b64_tr_b16 v[106:107], v19 offset:160
  v_mfma_f32_16x16x32_bf16 v[184:187], a[52:55], v[28:31], v[184:187]
  ds_read_b128 v[28:31], v11 offset:32768
  s_waitcnt lgkmcnt(8)
  buffer_store_dwordx4 v[96:99], v4, s[16:19], s32 offen offset:0 sc1
  v_mfma_f32_16x16x32_bf16 v[156:159], a[48:51], v[32:35], v[156:159]
  v_fma_f32 v120, v225, v120, v224
  v_fma_f32 v121, v225, v121, v224
  v_fma_f32 v122, v225, v122, v224
  v_fma_f32 v123, v225, v123, v224
  v_mfma_f32_16x16x32_bf16 v[188:191], a[52:55], v[32:35], v[188:191]
  ds_read_b128 v[32:35], v11 offset:33792
  v_cvt_pk_bf16_f32 v56, v120, v121
  v_cvt_pk_bf16_f32 v57, v122, v123
  v_mfma_f32_16x16x32_bf16 v[160:163], a[48:51], v[36:39], v[160:163]
  ds_write_b64 v247, v[56:57] offset:2560
  v_fma_f32 v124, v227, v124, v226
  v_fma_f32 v125, v227, v125, v226
  v_fma_f32 v126, v227, v126, v226
  v_mfma_f32_16x16x32_bf16 v[192:195], a[52:55], v[36:39], v[192:195]
  ds_read_b128 v[36:39], v12 offset:32768
  v_fma_f32 v127, v227, v127, v226
  v_cvt_pk_bf16_f32 v58, v124, v125
  v_cvt_pk_bf16_f32 v59, v126, v127
  v_mfma_f32_16x16x32_bf16 v[164:167], a[48:51], v[40:43], v[164:167]
  ds_write_b64 v247, v[58:59] offset:3200
  s_waitcnt lgkmcnt(7)
  ds_read_b64_tr_b16 v[112:113], v19 offset:1280
  ds_read_b64_tr_b16 v[114:115], v19 offset:1440
  v_mfma_f32_16x16x32_bf16 v[196:199], a[52:55], v[40:43], v[196:199]
  ds_read_b128 v[40:43], v12 offset:33792
  v_mfma_f32_16x16x32_bf16 v[168:171], a[48:51], v[44:47], v[168:171]
  s_waitcnt lgkmcnt(8)
  buffer_store_dwordx4 v[104:107], v4, s[16:19], s29 offen offset:1024 sc1
  v_fma_f32 v128, v229, v128, v228
  v_mfma_f32_16x16x32_bf16 v[200:203], a[52:55], v[44:47], v[200:203]
  ds_read_b128 v[44:47], v13 offset:32768
  v_fma_f32 v129, v229, v129, v228
  v_fma_f32 v130, v229, v130, v228
  v_fma_f32 v131, v229, v131, v228
  v_mfma_f32_16x16x32_bf16 v[172:175], a[48:51], v[48:51], v[172:175]
  v_cvt_pk_bf16_f32 v60, v128, v129
  v_cvt_pk_bf16_f32 v61, v130, v131
  ds_write_b64 v247, v[60:61] offset:3840
  v_fma_f32 v132, v231, v132, v230
  v_mfma_f32_16x16x32_bf16 v[204:207], a[52:55], v[48:51], v[204:207]
  ds_read_b128 v[48:51], v13 offset:33792
  v_fma_f32 v133, v231, v133, v230
  v_fma_f32 v134, v231, v134, v230
  v_mfma_f32_16x16x32_bf16 v[144:147], a[56:59], v[20:23], v[144:147]
  v_fma_f32 v135, v231, v135, v230
  v_cvt_pk_bf16_f32 v62, v132, v133
  v_cvt_pk_bf16_f32 v63, v134, v135
  ds_write_b64 v247, v[62:63] offset:4480
  v_mfma_f32_16x16x32_bf16 v[176:179], a[60:63], v[20:23], v[176:179]
  s_waitcnt lgkmcnt(7)
  ds_read_b64_tr_b16 v[120:121], v19 offset:2560
  ds_read_b64_tr_b16 v[122:123], v19 offset:2720
  v_mfma_f32_16x16x32_bf16 v[208:211], v[52:55], v[20:23], v[208:211]
  ds_read_b128 v[20:23], v10 offset:40960
  s_waitcnt lgkmcnt(8)
  buffer_store_dwordx4 v[112:115], v4, s[16:19], s30 offen offset:1024 sc1
  v_mfma_f32_16x16x32_bf16 v[148:151], a[56:59], v[24:27], v[148:151]
  v_fma_f32 v136, v217, v136, v216
  v_fma_f32 v137, v217, v137, v216
  v_fma_f32 v138, v217, v138, v216
  v_fma_f32 v139, v217, v139, v216
  v_mfma_f32_16x16x32_bf16 v[180:183], a[60:63], v[24:27], v[180:183]
  v_cvt_pk_bf16_f32 v56, v136, v137
  v_cvt_pk_bf16_f32 v57, v138, v139
  ds_write_b64 v247, v[56:57] offset:0
  v_fma_f32 v140, v219, v140, v218
  v_mfma_f32_16x16x32_bf16 v[212:215], v[52:55], v[24:27], v[212:215]
  ds_read_b128 v[24:27], v10 offset:41984
  ds_read_b128 v[52:55], v18 offset:35840
  v_fma_f32 v141, v219, v141, v218
  v_mfma_f32_16x16x32_bf16 v[152:155], a[56:59], v[28:31], v[152:155]
  v_fma_f32 v142, v219, v142, v218
  v_fma_f32 v143, v219, v143, v218
  v_cvt_pk_bf16_f32 v58, v140, v141
  v_cvt_pk_bf16_f32 v59, v142, v143
  v_mfma_f32_16x16x32_bf16 v[184:187], a[60:63], v[28:31], v[184:187]
  ds_read_b128 v[28:31], v11 offset:40960
  ds_write_b64 v247, v[58:59] offset:640
  s_waitcnt lgkmcnt(8)
  ds_read_b64_tr_b16 v[128:129], v19 offset:3840
  v_mfma_f32_16x16x32_bf16 v[156:159], a[56:59], v[32:35], v[156:159]
  ds_read_b64_tr_b16 v[130:131], v19 offset:4000
  s_waitcnt lgkmcnt(8)
  buffer_store_dwordx4 v[120:123], v4, s[16:19], s31 offen offset:1024 sc1
  v_mfma_f32_16x16x32_bf16 v[188:191], a[60:63], v[32:35], v[188:191]
  ds_read_b128 v[32:35], v11 offset:41984
  s_waitcnt lgkmcnt(3)
  ds_read_b64_tr_b16 v[136:137], v19 offset:0
  v_mfma_f32_16x16x32_bf16 v[160:163], a[56:59], v[36:39], v[160:163]
  ds_read_b64_tr_b16 v[138:139], v19 offset:160
  s_waitcnt lgkmcnt(3)
  buffer_store_dwordx4 v[128:131], v4, s[16:19], s32 offen offset:1024 sc1
  v_mfma_f32_16x16x32_bf16 v[192:195], a[60:63], v[36:39], v[192:195]
  ds_read_b128 v[36:39], v12 offset:40960
  s_waitcnt lgkmcnt(1)
  buffer_store_dwordx4 v[136:139], v4, s[16:19], s47 offen offset:0 sc1
  v_mfma_f32_16x16x32_bf16 v[164:167], a[56:59], v[40:43], v[164:167]
  s_lshl_b32 s26, s3, 11
  s_add_u32 s26, s26, 0
  v_add_u32 v240, s26, v4
  s_lshl_b32 s26, s3, 11
  v_mfma_f32_16x16x32_bf16 v[196:199], a[60:63], v[40:43], v[196:199]
  ds_read_b128 v[40:43], v12 offset:41984
  s_add_u32 s26, s26, 9216
  v_add_u32 v241, s26, v4
  v_mfma_f32_16x16x32_bf16 v[168:171], a[56:59], v[44:47], v[168:171]
  s_lshl_b32 s26, s3, 11
  s_add_u32 s26, s26, 18432
  v_add_u32 v242, s26, v4
  s_lshl_b32 s26, s3, 11
  v_mfma_f32_16x16x32_bf16 v[200:203], a[60:63], v[44:47], v[200:203]
  ds_read_b128 v[44:47], v13 offset:40960
  s_add_u32 s26, s26, 27648
  v_add_u32 v243, s26, v4
  s_mul_i32 s26, s3, 9216
  v_mfma_f32_16x16x32_bf16 v[172:175], a[56:59], v[48:51], v[172:175]
  s_add_u32 s26, s26, 8192
  v_add_u32 v244, s26, v4
  v_mfma_f32_16x16x32_bf16 v[204:207], a[60:63], v[48:51], v[204:207]
  s_waitcnt vmcnt(25)
  s_waitcnt vmcnt(17)
  s_barrier
  v_mfma_f32_16x16x32_bf16 v[144:147], a[64:67], v[20:23], v[144:147]
  ds_read_b128 v[48:51], v13 offset:41984
  v_mfma_f32_16x16x32_bf16 v[176:179], a[68:71], v[20:23], v[176:179]
  v_mfma_f32_16x16x32_bf16 v[208:211], v[52:55], v[20:23], v[208:211]
  ds_read_b128 v[20:23], v10 offset:49152
  v_mfma_f32_16x16x32_bf16 v[148:151], a[64:67], v[24:27], v[148:151]
  v_mfma_f32_16x16x32_bf16 v[180:183], a[68:71], v[24:27], v[180:183]
  v_mfma_f32_16x16x32_bf16 v[212:215], v[52:55], v[24:27], v[212:215]
  ds_read_b128 v[24:27], v10 offset:50176
  ds_read_b128 v[52:55], v18 offset:18432
  v_mfma_f32_16x16x32_bf16 v[152:155], a[64:67], v[28:31], v[152:155]
  v_mfma_f32_16x16x32_bf16 v[184:187], a[68:71], v[28:31], v[184:187]
  ds_read_b128 v[28:31], v11 offset:49152
  v_mfma_f32_16x16x32_bf16 v[156:159], a[64:67], v[32:35], v[156:159]
  v_mfma_f32_16x16x32_bf16 v[188:191], a[68:71], v[32:35], v[188:191]
  ds_read_b128 v[32:35], v11 offset:50176
  s_waitcnt lgkmcnt(7)
  v_mfma_f32_16x16x32_bf16 v[160:163], a[64:67], v[36:39], v[160:163]
  v_mfma_f32_16x16x32_bf16 v[192:195], a[68:71], v[36:39], v[192:195]
  ds_read_b128 v[36:39], v12 offset:49152
  v_mfma_f32_16x16x32_bf16 v[164:167], a[64:67], v[40:43], v[164:167]
  v_mfma_f32_16x16x32_bf16 v[196:199], a[68:71], v[40:43], v[196:199]
  ds_read_b128 v[40:43], v12 offset:50176
  s_waitcnt lgkmcnt(7)
  v_mfma_f32_16x16x32_bf16 v[168:171], a[64:67], v[44:47], v[168:171]
  v_mfma_f32_16x16x32_bf16 v[200:203], a[68:71], v[44:47], v[200:203]
  ds_read_b128 v[44:47], v13 offset:49152
  v_mfma_f32_16x16x32_bf16 v[172:175], a[64:67], v[48:51], v[172:175]
  v_mfma_f32_16x16x32_bf16 v[204:207], a[68:71], v[48:51], v[204:207]
  ds_read_b128 v[48:51], v13 offset:50176
  s_waitcnt lgkmcnt(6)
  v_mfma_f32_16x16x32_bf16 v[144:147], a[144:147], v[20:23], v[144:147]
  v_mfma_f32_16x16x32_bf16 v[176:179], a[148:151], v[20:23], v[176:179]
  v_mfma_f32_16x16x32_bf16 v[208:211], v[52:55], v[20:23], v[208:211]
  ds_read_b128 v[20:23], v10 offset:57344
  v_mfma_f32_16x16x32_bf16 v[148:151], a[144:147], v[24:27], v[148:151]
  v_mfma_f32_16x16x32_bf16 v[180:183], a[148:151], v[24:27], v[180:183]
  v_mfma_f32_16x16x32_bf16 v[212:215], v[52:55], v[24:27], v[212:215]
  ds_read_b128 v[24:27], v10 offset:58368
  ds_read_b128 v[52:55], v18 offset:19456
  s_waitcnt lgkmcnt(7)
  v_mfma_f32_16x16x32_bf16 v[152:155], a[144:147], v[28:31], v[152:155]
  v_mfma_f32_16x16x32_bf16 v[184:187], a[148:151], v[28:31], v[184:187]
  ds_read_b128 v[28:31], v11 offset:57344
  v_mfma_f32_16x16x32_bf16 v[156:159], a[144:147], v[32:35], v[156:159]
  v_mfma_f32_16x16x32_bf16 v[188:191], a[148:151], v[32:35], v[188:191]
  ds_read_b128 v[32:35], v11 offset:58368
  s_waitcnt lgkmcnt(7)
  v_mfma_f32_16x16x32_bf16 v[160:163], a[144:147], v[36:39], v[160:163]
  v_mfma_f32_16x16x32_bf16 v[192:195], a[148:151], v[36:39], v[192:195]
  ds_read_b128 v[36:39], v12 offset:57344
  v_mfma_f32_16x16x32_bf16 v[164:167], a[144:147], v[40:43], v[164:167]
  v_mfma_f32_16x16x32_bf16 v[196:199], a[148:151], v[40:43], v[196:199]
  ds_read_b128 v[40:43], v12 offset:58368
  s_waitcnt lgkmcnt(7)
  v_mfma_f32_16x16x32_bf16 v[168:171], a[144:147], v[44:47], v[168:171]
  v_mfma_f32_16x16x32_bf16 v[200:203], a[148:151], v[44:47], v[200:203]
  ds_read_b128 v[44:47], v13 offset:57344
  v_mfma_f32_16x16x32_bf16 v[172:175], a[144:147], v[48:51], v[172:175]
  v_mfma_f32_16x16x32_bf16 v[204:207], a[148:151], v[48:51], v[204:207]
  s_barrier
  s_waitcnt lgkmcnt(5)
  v_mfma_f32_16x16x32_bf16 v[144:147], a[152:155], v[20:23], v[144:147]
  ds_read_b128 v[48:51], v13 offset:58368
  s_add_u32 m0, s41, 73728
  v_mfma_f32_16x16x32_bf16 v[176:179], a[156:159], v[20:23], v[176:179]
  buffer_load_dwordx4 v68, s[60:63], s54 offen offset:0 lds
  v_mfma_f32_16x16x32_bf16 v[208:211], v[52:55], v[20:23], v[208:211]
  ds_read_b128 v[20:23], v10 offset:0
  v_mfma_f32_16x16x32_bf16 v[148:151], a[152:155], v[24:27], v[148:151]
  v_mfma_f32_16x16x32_bf16 v[180:183], a[156:159], v[24:27], v[180:183]
  v_mfma_f32_16x16x32_bf16 v[212:215], v[52:55], v[24:27], v[212:215]
  ds_read_b128 v[24:27], v10 offset:1024
  s_waitcnt lgkmcnt(6)
  v_mfma_f32_16x16x32_bf16 v[152:155], a[152:155], v[28:31], v[152:155]
  ds_read_b128 v[52:55], v18 offset:20480
  v_mfma_f32_16x16x32_bf16 v[184:187], a[156:159], v[28:31], v[184:187]
  ds_read_b128 v[28:31], v11 offset:0
  v_mfma_f32_16x16x32_bf16 v[156:159], a[152:155], v[32:35], v[156:159]
  buffer_load_dwordx4 v69, s[60:63], s54 offen offset:1024 lds
  v_mfma_f32_16x16x32_bf16 v[188:191], a[156:159], v[32:35], v[188:191]
  ds_read_b128 v[32:35], v11 offset:1024
  s_waitcnt lgkmcnt(7)
  v_mfma_f32_16x16x32_bf16 v[160:163], a[152:155], v[36:39], v[160:163]
  buffer_load_dwordx4 v70, s[60:63], s54 offen offset:2048 lds
  v_mfma_f32_16x16x32_bf16 v[192:195], a[156:159], v[36:39], v[192:195]
  ds_read_b128 v[36:39], v12 offset:0
  v_mfma_f32_16x16x32_bf16 v[164:167], a[152:155], v[40:43], v[164:167]
  v_mfma_f32_16x16x32_bf16 v[196:199], a[156:159], v[40:43], v[196:199]
  ds_read_b128 v[40:43], v12 offset:1024
  s_waitcnt lgkmcnt(7)
  v_mfma_f32_16x16x32_bf16 v[168:171], a[152:155], v[44:47], v[168:171]
  v_mfma_f32_16x16x32_bf16 v[200:203], a[156:159], v[44:47], v[200:203]
  ds_read_b128 v[44:47], v13 offset:0
  v_mfma_f32_16x16x32_bf16 v[172:175], a[152:155], v[48:51], v[172:175]
  buffer_load_dwordx4 v71, s[60:63], s54 offen offset:3072 lds
  v_mfma_f32_16x16x32_bf16 v[204:207], a[156:159], v[48:51], v[204:207]
  ds_read_b128 v[48:51], v13 offset:1024
  s_waitcnt lgkmcnt(6)
  v_mfma_f32_16x16x32_bf16 v[144:147], a[160:163], v[20:23], v[144:147]
  s_add_u32 s54, s54, 128
  v_mfma_f32_16x16x32_bf16 v[176:179], a[164:167], v[20:23], v[176:179]
  s_add_u32 m0, s41, 90112
  v_mfma_f32_16x16x32_bf16 v[208:211], v[52:55], v[20:23], v[208:211]
  ds_read_b128 v[20:23], v10 offset:8192
  v_mfma_f32_16x16x32_bf16 v[148:151], a[160:163], v[24:27], v[148:151]
  buffer_load_dwordx4 v68, s[60:63], s54 offen offset:0 lds
  v_mfma_f32_16x16x32_bf16 v[180:183], a[164:167], v[24:27], v[180:183]
  v_mfma_f32_16x16x32_bf16 v[212:215], v[52:55], v[24:27], v[212:215]
  ds_read_b128 v[24:27], v10 offset:9216
  s_waitcnt lgkmcnt(6)
  v_mfma_f32_16x16x32_bf16 v[152:155], a[160:163], v[28:31], v[152:155]
  ds_read_b128 v[52:55], v18 offset:21504
  v_mfma_f32_16x16x32_bf16 v[184:187], a[164:167], v[28:31], v[184:187]
  ds_read_b128 v[28:31], v11 offset:8192
  v_mfma_f32_16x16x32_bf16 v[156:159], a[160:163], v[32:35], v[156:159]
  buffer_load_dwordx4 v69, s[60:63], s54 offen offset:1024 lds
  v_mfma_f32_16x16x32_bf16 v[188:191], a[164:167], v[32:35], v[188:191]
  ds_read_b128 v[32:35], v11 offset:9216
  s_waitcnt lgkmcnt(7)
  v_mfma_f32_16x16x32_bf16 v[160:163], a[160:163], v[36:39], v[160:163]
  v_mfma_f32_16x16x32_bf16 v[192:195], a[164:167], v[36:39], v[192:195]
  ds_read_b128 v[36:39], v12 offset:8192
  v_mfma_f32_16x16x32_bf16 v[164:167], a[160:163], v[40:43], v[164:167]
  buffer_load_dwordx4 v70, s[60:63], s54 offen offset:2048 lds
  v_mfma_f32_16x16x32_bf16 v[196:199], a[164:167], v[40:43], v[196:199]
  ds_read_b128 v[40:43], v12 offset:9216
  s_waitcnt lgkmcnt(7)
  v_mfma_f32_16x16x32_bf16 v[168:171], a[160:163], v[44:47], v[168:171]
  v_mfma_f32_16x16x32_bf16 v[200:203], a[164:167], v[44:47], v[200:203]
  ds_read_b128 v[44:47], v13 offset:8192
  v_mfma_f32_16x16x32_bf16 v[172:175], a[160:163], v[48:51], v[172:175]
  v_mfma_f32_16x16x32_bf16 v[204:207], a[164:167], v[48:51], v[204:207]
  s_waitcnt lgkmcnt(5)
  v_mfma_f32_16x16x32_bf16 v[144:147], a[168:171], v[20:23], v[144:147]
  ds_read_b128 v[48:51], v13 offset:9216
  v_mfma_f32_16x16x32_bf16 v[176:179], a[172:175], v[20:23], v[176:179]
  buffer_load_dwordx4 v71, s[60:63], s54 offen offset:3072 lds
  v_mfma_f32_16x16x32_bf16 v[208:211], v[52:55], v[20:23], v[208:211]
  ds_read_b128 v[20:23], v14 offset:45056
  s_add_u32 s54, s54, 128
  v_mfma_f32_16x16x32_bf16 v[148:151], a[168:171], v[24:27], v[148:151]
  v_mfma_f32_16x16x32_bf16 v[180:183], a[172:175], v[24:27], v[180:183]
  v_mfma_f32_16x16x32_bf16 v[212:215], v[52:55], v[24:27], v[212:215]
  ds_read_b128 v[24:27], v14 offset:46080
  s_waitcnt lgkmcnt(6)
  v_mfma_f32_16x16x32_bf16 v[152:155], a[168:171], v[28:31], v[152:155]
  ds_read_b128 v[52:55], v18 offset:22528
  v_mfma_f32_16x16x32_bf16 v[184:187], a[172:175], v[28:31], v[184:187]
  ds_read_b128 v[28:31], v15 offset:45056
  v_mfma_f32_16x16x32_bf16 v[156:159], a[168:171], v[32:35], v[156:159]
  v_mfma_f32_16x16x32_bf16 v[188:191], a[172:175], v[32:35], v[188:191]
  ds_read_b128 v[32:35], v15 offset:46080
  s_waitcnt lgkmcnt(7)
  v_mfma_f32_16x16x32_bf16 v[160:163], a[168:171], v[36:39], v[160:163]
  v_mfma_f32_16x16x32_bf16 v[192:195], a[172:175], v[36:39], v[192:195]
  ds_read_b128 v[36:39], v16 offset:45056
  v_mfma_f32_16x16x32_bf16 v[164:167], a[168:171], v[40:43], v[164:167]
  v_mfma_f32_16x16x32_bf16 v[196:199], a[172:175], v[40:43], v[196:199]
  ds_read_b128 v[40:43], v16 offset:46080
  s_waitcnt lgkmcnt(7)
  v_mfma_f32_16x16x32_bf16 v[168:171], a[168:171], v[44:47], v[168:171]
  v_mfma_f32_16x16x32_bf16 v[200:203], a[172:175], v[44:47], v[200:203]
  ds_read_b128 v[44:47], v17 offset:45056
  v_mfma_f32_16x16x32_bf16 v[172:175], a[168:171], v[48:51], v[172:175]
  v_mfma_f32_16x16x32_bf16 v[204:207], a[172:175], v[48:51], v[204:207]
  ds_read_b128 v[48:51], v17 offset:46080
  s_waitcnt lgkmcnt(6)
  v_mfma_f32_16x16x32_bf16 v[144:147], a[176:179], v[20:23], v[144:147]
  v_mfma_f32_16x16x32_bf16 v[176:179], a[180:183], v[20:23], v[176:179]
  v_mfma_f32_16x16x32_bf16 v[208:211], v[52:55], v[20:23], v[208:211]
  ds_read_b128 v[20:23], v14 offset:53248
  v_mfma_f32_16x16x32_bf16 v[148:151], a[176:179], v[24:27], v[148:151]
  v_mfma_f32_16x16x32_bf16 v[180:183], a[180:183], v[24:27], v[180:183]
  v_mfma_f32_16x16x32_bf16 v[212:215], v[52:55], v[24:27], v[212:215]
  ds_read_b128 v[24:27], v14 offset:54272
  s_waitcnt lgkmcnt(6)
  v_mfma_f32_16x16x32_bf16 v[152:155], a[176:179], v[28:31], v[152:155]
  ds_read_b128 v[52:55], v18 offset:23552
  v_mfma_f32_16x16x32_bf16 v[184:187], a[180:183], v[28:31], v[184:187]
  ds_read_b128 v[28:31], v15 offset:53248
  v_mfma_f32_16x16x32_bf16 v[156:159], a[176:179], v[32:35], v[156:159]
  v_mfma_f32_16x16x32_bf16 v[188:191], a[180:183], v[32:35], v[188:191]
  ds_read_b128 v[32:35], v15 offset:54272
  s_waitcnt lgkmcnt(7)
  v_mfma_f32_16x16x32_bf16 v[160:163], a[176:179], v[36:39], v[160:163]
  v_mfma_f32_16x16x32_bf16 v[192:195], a[180:183], v[36:39], v[192:195]
  ds_read_b128 v[36:39], v16 offset:53248
  v_mfma_f32_16x16x32_bf16 v[164:167], a[176:179], v[40:43], v[164:167]
  v_mfma_f32_16x16x32_bf16 v[196:199], a[180:183], v[40:43], v[196:199]
  ds_read_b128 v[40:43], v16 offset:54272
  s_waitcnt lgkmcnt(7)
  v_mfma_f32_16x16x32_bf16 v[168:171], a[176:179], v[44:47], v[168:171]
  v_mfma_f32_16x16x32_bf16 v[200:203], a[180:183], v[44:47], v[200:203]
  ds_read_b128 v[44:47], v17 offset:53248
  v_mfma_f32_16x16x32_bf16 v[172:175], a[176:179], v[48:51], v[172:175]
  v_mfma_f32_16x16x32_bf16 v[204:207], a[180:183], v[48:51], v[204:207]
  s_waitcnt lgkmcnt(5)
  v_mfma_f32_16x16x32_bf16 v[144:147], a[184:187], v[20:23], v[144:147]
  ds_read_b128 v[48:51], v17 offset:54272
  v_mfma_f32_16x16x32_bf16 v[176:179], a[188:191], v[20:23], v[176:179]
  v_mfma_f32_16x16x32_bf16 v[208:211], v[52:55], v[20:23], v[208:211]
  v_mfma_f32_16x16x32_bf16 v[148:151], a[184:187], v[24:27], v[148:151]
  v_mfma_f32_16x16x32_bf16 v[180:183], a[188:191], v[24:27], v[180:183]
  v_mfma_f32_16x16x32_bf16 v[212:215], v[52:55], v[24:27], v[212:215]
  s_waitcnt lgkmcnt(4)
  v_mfma_f32_16x16x32_bf16 v[152:155], a[184:187], v[28:31], v[152:155]
  v_mfma_f32_16x16x32_bf16 v[184:187], a[188:191], v[28:31], v[184:187]
  v_mfma_f32_16x16x32_bf16 v[156:159], a[184:187], v[32:35], v[156:159]
  v_mfma_f32_16x16x32_bf16 v[188:191], a[188:191], v[32:35], v[188:191]
  s_waitcnt lgkmcnt(2)
  v_mfma_f32_16x16x32_bf16 v[160:163], a[184:187], v[36:39], v[160:163]
  v_mfma_f32_16x16x32_bf16 v[192:195], a[188:191], v[36:39], v[192:195]
  v_mfma_f32_16x16x32_bf16 v[164:167], a[184:187], v[40:43], v[164:167]
  v_mfma_f32_16x16x32_bf16 v[196:199], a[188:191], v[40:43], v[196:199]
  s_waitcnt lgkmcnt(0)
  v_mfma_f32_16x16x32_bf16 v[168:171], a[184:187], v[44:47], v[168:171]
  v_mfma_f32_16x16x32_bf16 v[200:203], a[188:191], v[44:47], v[200:203]
  v_mfma_f32_16x16x32_bf16 v[172:175], a[184:187], v[48:51], v[172:175]
  v_mfma_f32_16x16x32_bf16 v[204:207], a[188:191], v[48:51], v[204:207]
  v_lshlrev_b32 v6, 3, v3
  v_add_u32 v6, 147456, v6
  s_lshl_b32 s26, s50, 7
  v_add_u32 v7, s26, v6
  ds_read_b64 v[216:217], v7
  ds_read_b64 v[218:219], v7 offset:128
  s_lshl_b32 s26, s51, 7
  v_add_u32 v7, s26, v6
  ds_read_b64 v[220:221], v7
  ds_read_b64 v[222:223], v7 offset:128
  s_lshl_b32 s26, s52, 7
  v_add_u32 v7, s26, v6
  ds_read_b64 v[224:225], v7
  ds_read_b64 v[226:227], v7 offset:128
  s_lshl_b32 s26, s53, 7
  v_add_u32 v7, s26, v6
  ds_read_b64 v[228:229], v7
  ds_read_b64 v[230:231], v7 offset:128
  ds_read_b128 v[72:75], v9 offset:0
  ds_read_b128 v[76:79], v9 offset:64
  ds_read_b128 v[80:83], v9 offset:128
  ds_read_b128 v[84:87], v9 offset:192
  ds_read_b128 v[88:91], v8 offset:1024
  ds_read_b128 v[92:95], v8 offset:1088
  v_mov_b32 v64, 0xc0135761
  v_mov_b32 v65, 0xc0135761
  s_waitcnt lgkmcnt(0)
  s_waitcnt vmcnt(8)
  s_barrier
  s_cmp_lg_u32 s3, 0
  s_cbranch_scc1 L_sig_12
  s_lshl_b32 s24, s33, 6
  s_add_u32 s24, s24, 65536
  v_mov_b32 v1, 0
  v_mov_b32 v6, s97
  s_mov_b64 exec, 1
  buffer_store_dword v6, v1, s[56:59], s24 offen sc1
  s_mov_b64 exec, -1
L_sig_12:
  v_pk_fma_f32 v[56:57], v[216:217], v[72:73], v[76:77] op_sel:[0,0,0] op_sel_hi:[0,1,1]
  v_pk_fma_f32 v[58:59], v[216:217], v[74:75], v[78:79] op_sel:[0,0,0] op_sel_hi:[0,1,1]
  v_pk_fma_f32 v[144:145], v[216:217], v[144:145], v[56:57] op_sel:[1,0,0] op_sel_hi:[1,1,1]
  v_pk_fma_f32 v[146:147], v[216:217], v[146:147], v[58:59] op_sel:[1,0,0] op_sel_hi:[1,1,1]
  v_pk_mul_f32 v[56:57], v[144:145], v[144:145]
  v_pk_mul_f32 v[58:59], v[146:147], v[146:147]
  v_pk_fma_f32 v[56:57], v[56:57], v[66:67], v[64:65]
  v_pk_fma_f32 v[58:59], v[58:59], v[66:67], v[64:65]
  v_pk_mul_f32 v[56:57], v[56:57], v[144:145]
  v_pk_mul_f32 v[58:59], v[58:59], v[146:147]
  v_exp_f32 v56, v56
  v_exp_f32 v58, v58
  v_exp_f32 v57, v57
  v_exp_f32 v59, v59
  v_pk_add_f32 v[56:57], v[56:57], 1.0 op_sel_hi:[1,0]
  s_add_u32 m0, s41, 110592
  s_nop 0
  buffer_load_dwordx4 v68, s[60:63], s54 offen offset:0 lds
  v_pk_add_f32 v[58:59], v[58:59], 1.0 op_sel_hi:[1,0]
  v_rcp_f32 v56, v56
  v_rcp_f32 v58, v58
  v_rcp_f32 v57, v57
  v_rcp_f32 v59, v59
  v_pk_mul_f32 v[144:145], v[144:145], v[56:57]
  v_pk_mul_f32 v[146:147], v[146:147], v[58:59]
  v_pk_fma_f32 v[60:61], v[218:219], v[72:73], v[76:77] op_sel:[0,0,0] op_sel_hi:[0,1,1]
  v_pk_fma_f32 v[62:63], v[218:219], v[74:75], v[78:79] op_sel:[0,0,0] op_sel_hi:[0,1,1]
  v_pk_fma_f32 v[148:149], v[218:219], v[148:149], v[60:61] op_sel:[1,0,0] op_sel_hi:[1,1,1]
  v_pk_fma_f32 v[150:151], v[218:219], v[150:151], v[62:63] op_sel:[1,0,0] op_sel_hi:[1,1,1]
  v_pk_mul_f32 v[60:61], v[148:149], v[148:149]
  v_pk_mul_f32 v[62:63], v[150:151], v[150:151]
  v_pk_fma_f32 v[60:61], v[60:61], v[66:67], v[64:65]
  v_pk_fma_f32 v[62:63], v[62:63], v[66:67], v[64:65]
  buffer_load_dwordx4 v69, s[60:63], s54 offen offset:1024 lds
  v_pk_mul_f32 v[60:61], v[60:61], v[148:149]
  v_pk_mul_f32 v[62:63], v[62:63], v[150:151]
  v_exp_f32 v60, v60
  v_exp_f32 v62, v62
  v_exp_f32 v61, v61
  v_exp_f32 v63, v63
  v_pk_add_f32 v[60:61], v[60:61], 1.0 op_sel_hi:[1,0]
  v_pk_add_f32 v[62:63], v[62:63], 1.0 op_sel_hi:[1,0]
  v_rcp_f32 v60, v60
  v_rcp_f32 v62, v62
  v_rcp_f32 v61, v61
  v_rcp_f32 v63, v63
  v_pk_mul_f32 v[148:149], v[148:149], v[60:61]
  v_pk_mul_f32 v[150:151], v[150:151], v[62:63]
  v_pk_fma_f32 v[56:57], v[220:221], v[72:73], v[76:77] op_sel:[0,0,0] op_sel_hi:[0,1,1]
  buffer_load_dwordx4 v70, s[60:63], s54 offen offset:2048 lds
  v_pk_fma_f32 v[58:59], v[220:221], v[74:75], v[78:79] op_sel:[0,0,0] op_sel_hi:[0,1,1]
  v_pk_fma_f32 v[152:153], v[220:221], v[152:153], v[56:57] op_sel:[1,0,0] op_sel_hi:[1,1,1]
  v_pk_fma_f32 v[154:155], v[220:221], v[154:155], v[58:59] op_sel:[1,0,0] op_sel_hi:[1,1,1]
  v_pk_mul_f32 v[56:57], v[152:153], v[152:153]
  v_pk_mul_f32 v[58:59], v[154:155], v[154:155]
  v_pk_fma_f32 v[56:57], v[56:57], v[66:67], v[64:65]
  v_pk_fma_f32 v[58:59], v[58:59], v[66:67], v[64:65]
  v_pk_mul_f32 v[56:57], v[56:57], v[152:153]
  v_pk_mul_f32 v[58:59], v[58:59], v[154:155]
  v_exp_f32 v56, v56
  v_exp_f32 v58, v58
  v_exp_f32 v57, v57
  v_exp_f32 v59, v59
  v_pk_add_f32 v[56:57], v[56:57], 1.0 op_sel_hi:[1,0]
  v_pk_add_f32 v[58:59], v[58:59], 1.0 op_sel_hi:[1,0]
  buffer_load_dwordx4 v71, s[60:63], s54 offen offset:3072 lds
  s_add_u32 s54, s54, 128
  v_rcp_f32 v56, v56
  v_rcp_f32 v58, v58
  v_rcp_f32 v57, v57
  v_rcp_f32 v59, v59
  v_pk_mul_f32 v[152:153], v[152:153], v[56:57]
  v_pk_mul_f32 v[154:155], v[154:155], v[58:59]
  v_pk_fma_f32 v[60:61], v[222:223], v[72:73], v[76:77] op_sel:[0,0,0] op_sel_hi:[0,1,1]
  v_pk_fma_f32 v[62:63], v[222:223], v[74:75], v[78:79] op_sel:[0,0,0] op_sel_hi:[0,1,1]
  v_pk_fma_f32 v[156:157], v[222:223], v[156:157], v[60:61] op_sel:[1,0,0] op_sel_hi:[1,1,1]
  v_pk_fma_f32 v[158:159], v[222:223], v[158:159], v[62:63] op_sel:[1,0,0] op_sel_hi:[1,1,1]
  v_pk_mul_f32 v[60:61], v[156:157], v[156:157]
  v_pk_mul_f32 v[62:63], v[158:159], v[158:159]
  v_pk_fma_f32 v[60:61], v[60:61], v[66:67], v[64:65]
  v_pk_fma_f32 v[62:63], v[62:63], v[66:67], v[64:65]
  v_pk_mul_f32 v[60:61], v[60:61], v[156:157]
  s_add_u32 m0, s41, 126976
  s_nop 0
  buffer_load_dwordx4 v68, s[60:63], s54 offen offset:0 lds
  v_pk_mul_f32 v[62:63], v[62:63], v[158:159]
  v_exp_f32 v60, v60
  v_exp_f32 v62, v62
  v_exp_f32 v61, v61
  v_exp_f32 v63, v63
  v_pk_add_f32 v[60:61], v[60:61], 1.0 op_sel_hi:[1,0]
  v_pk_add_f32 v[62:63], v[62:63], 1.0 op_sel_hi:[1,0]
  v_rcp_f32 v60, v60
  v_rcp_f32 v62, v62
  v_rcp_f32 v61, v61
  v_rcp_f32 v63, v63
  v_pk_mul_f32 v[156:157], v[156:157], v[60:61]
  v_pk_mul_f32 v[158:159], v[158:159], v[62:63]
  v_pk_fma_f32 v[56:57], v[224:225], v[72:73], v[76:77] op_sel:[0,0,0] op_sel_hi:[0,1,1]
  v_pk_fma_f32 v[58:59], v[224:225], v[74:75], v[78:79] op_sel:[0,0,0] op_sel_hi:[0,1,1]
  buffer_load_dwordx4 v69, s[60:63], s54 offen offset:1024 lds
  v_pk_fma_f32 v[160:161], v[224:225], v[160:161], v[56:57] op_sel:[1,0,0] op_sel_hi:[1,1,1]
  v_pk_fma_f32 v[162:163], v[224:225], v[162:163], v[58:59] op_sel:[1,0,0] op_sel_hi:[1,1,1]
  v_pk_mul_f32 v[56:57], v[160:161], v[160:161]
  v_pk_mul_f32 v[58:59], v[162:163], v[162:163]
  v_pk_fma_f32 v[56:57], v[56:57], v[66:67], v[64:65]
  v_pk_fma_f32 v[58:59], v[58:59], v[66:67], v[64:65]
  v_pk_mul_f32 v[56:57], v[56:57], v[160:161]
  v_pk_mul_f32 v[58:59], v[58:59], v[162:163]
  v_exp_f32 v56, v56
  v_exp_f32 v58, v58
  v_exp_f32 v57, v57
  v_exp_f32 v59, v59
  v_pk_add_f32 v[56:57], v[56:57], 1.0 op_sel_hi:[1,0]
  v_pk_add_f32 v[58:59], v[58:59], 1.0 op_sel_hi:[1,0]
  v_rcp_f32 v56, v56
  buffer_load_dwordx4 v70, s[60:63], s54 offen offset:2048 lds
  v_rcp_f32 v58, v58
  v_rcp_f32 v57, v57
  v_rcp_f32 v59, v59
  v_pk_mul_f32 v[160:161], v[160:161], v[56:57]
  v_pk_mul_f32 v[162:163], v[162:163], v[58:59]
  v_pk_fma_f32 v[60:61], v[226:227], v[72:73], v[76:77] op_sel:[0,0,0] op_sel_hi:[0,1,1]
  v_pk_fma_f32 v[62:63], v[226:227], v[74:75], v[78:79] op_sel:[0,0,0] op_sel_hi:[0,1,1]
  v_pk_fma_f32 v[164:165], v[226:227], v[164:165], v[60:61] op_sel:[1,0,0] op_sel_hi:[1,1,1]
  v_pk_fma_f32 v[166:167], v[226:227], v[166:167], v[62:63] op_sel:[1,0,0] op_sel_hi:[1,1,1]
  v_pk_mul_f32 v[60:61], v[164:165], v[164:165]
  v_pk_mul_f32 v[62:63], v[166:167], v[166:167]
  v_pk_fma_f32 v[60:61], v[60:61], v[66:67], v[64:65]
  v_pk_fma_f32 v[62:63], v[62:63], v[66:67], v[64:65]
  v_pk_mul_f32 v[60:61], v[60:61], v[164:165]
  v_pk_mul_f32 v[62:63], v[62:63], v[166:167]
  buffer_load_dwordx4 v71, s[60:63], s54 offen offset:3072 lds
  s_add_u32 s54, s54, 128
  v_exp_f32 v60, v60
  v_exp_f32 v62, v62
  v_exp_f32 v61, v61
  v_exp_f32 v63, v63
  v_pk_add_f32 v[60:61], v[60:61], 1.0 op_sel_hi:[1,0]
  v_pk_add_f32 v[62:63], v[62:63], 1.0 op_sel_hi:[1,0]
  v_rcp_f32 v60, v60
  v_rcp_f32 v62, v62
  v_rcp_f32 v61, v61
  v_rcp_f32 v63, v63
  v_pk_mul_f32 v[164:165], v[164:165], v[60:61]
  v_pk_mul_f32 v[166:167], v[166:167], v[62:63]
  v_pk_fma_f32 v[56:57], v[228:229], v[72:73], v[76:77] op_sel:[0,0,0] op_sel_hi:[0,1,1]
  v_pk_fma_f32 v[58:59], v[228:229], v[74:75], v[78:79] op_sel:[0,0,0] op_sel_hi:[0,1,1]
  v_pk_fma_f32 v[168:169], v[228:229], v[168:169], v[56:57] op_sel:[1,0,0] op_sel_hi:[1,1,1]
  s_add_u32 m0, s41, 0
  s_nop 0
  buffer_load_dwordx4 v68, s[60:63], s54 offen offset:0 lds
  v_pk_fma_f32 v[170:171], v[228:229], v[170:171], v[58:59] op_sel:[1,0,0] op_sel_hi:[1,1,1]
  v_pk_mul_f32 v[56:57], v[168:169], v[168:169]
  v_pk_mul_f32 v[58:59], v[170:171], v[170:171]
  v_pk_fma_f32 v[56:57], v[56:57], v[66:67], v[64:65]
  v_pk_fma_f32 v[58:59], v[58:59], v[66:67], v[64:65]
  v_pk_mul_f32 v[56:57], v[56:57], v[168:169]
  v_pk_mul_f32 v[58:59], v[58:59], v[170:171]
  v_exp_f32 v56, v56
  v_exp_f32 v58, v58
  v_exp_f32 v57, v57
  v_exp_f32 v59, v59
  v_pk_add_f32 v[56:57], v[56:57], 1.0 op_sel_hi:[1,0]
  v_pk_add_f32 v[58:59], v[58:59], 1.0 op_sel_hi:[1,0]
  v_rcp_f32 v56, v56
  v_rcp_f32 v58, v58
  buffer_load_dwordx4 v69, s[60:63], s54 offen offset:1024 lds
  v_rcp_f32 v57, v57
  v_rcp_f32 v59, v59
  v_pk_mul_f32 v[168:169], v[168:169], v[56:57]
  v_pk_mul_f32 v[170:171], v[170:171], v[58:59]
  v_pk_fma_f32 v[60:61], v[230:231], v[72:73], v[76:77] op_sel:[0,0,0] op_sel_hi:[0,1,1]
  v_pk_fma_f32 v[62:63], v[230:231], v[74:75], v[78:79] op_sel:[0,0,0] op_sel_hi:[0,1,1]
  v_pk_fma_f32 v[172:173], v[230:231], v[172:173], v[60:61] op_sel:[1,0,0] op_sel_hi:[1,1,1]
  v_pk_fma_f32 v[174:175], v[230:231], v[174:175], v[62:63] op_sel:[1,0,0] op_sel_hi:[1,1,1]
  v_pk_mul_f32 v[60:61], v[172:173], v[172:173]
  v_pk_mul_f32 v[62:63], v[174:175], v[174:175]
  v_pk_fma_f32 v[60:61], v[60:61], v[66:67], v[64:65]
  v_pk_fma_f32 v[62:63], v[62:63], v[66:67], v[64:65]
  v_pk_mul_f32 v[60:61], v[60:61], v[172:173]
  v_pk_mul_f32 v[62:63], v[62:63], v[174:175]
  v_exp_f32 v60, v60
  buffer_load_dwordx4 v70, s[60:63], s54 offen offset:2048 lds
  v_exp_f32 v62, v62
  v_exp_f32 v61, v61
  v_exp_f32 v63, v63
  v_pk_add_f32 v[60:61], v[60:61], 1.0 op_sel_hi:[1,0]
  v_pk_add_f32 v[62:63], v[62:63], 1.0 op_sel_hi:[1,0]
  v_rcp_f32 v60, v60
  v_rcp_f32 v62, v62
  v_rcp_f32 v61, v61
  v_rcp_f32 v63, v63
  v_pk_mul_f32 v[172:173], v[172:173], v[60:61]
  v_pk_mul_f32 v[174:175], v[174:175], v[62:63]
  v_pk_fma_f32 v[56:57], v[216:217], v[80:81], v[84:85] op_sel:[0,0,0] op_sel_hi:[0,1,1]
  v_pk_fma_f32 v[58:59], v[216:217], v[82:83], v[86:87] op_sel:[0,0,0] op_sel_hi:[0,1,1]
  v_pk_fma_f32 v[176:177], v[216:217], v[176:177], v[56:57] op_sel:[1,0,0] op_sel_hi:[1,1,1]
  v_pk_fma_f32 v[178:179], v[216:217], v[178:179], v[58:59] op_sel:[1,0,0] op_sel_hi:[1,1,1]
  buffer_load_dwordx4 v71, s[60:63], s54 offen offset:3072 lds
  s_add_u32 s54, s54, 128
  v_pk_mul_f32 v[56:57], v[176:177], v[176:177]
  v_pk_mul_f32 v[58:59], v[178:179], v[178:179]
  v_pk_fma_f32 v[56:57], v[56:57], v[66:67], v[64:65]
  v_pk_fma_f32 v[58:59], v[58:59], v[66:67], v[64:65]
  v_pk_mul_f32 v[56:57], v[56:57], v[176:177]
  v_pk_mul_f32 v[58:59], v[58:59], v[178:179]
  v_exp_f32 v56, v56
  v_exp_f32 v58, v58
  v_exp_f32 v57, v57
  v_exp_f32 v59, v59
  v_pk_add_f32 v[56:57], v[56:57], 1.0 op_sel_hi:[1,0]
  v_pk_add_f32 v[58:59], v[58:59], 1.0 op_sel_hi:[1,0]
  v_rcp_f32 v56, v56
  v_rcp_f32 v58, v58
  v_rcp_f32 v57, v57
  s_add_u32 m0, s41, 16384
  s_nop 0
  buffer_load_dwordx4 v68, s[60:63], s54 offen offset:0 lds
  v_rcp_f32 v59, v59
  v_pk_mul_f32 v[176:177], v[176:177], v[56:57]
  v_pk_mul_f32 v[178:179], v[178:179], v[58:59]
  v_pk_fma_f32 v[60:61], v[218:219], v[80:81], v[84:85] op_sel:[0,0,0] op_sel_hi:[0,1,1]
  v_pk_fma_f32 v[62:63], v[218:219], v[82:83], v[86:87] op_sel:[0,0,0] op_sel_hi:[0,1,1]
  v_pk_fma_f32 v[180:181], v[218:219], v[180:181], v[60:61] op_sel:[1,0,0] op_sel_hi:[1,1,1]
  v_pk_fma_f32 v[182:183], v[218:219], v[182:183], v[62:63] op_sel:[1,0,0] op_sel_hi:[1,1,1]
  v_pk_mul_f32 v[60:61], v[180:181], v[180:181]
  v_pk_mul_f32 v[62:63], v[182:183], v[182:183]
  v_pk_fma_f32 v[60:61], v[60:61], v[66:67], v[64:65]
  v_pk_fma_f32 v[62:63], v[62:63], v[66:67], v[64:65]
  v_pk_mul_f32 v[60:61], v[60:61], v[180:181]
  v_pk_mul_f32 v[62:63], v[62:63], v[182:183]
  v_exp_f32 v60, v60
  v_exp_f32 v62, v62
  buffer_load_dwordx4 v69, s[60:63], s54 offen offset:1024 lds
  v_exp_f32 v61, v61
  v_exp_f32 v63, v63
  v_pk_add_f32 v[60:61], v[60:61], 1.0 op_sel_hi:[1,0]
  v_pk_add_f32 v[62:63], v[62:63], 1.0 op_sel_hi:[1,0]
  v_rcp_f32 v60, v60
  v_rcp_f32 v62, v62
  v_rcp_f32 v61, v61
  v_rcp_f32 v63, v63
  v_pk_mul_f32 v[180:181], v[180:181], v[60:61]
  v_pk_mul_f32 v[182:183], v[182:183], v[62:63]
  v_pk_fma_f32 v[56:57], v[220:221], v[80:81], v[84:85] op_sel:[0,0,0] op_sel_hi:[0,1,1]
  v_pk_fma_f32 v[58:59], v[220:221], v[82:83], v[86:87] op_sel:[0,0,0] op_sel_hi:[0,1,1]
  v_pk_fma_f32 v[184:185], v[220:221], v[184:185], v[56:57] op_sel:[1,0,0] op_sel_hi:[1,1,1]
  v_pk_fma_f32 v[186:187], v[220:221], v[186:187], v[58:59] op_sel:[1,0,0] op_sel_hi:[1,1,1]
  v_pk_mul_f32 v[56:57], v[184:185], v[184:185]
  buffer_load_dwordx4 v70, s[60:63], s54 offen offset:2048 lds
  v_pk_mul_f32 v[58:59], v[186:187], v[186:187]
  v_pk_fma_f32 v[56:57], v[56:57], v[66:67], v[64:65]
  v_pk_fma_f32 v[58:59], v[58:59], v[66:67], v[64:65]
  v_pk_mul_f32 v[56:57], v[56:57], v[184:185]
  v_pk_mul_f32 v[58:59], v[58:59], v[186:187]
  v_exp_f32 v56, v56
  v_exp_f32 v58, v58
  v_exp_f32 v57, v57
  v_exp_f32 v59, v59
  v_pk_add_f32 v[56:57], v[56:57], 1.0 op_sel_hi:[1,0]
  v_pk_add_f32 v[58:59], v[58:59], 1.0 op_sel_hi:[1,0]
  v_rcp_f32 v56, v56
  v_rcp_f32 v58, v58
  v_rcp_f32 v57, v57
  v_rcp_f32 v59, v59
  buffer_load_dwordx4 v71, s[60:63], s54 offen offset:3072 lds
  s_add_u32 s54, s54, 128
  v_pk_mul_f32 v[184:185], v[184:185], v[56:57]
  v_pk_mul_f32 v[186:187], v[186:187], v[58:59]
  v_pk_fma_f32 v[60:61], v[222:223], v[80:81], v[84:85] op_sel:[0,0,0] op_sel_hi:[0,1,1]
  v_pk_fma_f32 v[62:63], v[222:223], v[82:83], v[86:87] op_sel:[0,0,0] op_sel_hi:[0,1,1]
  v_pk_fma_f32 v[188:189], v[222:223], v[188:189], v[60:61] op_sel:[1,0,0] op_sel_hi:[1,1,1]
  v_pk_fma_f32 v[190:191], v[222:223], v[190:191], v[62:63] op_sel:[1,0,0] op_sel_hi:[1,1,1]
  v_pk_mul_f32 v[60:61], v[188:189], v[188:189]
  v_pk_mul_f32 v[62:63], v[190:191], v[190:191]
  v_pk_fma_f32 v[60:61], v[60:61], v[66:67], v[64:65]
  v_pk_fma_f32 v[62:63], v[62:63], v[66:67], v[64:65]
  v_pk_mul_f32 v[60:61], v[60:61], v[188:189]
  v_pk_mul_f32 v[62:63], v[62:63], v[190:191]
  v_exp_f32 v60, v60
  v_exp_f32 v62, v62
  v_exp_f32 v61, v61
  v_exp_f32 v63, v63
  v_pk_add_f32 v[60:61], v[60:61], 1.0 op_sel_hi:[1,0]
  v_pk_add_f32 v[62:63], v[62:63], 1.0 op_sel_hi:[1,0]
  v_rcp_f32 v60, v60
  v_rcp_f32 v62, v62
  v_rcp_f32 v61, v61
  v_rcp_f32 v63, v63
  v_pk_mul_f32 v[188:189], v[188:189], v[60:61]
  v_pk_mul_f32 v[190:191], v[190:191], v[62:63]
  v_pk_fma_f32 v[56:57], v[224:225], v[80:81], v[84:85] op_sel:[0,0,0] op_sel_hi:[0,1,1]
  v_pk_fma_f32 v[58:59], v[224:225], v[82:83], v[86:87] op_sel:[0,0,0] op_sel_hi:[0,1,1]
  v_pk_fma_f32 v[192:193], v[224:225], v[192:193], v[56:57] op_sel:[1,0,0] op_sel_hi:[1,1,1]
  v_pk_fma_f32 v[194:195], v[224:225], v[194:195], v[58:59] op_sel:[1,0,0] op_sel_hi:[1,1,1]
  v_pk_mul_f32 v[56:57], v[192:193], v[192:193]
  v_pk_mul_f32 v[58:59], v[194:195], v[194:195]
  v_pk_fma_f32 v[56:57], v[56:57], v[66:67], v[64:65]
  v_pk_fma_f32 v[58:59], v[58:59], v[66:67], v[64:65]
  v_pk_mul_f32 v[56:57], v[56:57], v[192:193]
  v_pk_mul_f32 v[58:59], v[58:59], v[194:195]
  v_exp_f32 v56, v56
  v_exp_f32 v58, v58
  v_exp_f32 v57, v57
  v_exp_f32 v59, v59
  v_pk_add_f32 v[56:57], v[56:57], 1.0 op_sel_hi:[1,0]
  v_pk_add_f32 v[58:59], v[58:59], 1.0 op_sel_hi:[1,0]
  v_rcp_f32 v56, v56
  v_rcp_f32 v58, v58
  v_rcp_f32 v57, v57
  v_rcp_f32 v59, v59
  v_pk_mul_f32 v[192:193], v[192:193], v[56:57]
  v_pk_mul_f32 v[194:195], v[194:195], v[58:59]
  v_pk_fma_f32 v[60:61], v[226:227], v[80:81], v[84:85] op_sel:[0,0,0] op_sel_hi:[0,1,1]
  v_pk_fma_f32 v[62:63], v[226:227], v[82:83], v[86:87] op_sel:[0,0,0] op_sel_hi:[0,1,1]
  v_pk_fma_f32 v[196:197], v[226:227], v[196:197], v[60:61] op_sel:[1,0,0] op_sel_hi:[1,1,1]
  v_pk_fma_f32 v[198:199], v[226:227], v[198:199], v[62:63] op_sel:[1,0,0] op_sel_hi:[1,1,1]
  v_pk_mul_f32 v[60:61], v[196:197], v[196:197]
  v_pk_mul_f32 v[62:63], v[198:199], v[198:199]
  v_pk_fma_f32 v[60:61], v[60:61], v[66:67], v[64:65]
  v_pk_fma_f32 v[62:63], v[62:63], v[66:67], v[64:65]
  v_pk_mul_f32 v[60:61], v[60:61], v[196:197]
  v_pk_mul_f32 v[62:63], v[62:63], v[198:199]
  v_exp_f32 v60, v60
  v_exp_f32 v62, v62
  v_exp_f32 v61, v61
  v_exp_f32 v63, v63
  v_pk_add_f32 v[60:61], v[60:61], 1.0 op_sel_hi:[1,0]
  v_pk_add_f32 v[62:63], v[62:63], 1.0 op_sel_hi:[1,0]
  v_rcp_f32 v60, v60
  v_rcp_f32 v62, v62
  v_rcp_f32 v61, v61
  v_rcp_f32 v63, v63
  v_pk_mul_f32 v[196:197], v[196:197], v[60:61]
  v_pk_mul_f32 v[198:199], v[198:199], v[62:63]
  s_cmp_lg_u32 s3, 0
  s_cbranch_scc1 L_aw_13_d
  s_lshl_b32 s24, s25, 6
  s_add_u32 s24, s24, 65536
  v_lshlrev_b32 v1, 6, v2
  s_mov_b64 exec, 0xffff
L_aw_13:
  buffer_load_dword v6, v1, s[56:59], s24 offen sc1
  s_waitcnt vmcnt(0)
  v_cmp_ne_u32 vcc, s97, v6
  s_nop 0
  s_cbranch_vccz L_aw_13_g
  s_branch L_aw_13
L_aw_13_g:
  s_mov_b64 exec, -1
L_aw_13_d:
  s_barrier
  s_add_u32 m0, s44, 73728
  s_nop 0
  buffer_load_dwordx4 v244, s[16:19], s55 offen sc1 lds
  s_add_u32 s55, s55, 36864
  buffer_load_dwordx4 a[72:75], v240, s[16:19], s46 offen offset:0 sc1
  buffer_load_dwordx4 a[76:79], v240, s[16:19], s46 offen offset:1024 sc1
  buffer_load_dwordx4 a[80:83], v241, s[16:19], s46 offen offset:0 sc1
  buffer_load_dwordx4 a[84:87], v241, s[16:19], s46 offen offset:1024 sc1
  buffer_load_dwordx4 a[88:91], v242, s[16:19], s46 offen offset:0 sc1
  buffer_load_dwordx4 a[92:95], v242, s[16:19], s46 offen offset:1024 sc1
  buffer_load_dwordx4 a[96:99], v243, s[16:19], s46 offen offset:0 sc1
  buffer_load_dwordx4 a[100:103], v243, s[16:19], s46 offen offset:1024 sc1
  s_add_u32 s46, s46, 36864
  v_pk_fma_f32 v[56:57], v[228:229], v[80:81], v[84:85] op_sel:[0,0,0] op_sel_hi:[0,1,1]
  v_pk_fma_f32 v[58:59], v[228:229], v[82:83], v[86:87] op_sel:[0,0,0] op_sel_hi:[0,1,1]
  v_pk_fma_f32 v[200:201], v[228:229], v[200:201], v[56:57] op_sel:[1,0,0] op_sel_hi:[1,1,1]
  v_pk_fma_f32 v[202:203], v[228:229], v[202:203], v[58:59] op_sel:[1,0,0] op_sel_hi:[1,1,1]
  v_pk_mul_f32 v[56:57], v[200:201], v[200:201]
  v_pk_mul_f32 v[58:59], v[202:203], v[202:203]
  v_pk_fma_f32 v[56:57], v[56:57], v[66:67], v[64:65]
  v_pk_fma_f32 v[58:59], v[58:59], v[66:67], v[64:65]
  s_add_u32 m0, s44, 110592
  s_nop 0
  buffer_load_dwordx4 v244, s[16:19], s55 offen sc1 lds
  s_add_u32 s55, s55, 36864
  v_pk_mul_f32 v[56:57], v[56:57], v[200:201]
  v_pk_mul_f32 v[58:59], v[58:59], v[202:203]
  v_exp_f32 v56, v56
  v_exp_f32 v58, v58
  v_exp_f32 v57, v57
  v_exp_f32 v59, v59
  v_pk_add_f32 v[56:57], v[56:57], 1.0 op_sel_hi:[1,0]
  v_pk_add_f32 v[58:59], v[58:59], 1.0 op_sel_hi:[1,0]
  buffer_load_dwordx4 a[104:107], v240, s[16:19], s46 offen offset:0 sc1
  v_rcp_f32 v56, v56
  v_rcp_f32 v58, v58
  v_rcp_f32 v57, v57
  v_rcp_f32 v59, v59
  v_pk_mul_f32 v[200:201], v[200:201], v[56:57]
  v_pk_mul_f32 v[202:203], v[202:203], v[58:59]
  v_pk_fma_f32 v[60:61], v[230:231], v[80:81], v[84:85] op_sel:[0,0,0] op_sel_hi:[0,1,1]
  v_pk_fma_f32 v[62:63], v[230:231], v[82:83], v[86:87] op_sel:[0,0,0] op_sel_hi:[0,1,1]
  buffer_load_dwordx4 a[108:111], v240, s[16:19], s46 offen offset:1024 sc1
  v_pk_fma_f32 v[204:205], v[230:231], v[204:205], v[60:61] op_sel:[1,0,0] op_sel_hi:[1,1,1]
  v_pk_fma_f32 v[206:207], v[230:231], v[206:207], v[62:63] op_sel:[1,0,0] op_sel_hi:[1,1,1]
  v_pk_mul_f32 v[60:61], v[204:205], v[204:205]
  v_pk_mul_f32 v[62:63], v[206:207], v[206:207]
  v_pk_fma_f32 v[60:61], v[60:61], v[66:67], v[64:65]
  v_pk_fma_f32 v[62:63], v[62:63], v[66:67], v[64:65]
  v_pk_mul_f32 v[60:61], v[60:61], v[204:205]
  v_pk_mul_f32 v[62:63], v[62:63], v[206:207]
  buffer_load_dwordx4 a[112:115], v241, s[16:19], s46 offen offset:0 sc1
  v_exp_f32 v60, v60
  v_exp_f32 v62, v62
  v_exp_f32 v61, v61
  v_exp_f32 v63, v63
  v_pk_add_f32 v[60:61], v[60:61], 1.0 op_sel_hi:[1,0]
  v_pk_add_f32 v[62:63], v[62:63], 1.0 op_sel_hi:[1,0]
  v_rcp_f32 v60, v60
  v_rcp_f32 v62, v62
  buffer_load_dwordx4 a[116:119], v241, s[16:19], s46 offen offset:1024 sc1
  v_rcp_f32 v61, v61
  v_rcp_f32 v63, v63
  v_pk_mul_f32 v[204:205], v[204:205], v[60:61]
  v_pk_mul_f32 v[206:207], v[206:207], v[62:63]
  v_pk_fma_f32 v[56:57], v[216:217], v[88:89], v[92:93] op_sel:[0,0,0] op_sel_hi:[0,1,1]
  v_pk_fma_f32 v[58:59], v[216:217], v[90:91], v[94:95] op_sel:[0,0,0] op_sel_hi:[0,1,1]
  v_pk_fma_f32 v[208:209], v[216:217], v[208:209], v[56:57] op_sel:[1,0,0] op_sel_hi:[1,1,1]
  v_pk_fma_f32 v[210:211], v[216:217], v[210:211], v[58:59] op_sel:[1,0,0] op_sel_hi:[1,1,1]
  buffer_load_dwordx4 a[120:123], v242, s[16:19], s46 offen offset:0 sc1
  v_pk_mul_f32 v[56:57], v[208:209], v[208:209]
  v_pk_mul_f32 v[58:59], v[210:211], v[210:211]
  v_pk_fma_f32 v[56:57], v[56:57], v[66:67], v[64:65]
  v_pk_fma_f32 v[58:59], v[58:59], v[66:67], v[64:65]
  v_pk_mul_f32 v[56:57], v[56:57], v[208:209]
  v_pk_mul_f32 v[58:59], v[58:59], v[210:211]
  v_exp_f32 v56, v56
  v_exp_f32 v58, v58
  buffer_load_dwordx4 a[124:127], v242, s[16:19], s46 offen offset:1024 sc1
  v_exp_f32 v57, v57
  v_exp_f32 v59, v59
  v_pk_add_f32 v[56:57], v[56:57], 1.0 op_sel_hi:[1,0]
  v_pk_add_f32 v[58:59], v[58:59], 1.0 op_sel_hi:[1,0]
  v_rcp_f32 v56, v56
  v_rcp_f32 v58, v58
  v_rcp_f32 v57, v57
  v_rcp_f32 v59, v59
  buffer_load_dwordx4 a[128:131], v243, s[16:19], s46 offen offset:0 sc1
  v_pk_mul_f32 v[208:209], v[208:209], v[56:57]
  v_pk_mul_f32 v[210:211], v[210:211], v[58:59]
  v_pk_fma_f32 v[60:61], v[218:219], v[88:89], v[92:93] op_sel:[0,0,0] op_sel_hi:[0,1,1]
  v_pk_fma_f32 v[62:63], v[218:219], v[90:91], v[94:95] op_sel:[0,0,0] op_sel_hi:[0,1,1]
  v_pk_fma_f32 v[212:213], v[218:219], v[212:213], v[60:61] op_sel:[1,0,0] op_sel_hi:[1,1,1]
  v_pk_fma_f32 v[214:215], v[218:219], v[214:215], v[62:63] op_sel:[1,0,0] op_sel_hi:[1,1,1]
  v_pk_mul_f32 v[60:61], v[212:213], v[212:213]
  v_pk_mul_f32 v[62:63], v[214:215], v[214:215]
  buffer_load_dwordx4 a[132:135], v243, s[16:19], s46 offen offset:1024 sc1
  s_add_u32 s46, s46, 36864
  v_pk_fma_f32 v[60:61], v[60:61], v[66:67], v[64:65]
  v_pk_fma_f32 v[62:63], v[62:63], v[66:67], v[64:65]
  v_pk_mul_f32 v[60:61], v[60:61], v[212:213]
  v_pk_mul_f32 v[62:63], v[62:63], v[214:215]
  v_exp_f32 v60, v60
  v_exp_f32 v62, v62
  v_exp_f32 v61, v61
  v_exp_f32 v63, v63
  s_add_u32 m0, s44, 0
  s_nop 0
  buffer_load_dwordx4 v244, s[16:19], s55 offen sc1 lds
  s_add_u32 s55, s55, 36864
  v_pk_add_f32 v[60:61], v[60:61], 1.0 op_sel_hi:[1,0]
  v_pk_add_f32 v[62:63], v[62:63], 1.0 op_sel_hi:[1,0]
  v_rcp_f32 v60, v60
  v_rcp_f32 v62, v62
  v_rcp_f32 v61, v61
  v_rcp_f32 v63, v63
  v_pk_mul_f32 v[212:213], v[212:213], v[60:61]
  v_pk_mul_f32 v[214:215], v[214:215], v[62:63]
  buffer_load_dwordx4 a[136:139], v240, s[16:19], s46 offen offset:0 sc1
  v_lshrrev_b32 v6, 1, v3
  v_xor_b32 v6, v6, v5
  v_lshlrev_b32 v6, 4, v6
  v_lshl_add_u32 v6, v3, 7, v6
  s_lshl_b32 s26, s50, 11
  v_add_u32 v216, s26, v6
  v_xor_b32 v220, 64, v216
  s_lshl_b32 s26, s51, 11
  buffer_load_dwordx4 a[140:143], v240, s[16:19], s46 offen offset:1024 sc1
  v_add_u32 v217, s26, v6
  v_xor_b32 v221, 64, v217
  s_lshl_b32 s26, s52, 11
  v_add_u32 v218, s26, v6
  v_xor_b32 v222, 64, v218
  s_lshl_b32 s26, s53, 11
  v_add_u32 v219, s26, v6
  v_xor_b32 v223, 64, v219
  buffer_load_dwordx4 a[144:147], v241, s[16:19], s46 offen offset:0 sc1
  v_add_u32 v224, 73728, v216
  v_add_u32 v225, 73728, v217
  v_add_u32 v226, 73728, v218
  v_add_u32 v227, 73728, v219
  v_add_u32 v228, 73728, v220
  v_add_u32 v229, 73728, v221
  v_add_u32 v230, 73728, v222
  v_add_u32 v231, 73728, v223
  buffer_load_dwordx4 a[148:151], v241, s[16:19], s46 offen offset:1024 sc1
  v_add_u32 v10, 32768, v4
  v_add_u32 v11, 73728, v10
  s_waitcnt vmcnt(22)
  s_barrier
L_code_p4:
  ds_read_b128 v[20:23], v224 offset:0
  ds_read_b128 v[24:27], v224 offset:2048
  ds_read_b128 v[52:55], v11 offset:0
  ds_read_b128 v[28:31], v225 offset:0
  ds_read_b128 v[32:35], v225 offset:2048
  ds_read_b128 v[36:39], v226 offset:0
  ds_read_b128 v[40:43], v226 offset:2048
  ds_read_b128 v[44:47], v227 offset:0
  ds_read_b128 v[48:51], v227 offset:2048
  s_waitcnt vmcnt(20)
  s_waitcnt lgkmcnt(6)
  v_mfma_f32_16x16x32_bf16 v[72:75], a[72:75], v[20:23], 0
  buffer_load_dwordx4 a[152:155], v242, s[16:19], s46 offen offset:0 sc1
  v_mfma_f32_16x16x32_bf16 v[104:107], a[76:79], v[20:23], 0
  s_add_u32 s12, s4, 10944512
  s_addc_u32 s13, s5, 0
  s_mov_b32 s14, 2949120
  v_mfma_f32_16x16x32_bf16 v[136:139], v[52:55], v[20:23], 0
  ds_read_b128 v[20:23], v228 offset:0
  buffer_load_dwordx4 a[156:159], v242, s[16:19], s46 offen offset:1024 sc1
  v_mfma_f32_16x16x32_bf16 v[76:79], a[72:75], v[24:27], 0
  s_mov_b32 s15, 0x20000
  s_add_u32 s8, s4, 40632320
  s_addc_u32 s9, s5, 0
  v_mfma_f32_16x16x32_bf16 v[108:111], a[76:79], v[24:27], 0
  buffer_load_dwordx4 a[160:163], v243, s[16:19], s46 offen offset:0 sc1
  s_mov_b32 s10, 9437184
  v_mfma_f32_16x16x32_bf16 v[140:143], v[52:55], v[24:27], 0
  ds_read_b128 v[24:27], v228 offset:2048
  ds_read_b128 v[52:55], v11 offset:1024
  s_waitcnt lgkmcnt(7)
  v_mfma_f32_16x16x32_bf16 v[80:83], a[72:75], v[28:31], 0
  buffer_load_dwordx4 a[164:167], v243, s[16:19], s46 offen offset:1024 sc1
  s_add_u32 s46, s46, 36864
  v_mfma_f32_16x16x32_bf16 v[112:115], a[76:79], v[28:31], 0
  ds_read_b128 v[28:31], v229 offset:0
  s_mov_b32 s11, 0x20000
  v_cmp_gt_u32 vcc, 8, v3
  v_mfma_f32_16x16x32_bf16 v[84:87], a[72:75], v[32:35], 0
  v_mov_b32 v9, 0x80000000
  s_mul_i32 s30, s23, 368640
  v_cndmask_b32 v9, v9, v4, vcc
  v_mfma_f32_16x16x32_bf16 v[116:119], a[76:79], v[32:35], 0
  ds_read_b128 v[32:35], v229 offset:2048
  s_mul_i32 s26, s3, 92160
  s_waitcnt lgkmcnt(7)
  v_mfma_f32_16x16x32_bf16 v[88:91], a[72:75], v[36:39], 0
  s_add_u32 s30, s30, s26
  s_add_u32 s31, s30, 4096
  s_mul_i32 s32, s3, 9216
  v_mfma_f32_16x16x32_bf16 v[120:123], a[76:79], v[36:39], 0
  ds_read_b128 v[36:39], v230 offset:0
  v_lshlrev_b32 v248, 16, v248
  v_lshlrev_b32 v249, 16, v249
  v_mfma_f32_16x16x32_bf16 v[92:95], a[72:75], v[40:43], 0
  v_lshlrev_b32 v250, 16, v250
  v_lshlrev_b32 v251, 16, v251
  v_lshlrev_b32 v252, 16, v252
  v_mfma_f32_16x16x32_bf16 v[124:127], a[76:79], v[40:43], 0
  ds_read_b128 v[40:43], v230 offset:2048
  v_lshlrev_b32 v253, 16, v253
  s_waitcnt lgkmcnt(7)
  v_mfma_f32_16x16x32_bf16 v[96:99], a[72:75], v[44:47], 0
  v_lshlrev_b32 v254, 16, v254
  v_lshlrev_b32 v255, 16, v255
  s_lshr_b32 s26, s21, 1
  v_mfma_f32_16x16x32_bf16 v[128:131], a[76:79], v[44:47], 0
  ds_read_b128 v[44:47], v231 offset:0
  s_mul_i32 s26, s26, 9
  s_and_b32 s27, s21, 1
  v_mfma_f32_16x16x32_bf16 v[100:103], a[72:75], v[48:51], 0
  s_lshl_b32 s28, s27, 2
  s_add_u32 s28, s28, s26
  s_add_u32 s28, s28, s3
  v_mfma_f32_16x16x32_bf16 v[132:135], a[76:79], v[48:51], 0
  ds_read_b128 v[48:51], v231 offset:2048
  s_waitcnt vmcnt(22)
  s_waitcnt lgkmcnt(6)
  v_mfma_f32_16x16x32_bf16 v[72:75], a[80:83], v[20:23], v[72:75]
  s_lshl_b32 s28, s28, 10
  s_mul_i32 s29, s20, 589824
  s_add_u32 s28, s28, s29
  v_mfma_f32_16x16x32_bf16 v[104:107], a[84:87], v[20:23], v[104:107]
  s_add_u32 s26, s26, 8
  s_lshl_b32 s26, s26, 10
  s_add_u32 s26, s26, s29
  v_mfma_f32_16x16x32_bf16 v[136:139], v[52:55], v[20:23], v[136:139]
  ds_read_b128 v[20:23], v224 offset:16384
  s_lshl_b32 s27, s27, 3
  s_add_u32 s26, s26, s27
  v_mfma_f32_16x16x32_bf16 v[76:79], a[80:83], v[24:27], v[76:79]
  s_mul_i32 s27, s50, 73728
  s_add_u32 s33, s26, s27
  v_mfma_f32_16x16x32_bf16 v[108:111], a[84:87], v[24:27], v[108:111]
  v_mfma_f32_16x16x32_bf16 v[140:143], v[52:55], v[24:27], v[140:143]
  ds_read_b128 v[24:27], v224 offset:18432
  ds_read_b128 v[52:55], v11 offset:2048
  s_waitcnt lgkmcnt(7)
  v_mfma_f32_16x16x32_bf16 v[80:83], a[80:83], v[28:31], v[80:83]
  v_mfma_f32_16x16x32_bf16 v[112:115], a[84:87], v[28:31], v[112:115]
  ds_read_b128 v[28:31], v225 offset:16384
  v_mfma_f32_16x16x32_bf16 v[84:87], a[80:83], v[32:35], v[84:87]
  v_mfma_f32_16x16x32_bf16 v[116:119], a[84:87], v[32:35], v[116:119]
  ds_read_b128 v[32:35], v225 offset:18432
  s_waitcnt lgkmcnt(7)
  v_mfma_f32_16x16x32_bf16 v[88:91], a[80:83], v[36:39], v[88:91]
  v_mfma_f32_16x16x32_bf16 v[120:123], a[84:87], v[36:39], v[120:123]
  ds_read_b128 v[36:39], v226 offset:16384
  v_mfma_f32_16x16x32_bf16 v[92:95], a[80:83], v[40:43], v[92:95]
  v_mfma_f32_16x16x32_bf16 v[124:127], a[84:87], v[40:43], v[124:127]
  ds_read_b128 v[40:43], v226 offset:18432
  s_waitcnt lgkmcnt(7)
  v_mfma_f32_16x16x32_bf16 v[96:99], a[80:83], v[44:47], v[96:99]
  v_mfma_f32_16x16x32_bf16 v[128:131], a[84:87], v[44:47], v[128:131]
  ds_read_b128 v[44:47], v227 offset:16384
  v_mfma_f32_16x16x32_bf16 v[100:103], a[80:83], v[48:51], v[100:103]
  v_mfma_f32_16x16x32_bf16 v[132:135], a[84:87], v[48:51], v[132:135]
  ds_read_b128 v[48:51], v227 offset:18432
  s_waitcnt vmcnt(20)
  s_waitcnt lgkmcnt(6)
  v_mfma_f32_16x16x32_bf16 v[72:75], a[88:91], v[20:23], v[72:75]
  v_mfma_f32_16x16x32_bf16 v[104:107], a[92:95], v[20:23], v[104:107]
  v_mfma_f32_16x16x32_bf16 v[136:139], v[52:55], v[20:23], v[136:139]
  ds_read_b128 v[20:23], v228 offset:16384
  v_mfma_f32_16x16x32_bf16 v[76:79], a[88:91], v[24:27], v[76:79]
  v_mfma_f32_16x16x32_bf16 v[108:111], a[92:95], v[24:27], v[108:111]
  v_mfma_f32_16x16x32_bf16 v[140:143], v[52:55], v[24:27], v[140:143]
  ds_read_b128 v[24:27], v228 offset:18432
  ds_read_b128 v[52:55], v11 offset:3072
  s_waitcnt lgkmcnt(7)
  v_mfma_f32_16x16x32_bf16 v[80:83], a[88:91], v[28:31], v[80:83]
  v_mfma_f32_16x16x32_bf16 v[112:115], a[92:95], v[28:31], v[112:115]
  ds_read_b128 v[28:31], v229 offset:16384
  v_mfma_f32_16x16x32_bf16 v[84:87], a[88:91], v[32:35], v[84:87]
  v_mfma_f32_16x16x32_bf16 v[116:119], a[92:95], v[32:35], v[116:119]
  ds_read_b128 v[32:35], v229 offset:18432
  s_waitcnt lgkmcnt(7)
  v_mfma_f32_16x16x32_bf16 v[88:91], a[88:91], v[36:39], v[88:91]
  v_mfma_f32_16x16x32_bf16 v[120:123], a[92:95], v[36:39], v[120:123]
  ds_read_b128 v[36:39], v230 offset:16384
  v_mfma_f32_16x16x32_bf16 v[92:95], a[88:91], v[40:43], v[92:95]
  v_mfma_f32_16x16x32_bf16 v[124:127], a[92:95], v[40:43], v[124:127]
  ds_read_b128 v[40:43], v230 offset:18432
  s_waitcnt lgkmcnt(7)
  v_mfma_f32_16x16x32_bf16 v[96:99], a[88:91], v[44:47], v[96:99]
  v_mfma_f32_16x16x32_bf16 v[128:131], a[92:95], v[44:47], v[128:131]
  ds_read_b128 v[44:47], v231 offset:16384
  v_mfma_f32_16x16x32_bf16 v[100:103], a[88:91], v[48:51], v[100:103]
  v_mfma_f32_16x16x32_bf16 v[132:135], a[92:95], v[48:51], v[132:135]
  s_waitcnt vmcnt(17)
  s_barrier
  s_waitcnt lgkmcnt(5)
  v_mfma_f32_16x16x32_bf16 v[72:75], a[96:99], v[20:23], v[72:75]
  ds_read_b128 v[48:51], v231 offset:18432
  s_add_u32 m0, s41, 36864
  v_mfma_f32_16x16x32_bf16 v[104:107], a[100:103], v[20:23], v[104:107]
  buffer_load_dwordx4 v68, s[60:63], s54 offen offset:0 lds
  v_mfma_f32_16x16x32_bf16 v[136:139], v[52:55], v[20:23], v[136:139]
  ds_read_b128 v[20:23], v224 offset:36864
  v_mfma_f32_16x16x32_bf16 v[76:79], a[96:99], v[24:27], v[76:79]
  v_mfma_f32_16x16x32_bf16 v[108:111], a[100:103], v[24:27], v[108:111]
  v_mfma_f32_16x16x32_bf16 v[140:143], v[52:55], v[24:27], v[140:143]
  ds_read_b128 v[24:27], v224 offset:38912
  ds_read_b128 v[52:55], v11 offset:36864
  s_waitcnt lgkmcnt(7)
  v_mfma_f32_16x16x32_bf16 v[80:83], a[96:99], v[28:31], v[80:83]
  buffer_load_dwordx4 v69, s[60:63], s54 offen offset:1024 lds
  v_mfma_f32_16x16x32_bf16 v[112:115], a[100:103], v[28:31], v[112:115]
  ds_read_b128 v[28:31], v225 offset:36864
  v_mfma_f32_16x16x32_bf16 v[84:87], a[96:99], v[32:35], v[84:87]
  v_mfma_f32_16x16x32_bf16 v[116:119], a[100:103], v[32:35], v[116:119]
  ds_read_b128 v[32:35], v225 offset:38912
  s_waitcnt lgkmcnt(7)
  v_mfma_f32_16x16x32_bf16 v[88:91], a[96:99], v[36:39], v[88:91]
  buffer_load_dwordx4 v70, s[60:63], s54 offen offset:2048 lds
  v_mfma_f32_16x16x32_bf16 v[120:123], a[100:103], v[36:39], v[120:123]
  ds_read_b128 v[36:39], v226 offset:36864
  v_mfma_f32_16x16x32_bf16 v[92:95], a[96:99], v[40:43], v[92:95]
  v_mfma_f32_16x16x32_bf16 v[124:127], a[100:103], v[40:43], v[124:127]
  ds_read_b128 v[40:43], v226 offset:38912
  s_waitcnt lgkmcnt(7)
  v_mfma_f32_16x16x32_bf16 v[96:99], a[96:99], v[44:47], v[96:99]
  buffer_load_dwordx4 v71, s[60:63], s54 offen offset:3072 lds
  s_add_u32 s54, s54, 128
  v_mfma_f32_16x16x32_bf16 v[128:131], a[100:103], v[44:47], v[128:131]
  ds_read_b128 v[44:47], v227 offset:36864
  v_mfma_f32_16x16x32_bf16 v[100:103], a[96:99], v[48:51], v[100:103]
  s_add_u32 m0, s41, 53248
  v_mfma_f32_16x16x32_bf16 v[132:135], a[100:103], v[48:51], v[132:135]
  ds_read_b128 v[48:51], v227 offset:38912
  s_waitcnt vmcnt(19)
  s_waitcnt lgkmcnt(6)
  v_mfma_f32_16x16x32_bf16 v[72:75], a[104:107], v[20:23], v[72:75]
  buffer_load_dwordx4 v68, s[60:63], s54 offen offset:0 lds
  v_mfma_f32_16x16x32_bf16 v[104:107], a[108:111], v[20:23], v[104:107]
  v_mfma_f32_16x16x32_bf16 v[136:139], v[52:55], v[20:23], v[136:139]
  ds_read_b128 v[20:23], v228 offset:36864
  v_mfma_f32_16x16x32_bf16 v[76:79], a[104:107], v[24:27], v[76:79]
  buffer_load_dwordx4 v69, s[60:63], s54 offen offset:1024 lds
  v_mfma_f32_16x16x32_bf16 v[108:111], a[108:111], v[24:27], v[108:111]
  v_mfma_f32_16x16x32_bf16 v[140:143], v[52:55], v[24:27], v[140:143]
  ds_read_b128 v[24:27], v228 offset:38912
  ds_read_b128 v[52:55], v11 offset:37888
  s_waitcnt lgkmcnt(7)
  v_mfma_f32_16x16x32_bf16 v[80:83], a[104:107], v[28:31], v[80:83]
  v_mfma_f32_16x16x32_bf16 v[112:115], a[108:111], v[28:31], v[112:115]
  ds_read_b128 v[28:31], v229 offset:36864
  buffer_load_dwordx4 v70, s[60:63], s54 offen offset:2048 lds
  v_mfma_f32_16x16x32_bf16 v[84:87], a[104:107], v[32:35], v[84:87]
  v_mfma_f32_16x16x32_bf16 v[116:119], a[108:111], v[32:35], v[116:119]
  ds_read_b128 v[32:35], v229 offset:38912
  s_waitcnt lgkmcnt(7)
  v_mfma_f32_16x16x32_bf16 v[88:91], a[104:107], v[36:39], v[88:91]
  v_mfma_f32_16x16x32_bf16 v[120:123], a[108:111], v[36:39], v[120:123]
  ds_read_b128 v[36:39], v230 offset:36864
  buffer_load_dwordx4 v71, s[60:63], s54 offen offset:3072 lds
  v_mfma_f32_16x16x32_bf16 v[92:95], a[104:107], v[40:43], v[92:95]
  s_add_u32 s54, s54, 128
  v_mfma_f32_16x16x32_bf16 v[124:127], a[108:111], v[40:43], v[124:127]
  ds_read_b128 v[40:43], v230 offset:38912
  s_waitcnt lgkmcnt(7)
  v_mfma_f32_16x16x32_bf16 v[96:99], a[104:107], v[44:47], v[96:99]
  s_add_u32 m0, s44, 36864
  v_mfma_f32_16x16x32_bf16 v[128:131], a[108:111], v[44:47], v[128:131]
  ds_read_b128 v[44:47], v231 offset:36864
  buffer_load_dwordx4 v244, s[16:19], s55 offen sc1 lds
  v_mfma_f32_16x16x32_bf16 v[100:103], a[104:107], v[48:51], v[100:103]
  s_add_u32 s55, s55, 36864
  v_mfma_f32_16x16x32_bf16 v[132:135], a[108:111], v[48:51], v[132:135]
  ds_read_b128 v[48:51], v231 offset:38912
  s_waitcnt vmcnt(22)
  s_waitcnt lgkmcnt(6)
  v_mfma_f32_16x16x32_bf16 v[72:75], a[112:115], v[20:23], v[72:75]
  v_mfma_f32_16x16x32_bf16 v[104:107], a[116:119], v[20:23], v[104:107]
  buffer_load_dwordx4 a[168:171], v240, s[16:19], s46 offen offset:0 sc1
  v_mfma_f32_16x16x32_bf16 v[136:139], v[52:55], v[20:23], v[136:139]
  ds_read_b128 v[20:23], v224 offset:53248
  v_mfma_f32_16x16x32_bf16 v[76:79], a[112:115], v[24:27], v[76:79]
  v_mfma_f32_16x16x32_bf16 v[108:111], a[116:119], v[24:27], v[108:111]
  v_mfma_f32_16x16x32_bf16 v[140:143], v[52:55], v[24:27], v[140:143]
  ds_read_b128 v[24:27], v224 offset:55296
  ds_read_b128 v[52:55], v11 offset:38912
  s_waitcnt lgkmcnt(7)
  v_mfma_f32_16x16x32_bf16 v[80:83], a[112:115], v[28:31], v[80:83]
  buffer_load_dwordx4 a[172:175], v240, s[16:19], s46 offen offset:1024 sc1
  v_mfma_f32_16x16x32_bf16 v[112:115], a[116:119], v[28:31], v[112:115]
  ds_read_b128 v[28:31], v225 offset:53248
  v_mfma_f32_16x16x32_bf16 v[84:87], a[112:115], v[32:35], v[84:87]
  v_mfma_f32_16x16x32_bf16 v[116:119], a[116:119], v[32:35], v[116:119]
  ds_read_b128 v[32:35], v225 offset:55296
  s_waitcnt lgkmcnt(7)
  v_mfma_f32_16x16x32_bf16 v[88:91], a[112:115], v[36:39], v[88:91]
  buffer_load_dwordx4 a[176:179], v241, s[16:19], s46 offen offset:0 sc1
  v_mfma_f32_16x16x32_bf16 v[120:123], a[116:119], v[36:39], v[120:123]
  ds_read_b128 v[36:39], v226 offset:53248
  v_mfma_f32_16x16x32_bf16 v[92:95], a[112:115], v[40:43], v[92:95]
  v_mfma_f32_16x16x32_bf16 v[124:127], a[116:119], v[40:43], v[124:127]
  ds_read_b128 v[40:43], v226 offset:55296
  s_waitcnt lgkmcnt(7)
  v_mfma_f32_16x16x32_bf16 v[96:99], a[112:115], v[44:47], v[96:99]
  buffer_load_dwordx4 a[180:183], v241, s[16:19], s46 offen offset:1024 sc1
  v_mfma_f32_16x16x32_bf16 v[128:131], a[116:119], v[44:47], v[128:131]
  ds_read_b128 v[44:47], v227 offset:53248
  v_mfma_f32_16x16x32_bf16 v[100:103], a[112:115], v[48:51], v[100:103]
  v_mfma_f32_16x16x32_bf16 v[132:135], a[116:119], v[48:51], v[132:135]
  ds_read_b128 v[48:51], v227 offset:55296
  s_waitcnt vmcnt(24)
  s_waitcnt lgkmcnt(6)
  v_mfma_f32_16x16x32_bf16 v[72:75], a[120:123], v[20:23], v[72:75]
  buffer_load_dwordx4 a[184:187], v242, s[16:19], s46 offen offset:0 sc1
  v_mfma_f32_16x16x32_bf16 v[104:107], a[124:127], v[20:23], v[104:107]
  v_mfma_f32_16x16x32_bf16 v[136:139], v[52:55], v[20:23], v[136:139]
  ds_read_b128 v[20:23], v228 offset:53248
  v_mfma_f32_16x16x32_bf16 v[76:79], a[120:123], v[24:27], v[76:79]
  buffer_load_dwordx4 a[188:191], v242, s[16:19], s46 offen offset:1024 sc1
  v_mfma_f32_16x16x32_bf16 v[108:111], a[124:127], v[24:27], v[108:111]
  v_mfma_f32_16x16x32_bf16 v[140:143], v[52:55], v[24:27], v[140:143]
  ds_read_b128 v[24:27], v228 offset:55296
  ds_read_b128 v[52:55], v11 offset:39936
  s_waitcnt lgkmcnt(7)
  v_mfma_f32_16x16x32_bf16 v[80:83], a[120:123], v[28:31], v[80:83]
  v_mfma_f32_16x16x32_bf16 v[112:115], a[124:127], v[28:31], v[112:115]
  ds_read_b128 v[28:31], v229 offset:53248
  buffer_load_dwordx4 a[192:195], v243, s[16:19], s46 offen offset:0 sc1
  v_mfma_f32_16x16x32_bf16 v[84:87], a[120:123], v[32:35], v[84:87]
  v_mfma_f32_16x16x32_bf16 v[116:119], a[124:127], v[32:35], v[116:119]
  ds_read_b128 v[32:35], v229 offset:55296
  s_waitcnt lgkmcnt(7)
  v_mfma_f32_16x16x32_bf16 v[88:91], a[120:123], v[36:39], v[88:91]
  v_mfma_f32_16x16x32_bf16 v[120:123], a[124:127], v[36:39], v[120:123]
  ds_read_b128 v[36:39], v230 offset:53248
  buffer_load_dwordx4 a[196:199], v243, s[16:19], s46 offen offset:1024 sc1
  v_mfma_f32_16x16x32_bf16 v[92:95], a[120:123], v[40:43], v[92:95]
  s_add_u32 s46, s46, 36864
  v_mfma_f32_16x16x32_bf16 v[124:127], a[124:127], v[40:43], v[124:127]
  ds_read_b128 v[40:43], v230 offset:55296
  s_waitcnt lgkmcnt(7)
  v_mfma_f32_16x16x32_bf16 v[96:99], a[120:123], v[44:47], v[96:99]
  v_mfma_f32_16x16x32_bf16 v[128:131], a[124:127], v[44:47], v[128:131]
  ds_read_b128 v[44:47], v231 offset:53248
  v_mfma_f32_16x16x32_bf16 v[100:103], a[120:123], v[48:51], v[100:103]
  v_mfma_f32_16x16x32_bf16 v[132:135], a[124:127], v[48:51], v[132:135]
  s_waitcnt vmcnt(25)
  s_barrier
  s_waitcnt lgkmcnt(5)
  v_mfma_f32_16x16x32_bf16 v[72:75], a[128:131], v[20:23], v[72:75]
  ds_read_b128 v[48:51], v231 offset:55296
  s_add_u32 m0, s41, 73728
  v_mfma_f32_16x16x32_bf16 v[104:107], a[132:135], v[20:23], v[104:107]
  buffer_load_dwordx4 v68, s[60:63], s54 offen offset:0 lds
  v_mfma_f32_16x16x32_bf16 v[136:139], v[52:55], v[20:23], v[136:139]
  ds_read_b128 v[20:23], v216 offset:0
  v_mfma_f32_16x16x32_bf16 v[76:79], a[128:131], v[24:27], v[76:79]
  v_mfma_f32_16x16x32_bf16 v[108:111], a[132:135], v[24:27], v[108:111]
  v_mfma_f32_16x16x32_bf16 v[140:143], v[52:55], v[24:27], v[140:143]
  ds_read_b128 v[24:27], v216 offset:2048
  ds_read_b128 v[52:55], v10 offset:0
  s_waitcnt lgkmcnt(7)
  v_mfma_f32_16x16x32_bf16 v[80:83], a[128:131], v[28:31], v[80:83]
  buffer_load_dwordx4 v69, s[60:63], s54 offen offset:1024 lds
  v_mfma_f32_16x16x32_bf16 v[112:115], a[132:135], v[28:31], v[112:115]
  ds_read_b128 v[28:31], v217 offset:0
  v_mfma_f32_16x16x32_bf16 v[84:87], a[128:131], v[32:35], v[84:87]
  v_mfma_f32_16x16x32_bf16 v[116:119], a[132:135], v[32:35], v[116:119]
  ds_read_b128 v[32:35], v217 offset:2048
  s_waitcnt lgkmcnt(7)
  v_mfma_f32_16x16x32_bf16 v[88:91], a[128:131], v[36:39], v[88:91]
  buffer_load_dwordx4 v70, s[60:63], s54 offen offset:2048 lds
  v_mfma_f32_16x16x32_bf16 v[120:123], a[132:135], v[36:39], v[120:123]
  ds_read_b128 v[36:39], v218 offset:0
  v_mfma_f32_16x16x32_bf16 v[92:95], a[128:131], v[40:43], v[92:95]
  v_mfma_f32_16x16x32_bf16 v[124:127], a[132:135], v[40:43], v[124:127]
  ds_read_b128 v[40:43], v218 offset:2048
  s_waitcnt lgkmcnt(7)
  v_mfma_f32_16x16x32_bf16 v[96:99], a[128:131], v[44:47], v[96:99]
  buffer_load_dwordx4 v71, s[60:63], s54 offen offset:3072 lds
  s_add_u32 s54, s54, 128
  v_mfma_f32_16x16x32_bf16 v[128:131], a[132:135], v[44:47], v[128:131]
  ds_read_b128 v[44:47], v219 offset:0
  v_mfma_f32_16x16x32_bf16 v[100:103], a[128:131], v[48:51], v[100:103]
  s_add_u32 m0, s41, 90112
  v_mfma_f32_16x16x32_bf16 v[132:135], a[132:135], v[48:51], v[132:135]
  ds_read_b128 v[48:51], v219 offset:2048
  s_waitcnt vmcnt(27)
  s_waitcnt lgkmcnt(6)
  v_mfma_f32_16x16x32_bf16 v[72:75], a[136:139], v[20:23], v[72:75]
  buffer_load_dwordx4 v68, s[60:63], s54 offen offset:0 lds
  v_mfma_f32_16x16x32_bf16 v[104:107], a[140:143], v[20:23], v[104:107]
  v_mfma_f32_16x16x32_bf16 v[136:139], v[52:55], v[20:23], v[136:139]
  ds_read_b128 v[20:23], v220 offset:0
  v_mfma_f32_16x16x32_bf16 v[76:79], a[136:139], v[24:27], v[76:79]
  buffer_load_dwordx4 v69, s[60:63], s54 offen offset:1024 lds
  v_mfma_f32_16x16x32_bf16 v[108:111], a[140:143], v[24:27], v[108:111]
  v_mfma_f32_16x16x32_bf16 v[140:143], v[52:55], v[24:27], v[140:143]
  ds_read_b128 v[24:27], v220 offset:2048
  ds_read_b128 v[52:55], v10 offset:1024
  s_waitcnt lgkmcnt(7)
  v_mfma_f32_16x16x32_bf16 v[80:83], a[136:139], v[28:31], v[80:83]
  v_mfma_f32_16x16x32_bf16 v[112:115], a[140:143], v[28:31], v[112:115]
  ds_read_b128 v[28:31], v221 offset:0
  buffer_load_dwordx4 v70, s[60:63], s54 offen offset:2048 lds
  v_mfma_f32_16x16x32_bf16 v[84:87], a[136:139], v[32:35], v[84:87]
  v_mfma_f32_16x16x32_bf16 v[116:119], a[140:143], v[32:35], v[116:119]
  ds_read_b128 v[32:35], v221 offset:2048
  s_waitcnt lgkmcnt(7)
  v_mfma_f32_16x16x32_bf16 v[88:91], a[136:139], v[36:39], v[88:91]
  v_mfma_f32_16x16x32_bf16 v[120:123], a[140:143], v[36:39], v[120:123]
  ds_read_b128 v[36:39], v222 offset:0
  buffer_load_dwordx4 v71, s[60:63], s54 offen offset:3072 lds
  v_mfma_f32_16x16x32_bf16 v[92:95], a[136:139], v[40:43], v[92:95]
  s_add_u32 s54, s54, 128
  v_mfma_f32_16x16x32_bf16 v[124:127], a[140:143], v[40:43], v[124:127]
  ds_read_b128 v[40:43], v222 offset:2048
  s_waitcnt lgkmcnt(7)
  v_mfma_f32_16x16x32_bf16 v[96:99], a[136:139], v[44:47], v[96:99]
  s_add_u32 m0, s44, 73728
  v_mfma_f32_16x16x32_bf16 v[128:131], a[140:143], v[44:47], v[128:131]
  ds_read_b128 v[44:47], v223 offset:0
  buffer_load_dwordx4 v244, s[16:19], s55 offen sc1 lds
  v_mfma_f32_16x16x32_bf16 v[100:103], a[136:139], v[48:51], v[100:103]
  s_add_u32 s55, s55, 36864
  v_mfma_f32_16x16x32_bf16 v[132:135], a[140:143], v[48:51], v[132:135]
  ds_read_b128 v[48:51], v223 offset:2048
  s_waitcnt vmcnt(30)
  s_waitcnt lgkmcnt(6)
  v_mfma_f32_16x16x32_bf16 v[72:75], a[144:147], v[20:23], v[72:75]
  v_mfma_f32_16x16x32_bf16 v[104:107], a[148:151], v[20:23], v[104:107]
  buffer_load_dwordx4 a[72:75], v240, s[16:19], s46 offen offset:0 sc1
  v_mfma_f32_16x16x32_bf16 v[136:139], v[52:55], v[20:23], v[136:139]
  ds_read_b128 v[20:23], v216 offset:16384
  v_mfma_f32_16x16x32_bf16 v[76:79], a[144:147], v[24:27], v[76:79]
  v_mfma_f32_16x16x32_bf16 v[108:111], a[148:151], v[24:27], v[108:111]
  v_mfma_f32_16x16x32_bf16 v[140:143], v[52:55], v[24:27], v[140:143]
  ds_read_b128 v[24:27], v216 offset:18432
  ds_read_b128 v[52:55], v10 offset:2048
  s_waitcnt lgkmcnt(7)
  v_mfma_f32_16x16x32_bf16 v[80:83], a[144:147], v[28:31], v[80:83]
  buffer_load_dwordx4 a[76:79], v240, s[16:19], s46 offen offset:1024 sc1
  v_mfma_f32_16x16x32_bf16 v[112:115], a[148:151], v[28:31], v[112:115]
  ds_read_b128 v[28:31], v217 offset:16384
  v_mfma_f32_16x16x32_bf16 v[84:87], a[144:147], v[32:35], v[84:87]
  v_mfma_f32_16x16x32_bf16 v[116:119], a[148:151], v[32:35], v[116:119]
  ds_read_b128 v[32:35], v217 offset:18432
  s_waitcnt lgkmcnt(7)
  v_mfma_f32_16x16x32_bf16 v[88:91], a[144:147], v[36:39], v[88:91]
  buffer_load_dwordx4 a[80:83], v241, s[16:19], s46 offen offset:0 sc1
  v_mfma_f32_16x16x32_bf16 v[120:123], a[148:151], v[36:39], v[120:123]
  ds_read_b128 v[36:39], v218 offset:16384
  v_mfma_f32_16x16x32_bf16 v[92:95], a[144:147], v[40:43], v[92:95]
  v_mfma_f32_16x16x32_bf16 v[124:127], a[148:151], v[40:43], v[124:127]
  ds_read_b128 v[40:43], v218 offset:18432
  s_waitcnt lgkmcnt(7)
  v_mfma_f32_16x16x32_bf16 v[96:99], a[144:147], v[44:47], v[96:99]
  buffer_load_dwordx4 a[84:87], v241, s[16:19], s46 offen offset:1024 sc1
  v_mfma_f32_16x16x32_bf16 v[128:131], a[148:151], v[44:47], v[128:131]
  ds_read_b128 v[44:47], v219 offset:16384
  v_mfma_f32_16x16x32_bf16 v[100:103], a[144:147], v[48:51], v[100:103]
  v_mfma_f32_16x16x32_bf16 v[132:135], a[148:151], v[48:51], v[132:135]
  ds_read_b128 v[48:51], v219 offset:18432
  s_waitcnt vmcnt(32)
  s_waitcnt lgkmcnt(6)
  v_mfma_f32_16x16x32_bf16 v[72:75], a[152:155], v[20:23], v[72:75]
  buffer_load_dwordx4 a[88:91], v242, s[16:19], s46 offen offset:0 sc1
  v_mfma_f32_16x16x32_bf16 v[104:107], a[156:159], v[20:23], v[104:107]
  v_mfma_f32_16x16x32_bf16 v[136:139], v[52:55], v[20:23], v[136:139]
  ds_read_b128 v[20:23], v220 offset:16384
  v_mfma_f32_16x16x32_bf16 v[76:79], a[152:155], v[24:27], v[76:79]
  buffer_load_dwordx4 a[92:95], v242, s[16:19], s46 offen offset:1024 sc1
  v_mfma_f32_16x16x32_bf16 v[108:111], a[156:159], v[24:27], v[108:111]
  v_mfma_f32_16x16x32_bf16 v[140:143], v[52:55], v[24:27], v[140:143]
  ds_read_b128 v[24:27], v220 offset:18432
  ds_read_b128 v[52:55], v10 offset:3072
  s_waitcnt lgkmcnt(7)
  v_mfma_f32_16x16x32_bf16 v[80:83], a[152:155], v[28:31], v[80:83]
  v_mfma_f32_16x16x32_bf16 v[112:115], a[156:159], v[28:31], v[112:115]
  ds_read_b128 v[28:31], v221 offset:16384
  buffer_load_dwordx4 a[96:99], v243, s[16:19], s46 offen offset:0 sc1
  v_mfma_f32_16x16x32_bf16 v[84:87], a[152:155], v[32:35], v[84:87]
  v_mfma_f32_16x16x32_bf16 v[116:119], a[156:159], v[32:35], v[116:119]
  ds_read_b128 v[32:35], v221 offset:18432
  s_waitcnt lgkmcnt(7)
  v_mfma_f32_16x16x32_bf16 v[88:91], a[152:155], v[36:39], v[88:91]
  v_mfma_f32_16x16x32_bf16 v[120:123], a[156:159], v[36:39], v[120:123]
  ds_read_b128 v[36:39], v222 offset:16384
  buffer_load_dwordx4 a[100:103], v243, s[16:19], s46 offen offset:1024 sc1
  v_mfma_f32_16x16x32_bf16 v[92:95], a[152:155], v[40:43], v[92:95]
  s_add_u32 s46, s46, 36864
  v_mfma_f32_16x16x32_bf16 v[124:127], a[156:159], v[40:43], v[124:127]
  ds_read_b128 v[40:43], v222 offset:18432
  s_waitcnt lgkmcnt(7)
  v_mfma_f32_16x16x32_bf16 v[96:99], a[152:155], v[44:47], v[96:99]
  v_mfma_f32_16x16x32_bf16 v[128:131], a[156:159], v[44:47], v[128:131]
  ds_read_b128 v[44:47], v223 offset:16384
  v_mfma_f32_16x16x32_bf16 v[100:103], a[152:155], v[48:51], v[100:103]
  v_mfma_f32_16x16x32_bf16 v[132:135], a[156:159], v[48:51], v[132:135]
  s_waitcnt vmcnt(25)
  s_barrier
  s_waitcnt lgkmcnt(5)
  v_mfma_f32_16x16x32_bf16 v[72:75], a[160:163], v[20:23], v[72:75]
  ds_read_b128 v[48:51], v223 offset:18432
  s_add_u32 m0, s41, 110592
  v_mfma_f32_16x16x32_bf16 v[104:107], a[164:167], v[20:23], v[104:107]
  buffer_load_dwordx4 v68, s[60:63], s54 offen offset:0 lds
  v_mfma_f32_16x16x32_bf16 v[136:139], v[52:55], v[20:23], v[136:139]
  ds_read_b128 v[20:23], v216 offset:36864
  v_mfma_f32_16x16x32_bf16 v[76:79], a[160:163], v[24:27], v[76:79]
  v_mfma_f32_16x16x32_bf16 v[108:111], a[164:167], v[24:27], v[108:111]
  v_mfma_f32_16x16x32_bf16 v[140:143], v[52:55], v[24:27], v[140:143]
  ds_read_b128 v[24:27], v216 offset:38912
  ds_read_b128 v[52:55], v10 offset:36864
  s_waitcnt lgkmcnt(7)
  v_mfma_f32_16x16x32_bf16 v[80:83], a[160:163], v[28:31], v[80:83]
  buffer_load_dwordx4 v69, s[60:63], s54 offen offset:1024 lds
  v_mfma_f32_16x16x32_bf16 v[112:115], a[164:167], v[28:31], v[112:115]
  ds_read_b128 v[28:31], v217 offset:36864
  v_mfma_f32_16x16x32_bf16 v[84:87], a[160:163], v[32:35], v[84:87]
  v_mfma_f32_16x16x32_bf16 v[116:119], a[164:167], v[32:35], v[116:119]
  ds_read_b128 v[32:35], v217 offset:38912
  s_waitcnt lgkmcnt(7)
  v_mfma_f32_16x16x32_bf16 v[88:91], a[160:163], v[36:39], v[88:91]
  buffer_load_dwordx4 v70, s[60:63], s54 offen offset:2048 lds
  v_mfma_f32_16x16x32_bf16 v[120:123], a[164:167], v[36:39], v[120:123]
  ds_read_b128 v[36:39], v218 offset:36864
  v_mfma_f32_16x16x32_bf16 v[92:95], a[160:163], v[40:43], v[92:95]
  v_mfma_f32_16x16x32_bf16 v[124:127], a[164:167], v[40:43], v[124:127]
  ds_read_b128 v[40:43], v218 offset:38912
  s_waitcnt lgkmcnt(7)
  v_mfma_f32_16x16x32_bf16 v[96:99], a[160:163], v[44:47], v[96:99]
  buffer_load_dwordx4 v71, s[60:63], s54 offen offset:3072 lds
  s_add_u32 s54, s54, 128
  v_mfma_f32_16x16x32_bf16 v[128:131], a[164:167], v[44:47], v[128:131]
  ds_read_b128 v[44:47], v219 offset:36864
  v_mfma_f32_16x16x32_bf16 v[100:103], a[160:163], v[48:51], v[100:103]
  s_add_u32 m0, s41, 126976
  v_mfma_f32_16x16x32_bf16 v[132:135], a[164:167], v[48:51], v[132:135]
  ds_read_b128 v[48:51], v219 offset:38912
  s_waitcnt vmcnt(27)
  s_waitcnt lgkmcnt(6)
  v_mfma_f32_16x16x32_bf16 v[72:75], a[168:171], v[20:23], v[72:75]
  buffer_load_dwordx4 v68, s[60:63], s54 offen offset:0 lds
  v_mfma_f32_16x16x32_bf16 v[104:107], a[172:175], v[20:23], v[104:107]
  v_mfma_f32_16x16x32_bf16 v[136:139], v[52:55], v[20:23], v[136:139]
  ds_read_b128 v[20:23], v220 offset:36864
  v_mfma_f32_16x16x32_bf16 v[76:79], a[168:171], v[24:27], v[76:79]
  buffer_load_dwordx4 v69, s[60:63], s54 offen offset:1024 lds
  v_mfma_f32_16x16x32_bf16 v[108:111], a[172:175], v[24:27], v[108:111]
  v_mfma_f32_16x16x32_bf16 v[140:143], v[52:55], v[24:27], v[140:143]
  ds_read_b128 v[24:27], v220 offset:38912
  ds_read_b128 v[52:55], v10 offset:37888
  s_waitcnt lgkmcnt(7)
  v_mfma_f32_16x16x32_bf16 v[80:83], a[168:171], v[28:31], v[80:83]
  v_mfma_f32_16x16x32_bf16 v[112:115], a[172:175], v[28:31], v[112:115]
  ds_read_b128 v[28:31], v221 offset:36864
  buffer_load_dwordx4 v70, s[60:63], s54 offen offset:2048 lds
  v_mfma_f32_16x16x32_bf16 v[84:87], a[168:171], v[32:35], v[84:87]
  v_mfma_f32_16x16x32_bf16 v[116:119], a[172:175], v[32:35], v[116:119]
  ds_read_b128 v[32:35], v221 offset:38912
  s_waitcnt lgkmcnt(7)
  v_mfma_f32_16x16x32_bf16 v[88:91], a[168:171], v[36:39], v[88:91]
  v_mfma_f32_16x16x32_bf16 v[120:123], a[172:175], v[36:39], v[120:123]
  ds_read_b128 v[36:39], v222 offset:36864
  buffer_load_dwordx4 v71, s[60:63], s54 offen offset:3072 lds
  v_mfma_f32_16x16x32_bf16 v[92:95], a[168:171], v[40:43], v[92:95]
  s_add_u32 s54, s54, 128
  v_mfma_f32_16x16x32_bf16 v[124:127], a[172:175], v[40:43], v[124:127]
  ds_read_b128 v[40:43], v222 offset:38912
  s_waitcnt lgkmcnt(7)
  v_mfma_f32_16x16x32_bf16 v[96:99], a[168:171], v[44:47], v[96:99]
  s_add_u32 m0, s44, 110592
  v_mfma_f32_16x16x32_bf16 v[128:131], a[172:175], v[44:47], v[128:131]
  ds_read_b128 v[44:47], v223 offset:36864
  buffer_load_dwordx4 v244, s[16:19], s55 offen sc1 lds
  v_mfma_f32_16x16x32_bf16 v[100:103], a[168:171], v[48:51], v[100:103]
  s_add_u32 s55, s55, 36864
  v_mfma_f32_16x16x32_bf16 v[132:135], a[172:175], v[48:51], v[132:135]
  ds_read_b128 v[48:51], v223 offset:38912
  s_waitcnt vmcnt(30)
  s_waitcnt lgkmcnt(6)
  v_mfma_f32_16x16x32_bf16 v[72:75], a[176:179], v[20:23], v[72:75]
  v_mfma_f32_16x16x32_bf16 v[104:107], a[180:183], v[20:23], v[104:107]
  buffer_load_dwordx4 a[104:107], v240, s[16:19], s46 offen offset:0 sc1
  v_mfma_f32_16x16x32_bf16 v[136:139], v[52:55], v[20:23], v[136:139]
  ds_read_b128 v[20:23], v216 offset:53248
  v_mfma_f32_16x16x32_bf16 v[76:79], a[176:179], v[24:27], v[76:79]
  v_mfma_f32_16x16x32_bf16 v[108:111], a[180:183], v[24:27], v[108:111]
  v_mfma_f32_16x16x32_bf16 v[140:143], v[52:55], v[24:27], v[140:143]
  ds_read_b128 v[24:27], v216 offset:55296
  ds_read_b128 v[52:55], v10 offset:38912
  s_waitcnt lgkmcnt(7)
  v_mfma_f32_16x16x32_bf16 v[80:83], a[176:179], v[28:31], v[80:83]
  buffer_load_dwordx4 a[108:111], v240, s[16:19], s46 offen offset:1024 sc1
  v_mfma_f32_16x16x32_bf16 v[112:115], a[180:183], v[28:31], v[112:115]
  ds_read_b128 v[28:31], v217 offset:53248
  v_mfma_f32_16x16x32_bf16 v[84:87], a[176:179], v[32:35], v[84:87]
  v_mfma_f32_16x16x32_bf16 v[116:119], a[180:183], v[32:35], v[116:119]
  ds_read_b128 v[32:35], v217 offset:55296
  s_waitcnt lgkmcnt(7)
  v_mfma_f32_16x16x32_bf16 v[88:91], a[176:179], v[36:39], v[88:91]
  buffer_load_dwordx4 a[112:115], v241, s[16:19], s46 offen offset:0 sc1
  v_mfma_f32_16x16x32_bf16 v[120:123], a[180:183], v[36:39], v[120:123]
  ds_read_b128 v[36:39], v218 offset:53248
  v_mfma_f32_16x16x32_bf16 v[92:95], a[176:179], v[40:43], v[92:95]
  v_mfma_f32_16x16x32_bf16 v[124:127], a[180:183], v[40:43], v[124:127]
  ds_read_b128 v[40:43], v218 offset:55296
  s_waitcnt lgkmcnt(7)
  v_mfma_f32_16x16x32_bf16 v[96:99], a[176:179], v[44:47], v[96:99]
  buffer_load_dwordx4 a[116:119], v241, s[16:19], s46 offen offset:1024 sc1
  v_mfma_f32_16x16x32_bf16 v[128:131], a[180:183], v[44:47], v[128:131]
  ds_read_b128 v[44:47], v219 offset:53248
  v_mfma_f32_16x16x32_bf16 v[100:103], a[176:179], v[48:51], v[100:103]
  v_mfma_f32_16x16x32_bf16 v[132:135], a[180:183], v[48:51], v[132:135]
  ds_read_b128 v[48:51], v219 offset:55296
  s_waitcnt vmcnt(32)
  s_waitcnt lgkmcnt(6)
  v_mfma_f32_16x16x32_bf16 v[72:75], a[184:187], v[20:23], v[72:75]
  buffer_load_dwordx4 a[120:123], v242, s[16:19], s46 offen offset:0 sc1
  v_mfma_f32_16x16x32_bf16 v[104:107], a[188:191], v[20:23], v[104:107]
  v_mfma_f32_16x16x32_bf16 v[136:139], v[52:55], v[20:23], v[136:139]
  ds_read_b128 v[20:23], v220 offset:53248
  v_mfma_f32_16x16x32_bf16 v[76:79], a[184:187], v[24:27], v[76:79]
  buffer_load_dwordx4 a[124:127], v242, s[16:19], s46 offen offset:1024 sc1
  v_mfma_f32_16x16x32_bf16 v[108:111], a[188:191], v[24:27], v[108:111]
  v_mfma_f32_16x16x32_bf16 v[140:143], v[52:55], v[24:27], v[140:143]
  ds_read_b128 v[24:27], v220 offset:55296
  ds_read_b128 v[52:55], v10 offset:39936
  s_waitcnt lgkmcnt(7)
  v_mfma_f32_16x16x32_bf16 v[80:83], a[184:187], v[28:31], v[80:83]
  v_mfma_f32_16x16x32_bf16 v[112:115], a[188:191], v[28:31], v[112:115]
  ds_read_b128 v[28:31], v221 offset:53248
  buffer_load_dwordx4 a[128:131], v243, s[16:19], s46 offen offset:0 sc1
  v_mfma_f32_16x16x32_bf16 v[84:87], a[184:187], v[32:35], v[84:87]
  v_mfma_f32_16x16x32_bf16 v[116:119], a[188:191], v[32:35], v[116:119]
  ds_read_b128 v[32:35], v221 offset:55296
  s_waitcnt lgkmcnt(7)
  v_mfma_f32_16x16x32_bf16 v[88:91], a[184:187], v[36:39], v[88:91]
  v_mfma_f32_16x16x32_bf16 v[120:123], a[188:191], v[36:39], v[120:123]
  ds_read_b128 v[36:39], v222 offset:53248
  buffer_load_dwordx4 a[132:135], v243, s[16:19], s46 offen offset:1024 sc1
  v_mfma_f32_16x16x32_bf16 v[92:95], a[184:187], v[40:43], v[92:95]
  s_add_u32 s46, s46, 36864
  v_mfma_f32_16x16x32_bf16 v[124:127], a[188:191], v[40:43], v[124:127]
  ds_read_b128 v[40:43], v222 offset:55296
  s_waitcnt lgkmcnt(7)
  v_mfma_f32_16x16x32_bf16 v[96:99], a[184:187], v[44:47], v[96:99]
  v_mfma_f32_16x16x32_bf16 v[128:131], a[188:191], v[44:47], v[128:131]
  ds_read_b128 v[44:47], v223 offset:53248
  v_mfma_f32_16x16x32_bf16 v[100:103], a[184:187], v[48:51], v[100:103]
  v_mfma_f32_16x16x32_bf16 v[132:135], a[188:191], v[48:51], v[132:135]
  s_waitcnt vmcnt(25)
  s_barrier
  s_waitcnt lgkmcnt(5)
  v_mfma_f32_16x16x32_bf16 v[72:75], a[192:195], v[20:23], v[72:75]
  ds_read_b128 v[48:51], v223 offset:55296
  s_add_u32 m0, s41, 0
  v_mfma_f32_16x16x32_bf16 v[104:107], a[196:199], v[20:23], v[104:107]
  buffer_load_dwordx4 v68, s[60:63], s54 offen offset:0 lds
  v_mfma_f32_16x16x32_bf16 v[136:139], v[52:55], v[20:23], v[136:139]
  ds_read_b128 v[20:23], v224 offset:0
  v_mfma_f32_16x16x32_bf16 v[76:79], a[192:195], v[24:27], v[76:79]
  v_mfma_f32_16x16x32_bf16 v[108:111], a[196:199], v[24:27], v[108:111]
  v_mfma_f32_16x16x32_bf16 v[140:143], v[52:55], v[24:27], v[140:143]
  ds_read_b128 v[24:27], v224 offset:2048
  ds_read_b128 v[52:55], v11 offset:0
  s_waitcnt lgkmcnt(7)
  v_mfma_f32_16x16x32_bf16 v[80:83], a[192:195], v[28:31], v[80:83]
  buffer_load_dwordx4 v69, s[60:63], s54 offen offset:1024 lds
  v_mfma_f32_16x16x32_bf16 v[112:115], a[196:199], v[28:31], v[112:115]
  ds_read_b128 v[28:31], v225 offset:0
  v_mfma_f32_16x16x32_bf16 v[84:87], a[192:195], v[32:35], v[84:87]
  v_mfma_f32_16x16x32_bf16 v[116:119], a[196:199], v[32:35], v[116:119]
  ds_read_b128 v[32:35], v225 offset:2048
  s_waitcnt lgkmcnt(7)
  v_mfma_f32_16x16x32_bf16 v[88:91], a[192:195], v[36:39], v[88:91]
  buffer_load_dwordx4 v70, s[60:63], s54 offen offset:2048 lds
  v_mfma_f32_16x16x32_bf16 v[120:123], a[196:199], v[36:39], v[120:123]
  ds_read_b128 v[36:39], v226 offset:0
  v_mfma_f32_16x16x32_bf16 v[92:95], a[192:195], v[40:43], v[92:95]
  v_mfma_f32_16x16x32_bf16 v[124:127], a[196:199], v[40:43], v[124:127]
  ds_read_b128 v[40:43], v226 offset:2048
  s_waitcnt lgkmcnt(7)
  v_mfma_f32_16x16x32_bf16 v[96:99], a[192:195], v[44:47], v[96:99]
  buffer_load_dwordx4 v71, s[60:63], s54 offen offset:3072 lds
  s_add_u32 s54, s54, 128
  v_mfma_f32_16x16x32_bf16 v[128:131], a[196:199], v[44:47], v[128:131]
  ds_read_b128 v[44:47], v227 offset:0
  v_mfma_f32_16x16x32_bf16 v[100:103], a[192:195], v[48:51], v[100:103]
  s_add_u32 m0, s41, 16384
  v_mfma_f32_16x16x32_bf16 v[132:135], a[196:199], v[48:51], v[132:135]
  ds_read_b128 v[48:51], v227 offset:2048
  s_waitcnt vmcnt(27)
  s_waitcnt lgkmcnt(6)
  v_mfma_f32_16x16x32_bf16 v[72:75], a[72:75], v[20:23], v[72:75]
  buffer_load_dwordx4 v68, s[60:63], s54 offen offset:0 lds
  v_mfma_f32_16x16x32_bf16 v[104:107], a[76:79], v[20:23], v[104:107]
  v_mfma_f32_16x16x32_bf16 v[136:139], v[52:55], v[20:23], v[136:139]
  ds_read_b128 v[20:23], v228 offset:0
  v_mfma_f32_16x16x32_bf16 v[76:79], a[72:75], v[24:27], v[76:79]
  buffer_load_dwordx4 v69, s[60:63], s54 offen offset:1024 lds
  v_mfma_f32_16x16x32_bf16 v[108:111], a[76:79], v[24:27], v[108:111]
  v_mfma_f32_16x16x32_bf16 v[140:143], v[52:55], v[24:27], v[140:143]
  ds_read_b128 v[24:27], v228 offset:2048
  ds_read_b128 v[52:55], v11 offset:1024
  s_waitcnt lgkmcnt(7)
  v_mfma_f32_16x16x32_bf16 v[80:83], a[72:75], v[28:31], v[80:83]
  v_mfma_f32_16x16x32_bf16 v[112:115], a[76:79], v[28:31], v[112:115]
  ds_read_b128 v[28:31], v229 offset:0
  buffer_load_dwordx4 v70, s[60:63], s54 offen offset:2048 lds
  v_mfma_f32_16x16x32_bf16 v[84:87], a[72:75], v[32:35], v[84:87]
  v_mfma_f32_16x16x32_bf16 v[116:119], a[76:79], v[32:35], v[116:119]
  ds_read_b128 v[32:35], v229 offset:2048
  s_waitcnt lgkmcnt(7)
  v_mfma_f32_16x16x32_bf16 v[88:91], a[72:75], v[36:39], v[88:91]
  v_mfma_f32_16x16x32_bf16 v[120:123], a[76:79], v[36:39], v[120:123]
  ds_read_b128 v[36:39], v230 offset:0
  buffer_load_dwordx4 v71, s[60:63], s54 offen offset:3072 lds
  v_mfma_f32_16x16x32_bf16 v[92:95], a[72:75], v[40:43], v[92:95]
  s_add_u32 s54, s54, 128
  v_mfma_f32_16x16x32_bf16 v[124:127], a[76:79], v[40:43], v[124:127]
  ds_read_b128 v[40:43], v230 offset:2048
  s_waitcnt lgkmcnt(7)
  v_mfma_f32_16x16x32_bf16 v[96:99], a[72:75], v[44:47], v[96:99]
  s_add_u32 m0, s44, 0
  v_mfma_f32_16x16x32_bf16 v[128:131], a[76:79], v[44:47], v[128:131]
  ds_read_b128 v[44:47], v231 offset:0
  buffer_load_dwordx4 v244, s[16:19], s55 offen sc1 lds
  v_mfma_f32_16x16x32_bf16 v[100:103], a[72:75], v[48:51], v[100:103]
  s_add_u32 s55, s55, 36864
  v_mfma_f32_16x16x32_bf16 v[132:135], a[76:79], v[48:51], v[132:135]
  ds_read_b128 v[48:51], v231 offset:2048
  s_waitcnt vmcnt(30)
  s_waitcnt lgkmcnt(6)
  v_mfma_f32_16x16x32_bf16 v[72:75], a[80:83], v[20:23], v[72:75]
  v_mfma_f32_16x16x32_bf16 v[104:107], a[84:87], v[20:23], v[104:107]
  buffer_load_dwordx4 a[136:139], v240, s[16:19], s46 offen offset:0 sc1
  v_mfma_f32_16x16x32_bf16 v[136:139], v[52:55], v[20:23], v[136:139]
  ds_read_b128 v[20:23], v224 offset:16384
  v_mfma_f32_16x16x32_bf16 v[76:79], a[80:83], v[24:27], v[76:79]
  v_mfma_f32_16x16x32_bf16 v[108:111], a[84:87], v[24:27], v[108:111]
  v_mfma_f32_16x16x32_bf16 v[140:143], v[52:55], v[24:27], v[140:143]
  ds_read_b128 v[24:27], v224 offset:18432
  ds_read_b128 v[52:55], v11 offset:2048
  s_waitcnt lgkmcnt(7)
  v_mfma_f32_16x16x32_bf16 v[80:83], a[80:83], v[28:31], v[80:83]
  buffer_load_dwordx4 a[140:143], v240, s[16:19], s46 offen offset:1024 sc1
  v_mfma_f32_16x16x32_bf16 v[112:115], a[84:87], v[28:31], v[112:115]
  ds_read_b128 v[28:31], v225 offset:16384
  v_mfma_f32_16x16x32_bf16 v[84:87], a[80:83], v[32:35], v[84:87]
  v_mfma_f32_16x16x32_bf16 v[116:119], a[84:87], v[32:35], v[116:119]
  ds_read_b128 v[32:35], v225 offset:18432
  s_waitcnt lgkmcnt(7)
  v_mfma_f32_16x16x32_bf16 v[88:91], a[80:83], v[36:39], v[88:91]
  buffer_load_dwordx4 a[144:147], v241, s[16:19], s46 offen offset:0 sc1
  v_mfma_f32_16x16x32_bf16 v[120:123], a[84:87], v[36:39], v[120:123]
  ds_read_b128 v[36:39], v226 offset:16384
  v_mfma_f32_16x16x32_bf16 v[92:95], a[80:83], v[40:43], v[92:95]
  v_mfma_f32_16x16x32_bf16 v[124:127], a[84:87], v[40:43], v[124:127]
  ds_read_b128 v[40:43], v226 offset:18432
  s_waitcnt lgkmcnt(7)
  v_mfma_f32_16x16x32_bf16 v[96:99], a[80:83], v[44:47], v[96:99]
  buffer_load_dwordx4 a[148:151], v241, s[16:19], s46 offen offset:1024 sc1
  v_mfma_f32_16x16x32_bf16 v[128:131], a[84:87], v[44:47], v[128:131]
  ds_read_b128 v[44:47], v227 offset:16384
  v_mfma_f32_16x16x32_bf16 v[100:103], a[80:83], v[48:51], v[100:103]
  v_mfma_f32_16x16x32_bf16 v[132:135], a[84:87], v[48:51], v[132:135]
  ds_read_b128 v[48:51], v227 offset:18432
  s_waitcnt vmcnt(32)
  s_waitcnt lgkmcnt(6)
  v_mfma_f32_16x16x32_bf16 v[72:75], a[88:91], v[20:23], v[72:75]
  buffer_load_dwordx4 a[152:155], v242, s[16:19], s46 offen offset:0 sc1
  v_mfma_f32_16x16x32_bf16 v[104:107], a[92:95], v[20:23], v[104:107]
  v_mfma_f32_16x16x32_bf16 v[136:139], v[52:55], v[20:23], v[136:139]
  ds_read_b128 v[20:23], v228 offset:16384
  v_mfma_f32_16x16x32_bf16 v[76:79], a[88:91], v[24:27], v[76:79]
  buffer_load_dwordx4 a[156:159], v242, s[16:19], s46 offen offset:1024 sc1
  v_mfma_f32_16x16x32_bf16 v[108:111], a[92:95], v[24:27], v[108:111]
  v_mfma_f32_16x16x32_bf16 v[140:143], v[52:55], v[24:27], v[140:143]
  ds_read_b128 v[24:27], v228 offset:18432
  ds_read_b128 v[52:55], v11 offset:3072
  s_waitcnt lgkmcnt(7)
  v_mfma_f32_16x16x32_bf16 v[80:83], a[88:91], v[28:31], v[80:83]
  v_mfma_f32_16x16x32_bf16 v[112:115], a[92:95], v[28:31], v[112:115]
  ds_read_b128 v[28:31], v229 offset:16384
  buffer_load_dwordx4 a[160:163], v243, s[16:19], s46 offen offset:0 sc1
  v_mfma_f32_16x16x32_bf16 v[84:87], a[88:91], v[32:35], v[84:87]
  v_mfma_f32_16x16x32_bf16 v[116:119], a[92:95], v[32:35], v[116:119]
  ds_read_b128 v[32:35], v229 offset:18432
  s_waitcnt lgkmcnt(7)
  v_mfma_f32_16x16x32_bf16 v[88:91], a[88:91], v[36:39], v[88:91]
  v_mfma_f32_16x16x32_bf16 v[120:123], a[92:95], v[36:39], v[120:123]
  ds_read_b128 v[36:39], v230 offset:16384
  buffer_load_dwordx4 a[164:167], v243, s[16:19], s46 offen offset:1024 sc1
  v_mfma_f32_16x16x32_bf16 v[92:95], a[88:91], v[40:43], v[92:95]
  s_add_u32 s46, s46, 36864
  v_mfma_f32_16x16x32_bf16 v[124:127], a[92:95], v[40:43], v[124:127]
  ds_read_b128 v[40:43], v230 offset:18432
  s_waitcnt lgkmcnt(7)
  v_mfma_f32_16x16x32_bf16 v[96:99], a[88:91], v[44:47], v[96:99]
  v_mfma_f32_16x16x32_bf16 v[128:131], a[92:95], v[44:47], v[128:131]
  ds_read_b128 v[44:47], v231 offset:16384
  v_mfma_f32_16x16x32_bf16 v[100:103], a[88:91], v[48:51], v[100:103]
  v_mfma_f32_16x16x32_bf16 v[132:135], a[92:95], v[48:51], v[132:135]
  s_waitcnt vmcnt(25)
  s_barrier
  s_waitcnt lgkmcnt(5)
  v_mfma_f32_16x16x32_bf16 v[72:75], a[96:99], v[20:23], v[72:75]
  ds_read_b128 v[48:51], v231 offset:18432
  s_add_u32 m0, s41, 36864
  v_mfma_f32_16x16x32_bf16 v[104:107], a[100:103], v[20:23], v[104:107]
  buffer_load_dwordx4 v68, s[60:63], s54 offen offset:0 lds
  v_mfma_f32_16x16x32_bf16 v[136:139], v[52:55], v[20:23], v[136:139]
  ds_read_b128 v[20:23], v224 offset:36864
  v_mfma_f32_16x16x32_bf16 v[76:79], a[96:99], v[24:27], v[76:79]
  v_mfma_f32_16x16x32_bf16 v[108:111], a[100:103], v[24:27], v[108:111]
  v_mfma_f32_16x16x32_bf16 v[140:143], v[52:55], v[24:27], v[140:143]
  ds_read_b128 v[24:27], v224 offset:38912
  ds_read_b128 v[52:55], v11 offset:36864
  s_waitcnt lgkmcnt(7)
  v_mfma_f32_16x16x32_bf16 v[80:83], a[96:99], v[28:31], v[80:83]
  buffer_load_dwordx4 v69, s[60:63], s54 offen offset:1024 lds
  v_mfma_f32_16x16x32_bf16 v[112:115], a[100:103], v[28:31], v[112:115]
  ds_read_b128 v[28:31], v225 offset:36864
  v_mfma_f32_16x16x32_bf16 v[84:87], a[96:99], v[32:35], v[84:87]
  v_mfma_f32_16x16x32_bf16 v[116:119], a[100:103], v[32:35], v[116:119]
  ds_read_b128 v[32:35], v225 offset:38912
  s_waitcnt lgkmcnt(7)
  v_mfma_f32_16x16x32_bf16 v[88:91], a[96:99], v[36:39], v[88:91]
  buffer_load_dwordx4 v70, s[60:63], s54 offen offset:2048 lds
  v_mfma_f32_16x16x32_bf16 v[120:123], a[100:103], v[36:39], v[120:123]
  ds_read_b128 v[36:39], v226 offset:36864
  v_mfma_f32_16x16x32_bf16 v[92:95], a[96:99], v[40:43], v[92:95]
  v_mfma_f32_16x16x32_bf16 v[124:127], a[100:103], v[40:43], v[124:127]
  ds_read_b128 v[40:43], v226 offset:38912
  s_waitcnt lgkmcnt(7)
  v_mfma_f32_16x16x32_bf16 v[96:99], a[96:99], v[44:47], v[96:99]
  buffer_load_dwordx4 v71, s[60:63], s54 offen offset:3072 lds
  s_add_u32 s54, s54, 128
  v_mfma_f32_16x16x32_bf16 v[128:131], a[100:103], v[44:47], v[128:131]
  ds_read_b128 v[44:47], v227 offset:36864
  v_mfma_f32_16x16x32_bf16 v[100:103], a[96:99], v[48:51], v[100:103]
  s_add_u32 m0, s41, 53248
  v_mfma_f32_16x16x32_bf16 v[132:135], a[100:103], v[48:51], v[132:135]
  ds_read_b128 v[48:51], v227 offset:38912
  s_waitcnt vmcnt(27)
  s_waitcnt lgkmcnt(6)
  v_mfma_f32_16x16x32_bf16 v[72:75], a[104:107], v[20:23], v[72:75]
  buffer_load_dwordx4 v68, s[60:63], s54 offen offset:0 lds
  v_mfma_f32_16x16x32_bf16 v[104:107], a[108:111], v[20:23], v[104:107]
  v_mfma_f32_16x16x32_bf16 v[136:139], v[52:55], v[20:23], v[136:139]
  ds_read_b128 v[20:23], v228 offset:36864
  v_mfma_f32_16x16x32_bf16 v[76:79], a[104:107], v[24:27], v[76:79]
  buffer_load_dwordx4 v69, s[60:63], s54 offen offset:1024 lds
  v_mfma_f32_16x16x32_bf16 v[108:111], a[108:111], v[24:27], v[108:111]
  v_mfma_f32_16x16x32_bf16 v[140:143], v[52:55], v[24:27], v[140:143]
  ds_read_b128 v[24:27], v228 offset:38912
  ds_read_b128 v[52:55], v11 offset:37888
  s_waitcnt lgkmcnt(7)
  v_mfma_f32_16x16x32_bf16 v[80:83], a[104:107], v[28:31], v[80:83]
  v_mfma_f32_16x16x32_bf16 v[112:115], a[108:111], v[28:31], v[112:115]
  ds_read_b128 v[28:31], v229 offset:36864
  buffer_load_dwordx4 v70, s[60:63], s54 offen offset:2048 lds
  v_mfma_f32_16x16x32_bf16 v[84:87], a[104:107], v[32:35], v[84:87]
  v_mfma_f32_16x16x32_bf16 v[116:119], a[108:111], v[32:35], v[116:119]
  ds_read_b128 v[32:35], v229 offset:38912
  s_waitcnt lgkmcnt(7)
  v_mfma_f32_16x16x32_bf16 v[88:91], a[104:107], v[36:39], v[88:91]
  v_mfma_f32_16x16x32_bf16 v[120:123], a[108:111], v[36:39], v[120:123]
  ds_read_b128 v[36:39], v230 offset:36864
  buffer_load_dwordx4 v71, s[60:63], s54 offen offset:3072 lds
  v_mfma_f32_16x16x32_bf16 v[92:95], a[104:107], v[40:43], v[92:95]
  s_add_u32 s54, s54, 128
  v_mfma_f32_16x16x32_bf16 v[124:127], a[108:111], v[40:43], v[124:127]
  ds_read_b128 v[40:43], v230 offset:38912
  s_waitcnt lgkmcnt(7)
  v_mfma_f32_16x16x32_bf16 v[96:99], a[104:107], v[44:47], v[96:99]
  s_add_u32 m0, s44, 36864
  v_mfma_f32_16x16x32_bf16 v[128:131], a[108:111], v[44:47], v[128:131]
  ds_read_b128 v[44:47], v231 offset:36864
  buffer_load_dwordx4 v244, s[16:19], s55 offen sc1 lds
  v_mfma_f32_16x16x32_bf16 v[100:103], a[104:107], v[48:51], v[100:103]
  s_add_u32 s55, s55, 36864
  v_mfma_f32_16x16x32_bf16 v[132:135], a[108:111], v[48:51], v[132:135]
  ds_read_b128 v[48:51], v231 offset:38912
  s_waitcnt vmcnt(30)
  s_waitcnt lgkmcnt(6)
  v_mfma_f32_16x16x32_bf16 v[72:75], a[112:115], v[20:23], v[72:75]
  v_mfma_f32_16x16x32_bf16 v[104:107], a[116:119], v[20:23], v[104:107]
  buffer_load_dwordx4 a[168:171], v240, s[16:19], s46 offen offset:0 sc1
  v_mfma_f32_16x16x32_bf16 v[136:139], v[52:55], v[20:23], v[136:139]
  ds_read_b128 v[20:23], v224 offset:53248
  v_mfma_f32_16x16x32_bf16 v[76:79], a[112:115], v[24:27], v[76:79]
  v_mfma_f32_16x16x32_bf16 v[108:111], a[116:119], v[24:27], v[108:111]
  v_mfma_f32_16x16x32_bf16 v[140:143], v[52:55], v[24:27], v[140:143]
  ds_read_b128 v[24:27], v224 offset:55296
  ds_read_b128 v[52:55], v11 offset:38912
  s_waitcnt lgkmcnt(7)
  v_mfma_f32_16x16x32_bf16 v[80:83], a[112:115], v[28:31], v[80:83]
  buffer_load_dwordx4 a[172:175], v240, s[16:19], s46 offen offset:1024 sc1
  v_mfma_f32_16x16x32_bf16 v[112:115], a[116:119], v[28:31], v[112:115]
  ds_read_b128 v[28:31], v225 offset:53248
  v_mfma_f32_16x16x32_bf16 v[84:87], a[112:115], v[32:35], v[84:87]
  v_mfma_f32_16x16x32_bf16 v[116:119], a[116:119], v[32:35], v[116:119]
  ds_read_b128 v[32:35], v225 offset:55296
  s_waitcnt lgkmcnt(7)
  v_mfma_f32_16x16x32_bf16 v[88:91], a[112:115], v[36:39], v[88:91]
  buffer_load_dwordx4 a[176:179], v241, s[16:19], s46 offen offset:0 sc1
  v_mfma_f32_16x16x32_bf16 v[120:123], a[116:119], v[36:39], v[120:123]
  ds_read_b128 v[36:39], v226 offset:53248
  v_mfma_f32_16x16x32_bf16 v[92:95], a[112:115], v[40:43], v[92:95]
  v_mfma_f32_16x16x32_bf16 v[124:127], a[116:119], v[40:43], v[124:127]
  ds_read_b128 v[40:43], v226 offset:55296
  s_waitcnt lgkmcnt(7)
  v_mfma_f32_16x16x32_bf16 v[96:99], a[112:115], v[44:47], v[96:99]
  buffer_load_dwordx4 a[180:183], v241, s[16:19], s46 offen offset:1024 sc1
  v_mfma_f32_16x16x32_bf16 v[128:131], a[116:119], v[44:47], v[128:131]
  ds_read_b128 v[44:47], v227 offset:53248
  v_mfma_f32_16x16x32_bf16 v[100:103], a[112:115], v[48:51], v[100:103]
  v_mfma_f32_16x16x32_bf16 v[132:135], a[116:119], v[48:51], v[132:135]
  ds_read_b128 v[48:51], v227 offset:55296
  s_waitcnt vmcnt(32)
  s_waitcnt lgkmcnt(6)
  v_mfma_f32_16x16x32_bf16 v[72:75], a[120:123], v[20:23], v[72:75]
  buffer_load_dwordx4 a[184:187], v242, s[16:19], s46 offen offset:0 sc1
  v_mfma_f32_16x16x32_bf16 v[104:107], a[124:127], v[20:23], v[104:107]
  v_mfma_f32_16x16x32_bf16 v[136:139], v[52:55], v[20:23], v[136:139]
  ds_read_b128 v[20:23], v228 offset:53248
  v_mfma_f32_16x16x32_bf16 v[76:79], a[120:123], v[24:27], v[76:79]
  buffer_load_dwordx4 a[188:191], v242, s[16:19], s46 offen offset:1024 sc1
  v_mfma_f32_16x16x32_bf16 v[108:111], a[124:127], v[24:27], v[108:111]
  v_mfma_f32_16x16x32_bf16 v[140:143], v[52:55], v[24:27], v[140:143]
  ds_read_b128 v[24:27], v228 offset:55296
  ds_read_b128 v[52:55], v11 offset:39936
  s_waitcnt lgkmcnt(7)
  v_mfma_f32_16x16x32_bf16 v[80:83], a[120:123], v[28:31], v[80:83]
  v_mfma_f32_16x16x32_bf16 v[112:115], a[124:127], v[28:31], v[112:115]
  ds_read_b128 v[28:31], v229 offset:53248
  buffer_load_dwordx4 a[192:195], v243, s[16:19], s46 offen offset:0 sc1
  v_mfma_f32_16x16x32_bf16 v[84:87], a[120:123], v[32:35], v[84:87]
  v_mfma_f32_16x16x32_bf16 v[116:119], a[124:127], v[32:35], v[116:119]
  ds_read_b128 v[32:35], v229 offset:55296
  s_waitcnt lgkmcnt(7)
  v_mfma_f32_16x16x32_bf16 v[88:91], a[120:123], v[36:39], v[88:91]
  v_mfma_f32_16x16x32_bf16 v[120:123], a[124:127], v[36:39], v[120:123]
  ds_read_b128 v[36:39], v230 offset:53248
  buffer_load_dwordx4 a[196:199], v243, s[16:19], s46 offen offset:1024 sc1
  v_mfma_f32_16x16x32_bf16 v[92:95], a[120:123], v[40:43], v[92:95]
  s_add_u32 s46, s46, 36864
  v_mfma_f32_16x16x32_bf16 v[124:127], a[124:127], v[40:43], v[124:127]
  ds_read_b128 v[40:43], v230 offset:55296
  s_waitcnt lgkmcnt(7)
  v_mfma_f32_16x16x32_bf16 v[96:99], a[120:123], v[44:47], v[96:99]
  v_mfma_f32_16x16x32_bf16 v[128:131], a[124:127], v[44:47], v[128:131]
  ds_read_b128 v[44:47], v231 offset:53248
  v_mfma_f32_16x16x32_bf16 v[100:103], a[120:123], v[48:51], v[100:103]
  v_mfma_f32_16x16x32_bf16 v[132:135], a[124:127], v[48:51], v[132:135]
  s_waitcnt vmcnt(25)
  s_barrier
  s_waitcnt lgkmcnt(5)
  v_mfma_f32_16x16x32_bf16 v[72:75], a[128:131], v[20:23], v[72:75]
  ds_read_b128 v[48:51], v231 offset:55296
  s_add_u32 m0, s41, 73728
  v_mfma_f32_16x16x32_bf16 v[104:107], a[132:135], v[20:23], v[104:107]
  buffer_load_dwordx4 v68, s[60:63], s54 offen offset:0 lds
  v_mfma_f32_16x16x32_bf16 v[136:139], v[52:55], v[20:23], v[136:139]
  ds_read_b128 v[20:23], v216 offset:0
  v_mfma_f32_16x16x32_bf16 v[76:79], a[128:131], v[24:27], v[76:79]
  v_mfma_f32_16x16x32_bf16 v[108:111], a[132:135], v[24:27], v[108:111]
  v_mfma_f32_16x16x32_bf16 v[140:143], v[52:55], v[24:27], v[140:143]
  ds_read_b128 v[24:27], v216 offset:2048
  ds_read_b128 v[52:55], v10 offset:0
  s_waitcnt lgkmcnt(7)
  v_mfma_f32_16x16x32_bf16 v[80:83], a[128:131], v[28:31], v[80:83]
  buffer_load_dwordx4 v69, s[60:63], s54 offen offset:1024 lds
  v_mfma_f32_16x16x32_bf16 v[112:115], a[132:135], v[28:31], v[112:115]
  ds_read_b128 v[28:31], v217 offset:0
  v_mfma_f32_16x16x32_bf16 v[84:87], a[128:131], v[32:35], v[84:87]
  v_mfma_f32_16x16x32_bf16 v[116:119], a[132:135], v[32:35], v[116:119]
  ds_read_b128 v[32:35], v217 offset:2048
  s_waitcnt lgkmcnt(7)
  v_mfma_f32_16x16x32_bf16 v[88:91], a[128:131], v[36:39], v[88:91]
  buffer_load_dwordx4 v70, s[60:63], s54 offen offset:2048 lds
  v_mfma_f32_16x16x32_bf16 v[120:123], a[132:135], v[36:39], v[120:123]
  ds_read_b128 v[36:39], v218 offset:0
  v_mfma_f32_16x16x32_bf16 v[92:95], a[128:131], v[40:43], v[92:95]
  v_mfma_f32_16x16x32_bf16 v[124:127], a[132:135], v[40:43], v[124:127]
  ds_read_b128 v[40:43], v218 offset:2048
  s_waitcnt lgkmcnt(7)
  v_mfma_f32_16x16x32_bf16 v[96:99], a[128:131], v[44:47], v[96:99]
  buffer_load_dwordx4 v71, s[60:63], s54 offen offset:3072 lds
  s_add_u32 s54, s54, 128
  v_mfma_f32_16x16x32_bf16 v[128:131], a[132:135], v[44:47], v[128:131]
  ds_read_b128 v[44:47], v219 offset:0
  v_mfma_f32_16x16x32_bf16 v[100:103], a[128:131], v[48:51], v[100:103]
  s_add_u32 m0, s41, 90112
  v_mfma_f32_16x16x32_bf16 v[132:135], a[132:135], v[48:51], v[132:135]
  ds_read_b128 v[48:51], v219 offset:2048
  s_waitcnt vmcnt(27)
  s_waitcnt lgkmcnt(6)
  v_mfma_f32_16x16x32_bf16 v[72:75], a[136:139], v[20:23], v[72:75]
  buffer_load_dwordx4 v68, s[60:63], s54 offen offset:0 lds
  v_mfma_f32_16x16x32_bf16 v[104:107], a[140:143], v[20:23], v[104:107]
  v_mfma_f32_16x16x32_bf16 v[136:139], v[52:55], v[20:23], v[136:139]
  ds_read_b128 v[20:23], v220 offset:0
  v_mfma_f32_16x16x32_bf16 v[76:79], a[136:139], v[24:27], v[76:79]
  buffer_load_dwordx4 v69, s[60:63], s54 offen offset:1024 lds
  v_mfma_f32_16x16x32_bf16 v[108:111], a[140:143], v[24:27], v[108:111]
  v_mfma_f32_16x16x32_bf16 v[140:143], v[52:55], v[24:27], v[140:143]
  ds_read_b128 v[24:27], v220 offset:2048
  ds_read_b128 v[52:55], v10 offset:1024
  s_waitcnt lgkmcnt(7)
  v_mfma_f32_16x16x32_bf16 v[80:83], a[136:139], v[28:31], v[80:83]
  v_mfma_f32_16x16x32_bf16 v[112:115], a[140:143], v[28:31], v[112:115]
  ds_read_b128 v[28:31], v221 offset:0
  buffer_load_dwordx4 v70, s[60:63], s54 offen offset:2048 lds
  v_mfma_f32_16x16x32_bf16 v[84:87], a[136:139], v[32:35], v[84:87]
  v_mfma_f32_16x16x32_bf16 v[116:119], a[140:143], v[32:35], v[116:119]
  ds_read_b128 v[32:35], v221 offset:2048
  s_waitcnt lgkmcnt(7)
  v_mfma_f32_16x16x32_bf16 v[88:91], a[136:139], v[36:39], v[88:91]
  v_mfma_f32_16x16x32_bf16 v[120:123], a[140:143], v[36:39], v[120:123]
  ds_read_b128 v[36:39], v222 offset:0
  buffer_load_dwordx4 v71, s[60:63], s54 offen offset:3072 lds
  v_mfma_f32_16x16x32_bf16 v[92:95], a[136:139], v[40:43], v[92:95]
  s_add_u32 s54, s54, 128
  v_mfma_f32_16x16x32_bf16 v[124:127], a[140:143], v[40:43], v[124:127]
  ds_read_b128 v[40:43], v222 offset:2048
  s_waitcnt lgkmcnt(7)
  v_mfma_f32_16x16x32_bf16 v[96:99], a[136:139], v[44:47], v[96:99]
  s_add_u32 m0, s44, 73728
  v_mfma_f32_16x16x32_bf16 v[128:131], a[140:143], v[44:47], v[128:131]
  ds_read_b128 v[44:47], v223 offset:0
  buffer_load_dwordx4 v244, s[16:19], s55 offen sc1 lds
  v_mfma_f32_16x16x32_bf16 v[100:103], a[136:139], v[48:51], v[100:103]
  s_add_u32 s55, s55, 36864
  v_mfma_f32_16x16x32_bf16 v[132:135], a[140:143], v[48:51], v[132:135]
  ds_read_b128 v[48:51], v223 offset:2048
  s_waitcnt vmcnt(30)
  s_waitcnt lgkmcnt(6)
  v_mfma_f32_16x16x32_bf16 v[72:75], a[144:147], v[20:23], v[72:75]
  v_mfma_f32_16x16x32_bf16 v[104:107], a[148:151], v[20:23], v[104:107]
  buffer_load_dwordx4 a[72:75], v240, s[16:19], s46 offen offset:0 sc1
  v_mfma_f32_16x16x32_bf16 v[136:139], v[52:55], v[20:23], v[136:139]
  ds_read_b128 v[20:23], v216 offset:16384
  v_mfma_f32_16x16x32_bf16 v[76:79], a[144:147], v[24:27], v[76:79]
  v_mfma_f32_16x16x32_bf16 v[108:111], a[148:151], v[24:27], v[108:111]
  v_mfma_f32_16x16x32_bf16 v[140:143], v[52:55], v[24:27], v[140:143]
  ds_read_b128 v[24:27], v216 offset:18432
  ds_read_b128 v[52:55], v10 offset:2048
  s_waitcnt lgkmcnt(7)
  v_mfma_f32_16x16x32_bf16 v[80:83], a[144:147], v[28:31], v[80:83]
  buffer_load_dwordx4 a[76:79], v240, s[16:19], s46 offen offset:1024 sc1
  v_mfma_f32_16x16x32_bf16 v[112:115], a[148:151], v[28:31], v[112:115]
  ds_read_b128 v[28:31], v217 offset:16384
  v_mfma_f32_16x16x32_bf16 v[84:87], a[144:147], v[32:35], v[84:87]
  v_mfma_f32_16x16x32_bf16 v[116:119], a[148:151], v[32:35], v[116:119]
  ds_read_b128 v[32:35], v217 offset:18432
  s_waitcnt lgkmcnt(7)
  v_mfma_f32_16x16x32_bf16 v[88:91], a[144:147], v[36:39], v[88:91]
  buffer_load_dwordx4 a[80:83], v241, s[16:19], s46 offen offset:0 sc1
  v_mfma_f32_16x16x32_bf16 v[120:123], a[148:151], v[36:39], v[120:123]
  ds_read_b128 v[36:39], v218 offset:16384
  v_mfma_f32_16x16x32_bf16 v[92:95], a[144:147], v[40:43], v[92:95]
  v_mfma_f32_16x16x32_bf16 v[124:127], a[148:151], v[40:43], v[124:127]
  ds_read_b128 v[40:43], v218 offset:18432
  s_waitcnt lgkmcnt(7)
  v_mfma_f32_16x16x32_bf16 v[96:99], a[144:147], v[44:47], v[96:99]
  buffer_load_dwordx4 a[84:87], v241, s[16:19], s46 offen offset:1024 sc1
  v_mfma_f32_16x16x32_bf16 v[128:131], a[148:151], v[44:47], v[128:131]
  ds_read_b128 v[44:47], v219 offset:16384
  v_mfma_f32_16x16x32_bf16 v[100:103], a[144:147], v[48:51], v[100:103]
  v_mfma_f32_16x16x32_bf16 v[132:135], a[148:151], v[48:51], v[132:135]
  ds_read_b128 v[48:51], v219 offset:18432
  s_waitcnt vmcnt(32)
  s_waitcnt lgkmcnt(6)
  v_mfma_f32_16x16x32_bf16 v[72:75], a[152:155], v[20:23], v[72:75]
  buffer_load_dwordx4 a[88:91], v242, s[16:19], s46 offen offset:0 sc1
  v_mfma_f32_16x16x32_bf16 v[104:107], a[156:159], v[20:23], v[104:107]
  v_mfma_f32_16x16x32_bf16 v[136:139], v[52:55], v[20:23], v[136:139]
  ds_read_b128 v[20:23], v220 offset:16384
  v_mfma_f32_16x16x32_bf16 v[76:79], a[152:155], v[24:27], v[76:79]
  buffer_load_dwordx4 a[92:95], v242, s[16:19], s46 offen offset:1024 sc1
  v_mfma_f32_16x16x32_bf16 v[108:111], a[156:159], v[24:27], v[108:111]
  v_mfma_f32_16x16x32_bf16 v[140:143], v[52:55], v[24:27], v[140:143]
  ds_read_b128 v[24:27], v220 offset:18432
  ds_read_b128 v[52:55], v10 offset:3072
  s_waitcnt lgkmcnt(7)
  v_mfma_f32_16x16x32_bf16 v[80:83], a[152:155], v[28:31], v[80:83]
  v_mfma_f32_16x16x32_bf16 v[112:115], a[156:159], v[28:31], v[112:115]
  ds_read_b128 v[28:31], v221 offset:16384
  buffer_load_dwordx4 a[96:99], v243, s[16:19], s46 offen offset:0 sc1
  v_mfma_f32_16x16x32_bf16 v[84:87], a[152:155], v[32:35], v[84:87]
  v_mfma_f32_16x16x32_bf16 v[116:119], a[156:159], v[32:35], v[116:119]
  ds_read_b128 v[32:35], v221 offset:18432
  s_waitcnt lgkmcnt(7)
  v_mfma_f32_16x16x32_bf16 v[88:91], a[152:155], v[36:39], v[88:91]
  v_mfma_f32_16x16x32_bf16 v[120:123], a[156:159], v[36:39], v[120:123]
  ds_read_b128 v[36:39], v222 offset:16384
  buffer_load_dwordx4 a[100:103], v243, s[16:19], s46 offen offset:1024 sc1
  v_mfma_f32_16x16x32_bf16 v[92:95], a[152:155], v[40:43], v[92:95]
  s_add_u32 s46, s46, 36864
  s_getpc_b64 s[100:101]
L_pc_14:
  s_add_u32 s100, s100, L_code_p5-L_pc_14
  s_addc_u32 s101, s101, 0
  s_sub_u32 s24, s2, 112
  s_cmp_lt_u32 s24, 16
  s_cselect_b32 s24, 128, 0
  v_mul_u32_u24 v1, s24, v0
  global_load_dword a251, v1, s[100:101]
  v_mfma_f32_16x16x32_bf16 v[124:127], a[156:159], v[40:43], v[124:127]
  ds_read_b128 v[40:43], v222 offset:18432
  s_waitcnt lgkmcnt(7)
  v_mfma_f32_16x16x32_bf16 v[96:99], a[152:155], v[44:47], v[96:99]
  v_mfma_f32_16x16x32_bf16 v[128:131], a[156:159], v[44:47], v[128:131]
  ds_read_b128 v[44:47], v223 offset:16384
  v_mfma_f32_16x16x32_bf16 v[100:103], a[152:155], v[48:51], v[100:103]
  v_mfma_f32_16x16x32_bf16 v[132:135], a[156:159], v[48:51], v[132:135]
  s_waitcnt vmcnt(26)
  s_barrier
  s_waitcnt lgkmcnt(5)
  v_mfma_f32_16x16x32_bf16 v[72:75], a[160:163], v[20:23], v[72:75]
  ds_read_b128 v[48:51], v223 offset:18432
  s_add_u32 m0, s41, 110592
  v_mfma_f32_16x16x32_bf16 v[104:107], a[164:167], v[20:23], v[104:107]
  buffer_load_dwordx4 v68, s[60:63], s54 offen offset:0 lds
  v_mfma_f32_16x16x32_bf16 v[136:139], v[52:55], v[20:23], v[136:139]
  ds_read_b128 v[20:23], v216 offset:36864
  v_mfma_f32_16x16x32_bf16 v[76:79], a[160:163], v[24:27], v[76:79]
  v_mfma_f32_16x16x32_bf16 v[108:111], a[164:167], v[24:27], v[108:111]
  v_mfma_f32_16x16x32_bf16 v[140:143], v[52:55], v[24:27], v[140:143]
  ds_read_b128 v[24:27], v216 offset:38912
  ds_read_b128 v[52:55], v10 offset:36864
  s_waitcnt lgkmcnt(7)
  v_mfma_f32_16x16x32_bf16 v[80:83], a[160:163], v[28:31], v[80:83]
  buffer_load_dwordx4 v69, s[60:63], s54 offen offset:1024 lds
  v_mfma_f32_16x16x32_bf16 v[112:115], a[164:167], v[28:31], v[112:115]
  ds_read_b128 v[28:31], v217 offset:36864
  v_mfma_f32_16x16x32_bf16 v[84:87], a[160:163], v[32:35], v[84:87]
  v_mfma_f32_16x16x32_bf16 v[116:119], a[164:167], v[32:35], v[116:119]
  ds_read_b128 v[32:35], v217 offset:38912
  s_waitcnt lgkmcnt(7)
  v_mfma_f32_16x16x32_bf16 v[88:91], a[160:163], v[36:39], v[88:91]
  buffer_load_dwordx4 v70, s[60:63], s54 offen offset:2048 lds
  v_mfma_f32_16x16x32_bf16 v[120:123], a[164:167], v[36:39], v[120:123]
  ds_read_b128 v[36:39], v218 offset:36864
  v_mfma_f32_16x16x32_bf16 v[92:95], a[160:163], v[40:43], v[92:95]
  v_mfma_f32_16x16x32_bf16 v[124:127], a[164:167], v[40:43], v[124:127]
  ds_read_b128 v[40:43], v218 offset:38912
  s_waitcnt lgkmcnt(7)
  v_mfma_f32_16x16x32_bf16 v[96:99], a[160:163], v[44:47], v[96:99]
  buffer_load_dwordx4 v71, s[60:63], s54 offen offset:3072 lds
  s_add_u32 s54, s54, 128
  v_mfma_f32_16x16x32_bf16 v[128:131], a[164:167], v[44:47], v[128:131]
  ds_read_b128 v[44:47], v219 offset:36864
  v_mfma_f32_16x16x32_bf16 v[100:103], a[160:163], v[48:51], v[100:103]
  s_add_u32 m0, s41, 126976
  v_mfma_f32_16x16x32_bf16 v[132:135], a[164:167], v[48:51], v[132:135]
  ds_read_b128 v[48:51], v219 offset:38912
  s_waitcnt vmcnt(28)
  s_waitcnt lgkmcnt(6)
  v_mfma_f32_16x16x32_bf16 v[72:75], a[168:171], v[20:23], v[72:75]
  buffer_load_dwordx4 v68, s[60:63], s54 offen offset:0 lds
  v_mfma_f32_16x16x32_bf16 v[104:107], a[172:175], v[20:23], v[104:107]
  v_mfma_f32_16x16x32_bf16 v[136:139], v[52:55], v[20:23], v[136:139]
  ds_read_b128 v[20:23], v220 offset:36864
  v_mfma_f32_16x16x32_bf16 v[76:79], a[168:171], v[24:27], v[76:79]
  buffer_load_dwordx4 v69, s[60:63], s54 offen offset:1024 lds
  v_mfma_f32_16x16x32_bf16 v[108:111], a[172:175], v[24:27], v[108:111]
  v_mfma_f32_16x16x32_bf16 v[140:143], v[52:55], v[24:27], v[140:143]
  ds_read_b128 v[24:27], v220 offset:38912
  ds_read_b128 v[52:55], v10 offset:37888
  s_waitcnt lgkmcnt(7)
  v_mfma_f32_16x16x32_bf16 v[80:83], a[168:171], v[28:31], v[80:83]
  v_mfma_f32_16x16x32_bf16 v[112:115], a[172:175], v[28:31], v[112:115]
  ds_read_b128 v[28:31], v221 offset:36864
  buffer_load_dwordx4 v70, s[60:63], s54 offen offset:2048 lds
  v_mfma_f32_16x16x32_bf16 v[84:87], a[168:171], v[32:35], v[84:87]
  v_mfma_f32_16x16x32_bf16 v[116:119], a[172:175], v[32:35], v[116:119]
  ds_read_b128 v[32:35], v221 offset:38912
  s_waitcnt lgkmcnt(7)
  v_mfma_f32_16x16x32_bf16 v[88:91], a[168:171], v[36:39], v[88:91]
  v_mfma_f32_16x16x32_bf16 v[120:123], a[172:175], v[36:39], v[120:123]
  ds_read_b128 v[36:39], v222 offset:36864
  buffer_load_dwordx4 v71, s[60:63], s54 offen offset:3072 lds
  v_mfma_f32_16x16x32_bf16 v[92:95], a[168:171], v[40:43], v[92:95]
  s_add_u32 s54, s54, 128
  v_mfma_f32_16x16x32_bf16 v[124:127], a[172:175], v[40:43], v[124:127]
  ds_read_b128 v[40:43], v222 offset:38912
  s_waitcnt lgkmcnt(7)
  v_mfma_f32_16x16x32_bf16 v[96:99], a[168:171], v[44:47], v[96:99]
  s_add_u32 m0, s44, 110592
  v_mfma_f32_16x16x32_bf16 v[128:131], a[172:175], v[44:47], v[128:131]
  ds_read_b128 v[44:47], v223 offset:36864
  buffer_load_dwordx4 v244, s[16:19], s55 offen sc1 lds
  v_mfma_f32_16x16x32_bf16 v[100:103], a[168:171], v[48:51], v[100:103]
  s_add_u32 s55, s55, 36864
  v_mfma_f32_16x16x32_bf16 v[132:135], a[172:175], v[48:51], v[132:135]
  ds_read_b128 v[48:51], v223 offset:38912
  s_waitcnt vmcnt(31)
  s_waitcnt lgkmcnt(6)
  v_mfma_f32_16x16x32_bf16 v[72:75], a[176:179], v[20:23], v[72:75]
  v_mfma_f32_16x16x32_bf16 v[104:107], a[180:183], v[20:23], v[104:107]
  buffer_load_dwordx4 a[104:107], v240, s[16:19], s46 offen offset:0 sc1
  v_mfma_f32_16x16x32_bf16 v[136:139], v[52:55], v[20:23], v[136:139]
  ds_read_b128 v[20:23], v216 offset:53248
  v_mfma_f32_16x16x32_bf16 v[76:79], a[176:179], v[24:27], v[76:79]
  v_mfma_f32_16x16x32_bf16 v[108:111], a[180:183], v[24:27], v[108:111]
  v_mfma_f32_16x16x32_bf16 v[140:143], v[52:55], v[24:27], v[140:143]
  ds_read_b128 v[24:27], v216 offset:55296
  ds_read_b128 v[52:55], v10 offset:38912
  s_waitcnt lgkmcnt(7)
  v_mfma_f32_16x16x32_bf16 v[80:83], a[176:179], v[28:31], v[80:83]
  buffer_load_dwordx4 a[108:111], v240, s[16:19], s46 offen offset:1024 sc1
  v_mfma_f32_16x16x32_bf16 v[112:115], a[180:183], v[28:31], v[112:115]
  ds_read_b128 v[28:31], v217 offset:53248
  v_mfma_f32_16x16x32_bf16 v[84:87], a[176:179], v[32:35], v[84:87]
  v_mfma_f32_16x16x32_bf16 v[116:119], a[180:183], v[32:35], v[116:119]
  ds_read_b128 v[32:35], v217 offset:55296
  s_waitcnt lgkmcnt(7)
  v_mfma_f32_16x16x32_bf16 v[88:91], a[176:179], v[36:39], v[88:91]
  buffer_load_dwordx4 a[112:115], v241, s[16:19], s46 offen offset:0 sc1
  v_mfma_f32_16x16x32_bf16 v[120:123], a[180:183], v[36:39], v[120:123]
  ds_read_b128 v[36:39], v218 offset:53248
  v_mfma_f32_16x16x32_bf16 v[92:95], a[176:179], v[40:43], v[92:95]
  v_mfma_f32_16x16x32_bf16 v[124:127], a[180:183], v[40:43], v[124:127]
  ds_read_b128 v[40:43], v218 offset:55296
  s_waitcnt lgkmcnt(7)
  v_mfma_f32_16x16x32_bf16 v[96:99], a[176:179], v[44:47], v[96:99]
  buffer_load_dwordx4 a[116:119], v241, s[16:19], s46 offen offset:1024 sc1
  v_mfma_f32_16x16x32_bf16 v[128:131], a[180:183], v[44:47], v[128:131]
  ds_read_b128 v[44:47], v219 offset:53248
  v_mfma_f32_16x16x32_bf16 v[100:103], a[176:179], v[48:51], v[100:103]
  v_mfma_f32_16x16x32_bf16 v[132:135], a[180:183], v[48:51], v[132:135]
  ds_read_b128 v[48:51], v219 offset:55296
  s_waitcnt vmcnt(33)
  s_waitcnt lgkmcnt(6)
  v_mfma_f32_16x16x32_bf16 v[72:75], a[184:187], v[20:23], v[72:75]
  buffer_load_dwordx4 a[120:123], v242, s[16:19], s46 offen offset:0 sc1
  v_mfma_f32_16x16x32_bf16 v[104:107], a[188:191], v[20:23], v[104:107]
  v_mfma_f32_16x16x32_bf16 v[136:139], v[52:55], v[20:23], v[136:139]
  ds_read_b128 v[20:23], v220 offset:53248
  v_mfma_f32_16x16x32_bf16 v[76:79], a[184:187], v[24:27], v[76:79]
  buffer_load_dwordx4 a[124:127], v242, s[16:19], s46 offen offset:1024 sc1
  v_mfma_f32_16x16x32_bf16 v[108:111], a[188:191], v[24:27], v[108:111]
  v_mfma_f32_16x16x32_bf16 v[140:143], v[52:55], v[24:27], v[140:143]
  ds_read_b128 v[24:27], v220 offset:55296
  ds_read_b128 v[52:55], v10 offset:39936
  s_waitcnt lgkmcnt(7)
  v_mfma_f32_16x16x32_bf16 v[80:83], a[184:187], v[28:31], v[80:83]
  v_mfma_f32_16x16x32_bf16 v[112:115], a[188:191], v[28:31], v[112:115]
  ds_read_b128 v[28:31], v221 offset:53248
  buffer_load_dwordx4 a[128:131], v243, s[16:19], s46 offen offset:0 sc1
  v_mfma_f32_16x16x32_bf16 v[84:87], a[184:187], v[32:35], v[84:87]
  v_mfma_f32_16x16x32_bf16 v[116:119], a[188:191], v[32:35], v[116:119]
  ds_read_b128 v[32:35], v221 offset:55296
  s_waitcnt lgkmcnt(7)
  v_mfma_f32_16x16x32_bf16 v[88:91], a[184:187], v[36:39], v[88:91]
  v_mfma_f32_16x16x32_bf16 v[120:123], a[188:191], v[36:39], v[120:123]
  ds_read_b128 v[36:39], v222 offset:53248
  buffer_load_dwordx4 a[132:135], v243, s[16:19], s46 offen offset:1024 sc1
  v_mfma_f32_16x16x32_bf16 v[92:95], a[184:187], v[40:43], v[92:95]
  s_add_u32 s46, s46, 36864
  v_mfma_f32_16x16x32_bf16 v[124:127], a[188:191], v[40:43], v[124:127]
  ds_read_b128 v[40:43], v222 offset:55296
  s_waitcnt lgkmcnt(7)
  v_mfma_f32_16x16x32_bf16 v[96:99], a[184:187], v[44:47], v[96:99]
  v_mfma_f32_16x16x32_bf16 v[128:131], a[188:191], v[44:47], v[128:131]
  ds_read_b128 v[44:47], v223 offset:53248
  v_mfma_f32_16x16x32_bf16 v[100:103], a[184:187], v[48:51], v[100:103]
  v_mfma_f32_16x16x32_bf16 v[132:135], a[188:191], v[48:51], v[132:135]
  s_waitcnt vmcnt(26)
  s_barrier
  s_waitcnt lgkmcnt(5)
  v_mfma_f32_16x16x32_bf16 v[72:75], a[192:195], v[20:23], v[72:75]
  ds_read_b128 v[48:51], v223 offset:55296
  s_add_u32 m0, s41, 0
  v_mfma_f32_16x16x32_bf16 v[104:107], a[196:199], v[20:23], v[104:107]
  buffer_load_dwordx4 v68, s[60:63], s54 offen offset:0 lds
  v_mfma_f32_16x16x32_bf16 v[136:139], v[52:55], v[20:23], v[136:139]
  ds_read_b128 v[20:23], v224 offset:0
  v_mfma_f32_16x16x32_bf16 v[76:79], a[192:195], v[24:27], v[76:79]
  v_mfma_f32_16x16x32_bf16 v[108:111], a[196:199], v[24:27], v[108:111]
  v_mfma_f32_16x16x32_bf16 v[140:143], v[52:55], v[24:27], v[140:143]
  ds_read_b128 v[24:27], v224 offset:2048
  ds_read_b128 v[52:55], v11 offset:0
  s_waitcnt lgkmcnt(7)
  v_mfma_f32_16x16x32_bf16 v[80:83], a[192:195], v[28:31], v[80:83]
  buffer_load_dwordx4 v69, s[60:63], s54 offen offset:1024 lds
  v_mfma_f32_16x16x32_bf16 v[112:115], a[196:199], v[28:31], v[112:115]
  ds_read_b128 v[28:31], v225 offset:0
  v_mfma_f32_16x16x32_bf16 v[84:87], a[192:195], v[32:35], v[84:87]
  v_mfma_f32_16x16x32_bf16 v[116:119], a[196:199], v[32:35], v[116:119]
  ds_read_b128 v[32:35], v225 offset:2048
  s_waitcnt lgkmcnt(7)
  v_mfma_f32_16x16x32_bf16 v[88:91], a[192:195], v[36:39], v[88:91]
  buffer_load_dwordx4 v70, s[60:63], s54 offen offset:2048 lds
  v_mfma_f32_16x16x32_bf16 v[120:123], a[196:199], v[36:39], v[120:123]
  ds_read_b128 v[36:39], v226 offset:0
  v_mfma_f32_16x16x32_bf16 v[92:95], a[192:195], v[40:43], v[92:95]
  v_mfma_f32_16x16x32_bf16 v[124:127], a[196:199], v[40:43], v[124:127]
  ds_read_b128 v[40:43], v226 offset:2048
  s_waitcnt lgkmcnt(7)
  v_mfma_f32_16x16x32_bf16 v[96:99], a[192:195], v[44:47], v[96:99]
  buffer_load_dwordx4 v71, s[60:63], s54 offen offset:3072 lds
  s_add_u32 s54, s54, 128
  v_mfma_f32_16x16x32_bf16 v[128:131], a[196:199], v[44:47], v[128:131]
  ds_read_b128 v[44:47], v227 offset:0
  v_mfma_f32_16x16x32_bf16 v[100:103], a[192:195], v[48:51], v[100:103]
  s_add_u32 m0, s41, 16384
  v_mfma_f32_16x16x32_bf16 v[132:135], a[196:199], v[48:51], v[132:135]
  ds_read_b128 v[48:51], v227 offset:2048
  s_waitcnt vmcnt(28)
  s_waitcnt lgkmcnt(6)
  v_mfma_f32_16x16x32_bf16 v[72:75], a[72:75], v[20:23], v[72:75]
  buffer_load_dwordx4 v68, s[60:63], s54 offen offset:0 lds
  v_mfma_f32_16x16x32_bf16 v[104:107], a[76:79], v[20:23], v[104:107]
  v_mfma_f32_16x16x32_bf16 v[136:139], v[52:55], v[20:23], v[136:139]
  ds_read_b128 v[20:23], v228 offset:0
  v_mfma_f32_16x16x32_bf16 v[76:79], a[72:75], v[24:27], v[76:79]
  buffer_load_dwordx4 v69, s[60:63], s54 offen offset:1024 lds
  v_mfma_f32_16x16x32_bf16 v[108:111], a[76:79], v[24:27], v[108:111]
  v_mfma_f32_16x16x32_bf16 v[140:143], v[52:55], v[24:27], v[140:143]
  ds_read_b128 v[24:27], v228 offset:2048
  ds_read_b128 v[52:55], v11 offset:1024
  s_waitcnt lgkmcnt(7)
  v_mfma_f32_16x16x32_bf16 v[80:83], a[72:75], v[28:31], v[80:83]
  v_mfma_f32_16x16x32_bf16 v[112:115], a[76:79], v[28:31], v[112:115]
  ds_read_b128 v[28:31], v229 offset:0
  buffer_load_dwordx4 v70, s[60:63], s54 offen offset:2048 lds
  v_mfma_f32_16x16x32_bf16 v[84:87], a[72:75], v[32:35], v[84:87]
  v_mfma_f32_16x16x32_bf16 v[116:119], a[76:79], v[32:35], v[116:119]
  ds_read_b128 v[32:35], v229 offset:2048
  s_waitcnt lgkmcnt(7)
  v_mfma_f32_16x16x32_bf16 v[88:91], a[72:75], v[36:39], v[88:91]
  v_mfma_f32_16x16x32_bf16 v[120:123], a[76:79], v[36:39], v[120:123]
  ds_read_b128 v[36:39], v230 offset:0
  buffer_load_dwordx4 v71, s[60:63], s54 offen offset:3072 lds
  v_mfma_f32_16x16x32_bf16 v[92:95], a[72:75], v[40:43], v[92:95]
  s_add_u32 s54, s54, 128
  v_mfma_f32_16x16x32_bf16 v[124:127], a[76:79], v[40:43], v[124:127]
  ds_read_b128 v[40:43], v230 offset:2048
  s_waitcnt lgkmcnt(7)
  v_mfma_f32_16x16x32_bf16 v[96:99], a[72:75], v[44:47], v[96:99]
  s_add_u32 m0, s44, 0
  v_mfma_f32_16x16x32_bf16 v[128:131], a[76:79], v[44:47], v[128:131]
  ds_read_b128 v[44:47], v231 offset:0
  buffer_load_dwordx4 v244, s[16:19], s55 offen sc1 lds
  v_mfma_f32_16x16x32_bf16 v[100:103], a[72:75], v[48:51], v[100:103]
  s_add_u32 s55, s55, 36864
  v_mfma_f32_16x16x32_bf16 v[132:135], a[76:79], v[48:51], v[132:135]
  ds_read_b128 v[48:51], v231 offset:2048
  s_waitcnt vmcnt(31)
  s_waitcnt lgkmcnt(6)
  v_mfma_f32_16x16x32_bf16 v[72:75], a[80:83], v[20:23], v[72:75]
  v_mfma_f32_16x16x32_bf16 v[104:107], a[84:87], v[20:23], v[104:107]
  buffer_load_dwordx4 a[136:139], v240, s[16:19], s46 offen offset:0 sc1
  v_mfma_f32_16x16x32_bf16 v[136:139], v[52:55], v[20:23], v[136:139]
  ds_read_b128 v[20:23], v224 offset:16384
  v_mfma_f32_16x16x32_bf16 v[76:79], a[80:83], v[24:27], v[76:79]
  v_mfma_f32_16x16x32_bf16 v[108:111], a[84:87], v[24:27], v[108:111]
  v_mfma_f32_16x16x32_bf16 v[140:143], v[52:55], v[24:27], v[140:143]
  ds_read_b128 v[24:27], v224 offset:18432
  ds_read_b128 v[52:55], v11 offset:2048
  s_waitcnt lgkmcnt(7)
  v_mfma_f32_16x16x32_bf16 v[80:83], a[80:83], v[28:31], v[80:83]
  buffer_load_dwordx4 a[140:143], v240, s[16:19], s46 offen offset:1024 sc1
  v_mfma_f32_16x16x32_bf16 v[112:115], a[84:87], v[28:31], v[112:115]
  ds_read_b128 v[28:31], v225 offset:16384
  v_mfma_f32_16x16x32_bf16 v[84:87], a[80:83], v[32:35], v[84:87]
  v_mfma_f32_16x16x32_bf16 v[116:119], a[84:87], v[32:35], v[116:119]
  ds_read_b128 v[32:35], v225 offset:18432
  s_waitcnt lgkmcnt(7)
  v_mfma_f32_16x16x32_bf16 v[88:91], a[80:83], v[36:39], v[88:91]
  buffer_load_dwordx4 a[144:147], v241, s[16:19], s46 offen offset:0 sc1
  v_mfma_f32_16x16x32_bf16 v[120:123], a[84:87], v[36:39], v[120:123]
  ds_read_b128 v[36:39], v226 offset:16384
  v_mfma_f32_16x16x32_bf16 v[92:95], a[80:83], v[40:43], v[92:95]
  v_mfma_f32_16x16x32_bf16 v[124:127], a[84:87], v[40:43], v[124:127]
  ds_read_b128 v[40:43], v226 offset:18432
  s_waitcnt lgkmcnt(7)
  v_mfma_f32_16x16x32_bf16 v[96:99], a[80:83], v[44:47], v[96:99]
  buffer_load_dwordx4 a[148:151], v241, s[16:19], s46 offen offset:1024 sc1
  v_mfma_f32_16x16x32_bf16 v[128:131], a[84:87], v[44:47], v[128:131]
  ds_read_b128 v[44:47], v227 offset:16384
  v_mfma_f32_16x16x32_bf16 v[100:103], a[80:83], v[48:51], v[100:103]
  v_mfma_f32_16x16x32_bf16 v[132:135], a[84:87], v[48:51], v[132:135]
  ds_read_b128 v[48:51], v227 offset:18432
  s_waitcnt vmcnt(33)
  s_waitcnt lgkmcnt(6)
  v_mfma_f32_16x16x32_bf16 v[72:75], a[88:91], v[20:23], v[72:75]
  buffer_load_dwordx4 a[152:155], v242, s[16:19], s46 offen offset:0 sc1
  v_mfma_f32_16x16x32_bf16 v[104:107], a[92:95], v[20:23], v[104:107]
  v_mfma_f32_16x16x32_bf16 v[136:139], v[52:55], v[20:23], v[136:139]
  ds_read_b128 v[20:23], v228 offset:16384
  v_mfma_f32_16x16x32_bf16 v[76:79], a[88:91], v[24:27], v[76:79]
  buffer_load_dwordx4 a[156:159], v242, s[16:19], s46 offen offset:1024 sc1
  v_mfma_f32_16x16x32_bf16 v[108:111], a[92:95], v[24:27], v[108:111]
  v_mfma_f32_16x16x32_bf16 v[140:143], v[52:55], v[24:27], v[140:143]
  ds_read_b128 v[24:27], v228 offset:18432
  ds_read_b128 v[52:55], v11 offset:3072
  s_waitcnt lgkmcnt(7)
  v_mfma_f32_16x16x32_bf16 v[80:83], a[88:91], v[28:31], v[80:83]
  v_mfma_f32_16x16x32_bf16 v[112:115], a[92:95], v[28:31], v[112:115]
  ds_read_b128 v[28:31], v229 offset:16384
  buffer_load_dwordx4 a[160:163], v243, s[16:19], s46 offen offset:0 sc1
  v_mfma_f32_16x16x32_bf16 v[84:87], a[88:91], v[32:35], v[84:87]
  v_mfma_f32_16x16x32_bf16 v[116:119], a[92:95], v[32:35], v[116:119]
  ds_read_b128 v[32:35], v229 offset:18432
  s_waitcnt lgkmcnt(7)
  v_mfma_f32_16x16x32_bf16 v[88:91], a[88:91], v[36:39], v[88:91]
  v_mfma_f32_16x16x32_bf16 v[120:123], a[92:95], v[36:39], v[120:123]
  ds_read_b128 v[36:39], v230 offset:16384
  buffer_load_dwordx4 a[164:167], v243, s[16:19], s46 offen offset:1024 sc1
  v_mfma_f32_16x16x32_bf16 v[92:95], a[88:91], v[40:43], v[92:95]
  s_add_u32 s46, s46, 36864
  v_mfma_f32_16x16x32_bf16 v[124:127], a[92:95], v[40:43], v[124:127]
  ds_read_b128 v[40:43], v230 offset:18432
  s_waitcnt lgkmcnt(7)
  v_mfma_f32_16x16x32_bf16 v[96:99], a[88:91], v[44:47], v[96:99]
  v_mfma_f32_16x16x32_bf16 v[128:131], a[92:95], v[44:47], v[128:131]
  ds_read_b128 v[44:47], v231 offset:16384
  v_mfma_f32_16x16x32_bf16 v[100:103], a[88:91], v[48:51], v[100:103]
  v_mfma_f32_16x16x32_bf16 v[132:135], a[92:95], v[48:51], v[132:135]
  s_waitcnt vmcnt(25)
  s_barrier
  s_waitcnt lgkmcnt(5)
  v_mfma_f32_16x16x32_bf16 v[72:75], a[96:99], v[20:23], v[72:75]
  ds_read_b128 v[48:51], v231 offset:18432
  s_add_u32 m0, s41, 36864
  v_mfma_f32_16x16x32_bf16 v[104:107], a[100:103], v[20:23], v[104:107]
  buffer_load_dwordx4 v68, s[60:63], s54 offen offset:0 lds
  v_mfma_f32_16x16x32_bf16 v[136:139], v[52:55], v[20:23], v[136:139]
  ds_read_b128 v[20:23], v224 offset:36864
  v_mfma_f32_16x16x32_bf16 v[76:79], a[96:99], v[24:27], v[76:79]
  v_mfma_f32_16x16x32_bf16 v[108:111], a[100:103], v[24:27], v[108:111]
  v_mfma_f32_16x16x32_bf16 v[140:143], v[52:55], v[24:27], v[140:143]
  ds_read_b128 v[24:27], v224 offset:38912
  ds_read_b128 v[52:55], v11 offset:36864
  s_waitcnt lgkmcnt(7)
  v_mfma_f32_16x16x32_bf16 v[80:83], a[96:99], v[28:31], v[80:83]
  buffer_load_dwordx4 v69, s[60:63], s54 offen offset:1024 lds
  v_mfma_f32_16x16x32_bf16 v[112:115], a[100:103], v[28:31], v[112:115]
  ds_read_b128 v[28:31], v225 offset:36864
  v_mfma_f32_16x16x32_bf16 v[84:87], a[96:99], v[32:35], v[84:87]
  v_mfma_f32_16x16x32_bf16 v[116:119], a[100:103], v[32:35], v[116:119]
  ds_read_b128 v[32:35], v225 offset:38912
  s_waitcnt lgkmcnt(7)
  v_mfma_f32_16x16x32_bf16 v[88:91], a[96:99], v[36:39], v[88:91]
  buffer_load_dwordx4 v70, s[60:63], s54 offen offset:2048 lds
  v_mfma_f32_16x16x32_bf16 v[120:123], a[100:103], v[36:39], v[120:123]
  ds_read_b128 v[36:39], v226 offset:36864
  v_mfma_f32_16x16x32_bf16 v[92:95], a[96:99], v[40:43], v[92:95]
  v_mfma_f32_16x16x32_bf16 v[124:127], a[100:103], v[40:43], v[124:127]
  ds_read_b128 v[40:43], v226 offset:38912
  s_waitcnt lgkmcnt(7)
  v_mfma_f32_16x16x32_bf16 v[96:99], a[96:99], v[44:47], v[96:99]
  buffer_load_dwordx4 v71, s[60:63], s54 offen offset:3072 lds
  s_add_u32 s54, s54, 128
  v_mfma_f32_16x16x32_bf16 v[128:131], a[100:103], v[44:47], v[128:131]
  ds_read_b128 v[44:47], v227 offset:36864
  v_mfma_f32_16x16x32_bf16 v[100:103], a[96:99], v[48:51], v[100:103]
  s_add_u32 m0, s41, 53248
  v_mfma_f32_16x16x32_bf16 v[132:135], a[100:103], v[48:51], v[132:135]
  ds_read_b128 v[48:51], v227 offset:38912
  s_waitcnt vmcnt(27)
  s_waitcnt lgkmcnt(6)
  v_mfma_f32_16x16x32_bf16 v[72:75], a[104:107], v[20:23], v[72:75]
  buffer_load_dwordx4 v68, s[60:63], s54 offen offset:0 lds
  v_mfma_f32_16x16x32_bf16 v[104:107], a[108:111], v[20:23], v[104:107]
  v_mfma_f32_16x16x32_bf16 v[136:139], v[52:55], v[20:23], v[136:139]
  ds_read_b128 v[20:23], v228 offset:36864
  v_mfma_f32_16x16x32_bf16 v[76:79], a[104:107], v[24:27], v[76:79]
  buffer_load_dwordx4 v69, s[60:63], s54 offen offset:1024 lds
  v_mfma_f32_16x16x32_bf16 v[108:111], a[108:111], v[24:27], v[108:111]
  v_mfma_f32_16x16x32_bf16 v[140:143], v[52:55], v[24:27], v[140:143]
  ds_read_b128 v[24:27], v228 offset:38912
  ds_read_b128 v[52:55], v11 offset:37888
  s_waitcnt lgkmcnt(7)
  v_mfma_f32_16x16x32_bf16 v[80:83], a[104:107], v[28:31], v[80:83]
  v_mfma_f32_16x16x32_bf16 v[112:115], a[108:111], v[28:31], v[112:115]
  ds_read_b128 v[28:31], v229 offset:36864
  buffer_load_dwordx4 v70, s[60:63], s54 offen offset:2048 lds
  v_mfma_f32_16x16x32_bf16 v[84:87], a[104:107], v[32:35], v[84:87]
  v_mfma_f32_16x16x32_bf16 v[116:119], a[108:111], v[32:35], v[116:119]
  ds_read_b128 v[32:35], v229 offset:38912
  s_waitcnt lgkmcnt(7)
  v_mfma_f32_16x16x32_bf16 v[88:91], a[104:107], v[36:39], v[88:91]
  v_mfma_f32_16x16x32_bf16 v[120:123], a[108:111], v[36:39], v[120:123]
  ds_read_b128 v[36:39], v230 offset:36864
  buffer_load_dwordx4 v71, s[60:63], s54 offen offset:3072 lds
  v_mfma_f32_16x16x32_bf16 v[92:95], a[104:107], v[40:43], v[92:95]
  s_add_u32 s54, s54, 128
  v_mfma_f32_16x16x32_bf16 v[124:127], a[108:111], v[40:43], v[124:127]
  ds_read_b128 v[40:43], v230 offset:38912
  s_waitcnt lgkmcnt(7)
  v_mfma_f32_16x16x32_bf16 v[96:99], a[104:107], v[44:47], v[96:99]
  s_add_u32 m0, s44, 36864
  v_mfma_f32_16x16x32_bf16 v[128:131], a[108:111], v[44:47], v[128:131]
  ds_read_b128 v[44:47], v231 offset:36864
  buffer_load_dwordx4 v244, s[16:19], s55 offen sc1 lds
  v_mfma_f32_16x16x32_bf16 v[100:103], a[104:107], v[48:51], v[100:103]
  s_add_u32 s55, s55, 36864
  v_mfma_f32_16x16x32_bf16 v[132:135], a[108:111], v[48:51], v[132:135]
  ds_read_b128 v[48:51], v231 offset:38912
  s_waitcnt vmcnt(30)
  s_waitcnt lgkmcnt(6)
  v_mfma_f32_16x16x32_bf16 v[72:75], a[112:115], v[20:23], v[72:75]
  v_mfma_f32_16x16x32_bf16 v[104:107], a[116:119], v[20:23], v[104:107]
  buffer_load_dwordx4 a[168:171], v240, s[16:19], s46 offen offset:0 sc1
  v_mfma_f32_16x16x32_bf16 v[136:139], v[52:55], v[20:23], v[136:139]
  ds_read_b128 v[20:23], v224 offset:53248
  v_mfma_f32_16x16x32_bf16 v[76:79], a[112:115], v[24:27], v[76:79]
  v_mfma_f32_16x16x32_bf16 v[108:111], a[116:119], v[24:27], v[108:111]
  v_mfma_f32_16x16x32_bf16 v[140:143], v[52:55], v[24:27], v[140:143]
  ds_read_b128 v[24:27], v224 offset:55296
  ds_read_b128 v[52:55], v11 offset:38912
  s_waitcnt lgkmcnt(7)
  v_mfma_f32_16x16x32_bf16 v[80:83], a[112:115], v[28:31], v[80:83]
  buffer_load_dwordx4 a[172:175], v240, s[16:19], s46 offen offset:1024 sc1
  v_mfma_f32_16x16x32_bf16 v[112:115], a[116:119], v[28:31], v[112:115]
  ds_read_b128 v[28:31], v225 offset:53248
  v_mfma_f32_16x16x32_bf16 v[84:87], a[112:115], v[32:35], v[84:87]
  v_mfma_f32_16x16x32_bf16 v[116:119], a[116:119], v[32:35], v[116:119]
  ds_read_b128 v[32:35], v225 offset:55296
  s_waitcnt lgkmcnt(7)
  v_mfma_f32_16x16x32_bf16 v[88:91], a[112:115], v[36:39], v[88:91]
  buffer_load_dwordx4 a[176:179], v241, s[16:19], s46 offen offset:0 sc1
  v_mfma_f32_16x16x32_bf16 v[120:123], a[116:119], v[36:39], v[120:123]
  ds_read_b128 v[36:39], v226 offset:53248
  v_mfma_f32_16x16x32_bf16 v[92:95], a[112:115], v[40:43], v[92:95]
  v_mfma_f32_16x16x32_bf16 v[124:127], a[116:119], v[40:43], v[124:127]
  ds_read_b128 v[40:43], v226 offset:55296
  s_waitcnt lgkmcnt(7)
  v_mfma_f32_16x16x32_bf16 v[96:99], a[112:115], v[44:47], v[96:99]
  buffer_load_dwordx4 a[180:183], v241, s[16:19], s46 offen offset:1024 sc1
  v_mfma_f32_16x16x32_bf16 v[128:131], a[116:119], v[44:47], v[128:131]
  ds_read_b128 v[44:47], v227 offset:53248
  v_mfma_f32_16x16x32_bf16 v[100:103], a[112:115], v[48:51], v[100:103]
  v_mfma_f32_16x16x32_bf16 v[132:135], a[116:119], v[48:51], v[132:135]
  ds_read_b128 v[48:51], v227 offset:55296
  s_waitcnt vmcnt(32)
  s_waitcnt lgkmcnt(6)
  v_mfma_f32_16x16x32_bf16 v[72:75], a[120:123], v[20:23], v[72:75]
  buffer_load_dwordx4 a[184:187], v242, s[16:19], s46 offen offset:0 sc1
  v_mfma_f32_16x16x32_bf16 v[104:107], a[124:127], v[20:23], v[104:107]
  v_mfma_f32_16x16x32_bf16 v[136:139], v[52:55], v[20:23], v[136:139]
  ds_read_b128 v[20:23], v228 offset:53248
  v_mfma_f32_16x16x32_bf16 v[76:79], a[120:123], v[24:27], v[76:79]
  buffer_load_dwordx4 a[188:191], v242, s[16:19], s46 offen offset:1024 sc1
  v_mfma_f32_16x16x32_bf16 v[108:111], a[124:127], v[24:27], v[108:111]
  v_mfma_f32_16x16x32_bf16 v[140:143], v[52:55], v[24:27], v[140:143]
  ds_read_b128 v[24:27], v228 offset:55296
  ds_read_b128 v[52:55], v11 offset:39936
  s_waitcnt lgkmcnt(7)
  v_mfma_f32_16x16x32_bf16 v[80:83], a[120:123], v[28:31], v[80:83]
  v_mfma_f32_16x16x32_bf16 v[112:115], a[124:127], v[28:31], v[112:115]
  ds_read_b128 v[28:31], v229 offset:53248
  buffer_load_dwordx4 a[192:195], v243, s[16:19], s46 offen offset:0 sc1
  v_mfma_f32_16x16x32_bf16 v[84:87], a[120:123], v[32:35], v[84:87]
  v_mfma_f32_16x16x32_bf16 v[116:119], a[124:127], v[32:35], v[116:119]
  ds_read_b128 v[32:35], v229 offset:55296
  s_waitcnt lgkmcnt(7)
  v_mfma_f32_16x16x32_bf16 v[88:91], a[120:123], v[36:39], v[88:91]
  v_mfma_f32_16x16x32_bf16 v[120:123], a[124:127], v[36:39], v[120:123]
  ds_read_b128 v[36:39], v230 offset:53248
  buffer_load_dwordx4 a[196:199], v243, s[16:19], s46 offen offset:1024 sc1
  v_mfma_f32_16x16x32_bf16 v[92:95], a[120:123], v[40:43], v[92:95]
  s_add_u32 s46, s46, 36864
  v_mfma_f32_16x16x32_bf16 v[124:127], a[124:127], v[40:43], v[124:127]
  ds_read_b128 v[40:43], v230 offset:55296
  s_waitcnt lgkmcnt(7)
  v_mfma_f32_16x16x32_bf16 v[96:99], a[120:123], v[44:47], v[96:99]
  v_mfma_f32_16x16x32_bf16 v[128:131], a[124:127], v[44:47], v[128:131]
  ds_read_b128 v[44:47], v231 offset:53248
  v_mfma_f32_16x16x32_bf16 v[100:103], a[120:123], v[48:51], v[100:103]
  v_mfma_f32_16x16x32_bf16 v[132:135], a[124:127], v[48:51], v[132:135]
  s_waitcnt vmcnt(25)
  s_barrier
  s_waitcnt lgkmcnt(5)
  v_mfma_f32_16x16x32_bf16 v[72:75], a[128:131], v[20:23], v[72:75]
  ds_read_b128 v[48:51], v231 offset:55296
  s_add_u32 m0, s41, 73728
  v_mfma_f32_16x16x32_bf16 v[104:107], a[132:135], v[20:23], v[104:107]
  buffer_load_dwordx4 v68, s[60:63], s54 offen offset:0 lds
  v_mfma_f32_16x16x32_bf16 v[136:139], v[52:55], v[20:23], v[136:139]
  ds_read_b128 v[20:23], v216 offset:0
  v_mfma_f32_16x16x32_bf16 v[76:79], a[128:131], v[24:27], v[76:79]
  v_mfma_f32_16x16x32_bf16 v[108:111], a[132:135], v[24:27], v[108:111]
  v_mfma_f32_16x16x32_bf16 v[140:143], v[52:55], v[24:27], v[140:143]
  ds_read_b128 v[24:27], v216 offset:2048
  ds_read_b128 v[52:55], v10 offset:0
  s_waitcnt lgkmcnt(7)
  v_mfma_f32_16x16x32_bf16 v[80:83], a[128:131], v[28:31], v[80:83]
  buffer_load_dwordx4 v69, s[60:63], s54 offen offset:1024 lds
  v_mfma_f32_16x16x32_bf16 v[112:115], a[132:135], v[28:31], v[112:115]
  ds_read_b128 v[28:31], v217 offset:0
  v_mfma_f32_16x16x32_bf16 v[84:87], a[128:131], v[32:35], v[84:87]
  v_mfma_f32_16x16x32_bf16 v[116:119], a[132:135], v[32:35], v[116:119]
  ds_read_b128 v[32:35], v217 offset:2048
  s_waitcnt lgkmcnt(7)
  v_mfma_f32_16x16x32_bf16 v[88:91], a[128:131], v[36:39], v[88:91]
  buffer_load_dwordx4 v70, s[60:63], s54 offen offset:2048 lds
  v_mfma_f32_16x16x32_bf16 v[120:123], a[132:135], v[36:39], v[120:123]
  ds_read_b128 v[36:39], v218 offset:0
  v_mfma_f32_16x16x32_bf16 v[92:95], a[128:131], v[40:43], v[92:95]
  v_mfma_f32_16x16x32_bf16 v[124:127], a[132:135], v[40:43], v[124:127]
  ds_read_b128 v[40:43], v218 offset:2048
  s_waitcnt lgkmcnt(7)
  v_mfma_f32_16x16x32_bf16 v[96:99], a[128:131], v[44:47], v[96:99]
  buffer_load_dwordx4 v71, s[60:63], s54 offen offset:3072 lds
  s_add_u32 s54, s54, 128
  v_mfma_f32_16x16x32_bf16 v[128:131], a[132:135], v[44:47], v[128:131]
  ds_read_b128 v[44:47], v219 offset:0
  v_mfma_f32_16x16x32_bf16 v[100:103], a[128:131], v[48:51], v[100:103]
  s_add_u32 m0, s41, 90112
  v_mfma_f32_16x16x32_bf16 v[132:135], a[132:135], v[48:51], v[132:135]
  ds_read_b128 v[48:51], v219 offset:2048
  s_waitcnt vmcnt(27)
  s_waitcnt lgkmcnt(6)
  v_mfma_f32_16x16x32_bf16 v[72:75], a[136:139], v[20:23], v[72:75]
  buffer_load_dwordx4 v68, s[60:63], s54 offen offset:0 lds
  v_mfma_f32_16x16x32_bf16 v[104:107], a[140:143], v[20:23], v[104:107]
  v_mfma_f32_16x16x32_bf16 v[136:139], v[52:55], v[20:23], v[136:139]
  ds_read_b128 v[20:23], v220 offset:0
  v_mfma_f32_16x16x32_bf16 v[76:79], a[136:139], v[24:27], v[76:79]
  buffer_load_dwordx4 v69, s[60:63], s54 offen offset:1024 lds
  v_mfma_f32_16x16x32_bf16 v[108:111], a[140:143], v[24:27], v[108:111]
  v_mfma_f32_16x16x32_bf16 v[140:143], v[52:55], v[24:27], v[140:143]
  ds_read_b128 v[24:27], v220 offset:2048
  ds_read_b128 v[52:55], v10 offset:1024
  s_waitcnt lgkmcnt(7)
  v_mfma_f32_16x16x32_bf16 v[80:83], a[136:139], v[28:31], v[80:83]
  v_mfma_f32_16x16x32_bf16 v[112:115], a[140:143], v[28:31], v[112:115]
  ds_read_b128 v[28:31], v221 offset:0
  buffer_load_dwordx4 v70, s[60:63], s54 offen offset:2048 lds
  v_mfma_f32_16x16x32_bf16 v[84:87], a[136:139], v[32:35], v[84:87]
  v_mfma_f32_16x16x32_bf16 v[116:119], a[140:143], v[32:35], v[116:119]
  ds_read_b128 v[32:35], v221 offset:2048
  s_waitcnt lgkmcnt(7)
  v_mfma_f32_16x16x32_bf16 v[88:91], a[136:139], v[36:39], v[88:91]
  v_mfma_f32_16x16x32_bf16 v[120:123], a[140:143], v[36:39], v[120:123]
  ds_read_b128 v[36:39], v222 offset:0
  buffer_load_dwordx4 v71, s[60:63], s54 offen offset:3072 lds
  v_mfma_f32_16x16x32_bf16 v[92:95], a[136:139], v[40:43], v[92:95]
  s_add_u32 s54, s54, 128
  v_mfma_f32_16x16x32_bf16 v[124:127], a[140:143], v[40:43], v[124:127]
  ds_read_b128 v[40:43], v222 offset:2048
  s_waitcnt lgkmcnt(7)
  v_mfma_f32_16x16x32_bf16 v[96:99], a[136:139], v[44:47], v[96:99]
  s_add_u32 m0, s44, 73728
  v_mfma_f32_16x16x32_bf16 v[128:131], a[140:143], v[44:47], v[128:131]
  ds_read_b128 v[44:47], v223 offset:0
  buffer_load_dwordx4 v244, s[16:19], s55 offen sc1 lds
  v_mfma_f32_16x16x32_bf16 v[100:103], a[136:139], v[48:51], v[100:103]
  s_add_u32 s55, s55, 36864
  v_mfma_f32_16x16x32_bf16 v[132:135], a[140:143], v[48:51], v[132:135]
  ds_read_b128 v[48:51], v223 offset:2048
  s_waitcnt vmcnt(30)
  s_waitcnt lgkmcnt(6)
  v_mfma_f32_16x16x32_bf16 v[72:75], a[144:147], v[20:23], v[72:75]
  v_mfma_f32_16x16x32_bf16 v[104:107], a[148:151], v[20:23], v[104:107]
  buffer_load_dwordx4 a[72:75], v240, s[16:19], s46 offen offset:0 sc1
  v_mfma_f32_16x16x32_bf16 v[136:139], v[52:55], v[20:23], v[136:139]
  ds_read_b128 v[20:23], v216 offset:16384
  v_mfma_f32_16x16x32_bf16 v[76:79], a[144:147], v[24:27], v[76:79]
  v_mfma_f32_16x16x32_bf16 v[108:111], a[148:151], v[24:27], v[108:111]
  v_mfma_f32_16x16x32_bf16 v[140:143], v[52:55], v[24:27], v[140:143]
  ds_read_b128 v[24:27], v216 offset:18432
  ds_read_b128 v[52:55], v10 offset:2048
  s_waitcnt lgkmcnt(7)
  v_mfma_f32_16x16x32_bf16 v[80:83], a[144:147], v[28:31], v[80:83]
  buffer_load_dwordx4 a[76:79], v240, s[16:19], s46 offen offset:1024 sc1
  v_mfma_f32_16x16x32_bf16 v[112:115], a[148:151], v[28:31], v[112:115]
  ds_read_b128 v[28:31], v217 offset:16384
  v_mfma_f32_16x16x32_bf16 v[84:87], a[144:147], v[32:35], v[84:87]
  v_mfma_f32_16x16x32_bf16 v[116:119], a[148:151], v[32:35], v[116:119]
  ds_read_b128 v[32:35], v217 offset:18432
  s_waitcnt lgkmcnt(7)
  v_mfma_f32_16x16x32_bf16 v[88:91], a[144:147], v[36:39], v[88:91]
  buffer_load_dwordx4 a[80:83], v241, s[16:19], s46 offen offset:0 sc1
  v_mfma_f32_16x16x32_bf16 v[120:123], a[148:151], v[36:39], v[120:123]
  ds_read_b128 v[36:39], v218 offset:16384
  v_mfma_f32_16x16x32_bf16 v[92:95], a[144:147], v[40:43], v[92:95]
  v_mfma_f32_16x16x32_bf16 v[124:127], a[148:151], v[40:43], v[124:127]
  ds_read_b128 v[40:43], v218 offset:18432
  s_waitcnt lgkmcnt(7)
  v_mfma_f32_16x16x32_bf16 v[96:99], a[144:147], v[44:47], v[96:99]
  buffer_load_dwordx4 a[84:87], v241, s[16:19], s46 offen offset:1024 sc1
  v_mfma_f32_16x16x32_bf16 v[128:131], a[148:151], v[44:47], v[128:131]
  ds_read_b128 v[44:47], v219 offset:16384
  v_mfma_f32_16x16x32_bf16 v[100:103], a[144:147], v[48:51], v[100:103]
  v_mfma_f32_16x16x32_bf16 v[132:135], a[148:151], v[48:51], v[132:135]
  ds_read_b128 v[48:51], v219 offset:18432
  s_waitcnt vmcnt(32)
  s_waitcnt lgkmcnt(6)
  v_mfma_f32_16x16x32_bf16 v[72:75], a[152:155], v[20:23], v[72:75]
  buffer_load_dwordx4 a[88:91], v242, s[16:19], s46 offen offset:0 sc1
  v_mfma_f32_16x16x32_bf16 v[104:107], a[156:159], v[20:23], v[104:107]
  v_mfma_f32_16x16x32_bf16 v[136:139], v[52:55], v[20:23], v[136:139]
  ds_read_b128 v[20:23], v220 offset:16384
  v_mfma_f32_16x16x32_bf16 v[76:79], a[152:155], v[24:27], v[76:79]
  buffer_load_dwordx4 a[92:95], v242, s[16:19], s46 offen offset:1024 sc1
  v_mfma_f32_16x16x32_bf16 v[108:111], a[156:159], v[24:27], v[108:111]
  v_mfma_f32_16x16x32_bf16 v[140:143], v[52:55], v[24:27], v[140:143]
  ds_read_b128 v[24:27], v220 offset:18432
  ds_read_b128 v[52:55], v10 offset:3072
  s_waitcnt lgkmcnt(7)
  v_mfma_f32_16x16x32_bf16 v[80:83], a[152:155], v[28:31], v[80:83]
  v_mfma_f32_16x16x32_bf16 v[112:115], a[156:159], v[28:31], v[112:115]
  ds_read_b128 v[28:31], v221 offset:16384
  buffer_load_dwordx4 a[96:99], v243, s[16:19], s46 offen offset:0 sc1
  v_mfma_f32_16x16x32_bf16 v[84:87], a[152:155], v[32:35], v[84:87]
  v_mfma_f32_16x16x32_bf16 v[116:119], a[156:159], v[32:35], v[116:119]
  ds_read_b128 v[32:35], v221 offset:18432
  s_waitcnt lgkmcnt(7)
  v_mfma_f32_16x16x32_bf16 v[88:91], a[152:155], v[36:39], v[88:91]
  v_mfma_f32_16x16x32_bf16 v[120:123], a[156:159], v[36:39], v[120:123]
  ds_read_b128 v[36:39], v222 offset:16384
  buffer_load_dwordx4 a[100:103], v243, s[16:19], s46 offen offset:1024 sc1
  v_mfma_f32_16x16x32_bf16 v[92:95], a[152:155], v[40:43], v[92:95]
  s_add_u32 s46, s46, 36864
  v_mfma_f32_16x16x32_bf16 v[124:127], a[156:159], v[40:43], v[124:127]
  ds_read_b128 v[40:43], v222 offset:18432
  s_waitcnt lgkmcnt(7)
  v_mfma_f32_16x16x32_bf16 v[96:99], a[152:155], v[44:47], v[96:99]
  v_mfma_f32_16x16x32_bf16 v[128:131], a[156:159], v[44:47], v[128:131]
  ds_read_b128 v[44:47], v223 offset:16384
  v_mfma_f32_16x16x32_bf16 v[100:103], a[152:155], v[48:51], v[100:103]
  v_mfma_f32_16x16x32_bf16 v[132:135], a[156:159], v[48:51], v[132:135]
  s_waitcnt vmcnt(25)
  s_barrier
  s_waitcnt lgkmcnt(5)
  v_mfma_f32_16x16x32_bf16 v[72:75], a[160:163], v[20:23], v[72:75]
  ds_read_b128 v[48:51], v223 offset:18432
  s_add_u32 m0, s41, 110592
  v_mfma_f32_16x16x32_bf16 v[104:107], a[164:167], v[20:23], v[104:107]
  buffer_load_dwordx4 v68, s[60:63], s54 offen offset:0 lds
  v_mfma_f32_16x16x32_bf16 v[136:139], v[52:55], v[20:23], v[136:139]
  ds_read_b128 v[20:23], v216 offset:36864
  v_mfma_f32_16x16x32_bf16 v[76:79], a[160:163], v[24:27], v[76:79]
  v_mfma_f32_16x16x32_bf16 v[108:111], a[164:167], v[24:27], v[108:111]
  v_mfma_f32_16x16x32_bf16 v[140:143], v[52:55], v[24:27], v[140:143]
  ds_read_b128 v[24:27], v216 offset:38912
  ds_read_b128 v[52:55], v10 offset:36864
  s_waitcnt lgkmcnt(7)
  v_mfma_f32_16x16x32_bf16 v[80:83], a[160:163], v[28:31], v[80:83]
  buffer_load_dwordx4 v69, s[60:63], s54 offen offset:1024 lds
  v_mfma_f32_16x16x32_bf16 v[112:115], a[164:167], v[28:31], v[112:115]
  ds_read_b128 v[28:31], v217 offset:36864
  v_mfma_f32_16x16x32_bf16 v[84:87], a[160:163], v[32:35], v[84:87]
  v_mfma_f32_16x16x32_bf16 v[116:119], a[164:167], v[32:35], v[116:119]
  ds_read_b128 v[32:35], v217 offset:38912
  s_waitcnt lgkmcnt(7)
  v_mfma_f32_16x16x32_bf16 v[88:91], a[160:163], v[36:39], v[88:91]
  buffer_load_dwordx4 v70, s[60:63], s54 offen offset:2048 lds
  v_mfma_f32_16x16x32_bf16 v[120:123], a[164:167], v[36:39], v[120:123]
  ds_read_b128 v[36:39], v218 offset:36864
  v_mfma_f32_16x16x32_bf16 v[92:95], a[160:163], v[40:43], v[92:95]
  v_mfma_f32_16x16x32_bf16 v[124:127], a[164:167], v[40:43], v[124:127]
  ds_read_b128 v[40:43], v218 offset:38912
  s_waitcnt lgkmcnt(7)
  v_mfma_f32_16x16x32_bf16 v[96:99], a[160:163], v[44:47], v[96:99]
  buffer_load_dwordx4 v71, s[60:63], s54 offen offset:3072 lds
  s_add_u32 s54, s54, 128
  v_mfma_f32_16x16x32_bf16 v[128:131], a[164:167], v[44:47], v[128:131]
  ds_read_b128 v[44:47], v219 offset:36864
  v_mfma_f32_16x16x32_bf16 v[100:103], a[160:163], v[48:51], v[100:103]
  s_add_u32 m0, s41, 126976
  v_mfma_f32_16x16x32_bf16 v[132:135], a[164:167], v[48:51], v[132:135]
  ds_read_b128 v[48:51], v219 offset:38912
  s_waitcnt vmcnt(27)
  s_waitcnt lgkmcnt(6)
  v_mfma_f32_16x16x32_bf16 v[72:75], a[168:171], v[20:23], v[72:75]
  buffer_load_dwordx4 v68, s[60:63], s54 offen offset:0 lds
  v_mfma_f32_16x16x32_bf16 v[104:107], a[172:175], v[20:23], v[104:107]
  v_mfma_f32_16x16x32_bf16 v[136:139], v[52:55], v[20:23], v[136:139]
  ds_read_b128 v[20:23], v220 offset:36864
  v_mfma_f32_16x16x32_bf16 v[76:79], a[168:171], v[24:27], v[76:79]
  buffer_load_dwordx4 v69, s[60:63], s54 offen offset:1024 lds
  v_mfma_f32_16x16x32_bf16 v[108:111], a[172:175], v[24:27], v[108:111]
  v_mfma_f32_16x16x32_bf16 v[140:143], v[52:55], v[24:27], v[140:143]
  ds_read_b128 v[24:27], v220 offset:38912
  ds_read_b128 v[52:55], v10 offset:37888
  s_waitcnt lgkmcnt(7)
  v_mfma_f32_16x16x32_bf16 v[80:83], a[168:171], v[28:31], v[80:83]
  v_mfma_f32_16x16x32_bf16 v[112:115], a[172:175], v[28:31], v[112:115]
  ds_read_b128 v[28:31], v221 offset:36864
  buffer_load_dwordx4 v70, s[60:63], s54 offen offset:2048 lds
  v_mfma_f32_16x16x32_bf16 v[84:87], a[168:171], v[32:35], v[84:87]
  v_mfma_f32_16x16x32_bf16 v[116:119], a[172:175], v[32:35], v[116:119]
  ds_read_b128 v[32:35], v221 offset:38912
  s_waitcnt lgkmcnt(7)
  v_mfma_f32_16x16x32_bf16 v[88:91], a[168:171], v[36:39], v[88:91]
  v_mfma_f32_16x16x32_bf16 v[120:123], a[172:175], v[36:39], v[120:123]
  ds_read_b128 v[36:39], v222 offset:36864
  buffer_load_dwordx4 v71, s[60:63], s54 offen offset:3072 lds
  v_mfma_f32_16x16x32_bf16 v[92:95], a[168:171], v[40:43], v[92:95]
  s_add_u32 s54, s54, 128
  v_mfma_f32_16x16x32_bf16 v[124:127], a[172:175], v[40:43], v[124:127]
  ds_read_b128 v[40:43], v222 offset:38912
  s_waitcnt lgkmcnt(7)
  v_mfma_f32_16x16x32_bf16 v[96:99], a[168:171], v[44:47], v[96:99]
  s_add_u32 m0, s44, 110592
  v_mfma_f32_16x16x32_bf16 v[128:131], a[172:175], v[44:47], v[128:131]
  ds_read_b128 v[44:47], v223 offset:36864
  buffer_load_dwordx4 v244, s[16:19], s55 offen sc1 lds
  v_mfma_f32_16x16x32_bf16 v[100:103], a[168:171], v[48:51], v[100:103]
  s_add_u32 s55, s55, 36864
  v_mfma_f32_16x16x32_bf16 v[132:135], a[172:175], v[48:51], v[132:135]
  ds_read_b128 v[48:51], v223 offset:38912
  s_waitcnt vmcnt(30)
  s_waitcnt lgkmcnt(6)
  v_mfma_f32_16x16x32_bf16 v[72:75], a[176:179], v[20:23], v[72:75]
  v_mfma_f32_16x16x32_bf16 v[104:107], a[180:183], v[20:23], v[104:107]
  buffer_load_dwordx4 a[104:107], v240, s[16:19], s46 offen offset:0 sc1
  v_mfma_f32_16x16x32_bf16 v[136:139], v[52:55], v[20:23], v[136:139]
  ds_read_b128 v[20:23], v216 offset:53248
  v_mfma_f32_16x16x32_bf16 v[76:79], a[176:179], v[24:27], v[76:79]
  v_mfma_f32_16x16x32_bf16 v[108:111], a[180:183], v[24:27], v[108:111]
  v_mfma_f32_16x16x32_bf16 v[140:143], v[52:55], v[24:27], v[140:143]
  ds_read_b128 v[24:27], v216 offset:55296
  ds_read_b128 v[52:55], v10 offset:38912
  s_waitcnt lgkmcnt(7)
  v_mfma_f32_16x16x32_bf16 v[80:83], a[176:179], v[28:31], v[80:83]
  buffer_load_dwordx4 a[108:111], v240, s[16:19], s46 offen offset:1024 sc1
  v_mfma_f32_16x16x32_bf16 v[112:115], a[180:183], v[28:31], v[112:115]
  ds_read_b128 v[28:31], v217 offset:53248
  v_mfma_f32_16x16x32_bf16 v[84:87], a[176:179], v[32:35], v[84:87]
  v_mfma_f32_16x16x32_bf16 v[116:119], a[180:183], v[32:35], v[116:119]
  ds_read_b128 v[32:35], v217 offset:55296
  s_waitcnt lgkmcnt(7)
  v_mfma_f32_16x16x32_bf16 v[88:91], a[176:179], v[36:39], v[88:91]
  buffer_load_dwordx4 a[112:115], v241, s[16:19], s46 offen offset:0 sc1
  v_mfma_f32_16x16x32_bf16 v[120:123], a[180:183], v[36:39], v[120:123]
  ds_read_b128 v[36:39], v218 offset:53248
  v_mfma_f32_16x16x32_bf16 v[92:95], a[176:179], v[40:43], v[92:95]
  v_mfma_f32_16x16x32_bf16 v[124:127], a[180:183], v[40:43], v[124:127]
  ds_read_b128 v[40:43], v218 offset:55296
  s_waitcnt lgkmcnt(7)
  v_mfma_f32_16x16x32_bf16 v[96:99], a[176:179], v[44:47], v[96:99]
  buffer_load_dwordx4 a[116:119], v241, s[16:19], s46 offen offset:1024 sc1
  v_mfma_f32_16x16x32_bf16 v[128:131], a[180:183], v[44:47], v[128:131]
  ds_read_b128 v[44:47], v219 offset:53248
  v_mfma_f32_16x16x32_bf16 v[100:103], a[176:179], v[48:51], v[100:103]
  v_mfma_f32_16x16x32_bf16 v[132:135], a[180:183], v[48:51], v[132:135]
  ds_read_b128 v[48:51], v219 offset:55296
  s_waitcnt vmcnt(32)
  s_waitcnt lgkmcnt(6)
  v_mfma_f32_16x16x32_bf16 v[72:75], a[184:187], v[20:23], v[72:75]
  buffer_load_dwordx4 a[120:123], v242, s[16:19], s46 offen offset:0 sc1
  v_mfma_f32_16x16x32_bf16 v[104:107], a[188:191], v[20:23], v[104:107]
  v_mfma_f32_16x16x32_bf16 v[136:139], v[52:55], v[20:23], v[136:139]
  ds_read_b128 v[20:23], v220 offset:53248
  v_mfma_f32_16x16x32_bf16 v[76:79], a[184:187], v[24:27], v[76:79]
  buffer_load_dwordx4 a[124:127], v242, s[16:19], s46 offen offset:1024 sc1
  v_mfma_f32_16x16x32_bf16 v[108:111], a[188:191], v[24:27], v[108:111]
  v_mfma_f32_16x16x32_bf16 v[140:143], v[52:55], v[24:27], v[140:143]
  ds_read_b128 v[24:27], v220 offset:55296
  ds_read_b128 v[52:55], v10 offset:39936
  s_waitcnt lgkmcnt(7)
  v_mfma_f32_16x16x32_bf16 v[80:83], a[184:187], v[28:31], v[80:83]
  v_mfma_f32_16x16x32_bf16 v[112:115], a[188:191], v[28:31], v[112:115]
  ds_read_b128 v[28:31], v221 offset:53248
  buffer_load_dwordx4 a[128:131], v243, s[16:19], s46 offen offset:0 sc1
  v_mfma_f32_16x16x32_bf16 v[84:87], a[184:187], v[32:35], v[84:87]
  v_mfma_f32_16x16x32_bf16 v[116:119], a[188:191], v[32:35], v[116:119]
  ds_read_b128 v[32:35], v221 offset:55296
  s_waitcnt lgkmcnt(7)
  v_mfma_f32_16x16x32_bf16 v[88:91], a[184:187], v[36:39], v[88:91]
  v_mfma_f32_16x16x32_bf16 v[120:123], a[188:191], v[36:39], v[120:123]
  ds_read_b128 v[36:39], v222 offset:53248
  buffer_load_dwordx4 a[132:135], v243, s[16:19], s46 offen offset:1024 sc1
  v_mfma_f32_16x16x32_bf16 v[92:95], a[184:187], v[40:43], v[92:95]
  s_add_u32 s46, s46, 36864
  v_mfma_f32_16x16x32_bf16 v[124:127], a[188:191], v[40:43], v[124:127]
  ds_read_b128 v[40:43], v222 offset:55296
  s_waitcnt lgkmcnt(7)
  v_mfma_f32_16x16x32_bf16 v[96:99], a[184:187], v[44:47], v[96:99]
  v_mfma_f32_16x16x32_bf16 v[128:131], a[188:191], v[44:47], v[128:131]
  ds_read_b128 v[44:47], v223 offset:53248
  v_mfma_f32_16x16x32_bf16 v[100:103], a[184:187], v[48:51], v[100:103]
  v_mfma_f32_16x16x32_bf16 v[132:135], a[188:191], v[48:51], v[132:135]
  s_waitcnt vmcnt(25)
  s_barrier
  s_waitcnt lgkmcnt(5)
  v_mfma_f32_16x16x32_bf16 v[72:75], a[192:195], v[20:23], v[72:75]
  ds_read_b128 v[48:51], v223 offset:55296
  s_add_u32 m0, s41, 0
  v_mfma_f32_16x16x32_bf16 v[104:107], a[196:199], v[20:23], v[104:107]
  buffer_load_dwordx4 v68, s[60:63], s54 offen offset:0 lds
  v_mfma_f32_16x16x32_bf16 v[136:139], v[52:55], v[20:23], v[136:139]
  ds_read_b128 v[20:23], v224 offset:0
  v_mfma_f32_16x16x32_bf16 v[76:79], a[192:195], v[24:27], v[76:79]
  v_mfma_f32_16x16x32_bf16 v[108:111], a[196:199], v[24:27], v[108:111]
  buffer_load_dwordx4 v69, s[60:63], s54 offen offset:1024 lds
  v_mfma_f32_16x16x32_bf16 v[140:143], v[52:55], v[24:27], v[140:143]
  ds_read_b128 v[24:27], v224 offset:2048
  ds_read_b128 v[52:55], v11 offset:0
  s_waitcnt lgkmcnt(7)
  v_mfma_f32_16x16x32_bf16 v[80:83], a[192:195], v[28:31], v[80:83]
  v_mfma_f32_16x16x32_bf16 v[112:115], a[196:199], v[28:31], v[112:115]
  ds_read_b128 v[28:31], v225 offset:0
  v_mfma_f32_16x16x32_bf16 v[84:87], a[192:195], v[32:35], v[84:87]
  buffer_load_dwordx4 v70, s[60:63], s54 offen offset:2048 lds
  v_mfma_f32_16x16x32_bf16 v[116:119], a[196:199], v[32:35], v[116:119]
  ds_read_b128 v[32:35], v225 offset:2048
  s_waitcnt lgkmcnt(7)
  v_mfma_f32_16x16x32_bf16 v[88:91], a[192:195], v[36:39], v[88:91]
  v_mfma_f32_16x16x32_bf16 v[120:123], a[196:199], v[36:39], v[120:123]
  ds_read_b128 v[36:39], v226 offset:0
  buffer_load_dwordx4 v71, s[60:63], s54 offen offset:3072 lds
  v_mfma_f32_16x16x32_bf16 v[92:95], a[192:195], v[40:43], v[92:95]
  s_add_u32 s54, s54, 128
  v_mfma_f32_16x16x32_bf16 v[124:127], a[196:199], v[40:43], v[124:127]
  ds_read_b128 v[40:43], v226 offset:2048
  s_waitcnt lgkmcnt(7)
  v_mfma_f32_16x16x32_bf16 v[96:99], a[192:195], v[44:47], v[96:99]
  s_add_u32 m0, s41, 16384
  v_mfma_f32_16x16x32_bf16 v[128:131], a[196:199], v[44:47], v[128:131]
  ds_read_b128 v[44:47], v227 offset:0
  buffer_load_dwordx4 v68, s[60:63], s54 offen offset:0 lds
  v_mfma_f32_16x16x32_bf16 v[100:103], a[192:195], v[48:51], v[100:103]
  v_mfma_f32_16x16x32_bf16 v[132:135], a[196:199], v[48:51], v[132:135]
  ds_read_b128 v[48:51], v227 offset:2048
  s_waitcnt vmcnt(28)
  s_waitcnt lgkmcnt(6)
  v_mfma_f32_16x16x32_bf16 v[72:75], a[72:75], v[20:23], v[72:75]
  buffer_load_dwordx4 v69, s[60:63], s54 offen offset:1024 lds
  v_mfma_f32_16x16x32_bf16 v[104:107], a[76:79], v[20:23], v[104:107]
  v_mfma_f32_16x16x32_bf16 v[136:139], v[52:55], v[20:23], v[136:139]
  ds_read_b128 v[20:23], v228 offset:0
  v_mfma_f32_16x16x32_bf16 v[76:79], a[72:75], v[24:27], v[76:79]
  v_mfma_f32_16x16x32_bf16 v[108:111], a[76:79], v[24:27], v[108:111]
  buffer_load_dwordx4 v70, s[60:63], s54 offen offset:2048 lds
  v_mfma_f32_16x16x32_bf16 v[140:143], v[52:55], v[24:27], v[140:143]
  ds_read_b128 v[24:27], v228 offset:2048
  ds_read_b128 v[52:55], v11 offset:1024
  s_waitcnt lgkmcnt(7)
  v_mfma_f32_16x16x32_bf16 v[80:83], a[72:75], v[28:31], v[80:83]
  v_mfma_f32_16x16x32_bf16 v[112:115], a[76:79], v[28:31], v[112:115]
  ds_read_b128 v[28:31], v229 offset:0
  buffer_load_dwordx4 v71, s[60:63], s54 offen offset:3072 lds
  v_mfma_f32_16x16x32_bf16 v[84:87], a[72:75], v[32:35], v[84:87]
  s_add_u32 s54, s54, 128
  v_mfma_f32_16x16x32_bf16 v[116:119], a[76:79], v[32:35], v[116:119]
  ds_read_b128 v[32:35], v229 offset:2048
  s_waitcnt lgkmcnt(7)
  v_mfma_f32_16x16x32_bf16 v[88:91], a[72:75], v[36:39], v[88:91]
  s_add_u32 m0, s44, 0
  v_mfma_f32_16x16x32_bf16 v[120:123], a[76:79], v[36:39], v[120:123]
  ds_read_b128 v[36:39], v230 offset:0
  buffer_load_dwordx4 v244, s[16:19], s55 offen sc1 lds
  v_mfma_f32_16x16x32_bf16 v[92:95], a[72:75], v[40:43], v[92:95]
  s_add_u32 s55, s55, 36864
  v_mfma_f32_16x16x32_bf16 v[124:127], a[76:79], v[40:43], v[124:127]
  ds_read_b128 v[40:43], v230 offset:2048
  s_waitcnt lgkmcnt(7)
  v_mfma_f32_16x16x32_bf16 v[96:99], a[72:75], v[44:47], v[96:99]
  buffer_load_dwordx4 a[136:139], v240, s[16:19], s46 offen offset:0 sc1
  v_mfma_f32_16x16x32_bf16 v[128:131], a[76:79], v[44:47], v[128:131]
  ds_read_b128 v[44:47], v231 offset:0
  v_mfma_f32_16x16x32_bf16 v[100:103], a[72:75], v[48:51], v[100:103]
  v_mfma_f32_16x16x32_bf16 v[132:135], a[76:79], v[48:51], v[132:135]
  ds_read_b128 v[48:51], v231 offset:2048
  s_waitcnt vmcnt(31)
  s_waitcnt lgkmcnt(6)
  v_mfma_f32_16x16x32_bf16 v[72:75], a[80:83], v[20:23], v[72:75]
  buffer_load_dwordx4 a[140:143], v240, s[16:19], s46 offen offset:1024 sc1
  v_mfma_f32_16x16x32_bf16 v[104:107], a[84:87], v[20:23], v[104:107]
  v_mfma_f32_16x16x32_bf16 v[136:139], v[52:55], v[20:23], v[136:139]
  ds_read_b128 v[20:23], v224 offset:16384
  v_mfma_f32_16x16x32_bf16 v[76:79], a[80:83], v[24:27], v[76:79]
  buffer_load_dwordx4 a[144:147], v241, s[16:19], s46 offen offset:0 sc1
  v_mfma_f32_16x16x32_bf16 v[108:111], a[84:87], v[24:27], v[108:111]
  v_mfma_f32_16x16x32_bf16 v[140:143], v[52:55], v[24:27], v[140:143]
  ds_read_b128 v[24:27], v224 offset:18432
  ds_read_b128 v[52:55], v11 offset:2048
  s_waitcnt lgkmcnt(7)
  v_mfma_f32_16x16x32_bf16 v[80:83], a[80:83], v[28:31], v[80:83]
  v_mfma_f32_16x16x32_bf16 v[112:115], a[84:87], v[28:31], v[112:115]
  ds_read_b128 v[28:31], v225 offset:16384
  buffer_load_dwordx4 a[148:151], v241, s[16:19], s46 offen offset:1024 sc1
  v_mfma_f32_16x16x32_bf16 v[84:87], a[80:83], v[32:35], v[84:87]
  v_mfma_f32_16x16x32_bf16 v[116:119], a[84:87], v[32:35], v[116:119]
  ds_read_b128 v[32:35], v225 offset:18432
  s_waitcnt lgkmcnt(7)
  v_mfma_f32_16x16x32_bf16 v[88:91], a[80:83], v[36:39], v[88:91]
  buffer_load_dwordx4 a[152:155], v242, s[16:19], s46 offen offset:0 sc1
  v_mfma_f32_16x16x32_bf16 v[120:123], a[84:87], v[36:39], v[120:123]
  ds_read_b128 v[36:39], v226 offset:16384
  v_mfma_f32_16x16x32_bf16 v[92:95], a[80:83], v[40:43], v[92:95]
  v_mfma_f32_16x16x32_bf16 v[124:127], a[84:87], v[40:43], v[124:127]
  ds_read_b128 v[40:43], v226 offset:18432
  s_waitcnt lgkmcnt(7)
  v_mfma_f32_16x16x32_bf16 v[96:99], a[80:83], v[44:47], v[96:99]
  buffer_load_dwordx4 a[156:159], v242, s[16:19], s46 offen offset:1024 sc1
  v_mfma_f32_16x16x32_bf16 v[128:131], a[84:87], v[44:47], v[128:131]
  ds_read_b128 v[44:47], v227 offset:16384
  v_mfma_f32_16x16x32_bf16 v[100:103], a[80:83], v[48:51], v[100:103]
  v_mfma_f32_16x16x32_bf16 v[132:135], a[84:87], v[48:51], v[132:135]
  ds_read_b128 v[48:51], v227 offset:18432
  s_waitcnt vmcnt(34)
  s_waitcnt lgkmcnt(6)
  v_mfma_f32_16x16x32_bf16 v[72:75], a[88:91], v[20:23], v[72:75]
  buffer_load_dwordx4 a[160:163], v243, s[16:19], s46 offen offset:0 sc1
  v_mfma_f32_16x16x32_bf16 v[104:107], a[92:95], v[20:23], v[104:107]
  v_mfma_f32_16x16x32_bf16 v[136:139], v[52:55], v[20:23], v[136:139]
  ds_read_b128 v[20:23], v228 offset:16384
  v_mfma_f32_16x16x32_bf16 v[76:79], a[88:91], v[24:27], v[76:79]
  buffer_load_dwordx4 a[164:167], v243, s[16:19], s46 offen offset:1024 sc1
  s_add_u32 s46, s46, 36864
  v_mfma_f32_16x16x32_bf16 v[108:111], a[92:95], v[24:27], v[108:111]
  v_mfma_f32_16x16x32_bf16 v[140:143], v[52:55], v[24:27], v[140:143]
  ds_read_b128 v[24:27], v228 offset:18432
  ds_read_b128 v[52:55], v11 offset:3072
  s_waitcnt lgkmcnt(7)
  v_mfma_f32_16x16x32_bf16 v[80:83], a[88:91], v[28:31], v[80:83]
  v_mfma_f32_16x16x32_bf16 v[112:115], a[92:95], v[28:31], v[112:115]
  ds_read_b128 v[28:31], v229 offset:16384
  v_mfma_f32_16x16x32_bf16 v[84:87], a[88:91], v[32:35], v[84:87]
  v_mfma_f32_16x16x32_bf16 v[116:119], a[92:95], v[32:35], v[116:119]
  ds_read_b128 v[32:35], v229 offset:18432
  s_waitcnt lgkmcnt(7)
  v_mfma_f32_16x16x32_bf16 v[88:91], a[88:91], v[36:39], v[88:91]
  v_mfma_f32_16x16x32_bf16 v[120:123], a[92:95], v[36:39], v[120:123]
  ds_read_b128 v[36:39], v230 offset:16384
  v_mfma_f32_16x16x32_bf16 v[92:95], a[88:91], v[40:43], v[92:95]
  v_mfma_f32_16x16x32_bf16 v[124:127], a[92:95], v[40:43], v[124:127]
  ds_read_b128 v[40:43], v230 offset:18432
  s_waitcnt lgkmcnt(7)
  v_mfma_f32_16x16x32_bf16 v[96:99], a[88:91], v[44:47], v[96:99]
  v_mfma_f32_16x16x32_bf16 v[128:131], a[92:95], v[44:47], v[128:131]
  ds_read_b128 v[44:47], v231 offset:16384
  v_mfma_f32_16x16x32_bf16 v[100:103], a[88:91], v[48:51], v[100:103]
  v_mfma_f32_16x16x32_bf16 v[132:135], a[92:95], v[48:51], v[132:135]
  s_waitcnt vmcnt(25)
  s_barrier
  s_waitcnt lgkmcnt(5)
  v_mfma_f32_16x16x32_bf16 v[72:75], a[96:99], v[20:23], v[72:75]
  ds_read_b128 v[48:51], v231 offset:18432
  s_add_u32 m0, s41, 36864
  v_mfma_f32_16x16x32_bf16 v[104:107], a[100:103], v[20:23], v[104:107]
  buffer_load_dwordx4 v68, s[60:63], s54 offen offset:0 lds
  v_mfma_f32_16x16x32_bf16 v[136:139], v[52:55], v[20:23], v[136:139]
  ds_read_b128 v[20:23], v224 offset:36864
  v_mfma_f32_16x16x32_bf16 v[76:79], a[96:99], v[24:27], v[76:79]
  v_mfma_f32_16x16x32_bf16 v[108:111], a[100:103], v[24:27], v[108:111]
  buffer_load_dwordx4 v69, s[60:63], s54 offen offset:1024 lds
  v_mfma_f32_16x16x32_bf16 v[140:143], v[52:55], v[24:27], v[140:143]
  ds_read_b128 v[24:27], v224 offset:38912
  ds_read_b128 v[52:55], v11 offset:36864
  s_waitcnt lgkmcnt(7)
  v_mfma_f32_16x16x32_bf16 v[80:83], a[96:99], v[28:31], v[80:83]
  v_mfma_f32_16x16x32_bf16 v[112:115], a[100:103], v[28:31], v[112:115]
  ds_read_b128 v[28:31], v225 offset:36864
  v_mfma_f32_16x16x32_bf16 v[84:87], a[96:99], v[32:35], v[84:87]
  buffer_load_dwordx4 v70, s[60:63], s54 offen offset:2048 lds
  v_mfma_f32_16x16x32_bf16 v[116:119], a[100:103], v[32:35], v[116:119]
  ds_read_b128 v[32:35], v225 offset:38912
  s_waitcnt lgkmcnt(7)
  v_mfma_f32_16x16x32_bf16 v[88:91], a[96:99], v[36:39], v[88:91]
  v_mfma_f32_16x16x32_bf16 v[120:123], a[100:103], v[36:39], v[120:123]
  ds_read_b128 v[36:39], v226 offset:36864
  buffer_load_dwordx4 v71, s[60:63], s54 offen offset:3072 lds
  v_mfma_f32_16x16x32_bf16 v[92:95], a[96:99], v[40:43], v[92:95]
  s_add_u32 s54, s54, 128
  v_mfma_f32_16x16x32_bf16 v[124:127], a[100:103], v[40:43], v[124:127]
  ds_read_b128 v[40:43], v226 offset:38912
  s_waitcnt lgkmcnt(7)
  v_mfma_f32_16x16x32_bf16 v[96:99], a[96:99], v[44:47], v[96:99]
  s_add_u32 m0, s41, 53248
  v_mfma_f32_16x16x32_bf16 v[128:131], a[100:103], v[44:47], v[128:131]
  ds_read_b128 v[44:47], v227 offset:36864
  buffer_load_dwordx4 v68, s[60:63], s54 offen offset:0 lds
  v_mfma_f32_16x16x32_bf16 v[100:103], a[96:99], v[48:51], v[100:103]
  v_mfma_f32_16x16x32_bf16 v[132:135], a[100:103], v[48:51], v[132:135]
  ds_read_b128 v[48:51], v227 offset:38912
  s_waitcnt vmcnt(28)
  s_waitcnt lgkmcnt(6)
  v_mfma_f32_16x16x32_bf16 v[72:75], a[104:107], v[20:23], v[72:75]
  buffer_load_dwordx4 v69, s[60:63], s54 offen offset:1024 lds
  v_mfma_f32_16x16x32_bf16 v[104:107], a[108:111], v[20:23], v[104:107]
  v_mfma_f32_16x16x32_bf16 v[136:139], v[52:55], v[20:23], v[136:139]
  ds_read_b128 v[20:23], v228 offset:36864
  v_mfma_f32_16x16x32_bf16 v[76:79], a[104:107], v[24:27], v[76:79]
  v_mfma_f32_16x16x32_bf16 v[108:111], a[108:111], v[24:27], v[108:111]
  buffer_load_dwordx4 v70, s[60:63], s54 offen offset:2048 lds
  v_mfma_f32_16x16x32_bf16 v[140:143], v[52:55], v[24:27], v[140:143]
  ds_read_b128 v[24:27], v228 offset:38912
  ds_read_b128 v[52:55], v11 offset:37888
  s_waitcnt lgkmcnt(7)
  v_mfma_f32_16x16x32_bf16 v[80:83], a[104:107], v[28:31], v[80:83]
  v_mfma_f32_16x16x32_bf16 v[112:115], a[108:111], v[28:31], v[112:115]
  ds_read_b128 v[28:31], v229 offset:36864
  buffer_load_dwordx4 v71, s[60:63], s54 offen offset:3072 lds
  v_mfma_f32_16x16x32_bf16 v[84:87], a[104:107], v[32:35], v[84:87]
  s_add_u32 s54, s54, 128
  v_mfma_f32_16x16x32_bf16 v[116:119], a[108:111], v[32:35], v[116:119]
  ds_read_b128 v[32:35], v229 offset:38912
  s_waitcnt lgkmcnt(7)
  v_mfma_f32_16x16x32_bf16 v[88:91], a[104:107], v[36:39], v[88:91]
  s_add_u32 m0, s44, 36864
  v_mfma_f32_16x16x32_bf16 v[120:123], a[108:111], v[36:39], v[120:123]
  ds_read_b128 v[36:39], v230 offset:36864
  buffer_load_dwordx4 v244, s[16:19], s55 offen sc1 lds
  v_mfma_f32_16x16x32_bf16 v[92:95], a[104:107], v[40:43], v[92:95]
  s_add_u32 s55, s55, 36864
  v_mfma_f32_16x16x32_bf16 v[124:127], a[108:111], v[40:43], v[124:127]
  ds_read_b128 v[40:43], v230 offset:38912
  s_waitcnt lgkmcnt(7)
  v_mfma_f32_16x16x32_bf16 v[96:99], a[104:107], v[44:47], v[96:99]
  buffer_load_dwordx4 a[168:171], v240, s[16:19], s46 offen offset:0 sc1
  v_mfma_f32_16x16x32_bf16 v[128:131], a[108:111], v[44:47], v[128:131]
  ds_read_b128 v[44:47], v231 offset:36864
  v_mfma_f32_16x16x32_bf16 v[100:103], a[104:107], v[48:51], v[100:103]
  v_mfma_f32_16x16x32_bf16 v[132:135], a[108:111], v[48:51], v[132:135]
  ds_read_b128 v[48:51], v231 offset:38912
  s_waitcnt vmcnt(31)
  s_waitcnt lgkmcnt(6)
  v_mfma_f32_16x16x32_bf16 v[72:75], a[112:115], v[20:23], v[72:75]
  buffer_load_dwordx4 a[172:175], v240, s[16:19], s46 offen offset:1024 sc1
  v_mfma_f32_16x16x32_bf16 v[104:107], a[116:119], v[20:23], v[104:107]
  v_mfma_f32_16x16x32_bf16 v[136:139], v[52:55], v[20:23], v[136:139]
  ds_read_b128 v[20:23], v224 offset:53248
  v_mfma_f32_16x16x32_bf16 v[76:79], a[112:115], v[24:27], v[76:79]
  buffer_load_dwordx4 a[176:179], v241, s[16:19], s46 offen offset:0 sc1
  v_mfma_f32_16x16x32_bf16 v[108:111], a[116:119], v[24:27], v[108:111]
  v_mfma_f32_16x16x32_bf16 v[140:143], v[52:55], v[24:27], v[140:143]
  ds_read_b128 v[24:27], v224 offset:55296
  ds_read_b128 v[52:55], v11 offset:38912
  s_waitcnt lgkmcnt(7)
  v_mfma_f32_16x16x32_bf16 v[80:83], a[112:115], v[28:31], v[80:83]
  v_mfma_f32_16x16x32_bf16 v[112:115], a[116:119], v[28:31], v[112:115]
  ds_read_b128 v[28:31], v225 offset:53248
  buffer_load_dwordx4 a[180:183], v241, s[16:19], s46 offen offset:1024 sc1
  v_mfma_f32_16x16x32_bf16 v[84:87], a[112:115], v[32:35], v[84:87]
  v_mfma_f32_16x16x32_bf16 v[116:119], a[116:119], v[32:35], v[116:119]
  ds_read_b128 v[32:35], v225 offset:55296
  s_waitcnt lgkmcnt(7)
  v_mfma_f32_16x16x32_bf16 v[88:91], a[112:115], v[36:39], v[88:91]
  buffer_load_dwordx4 a[184:187], v242, s[16:19], s46 offen offset:0 sc1
  v_mfma_f32_16x16x32_bf16 v[120:123], a[116:119], v[36:39], v[120:123]
  ds_read_b128 v[36:39], v226 offset:53248
  v_mfma_f32_16x16x32_bf16 v[92:95], a[112:115], v[40:43], v[92:95]
  v_mfma_f32_16x16x32_bf16 v[124:127], a[116:119], v[40:43], v[124:127]
  ds_read_b128 v[40:43], v226 offset:55296
  s_waitcnt lgkmcnt(7)
  v_mfma_f32_16x16x32_bf16 v[96:99], a[112:115], v[44:47], v[96:99]
  buffer_load_dwordx4 a[188:191], v242, s[16:19], s46 offen offset:1024 sc1
  v_mfma_f32_16x16x32_bf16 v[128:131], a[116:119], v[44:47], v[128:131]
  ds_read_b128 v[44:47], v227 offset:53248
  v_mfma_f32_16x16x32_bf16 v[100:103], a[112:115], v[48:51], v[100:103]
  v_mfma_f32_16x16x32_bf16 v[132:135], a[116:119], v[48:51], v[132:135]
  ds_read_b128 v[48:51], v227 offset:55296
  s_waitcnt vmcnt(34)
  s_waitcnt lgkmcnt(6)
  v_mfma_f32_16x16x32_bf16 v[72:75], a[120:123], v[20:23], v[72:75]
  buffer_load_dwordx4 a[192:195], v243, s[16:19], s46 offen offset:0 sc1
  v_mfma_f32_16x16x32_bf16 v[104:107], a[124:127], v[20:23], v[104:107]
  v_mfma_f32_16x16x32_bf16 v[136:139], v[52:55], v[20:23], v[136:139]
  ds_read_b128 v[20:23], v228 offset:53248
  v_mfma_f32_16x16x32_bf16 v[76:79], a[120:123], v[24:27], v[76:79]
  buffer_load_dwordx4 a[196:199], v243, s[16:19], s46 offen offset:1024 sc1
  s_add_u32 s46, s46, 36864
  v_mfma_f32_16x16x32_bf16 v[108:111], a[124:127], v[24:27], v[108:111]
  v_mfma_f32_16x16x32_bf16 v[140:143], v[52:55], v[24:27], v[140:143]
  ds_read_b128 v[24:27], v228 offset:55296
  ds_read_b128 v[52:55], v11 offset:39936
  s_waitcnt lgkmcnt(7)
  v_mfma_f32_16x16x32_bf16 v[80:83], a[120:123], v[28:31], v[80:83]
  v_mfma_f32_16x16x32_bf16 v[112:115], a[124:127], v[28:31], v[112:115]
  ds_read_b128 v[28:31], v229 offset:53248
  v_mfma_f32_16x16x32_bf16 v[84:87], a[120:123], v[32:35], v[84:87]
  v_mfma_f32_16x16x32_bf16 v[116:119], a[124:127], v[32:35], v[116:119]
  ds_read_b128 v[32:35], v229 offset:55296
  s_waitcnt lgkmcnt(7)
  v_mfma_f32_16x16x32_bf16 v[88:91], a[120:123], v[36:39], v[88:91]
  v_mfma_f32_16x16x32_bf16 v[120:123], a[124:127], v[36:39], v[120:123]
  ds_read_b128 v[36:39], v230 offset:53248
  v_mfma_f32_16x16x32_bf16 v[92:95], a[120:123], v[40:43], v[92:95]
  v_mfma_f32_16x16x32_bf16 v[124:127], a[124:127], v[40:43], v[124:127]
  ds_read_b128 v[40:43], v230 offset:55296
  s_waitcnt lgkmcnt(7)
  v_mfma_f32_16x16x32_bf16 v[96:99], a[120:123], v[44:47], v[96:99]
  v_mfma_f32_16x16x32_bf16 v[128:131], a[124:127], v[44:47], v[128:131]
  ds_read_b128 v[44:47], v231 offset:53248
  v_mfma_f32_16x16x32_bf16 v[100:103], a[120:123], v[48:51], v[100:103]
  v_mfma_f32_16x16x32_bf16 v[132:135], a[124:127], v[48:51], v[132:135]
  s_waitcnt vmcnt(25)
  s_barrier
  s_waitcnt lgkmcnt(5)
  v_mfma_f32_16x16x32_bf16 v[72:75], a[128:131], v[20:23], v[72:75]
  ds_read_b128 v[48:51], v231 offset:55296
  v_mfma_f32_16x16x32_bf16 v[104:107], a[132:135], v[20:23], v[104:107]
  buffer_load_dwordx4 a[0:3], v4, s[12:15], s30 offen offset:0 sc1
  v_mfma_f32_16x16x32_bf16 v[136:139], v[52:55], v[20:23], v[136:139]
  ds_read_b128 v[20:23], v216 offset:0
  v_mfma_f32_16x16x32_bf16 v[76:79], a[128:131], v[24:27], v[76:79]
  v_mfma_f32_16x16x32_bf16 v[108:111], a[132:135], v[24:27], v[108:111]
  buffer_load_dwordx4 a[4:7], v4, s[12:15], s30 offen offset:1024 sc1
  v_mfma_f32_16x16x32_bf16 v[140:143], v[52:55], v[24:27], v[140:143]
  ds_read_b128 v[24:27], v216 offset:2048
  ds_read_b128 v[52:55], v10 offset:0
  s_waitcnt lgkmcnt(7)
  v_mfma_f32_16x16x32_bf16 v[80:83], a[128:131], v[28:31], v[80:83]
  v_mfma_f32_16x16x32_bf16 v[112:115], a[132:135], v[28:31], v[112:115]
  ds_read_b128 v[28:31], v217 offset:0
  buffer_load_dwordx4 a[8:11], v4, s[12:15], s30 offen offset:2048 sc1
  v_mfma_f32_16x16x32_bf16 v[84:87], a[128:131], v[32:35], v[84:87]
  v_mfma_f32_16x16x32_bf16 v[116:119], a[132:135], v[32:35], v[116:119]
  ds_read_b128 v[32:35], v217 offset:2048
  s_waitcnt lgkmcnt(7)
  v_mfma_f32_16x16x32_bf16 v[88:91], a[128:131], v[36:39], v[88:91]
  buffer_load_dwordx4 a[12:15], v4, s[12:15], s30 offen offset:3072 sc1
  v_mfma_f32_16x16x32_bf16 v[120:123], a[132:135], v[36:39], v[120:123]
  ds_read_b128 v[36:39], v220 offset:0
  v_mfma_f32_16x16x32_bf16 v[92:95], a[128:131], v[40:43], v[92:95]
  v_mfma_f32_16x16x32_bf16 v[124:127], a[132:135], v[40:43], v[124:127]
  ds_read_b128 v[40:43], v220 offset:2048
  s_waitcnt lgkmcnt(7)
  v_mfma_f32_16x16x32_bf16 v[96:99], a[128:131], v[44:47], v[96:99]
  buffer_load_dwordx4 a[16:19], v9, s[12:15], s31 offen offset:0 sc1
  s_add_u32 s30, s30, 5120
  v_mfma_f32_16x16x32_bf16 v[128:131], a[132:135], v[44:47], v[128:131]
  ds_read_b128 v[44:47], v221 offset:0
  s_add_u32 s31, s31, 5120
  v_mfma_f32_16x16x32_bf16 v[100:103], a[128:131], v[48:51], v[100:103]
  buffer_load_dwordx4 a[20:23], v4, s[12:15], s30 offen offset:0 sc1
  v_mfma_f32_16x16x32_bf16 v[132:135], a[132:135], v[48:51], v[132:135]
  ds_read_b128 v[48:51], v221 offset:2048
L_code_p5:
  s_waitcnt vmcnt(29)
  s_waitcnt lgkmcnt(6)
  v_mfma_f32_16x16x32_bf16 v[72:75], a[136:139], v[20:23], v[72:75]
  v_mfma_f32_16x16x32_bf16 v[104:107], a[140:143], v[20:23], v[104:107]
  buffer_load_dwordx4 a[24:27], v4, s[12:15], s30 offen offset:1024 sc1
  v_mfma_f32_16x16x32_bf16 v[136:139], v[52:55], v[20:23], v[136:139]
  ds_read_b128 v[20:23], v216 offset:16384
  v_mfma_f32_16x16x32_bf16 v[76:79], a[136:139], v[24:27], v[76:79]
  v_mfma_f32_16x16x32_bf16 v[108:111], a[140:143], v[24:27], v[108:111]
  buffer_load_dwordx4 a[28:31], v4, s[12:15], s30 offen offset:2048 sc1
  v_mfma_f32_16x16x32_bf16 v[140:143], v[52:55], v[24:27], v[140:143]
  ds_read_b128 v[24:27], v216 offset:18432
  ds_read_b128 v[52:55], v10 offset:1024
  s_waitcnt lgkmcnt(7)
  v_mfma_f32_16x16x32_bf16 v[80:83], a[136:139], v[28:31], v[80:83]
  v_mfma_f32_16x16x32_bf16 v[112:115], a[140:143], v[28:31], v[112:115]
  ds_read_b128 v[28:31], v217 offset:16384
  buffer_load_dwordx4 a[32:35], v4, s[12:15], s30 offen offset:3072 sc1
  v_mfma_f32_16x16x32_bf16 v[84:87], a[136:139], v[32:35], v[84:87]
  v_mfma_f32_16x16x32_bf16 v[116:119], a[140:143], v[32:35], v[116:119]
  ds_read_b128 v[32:35], v217 offset:18432
  s_waitcnt vmcnt(30)
  s_waitcnt lgkmcnt(2)
  v_mfma_f32_16x16x32_bf16 v[72:75], a[144:147], v[36:39], v[72:75]
  buffer_load_dwordx4 a[36:39], v9, s[12:15], s31 offen offset:0 sc1
  s_add_u32 s30, s30, 5120
  v_mfma_f32_16x16x32_bf16 v[104:107], a[148:151], v[36:39], v[104:107]
  s_add_u32 s31, s31, 5120
  v_mfma_f32_16x16x32_bf16 v[136:139], v[52:55], v[36:39], v[136:139]
  ds_read_b128 v[36:39], v220 offset:16384
  v_mfma_f32_16x16x32_bf16 v[76:79], a[144:147], v[40:43], v[76:79]
  buffer_load_dwordx4 a[40:43], v4, s[12:15], s30 offen offset:0 sc1
  v_mfma_f32_16x16x32_bf16 v[108:111], a[148:151], v[40:43], v[108:111]
  v_mfma_f32_16x16x32_bf16 v[140:143], v[52:55], v[40:43], v[140:143]
  ds_read_b128 v[40:43], v220 offset:18432
  ds_read_b128 v[52:55], v10 offset:2048
  v_mfma_f32_16x16x32_bf16 v[80:83], a[144:147], v[44:47], v[80:83]
  buffer_load_dwordx4 a[44:47], v4, s[12:15], s30 offen offset:1024 sc1
  v_mfma_f32_16x16x32_bf16 v[112:115], a[148:151], v[44:47], v[112:115]
  ds_read_b128 v[44:47], v221 offset:16384
  v_mfma_f32_16x16x32_bf16 v[84:87], a[144:147], v[48:51], v[84:87]
  v_mfma_f32_16x16x32_bf16 v[116:119], a[148:151], v[48:51], v[116:119]
  s_waitcnt vmcnt(20)
  s_barrier
  s_waitcnt lgkmcnt(1)
  v_mfma_f32_16x16x32_bf16 v[72:75], a[152:155], v[20:23], v[72:75]
  ds_read_b128 v[48:51], v221 offset:18432
  buffer_load_dwordx4 a[48:51], v4, s[12:15], s30 offen offset:2048 sc1
  v_mfma_f32_16x16x32_bf16 v[104:107], a[156:159], v[20:23], v[104:107]
  v_mfma_f32_16x16x32_bf16 v[136:139], v[52:55], v[20:23], v[136:139]
  ds_read_b128 v[20:23], v216 offset:36864
  buffer_load_dwordx4 a[52:55], v4, s[12:15], s30 offen offset:3072 sc1
  v_mfma_f32_16x16x32_bf16 v[76:79], a[152:155], v[24:27], v[76:79]
  v_mfma_f32_16x16x32_bf16 v[108:111], a[156:159], v[24:27], v[108:111]
  v_mfma_f32_16x16x32_bf16 v[140:143], v[52:55], v[24:27], v[140:143]
  ds_read_b128 v[24:27], v216 offset:38912
  ds_read_b128 v[52:55], v10 offset:3072
  v_mfma_f32_16x16x32_bf16 v[80:83], a[152:155], v[28:31], v[80:83]
  buffer_load_dwordx4 a[56:59], v9, s[12:15], s31 offen offset:0 sc1
  s_add_u32 s30, s30, 5120
  v_mfma_f32_16x16x32_bf16 v[112:115], a[156:159], v[28:31], v[112:115]
  ds_read_b128 v[28:31], v217 offset:36864
  s_add_u32 s31, s31, 5120
  v_mfma_f32_16x16x32_bf16 v[84:87], a[152:155], v[32:35], v[84:87]
  buffer_load_dwordx4 a[60:63], v4, s[12:15], s30 offen offset:0 sc1
  v_mfma_f32_16x16x32_bf16 v[116:119], a[156:159], v[32:35], v[116:119]
  ds_read_b128 v[32:35], v217 offset:38912
  s_waitcnt lgkmcnt(2)
  v_mfma_f32_16x16x32_bf16 v[72:75], a[160:163], v[36:39], v[72:75]
  v_mfma_f32_16x16x32_bf16 v[104:107], a[164:167], v[36:39], v[104:107]
  buffer_load_dwordx4 a[64:67], v4, s[12:15], s30 offen offset:1024 sc1
  v_mfma_f32_16x16x32_bf16 v[136:139], v[52:55], v[36:39], v[136:139]
  ds_read_b128 v[36:39], v220 offset:36864
  v_mfma_f32_16x16x32_bf16 v[76:79], a[160:163], v[40:43], v[76:79]
  v_mfma_f32_16x16x32_bf16 v[108:111], a[164:167], v[40:43], v[108:111]
  buffer_load_dwordx4 a[68:71], v4, s[12:15], s30 offen offset:2048 sc1
  v_mfma_f32_16x16x32_bf16 v[140:143], v[52:55], v[40:43], v[140:143]
  ds_read_b128 v[40:43], v220 offset:38912
  ds_read_b128 v[52:55], v10 offset:36864
  v_mfma_f32_16x16x32_bf16 v[80:83], a[160:163], v[44:47], v[80:83]
  v_mfma_f32_16x16x32_bf16 v[112:115], a[164:167], v[44:47], v[112:115]
  ds_read_b128 v[44:47], v221 offset:36864
  buffer_load_dwordx4 a[200:203], v4, s[12:15], s30 offen offset:3072 sc1
  v_mfma_f32_16x16x32_bf16 v[84:87], a[160:163], v[48:51], v[84:87]
  v_mfma_f32_16x16x32_bf16 v[116:119], a[164:167], v[48:51], v[116:119]
  ds_read_b128 v[48:51], v221 offset:38912
  s_waitcnt vmcnt(25)
  s_waitcnt lgkmcnt(2)
  v_mfma_f32_16x16x32_bf16 v[72:75], a[168:171], v[20:23], v[72:75]
  buffer_load_dwordx4 a[204:207], v9, s[12:15], s31 offen offset:0 sc1
  s_add_u32 s30, s30, 5120
  v_mfma_f32_16x16x32_bf16 v[104:107], a[172:175], v[20:23], v[104:107]
  s_add_u32 s31, s31, 5120
  buffer_load_dwordx4 a[208:211], v4, s[12:15], s30 offen offset:0 sc1
  v_mfma_f32_16x16x32_bf16 v[136:139], v[52:55], v[20:23], v[136:139]
  ds_read_b128 v[20:23], v216 offset:53248
  buffer_load_dwordx4 a[212:215], v4, s[12:15], s30 offen offset:1024 sc1
  v_mfma_f32_16x16x32_bf16 v[76:79], a[168:171], v[24:27], v[76:79]
  buffer_load_dwordx4 a[216:219], v4, s[12:15], s30 offen offset:2048 sc1
  buffer_load_dwordx4 a[72:75], v4, s[12:15], s30 offen offset:3072 sc1
  v_mfma_f32_16x16x32_bf16 v[108:111], a[172:175], v[24:27], v[108:111]
  buffer_load_dwordx4 a[76:79], v9, s[12:15], s31 offen offset:0 sc1
  s_add_u32 s30, s30, 5120
  v_mfma_f32_16x16x32_bf16 v[140:143], v[52:55], v[24:27], v[140:143]
  ds_read_b128 v[24:27], v216 offset:55296
  ds_read_b128 v[52:55], v10 offset:37888
  v_mfma_f32_16x16x32_bf16 v[80:83], a[168:171], v[28:31], v[80:83]
  s_add_u32 s31, s31, 5120
  buffer_load_dwordx4 a[80:83], v4, s[12:15], s30 offen offset:0 sc1
  v_mfma_f32_16x16x32_bf16 v[112:115], a[172:175], v[28:31], v[112:115]
  ds_read_b128 v[28:31], v217 offset:53248
  buffer_load_dwordx4 a[84:87], v4, s[12:15], s30 offen offset:1024 sc1
  v_mfma_f32_16x16x32_bf16 v[84:87], a[168:171], v[32:35], v[84:87]
  buffer_load_dwordx4 a[88:91], v4, s[12:15], s30 offen offset:2048 sc1
  v_mfma_f32_16x16x32_bf16 v[116:119], a[172:175], v[32:35], v[116:119]
  ds_read_b128 v[32:35], v217 offset:55296
  s_waitcnt vmcnt(32)
  s_waitcnt lgkmcnt(2)
  v_mfma_f32_16x16x32_bf16 v[72:75], a[176:179], v[36:39], v[72:75]
  buffer_load_dwordx4 a[92:95], v4, s[12:15], s30 offen offset:3072 sc1
  v_mfma_f32_16x16x32_bf16 v[104:107], a[180:183], v[36:39], v[104:107]
  v_mfma_f32_16x16x32_bf16 v[136:139], v[52:55], v[36:39], v[136:139]
  ds_read_b128 v[36:39], v220 offset:53248
  buffer_load_dwordx4 a[96:99], v9, s[12:15], s31 offen offset:0 sc1
  v_mfma_f32_16x16x32_bf16 v[76:79], a[176:179], v[40:43], v[76:79]
  s_add_u32 s30, s30, 5120
  s_add_u32 s31, s31, 5120
  v_mfma_f32_16x16x32_bf16 v[108:111], a[180:183], v[40:43], v[108:111]
  v_mfma_f32_16x16x32_bf16 v[140:143], v[52:55], v[40:43], v[140:143]
  ds_read_b128 v[40:43], v220 offset:55296
  ds_read_b128 v[52:55], v10 offset:38912
  v_mfma_f32_16x16x32_bf16 v[80:83], a[176:179], v[44:47], v[80:83]
  buffer_load_dwordx4 a[100:103], v4, s[12:15], s30 offen offset:0 sc1
  v_mfma_f32_16x16x32_bf16 v[112:115], a[180:183], v[44:47], v[112:115]
  ds_read_b128 v[44:47], v221 offset:53248
  s_add_u32 m0, s32, 72704
  v_mfma_f32_16x16x32_bf16 v[84:87], a[176:179], v[48:51], v[84:87]
  buffer_load_dwordx4 v4, s[12:15], s30 offen offset:1024 sc1 lds
  v_mfma_f32_16x16x32_bf16 v[116:119], a[180:183], v[48:51], v[116:119]
  ds_read_b128 v[48:51], v221 offset:55296
  s_waitcnt vmcnt(34)
  s_waitcnt lgkmcnt(2)
  v_mfma_f32_16x16x32_bf16 v[72:75], a[184:187], v[20:23], v[72:75]
  v_mfma_f32_16x16x32_bf16 v[104:107], a[188:191], v[20:23], v[104:107]
  s_add_u32 m0, s32, 72704
  v_mfma_f32_16x16x32_bf16 v[136:139], v[52:55], v[20:23], v[136:139]
  ds_read_b128 v[20:23], v218 offset:0
  buffer_load_dwordx4 v4, s[12:15], s30 offen offset:2048 sc1 lds
  v_mfma_f32_16x16x32_bf16 v[76:79], a[184:187], v[24:27], v[76:79]
  v_mfma_f32_16x16x32_bf16 v[108:111], a[188:191], v[24:27], v[108:111]
  s_add_u32 m0, s32, 72704
  v_mfma_f32_16x16x32_bf16 v[140:143], v[52:55], v[24:27], v[140:143]
  ds_read_b128 v[24:27], v218 offset:2048
  ds_read_b128 v[52:55], v10 offset:39936
  v_mfma_f32_16x16x32_bf16 v[80:83], a[184:187], v[28:31], v[80:83]
  buffer_load_dwordx4 v4, s[12:15], s30 offen offset:3072 sc1 lds
  v_mfma_f32_16x16x32_bf16 v[112:115], a[188:191], v[28:31], v[112:115]
  ds_read_b128 v[28:31], v219 offset:0
  v_mfma_f32_16x16x32_bf16 v[84:87], a[184:187], v[32:35], v[84:87]
  s_add_u32 m0, s32, 76800
  v_mfma_f32_16x16x32_bf16 v[116:119], a[188:191], v[32:35], v[116:119]
  ds_read_b128 v[32:35], v219 offset:2048
  s_waitcnt vmcnt(34)
  s_waitcnt lgkmcnt(2)
  v_mfma_f32_16x16x32_bf16 v[72:75], a[192:195], v[36:39], v[72:75]
  buffer_load_dwordx4 v9, s[12:15], s31 offen offset:0 sc1 lds
  s_add_u32 s30, s30, 5120
  v_mfma_f32_16x16x32_bf16 v[104:107], a[196:199], v[36:39], v[104:107]
  s_add_u32 s31, s31, 5120
  s_add_u32 m0, s32, 77824
  v_mfma_f32_16x16x32_bf16 v[136:139], v[52:55], v[36:39], v[136:139]
  ds_read_b128 v[36:39], v222 offset:0
  buffer_load_dwordx4 v4, s[12:15], s30 offen offset:0 sc1 lds
  v_mfma_f32_16x16x32_bf16 v[76:79], a[192:195], v[40:43], v[76:79]
  v_mfma_f32_16x16x32_bf16 v[108:111], a[196:199], v[40:43], v[108:111]
  v_mfma_f32_16x16x32_bf16 v[140:143], v[52:55], v[40:43], v[140:143]
  ds_read_b128 v[40:43], v222 offset:2048
  s_add_u32 m0, s32, 77824
  v_mfma_f32_16x16x32_bf16 v[80:83], a[192:195], v[44:47], v[80:83]
  buffer_load_dwordx4 v4, s[12:15], s30 offen offset:1024 sc1 lds
  v_mfma_f32_16x16x32_bf16 v[112:115], a[196:199], v[44:47], v[112:115]
  ds_read_b128 v[44:47], v223 offset:0
  v_mfma_f32_16x16x32_bf16 v[84:87], a[192:195], v[48:51], v[84:87]
  s_add_u32 m0, s32, 77824
  v_mfma_f32_16x16x32_bf16 v[116:119], a[196:199], v[48:51], v[116:119]
  ds_read_b128 v[48:51], v223 offset:2048
  v_mfma_f32_16x16x32_bf16 v[88:91], a[136:139], v[20:23], v[88:91]
  buffer_load_dwordx4 v4, s[12:15], s30 offen offset:2048 sc1 lds
  v_add_f32 v72, v72, v248
  v_mfma_f32_16x16x32_bf16 v[120:123], a[140:143], v[20:23], v[120:123]
  ds_read_b128 v[20:23], v218 offset:16384
  v_add_f32 v73, v73, v248
  v_add_f32 v74, v74, v248
  v_mfma_f32_16x16x32_bf16 v[92:95], a[136:139], v[24:27], v[92:95]
  s_add_u32 m0, s32, 77824
  v_add_f32 v75, v75, v248
  v_mul_f32 v72, v72, v144
  v_mfma_f32_16x16x32_bf16 v[124:127], a[140:143], v[24:27], v[124:127]
  ds_read_b128 v[24:27], v218 offset:18432
  v_mul_f32 v73, v73, v145
  s_waitcnt lgkmcnt(6)
  v_mfma_f32_16x16x32_bf16 v[96:99], a[136:139], v[28:31], v[96:99]
  buffer_load_dwordx4 v4, s[12:15], s30 offen offset:3072 sc1 lds
  v_mul_f32 v74, v74, v146
  v_mfma_f32_16x16x32_bf16 v[128:131], a[140:143], v[28:31], v[128:131]
  ds_read_b128 v[28:31], v219 offset:16384
  s_add_u32 m0, s32, 81920
  v_mul_f32 v75, v75, v147
  v_mfma_f32_16x16x32_bf16 v[100:103], a[136:139], v[32:35], v[100:103]
  buffer_load_dwordx4 v9, s[12:15], s31 offen offset:0 sc1 lds
  s_add_u32 s30, s30, 5120
  v_mfma_f32_16x16x32_bf16 v[132:135], a[140:143], v[32:35], v[132:135]
  ds_read_b128 v[32:35], v219 offset:18432
  s_add_u32 s31, s31, 5120
  s_waitcnt lgkmcnt(6)
  v_mfma_f32_16x16x32_bf16 v[88:91], a[144:147], v[36:39], v[88:91]
  v_add_f32 v104, v104, v248
  v_add_f32 v105, v105, v248
  v_add_f32 v106, v106, v248
  v_mfma_f32_16x16x32_bf16 v[120:123], a[148:151], v[36:39], v[120:123]
  ds_read_b128 v[36:39], v222 offset:16384
  v_add_f32 v107, v107, v248
  v_mul_f32 v104, v104, v176
  v_mfma_f32_16x16x32_bf16 v[92:95], a[144:147], v[40:43], v[92:95]
  v_mul_f32 v105, v105, v177
  v_mul_f32 v106, v106, v178
  v_mul_f32 v107, v107, v179
  v_mfma_f32_16x16x32_bf16 v[124:127], a[148:151], v[40:43], v[124:127]
  ds_read_b128 v[40:43], v222 offset:18432
  v_add_f32 v136, v136, v248
  s_waitcnt lgkmcnt(6)
  v_mfma_f32_16x16x32_bf16 v[96:99], a[144:147], v[44:47], v[96:99]
  v_add_f32 v137, v137, v248
  v_add_f32 v138, v138, v248
  v_add_f32 v139, v139, v248
  v_mfma_f32_16x16x32_bf16 v[128:131], a[148:151], v[44:47], v[128:131]
  ds_read_b128 v[44:47], v223 offset:16384
  v_mul_f32 v136, v136, v208
  v_mul_f32 v137, v137, v209
  v_mfma_f32_16x16x32_bf16 v[100:103], a[144:147], v[48:51], v[100:103]
  v_mul_f32 v138, v138, v210
  v_mul_f32 v139, v139, v211
  v_cvt_pk_bf16_f32 v72, v72, v73
  v_mfma_f32_16x16x32_bf16 v[132:135], a[148:151], v[48:51], v[132:135]
  ds_read_b128 v[48:51], v223 offset:18432
  v_cvt_pk_bf16_f32 v73, v74, v75
  s_waitcnt lgkmcnt(6)
  v_mfma_f32_16x16x32_bf16 v[88:91], a[152:155], v[20:23], v[88:91]
  v_cvt_pk_bf16_f32 v74, v104, v105
  v_cvt_pk_bf16_f32 v75, v106, v107
  s_mul_i32 s27, s50, 73728
  v_mfma_f32_16x16x32_bf16 v[120:123], a[156:159], v[20:23], v[120:123]
  ds_read_b128 v[20:23], v218 offset:36864
  s_add_u32 s27, s27, s28
  v_mfma_f32_16x16x32_bf16 v[92:95], a[152:155], v[24:27], v[92:95]
  buffer_store_dwordx4 v[72:75], v4, s[8:11], s27 offen sc1
  v_cvt_pk_bf16_f32 v136, v136, v137
  v_mfma_f32_16x16x32_bf16 v[124:127], a[156:159], v[24:27], v[124:127]
  ds_read_b128 v[24:27], v218 offset:38912
  v_cvt_pk_bf16_f32 v137, v138, v139
  s_waitcnt lgkmcnt(6)
  v_mfma_f32_16x16x32_bf16 v[96:99], a[152:155], v[28:31], v[96:99]
  buffer_store_dwordx2 v[136:137], v4, s[8:11], s33 offen sc1
  s_add_u32 s33, s33, 73728
  v_mfma_f32_16x16x32_bf16 v[128:131], a[156:159], v[28:31], v[128:131]
  ds_read_b128 v[28:31], v219 offset:36864
  v_add_f32 v76, v76, v249
  v_add_f32 v77, v77, v249
  v_mfma_f32_16x16x32_bf16 v[100:103], a[152:155], v[32:35], v[100:103]
  v_add_f32 v78, v78, v249
  v_add_f32 v79, v79, v249
  v_mul_f32 v76, v76, v148
  v_mfma_f32_16x16x32_bf16 v[132:135], a[156:159], v[32:35], v[132:135]
  ds_read_b128 v[32:35], v219 offset:38912
  v_mul_f32 v77, v77, v149
  s_waitcnt lgkmcnt(6)
  v_mfma_f32_16x16x32_bf16 v[88:91], a[160:163], v[36:39], v[88:91]
  v_mul_f32 v78, v78, v150
  v_mul_f32 v79, v79, v151
  v_add_f32 v108, v108, v249
  v_mfma_f32_16x16x32_bf16 v[120:123], a[164:167], v[36:39], v[120:123]
  ds_read_b128 v[36:39], v222 offset:36864
  v_add_f32 v109, v109, v249
  v_add_f32 v110, v110, v249
  v_mfma_f32_16x16x32_bf16 v[92:95], a[160:163], v[40:43], v[92:95]
  v_add_f32 v111, v111, v249
  v_mul_f32 v108, v108, v180
  v_mul_f32 v109, v109, v181
  v_mfma_f32_16x16x32_bf16 v[124:127], a[164:167], v[40:43], v[124:127]
  ds_read_b128 v[40:43], v222 offset:38912
  v_mul_f32 v110, v110, v182
  s_waitcnt lgkmcnt(6)
  v_mfma_f32_16x16x32_bf16 v[96:99], a[160:163], v[44:47], v[96:99]
  v_mul_f32 v111, v111, v183
  v_add_f32 v140, v140, v249
  v_add_f32 v141, v141, v249
  v_mfma_f32_16x16x32_bf16 v[128:131], a[164:167], v[44:47], v[128:131]
  ds_read_b128 v[44:47], v223 offset:36864
  v_add_f32 v142, v142, v249
  v_add_f32 v143, v143, v249
  v_mfma_f32_16x16x32_bf16 v[100:103], a[160:163], v[48:51], v[100:103]
  v_mul_f32 v140, v140, v212
  v_mul_f32 v141, v141, v213
  v_mul_f32 v142, v142, v214
  v_mfma_f32_16x16x32_bf16 v[132:135], a[164:167], v[48:51], v[132:135]
  ds_read_b128 v[48:51], v223 offset:38912
  v_mul_f32 v143, v143, v215
  s_waitcnt lgkmcnt(6)
  v_mfma_f32_16x16x32_bf16 v[88:91], a[168:171], v[20:23], v[88:91]
  v_cvt_pk_bf16_f32 v76, v76, v77
  v_cvt_pk_bf16_f32 v77, v78, v79
  v_cvt_pk_bf16_f32 v78, v108, v109
  v_mfma_f32_16x16x32_bf16 v[120:123], a[172:175], v[20:23], v[120:123]
  ds_read_b128 v[20:23], v218 offset:53248
  v_cvt_pk_bf16_f32 v79, v110, v111
  s_add_u32 s27, s27, 73728
  v_mfma_f32_16x16x32_bf16 v[92:95], a[168:171], v[24:27], v[92:95]
  buffer_store_dwordx4 v[76:79], v4, s[8:11], s27 offen sc1
  v_cvt_pk_bf16_f32 v140, v140, v141
  v_mfma_f32_16x16x32_bf16 v[124:127], a[172:175], v[24:27], v[124:127]
  ds_read_b128 v[24:27], v218 offset:55296
  v_cvt_pk_bf16_f32 v141, v142, v143
  s_waitcnt lgkmcnt(6)
  v_mfma_f32_16x16x32_bf16 v[96:99], a[168:171], v[28:31], v[96:99]
  buffer_store_dwordx2 v[140:141], v4, s[8:11], s33 offen sc1
  s_add_u32 s33, s33, 73728
  v_mfma_f32_16x16x32_bf16 v[128:131], a[172:175], v[28:31], v[128:131]
  ds_read_b128 v[28:31], v219 offset:53248
  v_add_f32 v80, v80, v250
  v_add_f32 v81, v81, v250
  v_mfma_f32_16x16x32_bf16 v[100:103], a[168:171], v[32:35], v[100:103]
  v_add_f32 v82, v82, v250
  v_add_f32 v83, v83, v250
  v_mul_f32 v80, v80, v152
  v_mfma_f32_16x16x32_bf16 v[132:135], a[172:175], v[32:35], v[132:135]
  ds_read_b128 v[32:35], v219 offset:55296
  v_mul_f32 v81, v81, v153
  s_waitcnt lgkmcnt(6)
  v_mfma_f32_16x16x32_bf16 v[88:91], a[176:179], v[36:39], v[88:91]
  v_mul_f32 v82, v82, v154
  v_mul_f32 v83, v83, v155
  v_add_f32 v112, v112, v250
  v_mfma_f32_16x16x32_bf16 v[120:123], a[180:183], v[36:39], v[120:123]
  ds_read_b128 v[36:39], v222 offset:53248
  v_add_f32 v113, v113, v250
  v_add_f32 v114, v114, v250
  v_mfma_f32_16x16x32_bf16 v[92:95], a[176:179], v[40:43], v[92:95]
  v_add_f32 v115, v115, v250
  v_mul_f32 v112, v112, v184
  v_mul_f32 v113, v113, v185
  v_mfma_f32_16x16x32_bf16 v[124:127], a[180:183], v[40:43], v[124:127]
  ds_read_b128 v[40:43], v222 offset:55296
  v_mul_f32 v114, v114, v186
  s_waitcnt lgkmcnt(6)
  v_mfma_f32_16x16x32_bf16 v[96:99], a[176:179], v[44:47], v[96:99]
  v_mul_f32 v115, v115, v187
  v_cvt_pk_bf16_f32 v80, v80, v81
  v_cvt_pk_bf16_f32 v81, v82, v83
  v_mfma_f32_16x16x32_bf16 v[128:131], a[180:183], v[44:47], v[128:131]
  ds_read_b128 v[44:47], v223 offset:53248
  v_cvt_pk_bf16_f32 v82, v112, v113
  v_cvt_pk_bf16_f32 v83, v114, v115
  v_mfma_f32_16x16x32_bf16 v[100:103], a[176:179], v[48:51], v[100:103]
  s_mul_i32 s27, s51, 73728
  s_add_u32 s27, s27, s28
  v_mfma_f32_16x16x32_bf16 v[132:135], a[180:183], v[48:51], v[132:135]
  ds_read_b128 v[48:51], v223 offset:55296
  s_waitcnt lgkmcnt(6)
  v_mfma_f32_16x16x32_bf16 v[88:91], a[184:187], v[20:23], v[88:91]
  buffer_store_dwordx4 v[80:83], v4, s[8:11], s27 offen sc1
  v_add_f32 v84, v84, v251
  v_mfma_f32_16x16x32_bf16 v[120:123], a[188:191], v[20:23], v[120:123]
  v_add_f32 v85, v85, v251
  v_add_f32 v86, v86, v251
  v_add_f32 v87, v87, v251
  v_mfma_f32_16x16x32_bf16 v[92:95], a[184:187], v[24:27], v[92:95]
  v_mul_f32 v84, v84, v156
  v_mul_f32 v85, v85, v157
  v_mul_f32 v86, v86, v158
  v_mfma_f32_16x16x32_bf16 v[124:127], a[188:191], v[24:27], v[124:127]
  v_mul_f32 v87, v87, v159
  v_add_f32 v116, v116, v251
  s_waitcnt lgkmcnt(4)
  v_mfma_f32_16x16x32_bf16 v[96:99], a[184:187], v[28:31], v[96:99]
  v_add_f32 v117, v117, v251
  v_add_f32 v118, v118, v251
  v_add_f32 v119, v119, v251
  v_mfma_f32_16x16x32_bf16 v[128:131], a[188:191], v[28:31], v[128:131]
  v_mul_f32 v116, v116, v188
  v_mul_f32 v117, v117, v189
  v_mul_f32 v118, v118, v190
  v_mfma_f32_16x16x32_bf16 v[100:103], a[184:187], v[32:35], v[100:103]
  v_mul_f32 v119, v119, v191
  v_cvt_pk_bf16_f32 v84, v84, v85
  v_cvt_pk_bf16_f32 v85, v86, v87
  v_mfma_f32_16x16x32_bf16 v[132:135], a[188:191], v[32:35], v[132:135]
  v_cvt_pk_bf16_f32 v86, v116, v117
  v_cvt_pk_bf16_f32 v87, v118, v119
  s_waitcnt lgkmcnt(2)
  v_mfma_f32_16x16x32_bf16 v[88:91], a[192:195], v[36:39], v[88:91]
  s_add_u32 s27, s27, 73728
  buffer_store_dwordx4 v[84:87], v4, s[8:11], s27 offen sc1
  v_mfma_f32_16x16x32_bf16 v[120:123], a[196:199], v[36:39], v[120:123]
  v_mfma_f32_16x16x32_bf16 v[92:95], a[192:195], v[40:43], v[92:95]
  v_mfma_f32_16x16x32_bf16 v[124:127], a[196:199], v[40:43], v[124:127]
  s_waitcnt lgkmcnt(0)
  v_mfma_f32_16x16x32_bf16 v[96:99], a[192:195], v[44:47], v[96:99]
  v_mfma_f32_16x16x32_bf16 v[128:131], a[196:199], v[44:47], v[128:131]
  v_mfma_f32_16x16x32_bf16 v[100:103], a[192:195], v[48:51], v[100:103]
  v_mfma_f32_16x16x32_bf16 v[132:135], a[196:199], v[48:51], v[132:135]
  v_pk_add_f32 v[88:89], v[88:89], v[252:253] op_sel:[0,0] op_sel_hi:[1,0]
  v_pk_add_f32 v[90:91], v[90:91], v[252:253] op_sel:[0,0] op_sel_hi:[1,0]
  v_pk_add_f32 v[120:121], v[120:121], v[252:253] op_sel:[0,0] op_sel_hi:[1,0]
  v_pk_add_f32 v[122:123], v[122:123], v[252:253] op_sel:[0,0] op_sel_hi:[1,0]
  v_pk_mul_f32 v[88:89], v[88:89], v[160:161]
  v_pk_mul_f32 v[90:91], v[90:91], v[162:163]
  v_pk_mul_f32 v[120:121], v[120:121], v[192:193]
  v_pk_mul_f32 v[122:123], v[122:123], v[194:195]
  v_cvt_pk_bf16_f32 v36, v88, v89
  v_cvt_pk_bf16_f32 v37, v90, v91
  v_cvt_pk_bf16_f32 v38, v120, v121
  v_cvt_pk_bf16_f32 v39, v122, v123
  s_mul_i32 s27, s52, 73728
  s_add_u32 s27, s27, s28
  buffer_store_dwordx4 v[36:39], v4, s[8:11], s27 offen sc1
  v_pk_add_f32 v[92:93], v[92:93], v[252:253] op_sel:[0,1] op_sel_hi:[1,1]
  v_pk_add_f32 v[94:95], v[94:95], v[252:253] op_sel:[0,1] op_sel_hi:[1,1]
  v_pk_add_f32 v[124:125], v[124:125], v[252:253] op_sel:[0,1] op_sel_hi:[1,1]
  v_pk_add_f32 v[126:127], v[126:127], v[252:253] op_sel:[0,1] op_sel_hi:[1,1]
  v_pk_mul_f32 v[92:93], v[92:93], v[164:165]
  v_pk_mul_f32 v[94:95], v[94:95], v[166:167]
  v_pk_mul_f32 v[124:125], v[124:125], v[196:197]
  v_pk_mul_f32 v[126:127], v[126:127], v[198:199]
  v_cvt_pk_bf16_f32 v40, v92, v93
  v_cvt_pk_bf16_f32 v41, v94, v95
  v_cvt_pk_bf16_f32 v42, v124, v125
  v_cvt_pk_bf16_f32 v43, v126, v127
  s_add_u32 s27, s27, 73728
  buffer_store_dwordx4 v[40:43], v4, s[8:11], s27 offen sc1
  v_pk_add_f32 v[96:97], v[96:97], v[254:255] op_sel:[0,0] op_sel_hi:[1,0]
  v_pk_add_f32 v[98:99], v[98:99], v[254:255] op_sel:[0,0] op_sel_hi:[1,0]
  v_pk_add_f32 v[128:129], v[128:129], v[254:255] op_sel:[0,0] op_sel_hi:[1,0]
  v_pk_add_f32 v[130:131], v[130:131], v[254:255] op_sel:[0,0] op_sel_hi:[1,0]
  v_pk_mul_f32 v[96:97], v[96:97], v[168:169]
  v_pk_mul_f32 v[98:99], v[98:99], v[170:171]
  v_pk_mul_f32 v[128:129], v[128:129], v[200:201]
  v_pk_mul_f32 v[130:131], v[130:131], v[202:203]
  v_cvt_pk_bf16_f32 v44, v96, v97
  v_cvt_pk_bf16_f32 v45, v98, v99
  v_cvt_pk_bf16_f32 v46, v128, v129
  v_cvt_pk_bf16_f32 v47, v130, v131
  s_mul_i32 s27, s53, 73728
  s_add_u32 s27, s27, s28
  buffer_store_dwordx4 v[44:47], v4, s[8:11], s27 offen sc1
  v_pk_add_f32 v[100:101], v[100:101], v[254:255] op_sel:[0,1] op_sel_hi:[1,1]
  v_pk_add_f32 v[102:103], v[102:103], v[254:255] op_sel:[0,1] op_sel_hi:[1,1]
  v_pk_add_f32 v[132:133], v[132:133], v[254:255] op_sel:[0,1] op_sel_hi:[1,1]
  v_pk_add_f32 v[134:135], v[134:135], v[254:255] op_sel:[0,1] op_sel_hi:[1,1]
  v_pk_mul_f32 v[100:101], v[100:101], v[172:173]
  v_pk_mul_f32 v[102:103], v[102:103], v[174:175]
  v_pk_mul_f32 v[132:133], v[132:133], v[204:205]
  v_pk_mul_f32 v[134:135], v[134:135], v[206:207]
  v_cvt_pk_bf16_f32 v48, v100, v101
  v_cvt_pk_bf16_f32 v49, v102, v103
  v_cvt_pk_bf16_f32 v50, v132, v133
  v_cvt_pk_bf16_f32 v51, v134, v135
  s_add_u32 s27, s27, 73728
  buffer_store_dwordx4 v[48:51], v4, s[8:11], s27 offen sc1
  buffer_load_dwordx4 a[104:107], v4, s[12:15], s30 offen offset:0 sc1
  buffer_load_dwordx4 a[108:111], v4, s[12:15], s30 offen offset:1024 sc1
  buffer_load_dwordx4 a[112:115], v4, s[12:15], s30 offen offset:2048 sc1
  buffer_load_dwordx4 a[116:119], v4, s[12:15], s30 offen offset:3072 sc1
  buffer_load_dwordx4 a[120:123], v9, s[12:15], s31 offen offset:0 sc1
  s_add_u32 s30, s30, 5120
  s_add_u32 s31, s31, 5120
  buffer_load_dwordx4 a[124:127], v4, s[12:15], s30 offen offset:0 sc1
  buffer_load_dwordx4 a[128:131], v4, s[12:15], s30 offen offset:1024 sc1
  buffer_load_dwordx4 a[132:135], v4, s[12:15], s30 offen offset:2048 sc1
  s_add_u32 m0, s32, 107520
  s_nop 0
  buffer_load_dwordx4 v4, s[12:15], s30 offen offset:3072 sc1 lds
  s_add_u32 m0, s32, 111616
  s_nop 0
  buffer_load_dwordx4 v9, s[12:15], s31 offen offset:0 sc1 lds
  s_add_u32 s30, s30, 5120
  s_add_u32 s31, s31, 5120
  s_add_u32 m0, s32, 112640
  s_nop 0
  buffer_load_dwordx4 v4, s[12:15], s30 offen offset:0 sc1 lds
  s_add_u32 m0, s32, 112640
  s_nop 0
  buffer_load_dwordx4 v4, s[12:15], s30 offen offset:1024 sc1 lds
  s_waitcnt vmcnt(56)
  s_add_u32 m0, s32, 112640
  s_nop 0
  buffer_load_dwordx4 v4, s[12:15], s30 offen offset:2048 sc1 lds
  s_add_u32 m0, s32, 112640
  s_nop 0
  buffer_load_dwordx4 v4, s[12:15], s30 offen offset:3072 sc1 lds
  s_add_u32 m0, s32, 116736
  s_nop 0
  buffer_load_dwordx4 v9, s[12:15], s31 offen offset:0 sc1 lds
  s_add_u32 s30, s30, 5120
  s_add_u32 s31, s31, 5120
  s_add_u32 m0, s32, 117760
  s_nop 0
  buffer_load_dwordx4 v4, s[12:15], s30 offen offset:0 sc1 lds
  s_add_u32 m0, s32, 117760
  s_nop 0
  buffer_load_dwordx4 v4, s[12:15], s30 offen offset:1024 sc1 lds
  s_add_u32 s26, s3, 0
  s_and_b32 s50, s26, 3
  s_lshl_b32 s26, s22, 2
  s_add_u32 s26, s26, s50
  s_mul_i32 s26, s26, 73728
  s_mul_i32 s27, s3, 18432
  s_add_u32 s44, s26, s27
  s_add_u32 s26, s3, 1
  s_and_b32 s51, s26, 3
  s_lshl_b32 s26, s22, 2
  s_add_u32 s26, s26, s51
  s_mul_i32 s26, s26, 73728
  s_mul_i32 s27, s3, 18432
  s_add_u32 s45, s26, s27
  s_add_u32 s26, s3, 2
  s_and_b32 s52, s26, 3
  s_lshl_b32 s26, s22, 2
  s_add_u32 s26, s26, s52
  s_mul_i32 s26, s26, 73728
  s_mul_i32 s27, s3, 18432
  s_add_u32 s46, s26, s27
  s_add_u32 s26, s3, 3
  s_and_b32 s53, s26, 3
  s_lshl_b32 s26, s22, 2
  s_add_u32 s26, s26, s53
  s_mul_i32 s26, s26, 73728
  s_mul_i32 s27, s3, 18432
  s_add_u32 s47, s26, s27
  s_mov_b32 s40, s36
  s_mov_b32 s41, s37
  s_mov_b32 s42, 2359296
  s_mov_b32 s43, 0x20000
  v_add_u32 v7, s32, v4
  v_add_u32 v8, 73728, v7
  s_lshl_b32 s26, s22, 6
  s_lshl_b32 s27, s3, 4
  s_add_u32 s26, s26, s27
  v_add_u32 v14, s26, v3
  s_movk_i32 s27, 1152
  v_lshlrev_b32 v15, 3, v5
  v_mad_u32_u24 v15, v14, s27, v15
  v_cmp_gt_u32 vcc, 2, v5
  v_mov_b32 v16, 0x80000000
  s_nop 0
  v_cndmask_b32 v16, v16, v15, vcc
  s_mul_i32 s26, s51, 15360
  s_add_u32 s26, s26, 73728
  v_add_u32 v11, s26, v4
  s_mul_i32 s26, s52, 15360
  s_add_u32 s26, s26, 78848
  v_add_u32 v12, s26, v4
  s_mul_i32 s26, s53, 15360
  s_add_u32 s26, s26, 83968
  v_add_u32 v13, s26, v4
  s_mul_i32 s26, s3, 15360
  s_add_u32 s26, s26, 73728
  v_add_u32 v10, s26, v4
  s_mul_i32 s27, s23, 144
  s_lshl_b32 s33, s20, 4
  s_add_u32 s33, s33, s21
  s_lshr_b32 s25, s22, 1
  s_lshl_b32 s25, s25, 4
  s_waitcnt vmcnt(17)
  s_barrier
  s_cmp_lg_u32 s3, 0
  s_cbranch_scc1 L_sig_15
  s_lshl_b32 s24, s33, 6
  s_add_u32 s24, s24, 98304
  v_mov_b32 v1, 0
  v_mov_b32 v6, s97
  s_mov_b64 exec, 1
  buffer_store_dword v6, v1, s[56:59], s24 offen sc1
  s_mov_b64 exec, -1
L_sig_15:
  buffer_load_dwordx4 a[136:139], v4, s[12:15], s30 offen offset:2048 sc1
  buffer_load_dwordx4 a[140:143], v4, s[12:15], s30 offen offset:3072 sc1
  buffer_load_dwordx4 a[144:147], v9, s[12:15], s31 offen offset:0 sc1
  s_add_u32 s30, s30, 5120
  s_add_u32 s31, s31, 5120
  buffer_load_dwordx4 a[148:151], v4, s[12:15], s30 offen offset:0 sc1
  buffer_load_dwordx4 a[152:155], v4, s[12:15], s30 offen offset:1024 sc1
  buffer_load_dwordx4 a[156:159], v4, s[12:15], s30 offen offset:2048 sc1
  buffer_load_dwordx4 a[160:163], v4, s[12:15], s30 offen offset:3072 sc1
  buffer_load_dwordx4 a[164:167], v9, s[12:15], s31 offen offset:0 sc1
  s_add_u32 s30, s30, 5120
  s_add_u32 s31, s31, 5120
  s_add_u32 m0, s32, 0
  s_nop 0
  buffer_load_dwordx4 v4, s[12:15], s30 offen offset:0 sc1 lds
  s_add_u32 m0, s32, 0
  s_nop 0
  buffer_load_dwordx4 v4, s[12:15], s30 offen offset:1024 sc1 lds
  s_add_u32 m0, s32, 0
  s_nop 0
  buffer_load_dwordx4 v4, s[12:15], s30 offen offset:2048 sc1 lds
  s_add_u32 m0, s32, 0
  s_nop 0
  buffer_load_dwordx4 v4, s[12:15], s30 offen offset:3072 sc1 lds
  s_add_u32 m0, s32, 4096
  s_nop 0
  buffer_load_dwordx4 v9, s[12:15], s31 offen offset:0 sc1 lds
  s_add_u32 s30, s30, 5120
  s_add_u32 s31, s31, 5120
  s_add_u32 m0, s32, 5120
  s_nop 0
  buffer_load_dwordx4 v4, s[12:15], s30 offen offset:0 sc1 lds
  s_add_u32 m0, s32, 5120
  s_nop 0
  buffer_load_dwordx4 v4, s[12:15], s30 offen offset:1024 sc1 lds
  s_add_u32 m0, s32, 5120
  s_nop 0
  buffer_load_dwordx4 v4, s[12:15], s30 offen offset:2048 sc1 lds
  s_add_u32 m0, s32, 5120
  s_nop 0
  buffer_load_dwordx4 v4, s[12:15], s30 offen offset:3072 sc1 lds
  s_add_u32 m0, s32, 36864
  s_nop 0
  buffer_load_dwordx4 v9, s[12:15], s31 offen offset:0 sc1 lds
  s_add_u32 s30, s30, 5120
  s_add_u32 s31, s31, 5120
  s_add_u32 m0, s32, 37888
  s_nop 0
  buffer_load_dwordx4 v4, s[12:15], s30 offen offset:0 sc1 lds
  s_add_u32 m0, s32, 37888
  s_nop 0
  buffer_load_dwordx4 v4, s[12:15], s30 offen offset:1024 sc1 lds
  s_add_u32 m0, s32, 37888
  s_nop 0
  buffer_load_dwordx4 v4, s[12:15], s30 offen offset:2048 sc1 lds
  s_add_u32 m0, s32, 37888
  s_nop 0
  buffer_load_dwordx4 v4, s[12:15], s30 offen offset:3072 sc1 lds
  s_add_u32 m0, s32, 41984
  s_nop 0
  buffer_load_dwordx4 v9, s[12:15], s31 offen offset:0 sc1 lds
  s_add_u32 s30, s30, 5120
  s_add_u32 s31, s31, 5120
  s_add_u32 m0, s32, 43008
  s_nop 0
  buffer_load_dwordx4 v4, s[12:15], s30 offen offset:0 sc1 lds
  s_add_u32 m0, s32, 43008
  s_nop 0
  buffer_load_dwordx4 v4, s[12:15], s30 offen offset:1024 sc1 lds
  buffer_load_dwordx4 a[168:171], v4, s[12:15], s30 offen offset:2048 sc1
  buffer_load_dwordx4 a[172:175], v4, s[12:15], s30 offen offset:3072 sc1
  buffer_load_dwordx4 a[176:179], v9, s[12:15], s31 offen offset:0 sc1
  s_add_u32 s30, s30, 5120
  s_add_u32 s31, s31, 5120
  buffer_load_dwordx4 a[180:183], v4, s[12:15], s30 offen offset:0 sc1
  buffer_load_dwordx4 a[184:187], v4, s[12:15], s30 offen offset:1024 sc1
  buffer_load_dwordx4 a[188:191], v4, s[12:15], s30 offen offset:2048 sc1
  buffer_load_dwordx4 a[192:195], v4, s[12:15], s30 offen offset:3072 sc1
  buffer_load_dwordx4 a[196:199], v9, s[12:15], s31 offen offset:0 sc1
  s_add_u32 s30, s30, 5120
  s_add_u32 s31, s31, 5120
  s_cmp_lg_u32 s3, 0
  s_cbranch_scc1 L_aw_16_d
  s_lshl_b32 s24, s25, 6
  s_add_u32 s24, s24, 98304
  v_lshlrev_b32 v1, 6, v2
  s_mov_b64 exec, 0xffff
L_aw_16:
  buffer_load_dword v6, v1, s[56:59], s24 offen sc1
  s_waitcnt vmcnt(0)
  v_cmp_ne_u32 vcc, s97, v6
  s_nop 0
  s_cbranch_vccz L_aw_16_g
  s_branch L_aw_16
L_aw_16_g:
  s_mov_b64 exec, -1
L_aw_16_d:
  s_barrier
  buffer_load_dwordx4 v[100:103], v4, s[8:11], s44 offen offset:0 sc1
  buffer_load_dwordx4 v[104:107], v4, s[8:11], s45 offen offset:0 sc1
  buffer_load_dwordx4 v[108:111], v4, s[8:11], s46 offen offset:0 sc1
  buffer_load_dwordx4 v[112:115], v4, s[8:11], s47 offen offset:0 sc1
  buffer_load_dwordx4 v[116:119], v4, s[8:11], s44 offen offset:1024 sc1
  buffer_load_dwordx4 v[120:123], v4, s[8:11], s45 offen offset:1024 sc1
  buffer_load_dwordx4 v[124:127], v4, s[8:11], s46 offen offset:1024 sc1
  buffer_load_dwordx4 v[128:131], v4, s[8:11], s47 offen offset:1024 sc1
  buffer_load_dwordx4 v[132:135], v4, s[8:11], s44 offen offset:2048 sc1
  buffer_load_dwordx4 v[136:139], v4, s[8:11], s45 offen offset:2048 sc1
  buffer_load_dwordx4 v[140:143], v4, s[8:11], s46 offen offset:2048 sc1
  buffer_load_dwordx4 v[144:147], v4, s[8:11], s47 offen offset:2048 sc1
  s_waitcnt vmcnt(56)
  s_waitcnt vmcnt(8)
  v_mfma_f32_16x16x32_bf16 v[20:23], a[0:3], v[100:103], 0
  buffer_load_dwordx4 v[148:151], v4, s[8:11], s44 offen offset:3072 sc1
  v_mfma_f32_16x16x32_bf16 v[40:43], a[0:3], v[104:107], 0
  s_add_u32 s44, s44, 4096
  v_mfma_f32_16x16x32_bf16 v[60:63], a[0:3], v[108:111], 0
  buffer_load_dwordx4 v[152:155], v4, s[8:11], s45 offen offset:3072 sc1
  v_mfma_f32_16x16x32_bf16 v[80:83], a[0:3], v[112:115], 0
  ds_read_b128 v[228:231], v8 offset:0
  ds_read_b128 v[232:235], v8 offset:1024
  v_mfma_f32_16x16x32_bf16 v[24:27], a[4:7], v[100:103], 0
  ds_read_b128 v[236:239], v8 offset:2048
  ds_read_b128 v[240:243], v8 offset:3072
  v_mfma_f32_16x16x32_bf16 v[44:47], a[4:7], v[104:107], 0
  ds_read_b128 v[244:247], v8 offset:4096
  ds_read_b128 v[248:251], v8 offset:5120
  v_mfma_f32_16x16x32_bf16 v[64:67], a[4:7], v[108:111], 0
  s_add_u32 s45, s45, 4096
  v_mfma_f32_16x16x32_bf16 v[84:87], a[4:7], v[112:115], 0
  buffer_load_dwordx4 v[156:159], v4, s[8:11], s46 offen offset:3072 sc1
  v_mfma_f32_16x16x32_bf16 v[28:31], a[8:11], v[100:103], 0
  s_add_u32 s46, s46, 4096
  v_mfma_f32_16x16x32_bf16 v[48:51], a[8:11], v[104:107], 0
  buffer_load_dwordx4 v[160:163], v4, s[8:11], s47 offen offset:3072 sc1
  v_mfma_f32_16x16x32_bf16 v[68:71], a[8:11], v[108:111], 0
  s_add_u32 s47, s47, 4096
  v_mfma_f32_16x16x32_bf16 v[88:91], a[8:11], v[112:115], 0
  buffer_load_dwordx4 v[164:167], v4, s[8:11], s44 offen offset:0 sc1
  v_mfma_f32_16x16x32_bf16 v[32:35], a[12:15], v[100:103], 0
  buffer_load_dwordx4 v[168:171], v4, s[8:11], s45 offen offset:0 sc1
  v_mfma_f32_16x16x32_bf16 v[52:55], a[12:15], v[104:107], 0
  buffer_load_dwordx4 v[172:175], v4, s[8:11], s46 offen offset:0 sc1
  v_mfma_f32_16x16x32_bf16 v[72:75], a[12:15], v[108:111], 0
  buffer_load_dwordx4 v[176:179], v4, s[8:11], s47 offen offset:0 sc1
  v_mfma_f32_16x16x32_bf16 v[92:95], a[12:15], v[112:115], 0
  v_mfma_f32_16x16x32_bf16 v[36:39], a[16:19], v[100:103], 0
  buffer_load_dwordx4 v[180:183], v4, s[8:11], s44 offen offset:1024 sc1
  v_mfma_f32_16x16x32_bf16 v[56:59], a[16:19], v[104:107], 0
  v_mfma_f32_16x16x32_bf16 v[76:79], a[16:19], v[108:111], 0
  buffer_load_dwordx4 v[184:187], v4, s[8:11], s45 offen offset:1024 sc1
  v_mfma_f32_16x16x32_bf16 v[96:99], a[16:19], v[112:115], 0
  s_waitcnt vmcnt(14)
  v_mfma_f32_16x16x32_bf16 v[20:23], a[20:23], v[116:119], v[20:23]
  buffer_load_dwordx4 v[188:191], v4, s[8:11], s46 offen offset:1024 sc1
  v_mfma_f32_16x16x32_bf16 v[40:43], a[20:23], v[120:123], v[40:43]
  v_mfma_f32_16x16x32_bf16 v[60:63], a[20:23], v[124:127], v[60:63]
  buffer_load_dwordx4 v[192:195], v4, s[8:11], s47 offen offset:1024 sc1
  v_mfma_f32_16x16x32_bf16 v[80:83], a[20:23], v[128:131], v[80:83]
  v_mfma_f32_16x16x32_bf16 v[24:27], a[24:27], v[116:119], v[24:27]
  buffer_load_dwordx4 v[196:199], v4, s[8:11], s44 offen offset:2048 sc1
  v_mfma_f32_16x16x32_bf16 v[44:47], a[24:27], v[120:123], v[44:47]
  v_mfma_f32_16x16x32_bf16 v[64:67], a[24:27], v[124:127], v[64:67]
  buffer_load_dwordx4 v[200:203], v4, s[8:11], s45 offen offset:2048 sc1
  v_mfma_f32_16x16x32_bf16 v[84:87], a[24:27], v[128:131], v[84:87]
  v_mfma_f32_16x16x32_bf16 v[28:31], a[28:31], v[116:119], v[28:31]
  buffer_load_dwordx4 v[204:207], v4, s[8:11], s46 offen offset:2048 sc1
  v_mfma_f32_16x16x32_bf16 v[48:51], a[28:31], v[120:123], v[48:51]
  v_mfma_f32_16x16x32_bf16 v[68:71], a[28:31], v[124:127], v[68:71]
  buffer_load_dwordx4 v[208:211], v4, s[8:11], s47 offen offset:2048 sc1
  v_mfma_f32_16x16x32_bf16 v[88:91], a[28:31], v[128:131], v[88:91]
  buffer_load_dwordx4 v[212:215], v4, s[8:11], s44 offen offset:3072 sc1
  v_mfma_f32_16x16x32_bf16 v[32:35], a[32:35], v[116:119], v[32:35]
  s_add_u32 s44, s44, 4096
  buffer_load_dwordx4 v[216:219], v4, s[8:11], s45 offen offset:3072 sc1
  v_mfma_f32_16x16x32_bf16 v[52:55], a[32:35], v[120:123], v[52:55]
  s_add_u32 s45, s45, 4096
  buffer_load_dwordx4 v[220:223], v4, s[8:11], s46 offen offset:3072 sc1
  v_mfma_f32_16x16x32_bf16 v[72:75], a[32:35], v[124:127], v[72:75]
  s_add_u32 s46, s46, 4096
  buffer_load_dwordx4 v[224:227], v4, s[8:11], s47 offen offset:3072 sc1
  v_mfma_f32_16x16x32_bf16 v[92:95], a[32:35], v[128:131], v[92:95]
  s_add_u32 s47, s47, 4096
  buffer_load_dwordx4 v[100:103], v4, s[8:11], s44 offen offset:0 sc1
  v_mfma_f32_16x16x32_bf16 v[36:39], a[36:39], v[116:119], v[36:39]
  buffer_load_dwordx4 v[104:107], v4, s[8:11], s45 offen offset:0 sc1
  v_mfma_f32_16x16x32_bf16 v[56:59], a[36:39], v[120:123], v[56:59]
  buffer_load_dwordx4 v[108:111], v4, s[8:11], s46 offen offset:0 sc1
  v_mfma_f32_16x16x32_bf16 v[76:79], a[36:39], v[124:127], v[76:79]
  buffer_load_dwordx4 v[112:115], v4, s[8:11], s47 offen offset:0 sc1
  v_mfma_f32_16x16x32_bf16 v[96:99], a[36:39], v[128:131], v[96:99]
  s_waitcnt vmcnt(24)
  v_mfma_f32_16x16x32_bf16 v[20:23], a[40:43], v[132:135], v[20:23]
  v_mfma_f32_16x16x32_bf16 v[40:43], a[40:43], v[136:139], v[40:43]
  buffer_load_dwordx4 v[116:119], v4, s[8:11], s44 offen offset:1024 sc1
  v_mfma_f32_16x16x32_bf16 v[60:63], a[40:43], v[140:143], v[60:63]
  v_mfma_f32_16x16x32_bf16 v[80:83], a[40:43], v[144:147], v[80:83]
  v_mfma_f32_16x16x32_bf16 v[24:27], a[44:47], v[132:135], v[24:27]
  v_mfma_f32_16x16x32_bf16 v[44:47], a[44:47], v[136:139], v[44:47]
  buffer_load_dwordx4 v[120:123], v4, s[8:11], s45 offen offset:1024 sc1
  v_mfma_f32_16x16x32_bf16 v[64:67], a[44:47], v[140:143], v[64:67]
  v_mfma_f32_16x16x32_bf16 v[84:87], a[44:47], v[144:147], v[84:87]
  v_mfma_f32_16x16x32_bf16 v[28:31], a[48:51], v[132:135], v[28:31]
  v_mfma_f32_16x16x32_bf16 v[48:51], a[48:51], v[136:139], v[48:51]
  buffer_load_dwordx4 v[124:127], v4, s[8:11], s46 offen offset:1024 sc1
  v_mfma_f32_16x16x32_bf16 v[68:71], a[48:51], v[140:143], v[68:71]
  v_mfma_f32_16x16x32_bf16 v[88:91], a[48:51], v[144:147], v[88:91]
  v_mfma_f32_16x16x32_bf16 v[32:35], a[52:55], v[132:135], v[32:35]
  v_mfma_f32_16x16x32_bf16 v[52:55], a[52:55], v[136:139], v[52:55]
  buffer_load_dwordx4 v[128:131], v4, s[8:11], s47 offen offset:1024 sc1
  v_mfma_f32_16x16x32_bf16 v[72:75], a[52:55], v[140:143], v[72:75]
  v_mfma_f32_16x16x32_bf16 v[92:95], a[52:55], v[144:147], v[92:95]
  v_mfma_f32_16x16x32_bf16 v[36:39], a[56:59], v[132:135], v[36:39]
  v_mfma_f32_16x16x32_bf16 v[56:59], a[56:59], v[136:139], v[56:59]
  v_mfma_f32_16x16x32_bf16 v[76:79], a[56:59], v[140:143], v[76:79]
  v_mfma_f32_16x16x32_bf16 v[96:99], a[56:59], v[144:147], v[96:99]
  s_waitcnt vmcnt(24)
  v_mfma_f32_16x16x32_bf16 v[20:23], a[60:63], v[148:151], v[20:23]
  v_mfma_f32_16x16x32_bf16 v[40:43], a[60:63], v[152:155], v[40:43]
  buffer_load_dwordx4 v[132:135], v4, s[8:11], s44 offen offset:2048 sc1
  v_mfma_f32_16x16x32_bf16 v[60:63], a[60:63], v[156:159], v[60:63]
  v_mfma_f32_16x16x32_bf16 v[80:83], a[60:63], v[160:163], v[80:83]
  v_mfma_f32_16x16x32_bf16 v[24:27], a[64:67], v[148:151], v[24:27]
  v_mfma_f32_16x16x32_bf16 v[44:47], a[64:67], v[152:155], v[44:47]
  buffer_load_dwordx4 v[136:139], v4, s[8:11], s45 offen offset:2048 sc1
  v_mfma_f32_16x16x32_bf16 v[64:67], a[64:67], v[156:159], v[64:67]
  v_mfma_f32_16x16x32_bf16 v[84:87], a[64:67], v[160:163], v[84:87]
  v_mfma_f32_16x16x32_bf16 v[28:31], a[68:71], v[148:151], v[28:31]
  v_mfma_f32_16x16x32_bf16 v[48:51], a[68:71], v[152:155], v[48:51]
  buffer_load_dwordx4 v[140:143], v4, s[8:11], s46 offen offset:2048 sc1
  v_mfma_f32_16x16x32_bf16 v[68:71], a[68:71], v[156:159], v[68:71]
  v_mfma_f32_16x16x32_bf16 v[88:91], a[68:71], v[160:163], v[88:91]
  v_mfma_f32_16x16x32_bf16 v[32:35], a[200:203], v[148:151], v[32:35]
  v_mfma_f32_16x16x32_bf16 v[52:55], a[200:203], v[152:155], v[52:55]
  buffer_load_dwordx4 v[144:147], v4, s[8:11], s47 offen offset:2048 sc1
  v_mfma_f32_16x16x32_bf16 v[72:75], a[200:203], v[156:159], v[72:75]
  v_mfma_f32_16x16x32_bf16 v[92:95], a[200:203], v[160:163], v[92:95]
  v_mfma_f32_16x16x32_bf16 v[36:39], a[204:207], v[148:151], v[36:39]
  v_mfma_f32_16x16x32_bf16 v[56:59], a[204:207], v[152:155], v[56:59]
  v_mfma_f32_16x16x32_bf16 v[76:79], a[204:207], v[156:159], v[76:79]
  v_mfma_f32_16x16x32_bf16 v[96:99], a[204:207], v[160:163], v[96:99]
  s_waitcnt vmcnt(24)
  v_mfma_f32_16x16x32_bf16 v[20:23], a[208:211], v[164:167], v[20:23]
  v_mfma_f32_16x16x32_bf16 v[40:43], a[208:211], v[168:171], v[40:43]
  buffer_load_dwordx4 v[148:151], v4, s[8:11], s44 offen offset:3072 sc1
  v_mfma_f32_16x16x32_bf16 v[60:63], a[208:211], v[172:175], v[60:63]
  s_add_u32 s44, s44, 4096
  v_mfma_f32_16x16x32_bf16 v[80:83], a[208:211], v[176:179], v[80:83]
  v_mfma_f32_16x16x32_bf16 v[24:27], a[212:215], v[164:167], v[24:27]
  v_mfma_f32_16x16x32_bf16 v[44:47], a[212:215], v[168:171], v[44:47]
  buffer_load_dwordx4 v[152:155], v4, s[8:11], s45 offen offset:3072 sc1
  v_mfma_f32_16x16x32_bf16 v[64:67], a[212:215], v[172:175], v[64:67]
  s_add_u32 s45, s45, 4096
  v_mfma_f32_16x16x32_bf16 v[84:87], a[212:215], v[176:179], v[84:87]
  v_mfma_f32_16x16x32_bf16 v[28:31], a[216:219], v[164:167], v[28:31]
  v_mfma_f32_16x16x32_bf16 v[48:51], a[216:219], v[168:171], v[48:51]
  buffer_load_dwordx4 v[156:159], v4, s[8:11], s46 offen offset:3072 sc1
  v_mfma_f32_16x16x32_bf16 v[68:71], a[216:219], v[172:175], v[68:71]
  s_add_u32 s46, s46, 4096
  v_mfma_f32_16x16x32_bf16 v[88:91], a[216:219], v[176:179], v[88:91]
  v_mfma_f32_16x16x32_bf16 v[32:35], a[72:75], v[164:167], v[32:35]
  v_mfma_f32_16x16x32_bf16 v[52:55], a[72:75], v[168:171], v[52:55]
  buffer_load_dwordx4 v[160:163], v4, s[8:11], s47 offen offset:3072 sc1
  v_mfma_f32_16x16x32_bf16 v[72:75], a[72:75], v[172:175], v[72:75]
  s_add_u32 s47, s47, 4096
  v_mfma_f32_16x16x32_bf16 v[92:95], a[72:75], v[176:179], v[92:95]
  v_mfma_f32_16x16x32_bf16 v[36:39], a[76:79], v[164:167], v[36:39]
  v_mfma_f32_16x16x32_bf16 v[56:59], a[76:79], v[168:171], v[56:59]
  v_mfma_f32_16x16x32_bf16 v[76:79], a[76:79], v[172:175], v[76:79]
  v_mfma_f32_16x16x32_bf16 v[96:99], a[76:79], v[176:179], v[96:99]
  s_waitcnt vmcnt(24)
  v_mfma_f32_16x16x32_bf16 v[20:23], a[80:83], v[180:183], v[20:23]
  v_mfma_f32_16x16x32_bf16 v[40:43], a[80:83], v[184:187], v[40:43]
  buffer_load_dwordx4 v[164:167], v4, s[8:11], s44 offen offset:0 sc1
  v_mfma_f32_16x16x32_bf16 v[60:63], a[80:83], v[188:191], v[60:63]
  v_mfma_f32_16x16x32_bf16 v[80:83], a[80:83], v[192:195], v[80:83]
  v_mfma_f32_16x16x32_bf16 v[24:27], a[84:87], v[180:183], v[24:27]
  v_mfma_f32_16x16x32_bf16 v[44:47], a[84:87], v[184:187], v[44:47]
  buffer_load_dwordx4 v[168:171], v4, s[8:11], s45 offen offset:0 sc1
  v_mfma_f32_16x16x32_bf16 v[64:67], a[84:87], v[188:191], v[64:67]
  v_mfma_f32_16x16x32_bf16 v[84:87], a[84:87], v[192:195], v[84:87]
  v_mfma_f32_16x16x32_bf16 v[28:31], a[88:91], v[180:183], v[28:31]
  v_mfma_f32_16x16x32_bf16 v[48:51], a[88:91], v[184:187], v[48:51]
  buffer_load_dwordx4 v[172:175], v4, s[8:11], s46 offen offset:0 sc1
  v_mfma_f32_16x16x32_bf16 v[68:71], a[88:91], v[188:191], v[68:71]
  v_mfma_f32_16x16x32_bf16 v[88:91], a[88:91], v[192:195], v[88:91]
  v_mfma_f32_16x16x32_bf16 v[32:35], a[92:95], v[180:183], v[32:35]
  v_mfma_f32_16x16x32_bf16 v[52:55], a[92:95], v[184:187], v[52:55]
  buffer_load_dwordx4 v[176:179], v4, s[8:11], s47 offen offset:0 sc1
  v_mfma_f32_16x16x32_bf16 v[72:75], a[92:95], v[188:191], v[72:75]
  v_mfma_f32_16x16x32_bf16 v[92:95], a[92:95], v[192:195], v[92:95]
  v_mfma_f32_16x16x32_bf16 v[36:39], a[96:99], v[180:183], v[36:39]
  v_mfma_f32_16x16x32_bf16 v[56:59], a[96:99], v[184:187], v[56:59]
  v_mfma_f32_16x16x32_bf16 v[76:79], a[96:99], v[188:191], v[76:79]
  v_mfma_f32_16x16x32_bf16 v[96:99], a[96:99], v[192:195], v[96:99]
  s_waitcnt vmcnt(24)
  v_mfma_f32_16x16x32_bf16 v[20:23], a[100:103], v[196:199], v[20:23]
  v_mfma_f32_16x16x32_bf16 v[40:43], a[100:103], v[200:203], v[40:43]
  buffer_load_dwordx4 v[180:183], v4, s[8:11], s44 offen offset:1024 sc1
  v_mfma_f32_16x16x32_bf16 v[60:63], a[100:103], v[204:207], v[60:63]
  v_mfma_f32_16x16x32_bf16 v[80:83], a[100:103], v[208:211], v[80:83]
  s_waitcnt lgkmcnt(5)
  v_mfma_f32_16x16x32_bf16 v[24:27], v[228:231], v[196:199], v[24:27]
  v_mfma_f32_16x16x32_bf16 v[44:47], v[228:231], v[200:203], v[44:47]
  buffer_load_dwordx4 v[184:187], v4, s[8:11], s45 offen offset:1024 sc1
  v_mfma_f32_16x16x32_bf16 v[64:67], v[228:231], v[204:207], v[64:67]
  v_mfma_f32_16x16x32_bf16 v[84:87], v[228:231], v[208:211], v[84:87]
  ds_read_b128 v[228:231], v8 offset:6144
  s_waitcnt lgkmcnt(5)
  v_mfma_f32_16x16x32_bf16 v[28:31], v[232:235], v[196:199], v[28:31]
  v_mfma_f32_16x16x32_bf16 v[48:51], v[232:235], v[200:203], v[48:51]
  buffer_load_dwordx4 v[188:191], v4, s[8:11], s46 offen offset:1024 sc1
  v_mfma_f32_16x16x32_bf16 v[68:71], v[232:235], v[204:207], v[68:71]
  v_mfma_f32_16x16x32_bf16 v[88:91], v[232:235], v[208:211], v[88:91]
  ds_read_b128 v[232:235], v8 offset:7168
  s_waitcnt lgkmcnt(5)
  v_mfma_f32_16x16x32_bf16 v[32:35], v[236:239], v[196:199], v[32:35]
  v_mfma_f32_16x16x32_bf16 v[52:55], v[236:239], v[200:203], v[52:55]
  buffer_load_dwordx4 v[192:195], v4, s[8:11], s47 offen offset:1024 sc1
  v_mfma_f32_16x16x32_bf16 v[72:75], v[236:239], v[204:207], v[72:75]
  v_mfma_f32_16x16x32_bf16 v[92:95], v[236:239], v[208:211], v[92:95]
  ds_read_b128 v[236:239], v8 offset:8192
  s_waitcnt lgkmcnt(5)
  v_mfma_f32_16x16x32_bf16 v[36:39], v[240:243], v[196:199], v[36:39]
  v_mfma_f32_16x16x32_bf16 v[56:59], v[240:243], v[200:203], v[56:59]
  v_mfma_f32_16x16x32_bf16 v[76:79], v[240:243], v[204:207], v[76:79]
  v_mfma_f32_16x16x32_bf16 v[96:99], v[240:243], v[208:211], v[96:99]
  ds_read_b128 v[240:243], v8 offset:36864
  s_waitcnt vmcnt(24)
  s_waitcnt lgkmcnt(5)
  v_mfma_f32_16x16x32_bf16 v[20:23], v[244:247], v[212:215], v[20:23]
  v_mfma_f32_16x16x32_bf16 v[40:43], v[244:247], v[216:219], v[40:43]
  buffer_load_dwordx4 v[196:199], v4, s[8:11], s44 offen offset:2048 sc1
  v_mfma_f32_16x16x32_bf16 v[60:63], v[244:247], v[220:223], v[60:63]
  v_mfma_f32_16x16x32_bf16 v[80:83], v[244:247], v[224:227], v[80:83]
  ds_read_b128 v[244:247], v8 offset:37888
  s_waitcnt lgkmcnt(5)
  v_mfma_f32_16x16x32_bf16 v[24:27], v[248:251], v[212:215], v[24:27]
  v_mfma_f32_16x16x32_bf16 v[44:47], v[248:251], v[216:219], v[44:47]
  buffer_load_dwordx4 v[200:203], v4, s[8:11], s45 offen offset:2048 sc1
  v_mfma_f32_16x16x32_bf16 v[64:67], v[248:251], v[220:223], v[64:67]
  v_mfma_f32_16x16x32_bf16 v[84:87], v[248:251], v[224:227], v[84:87]
  ds_read_b128 v[248:251], v8 offset:38912
  s_waitcnt lgkmcnt(5)
  v_mfma_f32_16x16x32_bf16 v[28:31], v[228:231], v[212:215], v[28:31]
  v_mfma_f32_16x16x32_bf16 v[48:51], v[228:231], v[216:219], v[48:51]
  buffer_load_dwordx4 v[204:207], v4, s[8:11], s46 offen offset:2048 sc1
  v_mfma_f32_16x16x32_bf16 v[68:71], v[228:231], v[220:223], v[68:71]
  v_mfma_f32_16x16x32_bf16 v[88:91], v[228:231], v[224:227], v[88:91]
  ds_read_b128 v[228:231], v8 offset:39936
  s_waitcnt lgkmcnt(5)
  v_mfma_f32_16x16x32_bf16 v[32:35], v[232:235], v[212:215], v[32:35]
  v_mfma_f32_16x16x32_bf16 v[52:55], v[232:235], v[216:219], v[52:55]
  buffer_load_dwordx4 v[208:211], v4, s[8:11], s47 offen offset:2048 sc1
  v_mfma_f32_16x16x32_bf16 v[72:75], v[232:235], v[220:223], v[72:75]
  v_mfma_f32_16x16x32_bf16 v[92:95], v[232:235], v[224:227], v[92:95]
  ds_read_b128 v[232:235], v8 offset:40960
  s_waitcnt lgkmcnt(5)
  v_mfma_f32_16x16x32_bf16 v[36:39], v[236:239], v[212:215], v[36:39]
  v_mfma_f32_16x16x32_bf16 v[56:59], v[236:239], v[216:219], v[56:59]
  v_mfma_f32_16x16x32_bf16 v[76:79], v[236:239], v[220:223], v[76:79]
  v_mfma_f32_16x16x32_bf16 v[96:99], v[236:239], v[224:227], v[96:99]
  ds_read_b128 v[236:239], v8 offset:41984
  s_waitcnt vmcnt(24)
  v_mfma_f32_16x16x32_bf16 v[20:23], a[104:107], v[100:103], v[20:23]
  v_mfma_f32_16x16x32_bf16 v[40:43], a[104:107], v[104:107], v[40:43]
  buffer_load_dwordx4 v[212:215], v4, s[8:11], s44 offen offset:3072 sc1
  v_mfma_f32_16x16x32_bf16 v[60:63], a[104:107], v[108:111], v[60:63]
  s_add_u32 s44, s44, 4096
  v_mfma_f32_16x16x32_bf16 v[80:83], a[104:107], v[112:115], v[80:83]
  v_mfma_f32_16x16x32_bf16 v[24:27], a[108:111], v[100:103], v[24:27]
  v_mfma_f32_16x16x32_bf16 v[44:47], a[108:111], v[104:107], v[44:47]
  buffer_load_dwordx4 v[216:219], v4, s[8:11], s45 offen offset:3072 sc1
  v_mfma_f32_16x16x32_bf16 v[64:67], a[108:111], v[108:111], v[64:67]
  s_add_u32 s45, s45, 4096
  v_mfma_f32_16x16x32_bf16 v[84:87], a[108:111], v[112:115], v[84:87]
  v_mfma_f32_16x16x32_bf16 v[28:31], a[112:115], v[100:103], v[28:31]
  v_mfma_f32_16x16x32_bf16 v[48:51], a[112:115], v[104:107], v[48:51]
  buffer_load_dwordx4 v[220:223], v4, s[8:11], s46 offen offset:3072 sc1
  v_mfma_f32_16x16x32_bf16 v[68:71], a[112:115], v[108:111], v[68:71]
  s_add_u32 s46, s46, 4096
  v_mfma_f32_16x16x32_bf16 v[88:91], a[112:115], v[112:115], v[88:91]
  v_mfma_f32_16x16x32_bf16 v[32:35], a[116:119], v[100:103], v[32:35]
  v_mfma_f32_16x16x32_bf16 v[52:55], a[116:119], v[104:107], v[52:55]
  buffer_load_dwordx4 v[224:227], v4, s[8:11], s47 offen offset:3072 sc1
  v_mfma_f32_16x16x32_bf16 v[72:75], a[116:119], v[108:111], v[72:75]
  s_add_u32 s47, s47, 4096
  v_mfma_f32_16x16x32_bf16 v[92:95], a[116:119], v[112:115], v[92:95]
  v_mfma_f32_16x16x32_bf16 v[36:39], a[120:123], v[100:103], v[36:39]
  v_mfma_f32_16x16x32_bf16 v[56:59], a[120:123], v[104:107], v[56:59]
  v_mfma_f32_16x16x32_bf16 v[76:79], a[120:123], v[108:111], v[76:79]
  v_mfma_f32_16x16x32_bf16 v[96:99], a[120:123], v[112:115], v[96:99]
  s_waitcnt vmcnt(24)
  v_mfma_f32_16x16x32_bf16 v[20:23], a[124:127], v[116:119], v[20:23]
  v_mfma_f32_16x16x32_bf16 v[40:43], a[124:127], v[120:123], v[40:43]
  buffer_load_dwordx4 v[100:103], v4, s[8:11], s44 offen offset:0 sc1
  v_mfma_f32_16x16x32_bf16 v[60:63], a[124:127], v[124:127], v[60:63]
  v_mfma_f32_16x16x32_bf16 v[80:83], a[124:127], v[128:131], v[80:83]
  v_mfma_f32_16x16x32_bf16 v[24:27], a[128:131], v[116:119], v[24:27]
  v_mfma_f32_16x16x32_bf16 v[44:47], a[128:131], v[120:123], v[44:47]
  buffer_load_dwordx4 v[104:107], v4, s[8:11], s45 offen offset:0 sc1
  v_mfma_f32_16x16x32_bf16 v[64:67], a[128:131], v[124:127], v[64:67]
  v_mfma_f32_16x16x32_bf16 v[84:87], a[128:131], v[128:131], v[84:87]
  v_mfma_f32_16x16x32_bf16 v[28:31], a[132:135], v[116:119], v[28:31]
  v_mfma_f32_16x16x32_bf16 v[48:51], a[132:135], v[120:123], v[48:51]
  buffer_load_dwordx4 v[108:111], v4, s[8:11], s46 offen offset:0 sc1
  v_mfma_f32_16x16x32_bf16 v[68:71], a[132:135], v[124:127], v[68:71]
  v_mfma_f32_16x16x32_bf16 v[88:91], a[132:135], v[128:131], v[88:91]
  s_waitcnt lgkmcnt(5)
  v_mfma_f32_16x16x32_bf16 v[32:35], v[240:243], v[116:119], v[32:35]
  v_mfma_f32_16x16x32_bf16 v[52:55], v[240:243], v[120:123], v[52:55]
  buffer_load_dwordx4 v[112:115], v4, s[8:11], s47 offen offset:0 sc1
  v_mfma_f32_16x16x32_bf16 v[72:75], v[240:243], v[124:127], v[72:75]
  v_mfma_f32_16x16x32_bf16 v[92:95], v[240:243], v[128:131], v[92:95]
  ds_read_b128 v[240:243], v8 offset:43008
  s_waitcnt lgkmcnt(5)
  v_mfma_f32_16x16x32_bf16 v[36:39], v[244:247], v[116:119], v[36:39]
  v_mfma_f32_16x16x32_bf16 v[56:59], v[244:247], v[120:123], v[56:59]
  v_mfma_f32_16x16x32_bf16 v[76:79], v[244:247], v[124:127], v[76:79]
  v_mfma_f32_16x16x32_bf16 v[96:99], v[244:247], v[128:131], v[96:99]
  ds_read_b128 v[244:247], v8 offset:44032
  s_waitcnt vmcnt(24)
  s_waitcnt lgkmcnt(5)
  v_mfma_f32_16x16x32_bf16 v[20:23], v[248:251], v[132:135], v[20:23]
  v_mfma_f32_16x16x32_bf16 v[40:43], v[248:251], v[136:139], v[40:43]
  buffer_load_dwordx4 v[116:119], v4, s[8:11], s44 offen offset:1024 sc1
  v_mfma_f32_16x16x32_bf16 v[60:63], v[248:251], v[140:143], v[60:63]
  v_mfma_f32_16x16x32_bf16 v[80:83], v[248:251], v[144:147], v[80:83]
  ds_read_b128 v[248:251], v8 offset:45056
  s_waitcnt lgkmcnt(5)
  v_mfma_f32_16x16x32_bf16 v[24:27], v[228:231], v[132:135], v[24:27]
  v_mfma_f32_16x16x32_bf16 v[44:47], v[228:231], v[136:139], v[44:47]
  buffer_load_dwordx4 v[120:123], v4, s[8:11], s45 offen offset:1024 sc1
  v_mfma_f32_16x16x32_bf16 v[64:67], v[228:231], v[140:143], v[64:67]
  v_mfma_f32_16x16x32_bf16 v[84:87], v[228:231], v[144:147], v[84:87]
  ds_read_b128 v[228:231], v7 offset:0
  s_waitcnt lgkmcnt(5)
  v_mfma_f32_16x16x32_bf16 v[28:31], v[232:235], v[132:135], v[28:31]
  v_mfma_f32_16x16x32_bf16 v[48:51], v[232:235], v[136:139], v[48:51]
  buffer_load_dwordx4 v[124:127], v4, s[8:11], s46 offen offset:1024 sc1
  v_mfma_f32_16x16x32_bf16 v[68:71], v[232:235], v[140:143], v[68:71]
  v_mfma_f32_16x16x32_bf16 v[88:91], v[232:235], v[144:147], v[88:91]
  ds_read_b128 v[232:235], v7 offset:1024
  s_waitcnt lgkmcnt(5)
  v_mfma_f32_16x16x32_bf16 v[32:35], v[236:239], v[132:135], v[32:35]
  v_mfma_f32_16x16x32_bf16 v[52:55], v[236:239], v[136:139], v[52:55]
  buffer_load_dwordx4 v[128:131], v4, s[8:11], s47 offen offset:1024 sc1
  v_mfma_f32_16x16x32_bf16 v[72:75], v[236:239], v[140:143], v[72:75]
  v_mfma_f32_16x16x32_bf16 v[92:95], v[236:239], v[144:147], v[92:95]
  ds_read_b128 v[236:239], v7 offset:2048
  s_waitcnt lgkmcnt(5)
  v_mfma_f32_16x16x32_bf16 v[36:39], v[240:243], v[132:135], v[36:39]
  v_mfma_f32_16x16x32_bf16 v[56:59], v[240:243], v[136:139], v[56:59]
  v_mfma_f32_16x16x32_bf16 v[76:79], v[240:243], v[140:143], v[76:79]
  v_mfma_f32_16x16x32_bf16 v[96:99], v[240:243], v[144:147], v[96:99]
  ds_read_b128 v[240:243], v7 offset:3072
  s_waitcnt vmcnt(24)
  s_waitcnt lgkmcnt(5)
  v_mfma_f32_16x16x32_bf16 v[20:23], v[244:247], v[148:151], v[20:23]
  v_mfma_f32_16x16x32_bf16 v[40:43], v[244:247], v[152:155], v[40:43]
  v_mfma_f32_16x16x32_bf16 v[60:63], v[244:247], v[156:159], v[60:63]
  v_mfma_f32_16x16x32_bf16 v[80:83], v[244:247], v[160:163], v[80:83]
  ds_read_b128 v[244:247], v7 offset:4096
  s_waitcnt lgkmcnt(5)
  v_mfma_f32_16x16x32_bf16 v[24:27], v[248:251], v[148:151], v[24:27]
  v_mfma_f32_16x16x32_bf16 v[44:47], v[248:251], v[152:155], v[44:47]
  v_mfma_f32_16x16x32_bf16 v[64:67], v[248:251], v[156:159], v[64:67]
  v_mfma_f32_16x16x32_bf16 v[84:87], v[248:251], v[160:163], v[84:87]
  ds_read_b128 v[248:251], v7 offset:5120
  v_mfma_f32_16x16x32_bf16 v[28:31], a[136:139], v[148:151], v[28:31]
  v_mfma_f32_16x16x32_bf16 v[48:51], a[136:139], v[152:155], v[48:51]
  v_mfma_f32_16x16x32_bf16 v[68:71], a[136:139], v[156:159], v[68:71]
  v_mfma_f32_16x16x32_bf16 v[88:91], a[136:139], v[160:163], v[88:91]
  v_mfma_f32_16x16x32_bf16 v[32:35], a[140:143], v[148:151], v[32:35]
  v_mfma_f32_16x16x32_bf16 v[52:55], a[140:143], v[152:155], v[52:55]
  v_mfma_f32_16x16x32_bf16 v[72:75], a[140:143], v[156:159], v[72:75]
  v_mfma_f32_16x16x32_bf16 v[92:95], a[140:143], v[160:163], v[92:95]
  v_mfma_f32_16x16x32_bf16 v[36:39], a[144:147], v[148:151], v[36:39]
  v_mfma_f32_16x16x32_bf16 v[56:59], a[144:147], v[152:155], v[56:59]
  v_mfma_f32_16x16x32_bf16 v[76:79], a[144:147], v[156:159], v[76:79]
  v_mfma_f32_16x16x32_bf16 v[96:99], a[144:147], v[160:163], v[96:99]
  s_waitcnt vmcnt(20)
  v_mfma_f32_16x16x32_bf16 v[20:23], a[148:151], v[164:167], v[20:23]
  v_mfma_f32_16x16x32_bf16 v[40:43], a[148:151], v[168:171], v[40:43]
  v_mfma_f32_16x16x32_bf16 v[60:63], a[148:151], v[172:175], v[60:63]
  v_mfma_f32_16x16x32_bf16 v[80:83], a[148:151], v[176:179], v[80:83]
  v_mfma_f32_16x16x32_bf16 v[24:27], a[152:155], v[164:167], v[24:27]
  v_mfma_f32_16x16x32_bf16 v[44:47], a[152:155], v[168:171], v[44:47]
  v_mfma_f32_16x16x32_bf16 v[64:67], a[152:155], v[172:175], v[64:67]
  v_mfma_f32_16x16x32_bf16 v[84:87], a[152:155], v[176:179], v[84:87]
  v_mfma_f32_16x16x32_bf16 v[28:31], a[156:159], v[164:167], v[28:31]
  v_mfma_f32_16x16x32_bf16 v[48:51], a[156:159], v[168:171], v[48:51]
  v_mfma_f32_16x16x32_bf16 v[68:71], a[156:159], v[172:175], v[68:71]
  v_mfma_f32_16x16x32_bf16 v[88:91], a[156:159], v[176:179], v[88:91]
  v_mfma_f32_16x16x32_bf16 v[32:35], a[160:163], v[164:167], v[32:35]
  v_mfma_f32_16x16x32_bf16 v[52:55], a[160:163], v[168:171], v[52:55]
  v_mfma_f32_16x16x32_bf16 v[72:75], a[160:163], v[172:175], v[72:75]
  v_mfma_f32_16x16x32_bf16 v[92:95], a[160:163], v[176:179], v[92:95]
  v_mfma_f32_16x16x32_bf16 v[36:39], a[164:167], v[164:167], v[36:39]
  v_mfma_f32_16x16x32_bf16 v[56:59], a[164:167], v[168:171], v[56:59]
  v_mfma_f32_16x16x32_bf16 v[76:79], a[164:167], v[172:175], v[76:79]
  v_mfma_f32_16x16x32_bf16 v[96:99], a[164:167], v[176:179], v[96:99]
  s_waitcnt vmcnt(16)
  s_waitcnt lgkmcnt(5)
  v_mfma_f32_16x16x32_bf16 v[20:23], v[228:231], v[180:183], v[20:23]
  v_mfma_f32_16x16x32_bf16 v[40:43], v[228:231], v[184:187], v[40:43]
  v_mfma_f32_16x16x32_bf16 v[60:63], v[228:231], v[188:191], v[60:63]
  v_mfma_f32_16x16x32_bf16 v[80:83], v[228:231], v[192:195], v[80:83]
  ds_read_b128 v[228:231], v7 offset:6144
  s_waitcnt lgkmcnt(5)
  v_mfma_f32_16x16x32_bf16 v[24:27], v[232:235], v[180:183], v[24:27]
  v_mfma_f32_16x16x32_bf16 v[44:47], v[232:235], v[184:187], v[44:47]
  v_mfma_f32_16x16x32_bf16 v[64:67], v[232:235], v[188:191], v[64:67]
  v_mfma_f32_16x16x32_bf16 v[84:87], v[232:235], v[192:195], v[84:87]
  ds_read_b128 v[232:235], v7 offset:7168
  s_waitcnt lgkmcnt(5)
  v_mfma_f32_16x16x32_bf16 v[28:31], v[236:239], v[180:183], v[28:31]
  v_mfma_f32_16x16x32_bf16 v[48:51], v[236:239], v[184:187], v[48:51]
  v_mfma_f32_16x16x32_bf16 v[68:71], v[236:239], v[188:191], v[68:71]
  v_mfma_f32_16x16x32_bf16 v[88:91], v[236:239], v[192:195], v[88:91]
  ds_read_b128 v[236:239], v7 offset:8192
  s_waitcnt lgkmcnt(5)
  v_mfma_f32_16x16x32_bf16 v[32:35], v[240:243], v[180:183], v[32:35]
  v_mfma_f32_16x16x32_bf16 v[52:55], v[240:243], v[184:187], v[52:55]
  v_mfma_f32_16x16x32_bf16 v[72:75], v[240:243], v[188:191], v[72:75]
  v_mfma_f32_16x16x32_bf16 v[92:95], v[240:243], v[192:195], v[92:95]
  ds_read_b128 v[240:243], v7 offset:36864
  s_waitcnt lgkmcnt(5)
  v_mfma_f32_16x16x32_bf16 v[36:39], v[244:247], v[180:183], v[36:39]
  v_mfma_f32_16x16x32_bf16 v[56:59], v[244:247], v[184:187], v[56:59]
  v_mfma_f32_16x16x32_bf16 v[76:79], v[244:247], v[188:191], v[76:79]
  v_mfma_f32_16x16x32_bf16 v[96:99], v[244:247], v[192:195], v[96:99]
  ds_read_b128 v[244:247], v7 offset:37888
  s_barrier
  s_waitcnt vmcnt(12)
  s_waitcnt lgkmcnt(5)
  v_mfma_f32_16x16x32_bf16 v[20:23], v[248:251], v[196:199], v[20:23]
  v_mfma_f32_16x16x32_bf16 v[40:43], v[248:251], v[200:203], v[40:43]
  v_mfma_f32_16x16x32_bf16 v[60:63], v[248:251], v[204:207], v[60:63]
  v_mfma_f32_16x16x32_bf16 v[80:83], v[248:251], v[208:211], v[80:83]
  ds_read_b128 v[248:251], v7 offset:38912
  s_waitcnt lgkmcnt(5)
  v_mfma_f32_16x16x32_bf16 v[24:27], v[228:231], v[196:199], v[24:27]
  v_mfma_f32_16x16x32_bf16 v[44:47], v[228:231], v[200:203], v[44:47]
  v_mfma_f32_16x16x32_bf16 v[64:67], v[228:231], v[204:207], v[64:67]
  v_mfma_f32_16x16x32_bf16 v[84:87], v[228:231], v[208:211], v[84:87]
  ds_read_b128 v[228:231], v7 offset:39936
  s_waitcnt lgkmcnt(5)
  v_mfma_f32_16x16x32_bf16 v[28:31], v[232:235], v[196:199], v[28:31]
  v_mfma_f32_16x16x32_bf16 v[48:51], v[232:235], v[200:203], v[48:51]
  v_mfma_f32_16x16x32_bf16 v[68:71], v[232:235], v[204:207], v[68:71]
  v_mfma_f32_16x16x32_bf16 v[88:91], v[232:235], v[208:211], v[88:91]
  ds_read_b128 v[232:235], v7 offset:40960
  s_waitcnt lgkmcnt(5)
  v_mfma_f32_16x16x32_bf16 v[32:35], v[236:239], v[196:199], v[32:35]
  v_mfma_f32_16x16x32_bf16 v[52:55], v[236:239], v[200:203], v[52:55]
  v_mfma_f32_16x16x32_bf16 v[72:75], v[236:239], v[204:207], v[72:75]
  v_mfma_f32_16x16x32_bf16 v[92:95], v[236:239], v[208:211], v[92:95]
  ds_read_b128 v[236:239], v7 offset:41984
  s_waitcnt lgkmcnt(5)
  v_mfma_f32_16x16x32_bf16 v[36:39], v[240:243], v[196:199], v[36:39]
  v_mfma_f32_16x16x32_bf16 v[56:59], v[240:243], v[200:203], v[56:59]
  v_mfma_f32_16x16x32_bf16 v[76:79], v[240:243], v[204:207], v[76:79]
  v_mfma_f32_16x16x32_bf16 v[96:99], v[240:243], v[208:211], v[96:99]
  ds_read_b128 v[240:243], v7 offset:43008
  s_waitcnt vmcnt(8)
  s_waitcnt lgkmcnt(5)
  v_mfma_f32_16x16x32_bf16 v[20:23], v[244:247], v[212:215], v[20:23]
  v_mfma_f32_16x16x32_bf16 v[40:43], v[244:247], v[216:219], v[40:43]
  v_mfma_f32_16x16x32_bf16 v[60:63], v[244:247], v[220:223], v[60:63]
  v_mfma_f32_16x16x32_bf16 v[80:83], v[244:247], v[224:227], v[80:83]
  ds_read_b128 v[244:247], v7 offset:44032
  s_waitcnt lgkmcnt(5)
  v_mfma_f32_16x16x32_bf16 v[24:27], v[248:251], v[212:215], v[24:27]
  v_mfma_f32_16x16x32_bf16 v[44:47], v[248:251], v[216:219], v[44:47]
  v_mfma_f32_16x16x32_bf16 v[64:67], v[248:251], v[220:223], v[64:67]
  v_mfma_f32_16x16x32_bf16 v[84:87], v[248:251], v[224:227], v[84:87]
  s_waitcnt lgkmcnt(4)
  v_mfma_f32_16x16x32_bf16 v[28:31], v[228:231], v[212:215], v[28:31]
  v_mfma_f32_16x16x32_bf16 v[48:51], v[228:231], v[216:219], v[48:51]
  v_mfma_f32_16x16x32_bf16 v[68:71], v[228:231], v[220:223], v[68:71]
  v_mfma_f32_16x16x32_bf16 v[88:91], v[228:231], v[224:227], v[88:91]
  s_waitcnt lgkmcnt(3)
  v_mfma_f32_16x16x32_bf16 v[32:35], v[232:235], v[212:215], v[32:35]
  v_mfma_f32_16x16x32_bf16 v[52:55], v[232:235], v[216:219], v[52:55]
  v_mfma_f32_16x16x32_bf16 v[72:75], v[232:235], v[220:223], v[72:75]
  v_mfma_f32_16x16x32_bf16 v[92:95], v[232:235], v[224:227], v[92:95]
  s_waitcnt lgkmcnt(2)
  v_mfma_f32_16x16x32_bf16 v[36:39], v[236:239], v[212:215], v[36:39]
  v_mfma_f32_16x16x32_bf16 v[56:59], v[236:239], v[216:219], v[56:59]
  v_mfma_f32_16x16x32_bf16 v[76:79], v[236:239], v[220:223], v[76:79]
  v_mfma_f32_16x16x32_bf16 v[96:99], v[236:239], v[224:227], v[96:99]
  s_waitcnt vmcnt(4)
  s_waitcnt lgkmcnt(1)
  v_mfma_f32_16x16x32_bf16 v[20:23], v[240:243], v[100:103], v[20:23]
  v_accvgpr_read_b32 v140, a220
  v_accvgpr_read_b32 v141, a221
  v_mfma_f32_16x16x32_bf16 v[40:43], v[240:243], v[104:107], v[40:43]
  v_accvgpr_read_b32 v142, a222
  v_accvgpr_read_b32 v143, a223
  v_mfma_f32_16x16x32_bf16 v[60:63], v[240:243], v[108:111], v[60:63]
  v_accvgpr_read_b32 v144, a224
  v_accvgpr_read_b32 v145, a225
  v_mfma_f32_16x16x32_bf16 v[80:83], v[240:243], v[112:115], v[80:83]
  v_accvgpr_read_b32 v146, a226
  s_waitcnt lgkmcnt(0)
  v_mfma_f32_16x16x32_bf16 v[24:27], v[244:247], v[100:103], v[24:27]
  v_accvgpr_read_b32 v147, a227
  v_accvgpr_read_b32 v148, a228
  v_mfma_f32_16x16x32_bf16 v[44:47], v[244:247], v[104:107], v[44:47]
  v_accvgpr_read_b32 v149, a229
  v_accvgpr_read_b32 v150, a230
  v_mfma_f32_16x16x32_bf16 v[64:67], v[244:247], v[108:111], v[64:67]
  v_accvgpr_read_b32 v151, a231
  v_accvgpr_read_b32 v152, a232
  v_mfma_f32_16x16x32_bf16 v[84:87], v[244:247], v[112:115], v[84:87]
  v_accvgpr_read_b32 v153, a233
  v_accvgpr_read_b32 v154, a234
  v_mfma_f32_16x16x32_bf16 v[28:31], a[168:171], v[100:103], v[28:31]
  v_accvgpr_read_b32 v155, a235
  v_accvgpr_read_b32 v156, a236
  v_mfma_f32_16x16x32_bf16 v[48:51], a[168:171], v[104:107], v[48:51]
  v_accvgpr_read_b32 v157, a237
  v_accvgpr_read_b32 v158, a238
  v_mfma_f32_16x16x32_bf16 v[68:71], a[168:171], v[108:111], v[68:71]
  v_accvgpr_read_b32 v159, a239
  v_accvgpr_read_b32 v160, a240
  v_mfma_f32_16x16x32_bf16 v[88:91], a[168:171], v[112:115], v[88:91]
  v_accvgpr_read_b32 v161, a241
  v_accvgpr_read_b32 v162, a242
  v_mfma_f32_16x16x32_bf16 v[32:35], a[172:175], v[100:103], v[32:35]
  v_accvgpr_read_b32 v163, a243
  v_accvgpr_read_b32 v164, a244
  v_mfma_f32_16x16x32_bf16 v[52:55], a[172:175], v[104:107], v[52:55]
  v_accvgpr_read_b32 v165, a245
  v_accvgpr_read_b32 v166, a246
  v_mfma_f32_16x16x32_bf16 v[72:75], a[172:175], v[108:111], v[72:75]
  v_accvgpr_read_b32 v167, a247
  v_accvgpr_read_b32 v168, a248
  v_mfma_f32_16x16x32_bf16 v[92:95], a[172:175], v[112:115], v[92:95]
  v_accvgpr_read_b32 v169, a249
  v_mfma_f32_16x16x32_bf16 v[36:39], a[176:179], v[100:103], v[36:39]
  v_mfma_f32_16x16x32_bf16 v[56:59], a[176:179], v[104:107], v[56:59]
  v_mfma_f32_16x16x32_bf16 v[76:79], a[176:179], v[108:111], v[76:79]
  v_mfma_f32_16x16x32_bf16 v[96:99], a[176:179], v[112:115], v[96:99]
  s_waitcnt vmcnt(0)
  v_mfma_f32_16x16x32_bf16 v[20:23], a[180:183], v[116:119], v[20:23]
  v_mfma_f32_16x16x32_bf16 v[40:43], a[180:183], v[120:123], v[40:43]
  v_mfma_f32_16x16x32_bf16 v[60:63], a[180:183], v[124:127], v[60:63]
  v_mfma_f32_16x16x32_bf16 v[80:83], a[180:183], v[128:131], v[80:83]
  v_mfma_f32_16x16x32_bf16 v[24:27], a[184:187], v[116:119], v[24:27]
  v_mfma_f32_16x16x32_bf16 v[44:47], a[184:187], v[120:123], v[44:47]
  v_mfma_f32_16x16x32_bf16 v[64:67], a[184:187], v[124:127], v[64:67]
  v_mfma_f32_16x16x32_bf16 v[84:87], a[184:187], v[128:131], v[84:87]
  v_mfma_f32_16x16x32_bf16 v[28:31], a[188:191], v[116:119], v[28:31]
  v_mfma_f32_16x16x32_bf16 v[48:51], a[188:191], v[120:123], v[48:51]
  v_mfma_f32_16x16x32_bf16 v[68:71], a[188:191], v[124:127], v[68:71]
  v_mfma_f32_16x16x32_bf16 v[88:91], a[188:191], v[128:131], v[88:91]
  v_mfma_f32_16x16x32_bf16 v[32:35], a[192:195], v[116:119], v[32:35]
  v_mfma_f32_16x16x32_bf16 v[52:55], a[192:195], v[120:123], v[52:55]
  v_mfma_f32_16x16x32_bf16 v[72:75], a[192:195], v[124:127], v[72:75]
  v_mfma_f32_16x16x32_bf16 v[92:95], a[192:195], v[128:131], v[92:95]
  v_mfma_f32_16x16x32_bf16 v[36:39], a[196:199], v[116:119], v[36:39]
  v_mfma_f32_16x16x32_bf16 v[56:59], a[196:199], v[120:123], v[56:59]
  v_mfma_f32_16x16x32_bf16 v[76:79], a[196:199], v[124:127], v[76:79]
  v_mfma_f32_16x16x32_bf16 v[96:99], a[196:199], v[128:131], v[96:99]
  ds_write_b128 v11, v[40:43] offset:0
  ds_write_b128 v11, v[44:47] offset:1024
  ds_write_b128 v11, v[48:51] offset:2048
  ds_write_b128 v11, v[52:55] offset:3072
  s_nop 1
  ds_write_b128 v11, v[56:59] offset:4096
  ds_write_b128 v12, v[60:63] offset:0
  ds_write_b128 v12, v[64:67] offset:1024
  ds_write_b128 v12, v[68:71] offset:2048
  ds_write_b128 v12, v[72:75] offset:3072
  ds_write_b128 v12, v[76:79] offset:4096
  ds_write_b128 v13, v[80:83] offset:0
  ds_write_b128 v13, v[84:87] offset:1024
  ds_write_b128 v13, v[88:91] offset:2048
  ds_write_b128 v13, v[92:95] offset:3072
  ds_write_b128 v13, v[96:99] offset:4096
  s_waitcnt lgkmcnt(0)
  s_barrier
  ds_read_b128 v[40:43], v10 offset:0
  ds_read_b128 v[60:63], v10 offset:5120
  ds_read_b128 v[80:83], v10 offset:10240
  ds_read_b128 v[44:47], v10 offset:1024
  ds_read_b128 v[64:67], v10 offset:6144
  ds_read_b128 v[84:87], v10 offset:11264
  ds_read_b128 v[48:51], v10 offset:2048
  ds_read_b128 v[68:71], v10 offset:7168
  ds_read_b128 v[88:91], v10 offset:12288
  ds_read_b128 v[52:55], v10 offset:3072
  ds_read_b128 v[72:75], v10 offset:8192
  ds_read_b128 v[92:95], v10 offset:13312
  ds_read_b128 v[56:59], v10 offset:4096
  ds_read_b128 v[76:79], v10 offset:9216
  ds_read_b128 v[96:99], v10 offset:14336
  s_waitcnt lgkmcnt(12)
  v_pk_add_f32 v[20:21], v[20:21], v[40:41]
  v_pk_add_f32 v[22:23], v[22:23], v[42:43]
  v_pk_add_f32 v[20:21], v[20:21], v[60:61]
  v_pk_add_f32 v[22:23], v[22:23], v[62:63]
  v_pk_add_f32 v[20:21], v[20:21], v[80:81]
  v_pk_add_f32 v[22:23], v[22:23], v[82:83]
  v_lshlrev_b32 v172, 16, v160
  v_lshlrev_b32 v174, 16, v161
  v_and_b32 v173, 0xffff0000, v160
  v_and_b32 v175, 0xffff0000, v161
  v_pk_fma_f32 v[20:21], v[20:21], v[140:141], v[172:173]
  v_pk_fma_f32 v[22:23], v[22:23], v[142:143], v[174:175]
  v_cvt_pk_bf16_f32 v180, v20, v21
  v_cvt_pk_bf16_f32 v181, v22, v23
  buffer_store_dwordx2 v[180:181], v15, s[40:43], s27 offen offset:0
  s_waitcnt lgkmcnt(9)
  v_pk_add_f32 v[24:25], v[24:25], v[44:45]
  v_pk_add_f32 v[26:27], v[26:27], v[46:47]
  v_pk_add_f32 v[24:25], v[24:25], v[64:65]
  v_pk_add_f32 v[26:27], v[26:27], v[66:67]
  v_pk_add_f32 v[24:25], v[24:25], v[84:85]
  v_pk_add_f32 v[26:27], v[26:27], v[86:87]
  v_lshlrev_b32 v172, 16, v162
  v_lshlrev_b32 v174, 16, v163
  v_and_b32 v173, 0xffff0000, v162
  v_and_b32 v175, 0xffff0000, v163
  v_pk_fma_f32 v[24:25], v[24:25], v[144:145], v[172:173]
  v_pk_fma_f32 v[26:27], v[26:27], v[146:147], v[174:175]
  v_cvt_pk_bf16_f32 v182, v24, v25
  v_cvt_pk_bf16_f32 v183, v26, v27
  buffer_store_dwordx2 v[182:183], v15, s[40:43], s27 offen offset:32
  s_waitcnt lgkmcnt(6)
  v_pk_add_f32 v[28:29], v[28:29], v[48:49]
  v_pk_add_f32 v[30:31], v[30:31], v[50:51]
  v_pk_add_f32 v[28:29], v[28:29], v[68:69]
  v_pk_add_f32 v[30:31], v[30:31], v[70:71]
  v_pk_add_f32 v[28:29], v[28:29], v[88:89]
  v_pk_add_f32 v[30:31], v[30:31], v[90:91]
  v_lshlrev_b32 v172, 16, v164
  v_lshlrev_b32 v174, 16, v165
  v_and_b32 v173, 0xffff0000, v164
  v_and_b32 v175, 0xffff0000, v165
  v_pk_fma_f32 v[28:29], v[28:29], v[148:149], v[172:173]
  v_pk_fma_f32 v[30:31], v[30:31], v[150:151], v[174:175]
  v_cvt_pk_bf16_f32 v184, v28, v29
  v_cvt_pk_bf16_f32 v185, v30, v31
  buffer_store_dwordx2 v[184:185], v15, s[40:43], s27 offen offset:64
  s_waitcnt lgkmcnt(3)
  v_pk_add_f32 v[32:33], v[32:33], v[52:53]
  v_pk_add_f32 v[34:35], v[34:35], v[54:55]
  v_pk_add_f32 v[32:33], v[32:33], v[72:73]
  v_pk_add_f32 v[34:35], v[34:35], v[74:75]
  v_pk_add_f32 v[32:33], v[32:33], v[92:93]
  v_pk_add_f32 v[34:35], v[34:35], v[94:95]
  v_lshlrev_b32 v172, 16, v166
  v_lshlrev_b32 v174, 16, v167
  v_and_b32 v173, 0xffff0000, v166
  v_and_b32 v175, 0xffff0000, v167
  v_pk_fma_f32 v[32:33], v[32:33], v[152:153], v[172:173]
  v_pk_fma_f32 v[34:35], v[34:35], v[154:155], v[174:175]
  v_cvt_pk_bf16_f32 v186, v32, v33
  v_cvt_pk_bf16_f32 v187, v34, v35
  buffer_store_dwordx2 v[186:187], v15, s[40:43], s27 offen offset:96
  s_waitcnt lgkmcnt(0)
  v_pk_add_f32 v[36:37], v[36:37], v[56:57]
  v_pk_add_f32 v[38:39], v[38:39], v[58:59]
  v_pk_add_f32 v[36:37], v[36:37], v[76:77]
  v_pk_add_f32 v[38:39], v[38:39], v[78:79]
  v_pk_add_f32 v[36:37], v[36:37], v[96:97]
  v_pk_add_f32 v[38:39], v[38:39], v[98:99]
  v_lshlrev_b32 v172, 16, v168
  v_lshlrev_b32 v174, 16, v169
  v_and_b32 v173, 0xffff0000, v168
  v_and_b32 v175, 0xffff0000, v169
  v_pk_fma_f32 v[36:37], v[36:37], v[156:157], v[172:173]
  v_pk_fma_f32 v[38:39], v[38:39], v[158:159], v[174:175]
  v_cvt_pk_bf16_f32 v188, v36, v37
  v_cvt_pk_bf16_f32 v189, v38, v39
  buffer_store_dwordx2 v[188:189], v16, s[40:43], s27 offen offset:128
L_m_end:
L_m_end_x:
  s_endpgm
.fill 8192, 4, 0xbf800000
.section .rodata,"a"
.p2align 6
.amdhsa_kernel adaLN_cond__sliding_local_dilated__mixer_gmlp__prompt_kernel
  .amdhsa_next_free_vgpr 512
  .amdhsa_next_free_sgpr 102
  .amdhsa_accum_offset 256
  .amdhsa_group_segment_fixed_size 0
  .amdhsa_kernarg_size 104
  .amdhsa_user_sgpr_count 2
  .amdhsa_user_sgpr_kernarg_segment_ptr 1
  .amdhsa_system_sgpr_workgroup_id_x 1
  .amdhsa_float_denorm_mode_32 3
.end_amdhsa_kernel
```
